```python
import torch

def _softmax(x, axis=-1):
    return torch.softmax(x, dim=axis)
def _gelu(x):
    return torch.nn.functional.gelu(x, approximate="tanh")
def _silu(x):
    return torch.nn.functional.silu(x)
def _sigmoid(x):
    return torch.sigmoid(x)
def _layernorm(x, axis=-1, eps=1e-5):
    m = x.mean(dim=axis, keepdim=True)
    v = x.var(dim=axis, keepdim=True, unbiased=False)
    return (x - m) / torch.sqrt(v + eps)
def _scatter_add(tgt, idx, src, axis=0):
    return tgt.clone().index_add_(axis, idx, src)
def _segment_sum(src, seg, n):
    out = torch.zeros((n,) + src.shape[1:], dtype=src.dtype)
    return out.index_add_(0, seg, src)
def _pad(x, pw):
    flat = tuple(v for pair in reversed(pw) for v in pair)
    return torch.nn.functional.pad(x, flat)

kernel_name = 'standalone__convnext_block__vision'

def setup_inputs():

    _w = (lambda a: (lambda t: t.to(torch.bfloat16) if t.is_floating_point() else t)(torch.as_tensor(a)))
    H = W = 512
    C = 96
    return {
        "x": _w((lambda *s: torch.randn(*s, dtype=torch.bfloat16) * 0.05)(1, H, W, C)),
        "dw": _w((lambda *s: torch.randn(*s, dtype=torch.bfloat16) * 0.05)(7, 7, C)),
        "w1": _w((lambda *s: torch.randn(*s, dtype=torch.bfloat16) * 0.05)(C, 4 * C)),
        "w2": _w((lambda *s: torch.randn(*s, dtype=torch.bfloat16) * 0.05)(4 * C, C)),
    }

def reference(x, dw, w1, w2):
    B, H, W, C = x.shape
    pad = 3
    xp = _pad(x, ((0,0),(pad,pad),(pad,pad),(0,0)))
    out = torch.zeros_like(x)
    for i in range(7):
        for j in range(7):
            out = out + xp[:, i:i+H, j:j+W, :] * dw[i, j][None, None, None, :]
    h = _layernorm(out, axis=-1)
    return x + _gelu(h @ w1) @ w2
```

```asm
; @launch grid=(256,1,1) block=(512,1,1) lds=163840
.amdgcn_target "amdgcn-amd-amdhsa--gfx950"
.text
.globl standalone__convnext_block__vision_kernel
.p2align 8
.type standalone__convnext_block__vision_kernel,@function
standalone__convnext_block__vision_kernel:
  s_load_dwordx8 s[4:11], s[0:1], 0
  s_load_dwordx2 s[12:13], s[0:1], 32
  s_getpc_b64 s[60:61]
  s_cmp_ge_u32 s2, 256
  s_cbranch_scc1 L_exit
  v_lshlrev_b32 v2, 7, v0
  v_min_u32 v2, L_end-standalone__convnext_block__vision_kernel-64, v2
  v_lshrrev_b32 v1, 6, v0
  global_load_dword v255, v2, s[60:61]
  v_and_b32 v0, 63, v0
  v_readfirstlane_b32 s14, v1
  s_bfe_u32 s16, s2, 0x20001
  s_lshr_b32 s50, s2, 6
  s_lshl2_add_u32 s16, s16, s50
  s_lshl_b32 s16, s16, 5
  s_bitcmp1_b32 s2, 6
  s_cselect_b32 s54, 1, -1
  s_cselect_b32 s49, -3, 34
  s_add_u32 s16, s16, s49
  s_and_b32 s17, s2, 1
  s_bfe_u32 s50, s2, 0x30003
  s_lshl3_add_u32 s17, s17, s50
  s_lshl_b32 s17, s17, 5
  s_and_b32 s15, s14, 3
  s_mov_b32 s23, 0x20000
  s_mov_b32 s65, 0x38800000
L_again:
  s_cmp_ge_u32 s14, 4
  s_cbranch_scc1 L_prod
  s_mul_i32 s19, s17, 192
  s_sub_u32 s19, s19, 576
  v_lshrrev_b32 v14, 2, v0
  v_and_b32 v15, 3, v0
  v_mul_u32_u24 v2, 192, v14
  v_lshl_add_u32 v2, v15, 4, v2
  v_add_u32 v2, s19, v2
  v_add_u32 v3, 3072, v2
  v_lshrrev_b32 v14, 5, v0
  v_mul_u32_u24 v14, 1472, v14
  v_sub_u32 v4, v2, v14
  v_add_u32 v4, 6144, v4
  s_waitcnt lgkmcnt(0)
  s_add_u32 s53, s15, 0
  s_mul_i32 s19, s54, s53
  s_add_u32 s19, s16, s19
  s_cmp_lt_u32 s19, 512
  s_cselect_b32 s22, 98304, 0
  s_cselect_b32 s19, s19, 0
  s_mul_i32 s19, s19, 98304
  s_add_u32 s20, s4, s19
  s_addc_u32 s21, s5, 0
  buffer_load_dwordx4 v[32:35], v2, s[20:23], 0 offen offset:0
  buffer_load_dwordx4 v[36:39], v2, s[20:23], 0 offen offset:64
  buffer_load_dwordx4 v[40:43], v2, s[20:23], 0 offen offset:128
  buffer_load_dwordx4 v[44:47], v3, s[20:23], 0 offen offset:0
  buffer_load_dwordx4 v[48:51], v3, s[20:23], 0 offen offset:64
  buffer_load_dwordx4 v[52:55], v3, s[20:23], 0 offen offset:128
  s_mov_b32 exec_lo, 0xffffff
  s_mov_b32 exec_hi, 0xffffff
  buffer_load_dwordx4 v[56:59], v4, s[20:23], 0 offen offset:0
  s_mov_b32 exec_hi, 0
  buffer_load_dwordx4 v[60:63], v4, s[20:23], 0 offen offset:128
  s_mov_b64 exec, -1
  s_add_u32 s53, s15, 4
  s_mul_i32 s19, s54, s53
  s_add_u32 s19, s16, s19
  s_cmp_lt_u32 s19, 512
  s_cselect_b32 s22, 98304, 0
  s_cselect_b32 s19, s19, 0
  s_mul_i32 s19, s19, 98304
  s_add_u32 s20, s4, s19
  s_addc_u32 s21, s5, 0
  buffer_load_dwordx4 v[64:67], v2, s[20:23], 0 offen offset:0
  buffer_load_dwordx4 v[68:71], v2, s[20:23], 0 offen offset:64
  buffer_load_dwordx4 v[72:75], v2, s[20:23], 0 offen offset:128
  buffer_load_dwordx4 v[76:79], v3, s[20:23], 0 offen offset:0
  buffer_load_dwordx4 v[80:83], v3, s[20:23], 0 offen offset:64
  buffer_load_dwordx4 v[84:87], v3, s[20:23], 0 offen offset:128
  s_mov_b32 exec_lo, 0xffffff
  s_mov_b32 exec_hi, 0xffffff
  buffer_load_dwordx4 v[88:91], v4, s[20:23], 0 offen offset:0
  s_mov_b32 exec_hi, 0
  buffer_load_dwordx4 v[92:95], v4, s[20:23], 0 offen offset:128
  s_mov_b64 exec, -1
  s_add_u32 s53, s15, 8
  s_mul_i32 s19, s54, s53
  s_add_u32 s19, s16, s19
  s_cmp_lt_u32 s53, 10
  s_cselect_b32 s19, s19, 0x1000
  s_cmp_lt_u32 s19, 512
  s_cselect_b32 s22, 98304, 0
  s_cselect_b32 s19, s19, 0
  s_mul_i32 s19, s19, 98304
  s_add_u32 s20, s4, s19
  s_addc_u32 s21, s5, 0
  buffer_load_dwordx4 v[96:99], v2, s[20:23], 0 offen offset:0
  buffer_load_dwordx4 v[100:103], v2, s[20:23], 0 offen offset:64
  buffer_load_dwordx4 v[104:107], v2, s[20:23], 0 offen offset:128
  buffer_load_dwordx4 v[108:111], v3, s[20:23], 0 offen offset:0
  buffer_load_dwordx4 v[112:115], v3, s[20:23], 0 offen offset:64
  buffer_load_dwordx4 v[116:119], v3, s[20:23], 0 offen offset:128
  s_mov_b32 exec_lo, 0xffffff
  s_mov_b32 exec_hi, 0xffffff
  buffer_load_dwordx4 v[120:123], v4, s[20:23], 0 offen offset:0
  s_mov_b32 exec_hi, 0
  buffer_load_dwordx4 v[124:127], v4, s[20:23], 0 offen offset:128
  s_mov_b64 exec, -1
  v_and_b32 v15, 3, v0
  v_mul_u32_u24 v5, 1248, v15
  v_and_b32 v14, 60, v0
  v_add_u32 v5, v5, v14
  v_lshrrev_b32 v14, 5, v0
  v_mul_u32_u24 v14, 4960, v14
  v_add3_u32 v6, v5, v14, 64
  v_add_u32 v6, 64, v6
  s_add_u32 s53, s15, 0
  s_lshr_b32 s50, s53, 1
  s_mul_i32 s49, s50, 14976
  s_cmp_ge_u32 s50, 4
  s_cselect_b32 s50, 5632, 0
  s_add_u32 s49, s49, s50
  s_and_b32 s50, s53, 1
  s_mul_i32 s50, s50, 152
  s_add_u32 s49, s49, s50
  s_add_u32 s49, s49, 41984
  v_add_u32 v16, s49, v5
  v_add_u32 v17, 4992, v16
  v_add_u32 v18, 9984, v16
  v_add_u32 v19, s49, v6
  v_add_u32 v20, 9984, v19
  s_waitcnt vmcnt(23)
  ds_write2_b32 v16, v32, v33 offset0:0 offset1:78
  ds_write2_b32 v16, v34, v35 offset0:156 offset1:234
  s_waitcnt vmcnt(22)
  ds_write2_b32 v17, v36, v37 offset0:0 offset1:78
  ds_write2_b32 v17, v38, v39 offset0:156 offset1:234
  s_waitcnt vmcnt(21)
  ds_write2_b32 v18, v40, v41 offset0:0 offset1:78
  ds_write2_b32 v18, v42, v43 offset0:156 offset1:234
  s_waitcnt vmcnt(20)
  ds_write2_b32 v16, v44, v45 offset0:16 offset1:94
  ds_write2_b32 v16, v46, v47 offset0:172 offset1:250
  s_waitcnt vmcnt(19)
  ds_write2_b32 v17, v48, v49 offset0:16 offset1:94
  ds_write2_b32 v17, v50, v51 offset0:172 offset1:250
  s_waitcnt vmcnt(18)
  ds_write2_b32 v18, v52, v53 offset0:16 offset1:94
  ds_write2_b32 v18, v54, v55 offset0:172 offset1:250
  s_mov_b32 exec_lo, 0xffffff
  s_mov_b32 exec_hi, 0xffffff
  s_waitcnt vmcnt(17)
  ds_write2_b32 v19, v56, v57 offset0:0 offset1:78
  ds_write2_b32 v19, v58, v59 offset0:156 offset1:234
  s_mov_b32 exec_hi, 0
  s_waitcnt vmcnt(16)
  ds_write2_b32 v20, v60, v61 offset0:0 offset1:78
  s_waitcnt lgkmcnt(14)
  ds_write2_b32 v20, v62, v63 offset0:156 offset1:234
  s_mov_b64 exec, -1
  s_add_u32 s53, s15, 4
  s_lshr_b32 s50, s53, 1
  s_mul_i32 s49, s50, 14976
  s_cmp_ge_u32 s50, 4
  s_cselect_b32 s50, 5632, 0
  s_add_u32 s49, s49, s50
  s_and_b32 s50, s53, 1
  s_mul_i32 s50, s50, 152
  s_add_u32 s49, s49, s50
  s_add_u32 s49, s49, 41984
  v_add_u32 v21, s49, v5
  v_add_u32 v22, 4992, v21
  v_add_u32 v23, 9984, v21
  v_add_u32 v24, s49, v6
  v_add_u32 v25, 9984, v24
  s_waitcnt vmcnt(15) lgkmcnt(14)
  ds_write2_b32 v21, v64, v65 offset0:0 offset1:78
  s_waitcnt lgkmcnt(14)
  ds_write2_b32 v21, v66, v67 offset0:156 offset1:234
  s_waitcnt vmcnt(14) lgkmcnt(14)
  ds_write2_b32 v22, v68, v69 offset0:0 offset1:78
  s_waitcnt lgkmcnt(14)
  ds_write2_b32 v22, v70, v71 offset0:156 offset1:234
  s_waitcnt vmcnt(13) lgkmcnt(14)
  ds_write2_b32 v23, v72, v73 offset0:0 offset1:78
  s_waitcnt lgkmcnt(14)
  ds_write2_b32 v23, v74, v75 offset0:156 offset1:234
  s_waitcnt vmcnt(12) lgkmcnt(14)
  ds_write2_b32 v21, v76, v77 offset0:16 offset1:94
  s_waitcnt lgkmcnt(14)
  ds_write2_b32 v21, v78, v79 offset0:172 offset1:250
  s_waitcnt vmcnt(11) lgkmcnt(14)
  ds_write2_b32 v22, v80, v81 offset0:16 offset1:94
  s_waitcnt lgkmcnt(14)
  ds_write2_b32 v22, v82, v83 offset0:172 offset1:250
  s_waitcnt vmcnt(10) lgkmcnt(14)
  ds_write2_b32 v23, v84, v85 offset0:16 offset1:94
  s_waitcnt lgkmcnt(14)
  ds_write2_b32 v23, v86, v87 offset0:172 offset1:250
  s_mov_b32 exec_lo, 0xffffff
  s_mov_b32 exec_hi, 0xffffff
  s_waitcnt vmcnt(9) lgkmcnt(14)
  ds_write2_b32 v24, v88, v89 offset0:0 offset1:78
  s_waitcnt lgkmcnt(14)
  ds_write2_b32 v24, v90, v91 offset0:156 offset1:234
  s_mov_b32 exec_hi, 0
  s_waitcnt vmcnt(8) lgkmcnt(14)
  ds_write2_b32 v25, v92, v93 offset0:0 offset1:78
  s_waitcnt lgkmcnt(14)
  ds_write2_b32 v25, v94, v95 offset0:156 offset1:234
  s_mov_b64 exec, -1
  s_waitcnt lgkmcnt(0)
  s_barrier
  s_add_u32 s53, s15, 10
  s_mul_i32 s19, s54, s53
  s_add_u32 s19, s16, s19
  s_cmp_lt_u32 s19, 512
  s_cselect_b32 s22, 98304, 0
  s_cselect_b32 s19, s19, 0
  s_mul_i32 s19, s19, 98304
  s_add_u32 s20, s4, s19
  s_addc_u32 s21, s5, 0
  buffer_load_dwordx4 v[160:163], v2, s[20:23], 0 offen offset:0
  buffer_load_dwordx4 v[164:167], v2, s[20:23], 0 offen offset:64
  buffer_load_dwordx4 v[168:171], v2, s[20:23], 0 offen offset:128
  buffer_load_dwordx4 v[172:175], v3, s[20:23], 0 offen offset:0
  buffer_load_dwordx4 v[176:179], v3, s[20:23], 0 offen offset:64
  buffer_load_dwordx4 v[180:183], v3, s[20:23], 0 offen offset:128
  s_mov_b32 exec_lo, 0xffffff
  s_mov_b32 exec_hi, 0xffffff
  buffer_load_dwordx4 v[184:187], v4, s[20:23], 0 offen offset:0
  s_mov_b32 exec_hi, 0
  buffer_load_dwordx4 v[188:191], v4, s[20:23], 0 offen offset:128
  s_mov_b64 exec, -1
  s_cmp_ge_u32 s15, 2
  s_cbranch_scc1 L_w2skip
  s_add_u32 s53, s15, 8
  s_lshr_b32 s50, s53, 1
  s_mul_i32 s49, s50, 14976
  s_cmp_ge_u32 s50, 4
  s_cselect_b32 s50, 5632, 0
  s_add_u32 s49, s49, s50
  s_and_b32 s50, s53, 1
  s_mul_i32 s50, s50, 152
  s_add_u32 s49, s49, s50
  s_add_u32 s49, s49, 41984
  v_add_u32 v26, s49, v5
  v_add_u32 v27, 4992, v26
  v_add_u32 v28, 9984, v26
  v_add_u32 v29, s49, v6
  v_add_u32 v30, 9984, v29
  s_waitcnt vmcnt(15)
  ds_write2_b32 v26, v96, v97 offset0:0 offset1:78
  ds_write2_b32 v26, v98, v99 offset0:156 offset1:234
  s_waitcnt vmcnt(14)
  ds_write2_b32 v27, v100, v101 offset0:0 offset1:78
  ds_write2_b32 v27, v102, v103 offset0:156 offset1:234
  s_waitcnt vmcnt(13)
  ds_write2_b32 v28, v104, v105 offset0:0 offset1:78
  ds_write2_b32 v28, v106, v107 offset0:156 offset1:234
  s_waitcnt vmcnt(12)
  ds_write2_b32 v26, v108, v109 offset0:16 offset1:94
  ds_write2_b32 v26, v110, v111 offset0:172 offset1:250
  s_waitcnt vmcnt(11)
  ds_write2_b32 v27, v112, v113 offset0:16 offset1:94
  ds_write2_b32 v27, v114, v115 offset0:172 offset1:250
  s_waitcnt vmcnt(10)
  ds_write2_b32 v28, v116, v117 offset0:16 offset1:94
  ds_write2_b32 v28, v118, v119 offset0:172 offset1:250
  s_mov_b32 exec_lo, 0xffffff
  s_mov_b32 exec_hi, 0xffffff
  s_waitcnt vmcnt(9)
  ds_write2_b32 v29, v120, v121 offset0:0 offset1:78
  ds_write2_b32 v29, v122, v123 offset0:156 offset1:234
  s_mov_b32 exec_hi, 0
  s_waitcnt vmcnt(8)
  ds_write2_b32 v30, v124, v125 offset0:0 offset1:78
  s_waitcnt lgkmcnt(14)
  ds_write2_b32 v30, v126, v127 offset0:156 offset1:234
  s_mov_b64 exec, -1
  s_waitcnt lgkmcnt(0)
L_w2skip:
  s_barrier
  s_and_b32 s49, s15, 1
  s_mul_i32 s49, s49, 152
  s_mov_b32 s50, 122496
  s_cmp_lt_u32 s15, 2
  s_cselect_b32 s50, s50, 41984
  s_add_u32 s49, s49, s50
  v_add_u32 v26, s49, v5
  v_add_u32 v27, 4992, v26
  v_add_u32 v28, 9984, v26
  v_add_u32 v29, s49, v6
  v_add_u32 v30, 9984, v29
  v_lshrrev_b32 v16, 5, v0
  v_bfe_u32 v17, v0, 4, 1
  v_bfe_u32 v18, v0, 2, 2
  v_and_b32 v19, 3, v0
  v_lshl_add_u32 v20, v16, 3, v18
  v_lshlrev_b32 v1, 6, v20
  v_lshl_add_u32 v1, v17, 5, v1
  v_lshl_add_u32 v1, v19, 3, v1
  v_lshl_add_u32 v20, v16, 2, v18
  v_mul_u32_u24 v7, 192, v20
  v_lshl_add_u32 v7, v17, 5, v7
  v_and_b32 v20, 1, v0
  v_lshl_add_u32 v7, v20, 4, v7
  v_bfe_u32 v20, v0, 1, 1
  v_lshl_add_u32 v7, v20, 3, v7
  s_lshl_b32 s49, s15, 9
  s_add_u32 s49, s49, 137472
  v_and_b32 v20, 31, v0
  v_lshlrev_b32 v3, 4, v20
  v_lshl_add_u32 v3, v16, 11, v3
  v_add_u32 v3, s49, v3
  v_and_b32 v20, 15, v0
  v_lshl_add_u32 v20, v20, 1, v17
  v_mul_u32_u24 v2, 192, v20
  v_lshl_add_u32 v2, v16, 4, v2
  v_mul_u32_u24 v21, 160, v17
  v_sub_u32 v2, v2, v21
  s_add_u32 s49, s15, 1
  s_and_b32 s49, s49, 1
  s_mul_i32 s49, s49, 152
  s_add_u32 s49, s49, 12
  v_mul_u32_u24 v4, 1248, v16
  v_lshl_add_u32 v4, v20, 2, v4
  v_add_u32 v4, s49, v4
  s_add_u32 s51, s15, 3
  s_and_b32 s51, s51, 0xfe
  s_sub_u32 s49, s51, 12
  s_cmp_ge_u32 s51, 12
  s_cselect_b32 s51, s49, s51
  s_lshr_b32 s50, s51, 1
  s_mul_i32 s43, s50, 14976
  s_cmp_ge_u32 s50, 4
  s_cselect_b32 s50, 5632, 0
  s_add_u32 s43, s43, s50
  s_and_b32 s50, s51, 1
  s_mul_i32 s50, s50, 152
  s_add_u32 s43, s43, s50
  s_add_u32 s43, s43, 41984
  s_add_u32 s51, s15, 7
  s_and_b32 s51, s51, 0xfe
  s_sub_u32 s49, s51, 12
  s_cmp_ge_u32 s51, 12
  s_cselect_b32 s51, s49, s51
  s_lshr_b32 s50, s51, 1
  s_mul_i32 s44, s50, 14976
  s_cmp_ge_u32 s50, 4
  s_cselect_b32 s50, 5632, 0
  s_add_u32 s44, s44, s50
  s_and_b32 s50, s51, 1
  s_mul_i32 s50, s50, 152
  s_add_u32 s44, s44, s50
  s_add_u32 s44, s44, 41984
  s_add_u32 s51, s15, 11
  s_and_b32 s51, s51, 0xfe
  s_sub_u32 s49, s51, 12
  s_cmp_ge_u32 s51, 12
  s_cselect_b32 s51, s49, s51
  s_lshr_b32 s50, s51, 1
  s_mul_i32 s45, s50, 14976
  s_cmp_ge_u32 s50, 4
  s_cselect_b32 s50, 5632, 0
  s_add_u32 s45, s45, s50
  s_and_b32 s50, s51, 1
  s_mul_i32 s50, s50, 152
  s_add_u32 s45, s45, s50
  s_add_u32 s45, s45, 41984
  s_mov_b32 s28, s12
  s_mov_b32 s29, s13
  s_mov_b32 s30, 50331648
  s_mov_b32 s31, 0x20000
  s_add_u32 s49, s15, 3
  s_mul_i32 s49, s49, s54
  s_add_u32 s49, s49, s16
  s_mul_i32 s41, s54, 393216
  s_lshl_b32 s49, s49, 9
  s_add_u32 s49, s49, s17
  s_mul_i32 s40, s49, 192
  s_mov_b32 s36, 0x3eeff558
  s_mov_b32 s42, 0
  s_mov_b32 s56, 0x44ea44ea
  s_mov_b32 s57, 0x37803780
  s_add_u32 s37, s65, 0x3eeff558
  s_barrier
  s_waitcnt vmcnt(7)
  ds_write2_b32 v26, v160, v161 offset0:0 offset1:78
  ds_write2_b32 v26, v162, v163 offset0:156 offset1:234
  s_waitcnt vmcnt(6)
  ds_write2_b32 v27, v164, v165 offset0:0 offset1:78
  ds_write2_b32 v27, v166, v167 offset0:156 offset1:234
  s_waitcnt vmcnt(5)
  ds_write2_b32 v28, v168, v169 offset0:0 offset1:78
  ds_write2_b32 v28, v170, v171 offset0:156 offset1:234
  s_waitcnt vmcnt(4)
  ds_write2_b32 v26, v172, v173 offset0:16 offset1:94
  ds_write2_b32 v26, v174, v175 offset0:172 offset1:250
  s_waitcnt vmcnt(3)
  ds_write2_b32 v27, v176, v177 offset0:16 offset1:94
  ds_write2_b32 v27, v178, v179 offset0:172 offset1:250
  s_waitcnt vmcnt(2)
  ds_write2_b32 v28, v180, v181 offset0:16 offset1:94
  ds_write2_b32 v28, v182, v183 offset0:172 offset1:250
  s_mov_b32 exec_lo, 0xffffff
  s_mov_b32 exec_hi, 0xffffff
  s_waitcnt vmcnt(1)
  ds_write2_b32 v29, v184, v185 offset0:0 offset1:78
  ds_write2_b32 v29, v186, v187 offset0:156 offset1:234
  s_mov_b32 exec_hi, 0
  s_waitcnt vmcnt(0)
  ds_write2_b32 v30, v188, v189 offset0:0 offset1:78
  s_waitcnt lgkmcnt(14)
  ds_write2_b32 v30, v190, v191 offset0:156 offset1:234
  s_mov_b64 exec, -1
  v_bfe_u32 v20, v0, 2, 1
  v_bfe_u32 v21, v0, 3, 1
  v_lshl_add_u32 v20, v20, 1, v21
  v_xor_b32 v21, v16, v17
  v_lshl_add_u32 v20, v21, 2, v20
  v_and_b32 v21, 3, v0
  v_cmp_eq_u32 vcc, 3, v21
  v_mov_b32 v22, 0x3f80
  v_mov_b32 v23, 0x3f800000
  v_cndmask_b32 v22, v22, v23, vcc
  v_cndmask_b32 v21, v21, 0, vcc
  v_or_b32 v21, 12, v21
  v_mul_u32_u24 v5, 0x1111, v21
  v_cmp_eq_u32 vcc, 0, v20
  s_nop 1
  v_cndmask_b32 v12, 0, v22, vcc
  v_cmp_eq_u32 vcc, 1, v20
  s_nop 1
  v_cndmask_b32 v13, 0, v22, vcc
  v_cmp_eq_u32 vcc, 2, v20
  s_nop 1
  v_cndmask_b32 v14, 0, v22, vcc
  v_cmp_eq_u32 vcc, 3, v20
  s_nop 1
  v_cndmask_b32 v15, 0, v22, vcc
  s_setprio 2
  s_waitcnt lgkmcnt(0)
  s_cmp_eq_u32 s65, 1065353216
  s_cbranch_scc1 F_main
  s_branch L_main
L_prod:
  s_setprio 3
  s_mul_i32 s49, s15, 48
  v_and_b32 v14, 7, v0
  v_lshrrev_b32 v15, 3, v0
  v_min_u32 v15, 5, v15
  s_and_b32 s50, s54, 6
  v_mul_i32_i24 v16, s54, v14
  v_add_u32 v16, s50, v16
  v_and_b32 v16, 7, v16
  v_mul_u32_u24 v16, 1344, v16
  v_lshl_add_u32 v16, v15, 3, v16
  s_mov_b32 s34, 9408
  s_mov_b32 s35, 0x20000
  s_waitcnt lgkmcnt(0)
  s_mov_b32 s32, s6
  s_mov_b32 s33, s7
  buffer_load_dwordx2 v[64:65], v16, s[32:35], s49 offen offset:0
  buffer_load_dwordx2 v[66:67], v16, s[32:35], s49 offen offset:192
  buffer_load_dwordx2 v[68:69], v16, s[32:35], s49 offen offset:384
  buffer_load_dwordx2 v[70:71], v16, s[32:35], s49 offen offset:576
  buffer_load_dwordx2 v[72:73], v16, s[32:35], s49 offen offset:768
  buffer_load_dwordx2 v[74:75], v16, s[32:35], s49 offen offset:960
  buffer_load_dwordx2 v[76:77], v16, s[32:35], s49 offen offset:1152
  s_cmp_ge_u32 s15, 2
  s_cselect_b32 s24, s8, s10
  s_cselect_b32 s25, s9, s11
  s_mov_b32 s26, 73728
  s_mov_b32 s27, 0x20000
  s_cselect_b32 s55, 64, 6144
  s_mov_b32 s50, 12288
  s_cselect_b32 s57, s50, 1024
  s_cselect_b32 s41, 1, 11
  s_cselect_b64 vcc, -1, 0
  s_and_b32 s49, s15, 1
  s_mul_i32 s63, s57, s49
  s_mul_i32 s63, s63, 3
  s_mul_i32 s41, s41, s55
  s_mul_i32 s42, s55, 12
  s_mul_i32 s56, s15, 3072
  s_add_u32 s24, s24, s63
  s_addc_u32 s25, s25, 0
  s_sub_u32 s26, s26, s63
  s_add_u32 s28, s24, s57
  s_addc_u32 s29, s25, 0
  s_sub_u32 s30, s26, s57
  s_mov_b32 s31, 0x20000
  s_add_u32 s32, s28, s57
  s_addc_u32 s33, s29, 0
  s_sub_u32 s34, s30, s57
  s_mov_b32 s35, 0x20000
  v_lshlrev_b32 v13, 4, v0
  v_lshrrev_b32 v17, 2, v0
  v_mul_u32_u24 v17, 768, v17
  v_and_b32 v18, 3, v0
  v_lshl_add_u32 v17, v18, 4, v17
  v_cndmask_b32 v13, v13, v17, vcc
  s_mul_i32 s19, s17, 192
  s_sub_u32 s19, s19, 576
  v_lshrrev_b32 v17, 2, v0
  v_and_b32 v18, 3, v0
  v_mul_u32_u24 v2, 192, v17
  v_lshl_add_u32 v2, v18, 4, v2
  v_add_u32 v2, s19, v2
  v_add_u32 v3, 3072, v2
  v_lshrrev_b32 v17, 5, v0
  v_mul_u32_u24 v17, 1472, v17
  v_sub_u32 v4, v2, v17
  v_add_u32 v4, 6144, v4
  v_and_b32 v18, 3, v0
  v_mul_u32_u24 v5, 1248, v18
  v_and_b32 v17, 60, v0
  v_add_u32 v5, v5, v17
  v_lshrrev_b32 v17, 5, v0
  v_mul_u32_u24 v17, 4960, v17
  v_add3_u32 v6, v5, v17, 64
  v_add_u32 v6, 64, v6
  s_mul_i32 s49, s15, 6144
  s_add_u32 s49, s49, 137472
  s_mov_b32 s3, s49
  v_lshlrev_b32 v16, 10, v15
  v_lshl_add_u32 v16, v14, 6, v16
  v_lshrrev_b32 v17, 1, v14
  v_lshl_add_u32 v16, v17, 4, v16
  v_add_u32 v16, s49, v16
  v_xor_b32 v57, 16, v16
  v_xor_b32 v58, 32, v16
  v_xor_b32 v59, 48, v16
  v_lshrrev_b32 v14, 5, v0
  v_mul_u32_u24 v1, 152, v14
  v_and_b32 v14, 15, v0
  v_lshl_add_u32 v1, v14, 3, v1
  v_bfe_u32 v14, v0, 4, 1
  v_lshl_add_u32 v1, v14, 4, v1
  s_mul_i32 s50, s15, 3744
  v_add_u32 v1, s50, v1
  v_and_b32 v14, 1, v0
  v_mul_u32_u24 v7, 0x5555, v14
  v_add_u32 v7, 0x8888, v7
  v_bfe_u32 v15, v0, 2, 1
  v_lshl_add_u32 v20, v15, 1, v14
  v_and_b32 v21, 2, v0
  v_bfe_u32 v15, v0, 3, 1
  v_add_u32 v21, v21, v15
  v_lshrrev_b32 v22, 4, v0
  v_lshrrev_b32 v24, 1, v22
  v_sub_u32 v24, v24, v21
  v_min_u32 v24, 7, v24
  v_lshrrev_b32 v15, 1, v24
  v_xor_b32 v15, v15, v20
  v_lshlrev_b32 v24, 6, v24
  v_lshl_add_u32 v24, v15, 4, v24
  v_add_u32 v24, s49, v24
  v_add_u32 v25, 2, v22
  v_sub_u32 v25, v25, v21
  v_min_u32 v25, 7, v25
  v_lshrrev_b32 v15, 1, v25
  v_xor_b32 v15, v15, v20
  v_lshlrev_b32 v25, 6, v25
  v_lshl_add_u32 v25, v15, 4, v25
  v_add_u32 v25, s49, v25
  v_add_u32 v26, 6, v22
  v_sub_u32 v26, v26, v21
  v_min_u32 v26, 7, v26
  v_lshrrev_b32 v15, 1, v26
  v_xor_b32 v15, v15, v20
  v_lshlrev_b32 v26, 6, v26
  v_lshl_add_u32 v26, v15, 4, v26
  v_add_u32 v26, s49, v26
  v_and_b32 v15, 1, v22
  v_lshl_add_u32 v24, v15, 3, v24
  v_cmp_eq_u32 vcc, 1, v14
  v_mov_b32 v28, 0x0c0c0100
  v_mov_b32 v29, 0x01000c0c
  v_cndmask_b32 v28, v28, v29, vcc
  v_mov_b32 v29, 0x0c0c0302
  v_mov_b32 v30, 0x03020c0c
  v_cndmask_b32 v29, v29, v30, vcc
  s_mov_b32 s43, 41984
  s_mov_b32 s44, 56960
  s_mov_b32 s45, 71936
  s_mov_b32 s46, 86912
  s_mov_b32 s47, 107520
  s_mov_b32 s48, 122496
  s_mov_b32 s52, 1
  s_mov_b32 s58, 0x3c2aaaab
  s_add_u32 s53, s15, 10
  s_mov_b32 s49, 0x05040100
  s_mov_b32 s50, 0x07060302
  v_mov_b32 v78, 0
  v_mov_b32 v79, 0
  s_add_u32 s37, s65, 0x3eeff558
  s_mov_b32 s36, 0x3eeff558
  s_lshl_b32 s51, s15, 6
  v_add_u32 v63, s51, v0
  v_lshlrev_b32 v232, 17, v63
  v_lshlrev_b32 v233, 2, v63
  v_add_u32 v234, 102400, v233
  v_add_u32 v233, 36864, v233
  v_add_u32 v236, 0x0, v232
  v_add_u32 v237, 0x10000, v232
  v_mul_f32 v236, s37, v236
  v_mul_f32 v237, s37, v237
  v_fmaak_f32 v238, v236, v236, 0x409d30fc
  v_fmaak_f32 v239, v237, v237, 0x409d30fc
  v_mul_f32 v238, v236, v238
  v_mul_f32 v239, v237, v239
  v_exp_f32 v238, -v238
  v_exp_f32 v239, -v239
  v_fma_f32 v238, v238, s36, s36
  v_fma_f32 v239, v239, s36, s36
  v_rcp_f32 v238, v238
  v_rcp_f32 v239, v239
  v_mul_f32 v236, v236, v238
  v_mul_f32 v237, v237, v239
  v_cvt_pk_bf16_f32 v236, v236, v237
  ds_write_b32 v233, v236 offset:0
  v_add_u32 v240, 0x2000000, v232
  v_add_u32 v241, 0x2010000, v232
  v_mul_f32 v240, s37, v240
  v_mul_f32 v241, s37, v241
  v_fmaak_f32 v242, v240, v240, 0x409d30fc
  v_fmaak_f32 v243, v241, v241, 0x409d30fc
  v_mul_f32 v242, v240, v242
  v_mul_f32 v243, v241, v243
  v_exp_f32 v242, -v242
  v_exp_f32 v243, -v243
  v_fma_f32 v242, v242, s36, s36
  v_fma_f32 v243, v243, s36, s36
  v_rcp_f32 v242, v242
  v_rcp_f32 v243, v243
  v_mul_f32 v240, v240, v242
  v_mul_f32 v241, v241, v243
  v_cvt_pk_bf16_f32 v240, v240, v241
  ds_write_b32 v233, v240 offset:1024
  v_add_u32 v244, 0x4000000, v232
  v_add_u32 v245, 0x4010000, v232
  v_mul_f32 v244, s37, v244
  v_mul_f32 v245, s37, v245
  v_fmaak_f32 v246, v244, v244, 0x409d30fc
  v_fmaak_f32 v247, v245, v245, 0x409d30fc
  v_mul_f32 v246, v244, v246
  v_mul_f32 v247, v245, v247
  v_exp_f32 v246, -v246
  v_exp_f32 v247, -v247
  v_fma_f32 v246, v246, s36, s36
  v_fma_f32 v247, v247, s36, s36
  v_rcp_f32 v246, v246
  v_rcp_f32 v247, v247
  v_mul_f32 v244, v244, v246
  v_mul_f32 v245, v245, v247
  v_cvt_pk_bf16_f32 v244, v244, v245
  ds_write_b32 v233, v244 offset:2048
  v_add_u32 v236, 0x6000000, v232
  v_add_u32 v237, 0x6010000, v232
  v_mul_f32 v236, s37, v236
  v_mul_f32 v237, s37, v237
  v_fmaak_f32 v238, v236, v236, 0x409d30fc
  v_fmaak_f32 v239, v237, v237, 0x409d30fc
  v_mul_f32 v238, v236, v238
  v_mul_f32 v239, v237, v239
  v_exp_f32 v238, -v238
  v_exp_f32 v239, -v239
  v_fma_f32 v238, v238, s36, s36
  v_fma_f32 v239, v239, s36, s36
  v_rcp_f32 v238, v238
  v_rcp_f32 v239, v239
  v_mul_f32 v236, v236, v238
  v_mul_f32 v237, v237, v239
  v_cvt_pk_bf16_f32 v236, v236, v237
  ds_write_b32 v233, v236 offset:3072
  v_add_u32 v240, 0x8000000, v232
  v_add_u32 v241, 0x8010000, v232
  v_mul_f32 v240, s37, v240
  v_mul_f32 v241, s37, v241
  v_fmaak_f32 v242, v240, v240, 0x409d30fc
  v_fmaak_f32 v243, v241, v241, 0x409d30fc
  v_mul_f32 v242, v240, v242
  v_mul_f32 v243, v241, v243
  v_exp_f32 v242, -v242
  v_exp_f32 v243, -v243
  v_fma_f32 v242, v242, s36, s36
  v_fma_f32 v243, v243, s36, s36
  v_rcp_f32 v242, v242
  v_rcp_f32 v243, v243
  v_mul_f32 v240, v240, v242
  v_mul_f32 v241, v241, v243
  v_cvt_pk_bf16_f32 v240, v240, v241
  ds_write_b32 v233, v240 offset:4096
  v_add_u32 v244, 0x80000000, v232
  v_add_u32 v245, 0x80010000, v232
  v_mul_f32 v244, s37, v244
  v_mul_f32 v245, s37, v245
  v_fmaak_f32 v246, v244, v244, 0x409d30fc
  v_fmaak_f32 v247, v245, v245, 0x409d30fc
  v_mul_f32 v246, v244, v246
  v_mul_f32 v247, v245, v247
  v_exp_f32 v246, -v246
  v_exp_f32 v247, -v247
  v_fma_f32 v246, v246, s36, s36
  v_fma_f32 v247, v247, s36, s36
  v_rcp_f32 v246, v246
  v_rcp_f32 v247, v247
  v_mul_f32 v244, v244, v246
  v_mul_f32 v245, v245, v247
  v_cvt_pk_bf16_f32 v244, v244, v245
  ds_write_b32 v234, v244 offset:0
  v_add_u32 v236, 0x82000000, v232
  v_add_u32 v237, 0x82010000, v232
  v_mul_f32 v236, s37, v236
  v_mul_f32 v237, s37, v237
  v_fmaak_f32 v238, v236, v236, 0x409d30fc
  v_fmaak_f32 v239, v237, v237, 0x409d30fc
  v_mul_f32 v238, v236, v238
  v_mul_f32 v239, v237, v239
  v_exp_f32 v238, -v238
  v_exp_f32 v239, -v239
  v_fma_f32 v238, v238, s36, s36
  v_fma_f32 v239, v239, s36, s36
  v_rcp_f32 v238, v238
  v_rcp_f32 v239, v239
  v_mul_f32 v236, v236, v238
  v_mul_f32 v237, v237, v239
  v_cvt_pk_bf16_f32 v236, v236, v237
  ds_write_b32 v234, v236 offset:1024
  v_add_u32 v240, 0x84000000, v232
  v_add_u32 v241, 0x84010000, v232
  v_mul_f32 v240, s37, v240
  v_mul_f32 v241, s37, v241
  v_fmaak_f32 v242, v240, v240, 0x409d30fc
  v_fmaak_f32 v243, v241, v241, 0x409d30fc
  v_mul_f32 v242, v240, v242
  v_mul_f32 v243, v241, v243
  v_exp_f32 v242, -v242
  v_exp_f32 v243, -v243
  v_fma_f32 v242, v242, s36, s36
  v_fma_f32 v243, v243, s36, s36
  v_rcp_f32 v242, v242
  v_rcp_f32 v243, v243
  v_mul_f32 v240, v240, v242
  v_mul_f32 v241, v241, v243
  v_cvt_pk_bf16_f32 v240, v240, v241
  ds_write_b32 v234, v240 offset:2048
  s_waitcnt vmcnt(5)
  v_perm_b32 v80, v66, v64, s49
  s_waitcnt vmcnt(3)
  v_perm_b32 v81, v70, v68, s49
  s_waitcnt vmcnt(1)
  v_perm_b32 v82, v74, v72, s49
  s_waitcnt vmcnt(0)
  v_perm_b32 v83, v78, v76, s49
  v_perm_b32 v84, v64, v78, s49
  v_perm_b32 v85, v68, v66, s49
  v_perm_b32 v86, v72, v70, s49
  v_perm_b32 v87, v76, v74, s49
  v_perm_b32 v88, v66, v64, s50
  v_perm_b32 v89, v70, v68, s50
  v_perm_b32 v90, v74, v72, s50
  v_perm_b32 v91, v78, v76, s50
  v_perm_b32 v92, v64, v78, s50
  v_perm_b32 v93, v68, v66, s50
  v_perm_b32 v94, v72, v70, s50
  v_perm_b32 v95, v76, v74, s50
  v_perm_b32 v96, v67, v65, s49
  v_perm_b32 v97, v71, v69, s49
  v_perm_b32 v98, v75, v73, s49
  v_perm_b32 v99, v79, v77, s49
  v_perm_b32 v100, v65, v79, s49
  v_perm_b32 v101, v69, v67, s49
  v_perm_b32 v102, v73, v71, s49
  v_perm_b32 v103, v77, v75, s49
  v_perm_b32 v104, v67, v65, s50
  v_perm_b32 v105, v71, v69, s50
  v_perm_b32 v106, v75, v73, s50
  v_perm_b32 v107, v79, v77, s50
  v_perm_b32 v108, v65, v79, s50
  v_perm_b32 v109, v69, v67, s50
  v_perm_b32 v110, v73, v71, s50
  v_perm_b32 v111, v77, v75, s50
  ds_write_b128 v16, v[80:83] offset:0
  ds_write_b128 v58, v[84:87] offset:0
  ds_write_b128 v57, v[88:91] offset:0
  ds_write_b128 v59, v[92:95] offset:0
  ds_write_b128 v16, v[96:99] offset:512
  ds_write_b128 v58, v[100:103] offset:512
  ds_write_b128 v57, v[104:107] offset:512
  s_waitcnt lgkmcnt(14)
  ds_write_b128 v59, v[108:111] offset:512
  s_waitcnt lgkmcnt(0)
  s_waitcnt lgkmcnt(0)
  s_sub_u32 s38, 0x3f800000, s65
  s_cmp_eq_u32 s38, 0
  s_cselect_b32 s38, 0x3eeff558, s38
  s_sub_u32 s39, 0x3f800000, s65
  s_cmp_eq_u32 s39, 0
  s_cselect_b32 s39, 0x3eeff558, s39
  s_mov_b64 s[70:71], 0
  ds_read_b64 v[32:33], v24 offset:0
  ds_read_b64 v[34:35], v24 offset:512
  ds_read_b64 v[36:37], v24 offset:1024
  ds_read_b64 v[38:39], v24 offset:1536
  ds_read_b64 v[40:41], v24 offset:2048
  ds_read_b64 v[42:43], v24 offset:2560
  ds_read_b64 v[44:45], v24 offset:3072
  ds_read_b64 v[46:47], v24 offset:3584
  ds_read_b64 v[48:49], v24 offset:4096
  ds_read_b64 v[50:51], v24 offset:4608
  ds_read_b64 v[52:53], v24 offset:5120
  ds_read_b64 v[54:55], v24 offset:5632
  ds_read_b128 v[116:119], v25 offset:0
  ds_read_b128 v[120:123], v26 offset:0
  ds_read_b128 v[128:131], v25 offset:512
  s_waitcnt lgkmcnt(14)
  ds_read_b128 v[132:135], v26 offset:512
  s_waitcnt lgkmcnt(14)
  ds_read_b128 v[140:143], v25 offset:1024
  s_waitcnt lgkmcnt(14)
  ds_read_b128 v[144:147], v26 offset:1024
  s_waitcnt lgkmcnt(14)
  ds_read_b128 v[152:155], v25 offset:1536
  s_waitcnt lgkmcnt(14)
  ds_read_b128 v[156:159], v26 offset:1536
  s_waitcnt lgkmcnt(14)
  ds_read_b128 v[164:167], v25 offset:2048
  s_waitcnt lgkmcnt(14)
  ds_read_b128 v[168:171], v26 offset:2048
  s_waitcnt lgkmcnt(14)
  ds_read_b128 v[176:179], v25 offset:2560
  s_waitcnt lgkmcnt(14)
  ds_read_b128 v[180:183], v26 offset:2560
  s_waitcnt lgkmcnt(14)
  ds_read_b128 v[188:191], v25 offset:3072
  s_waitcnt lgkmcnt(14)
  ds_read_b128 v[192:195], v26 offset:3072
  s_waitcnt lgkmcnt(14)
  ds_read_b128 v[200:203], v25 offset:3584
  s_waitcnt lgkmcnt(14)
  ds_read_b128 v[204:207], v26 offset:3584
  s_waitcnt lgkmcnt(14)
  ds_read_b128 v[212:215], v25 offset:4096
  s_waitcnt lgkmcnt(14)
  ds_read_b128 v[216:219], v26 offset:4096
  s_waitcnt lgkmcnt(14)
  ds_read_b128 v[224:227], v25 offset:4608
  s_waitcnt lgkmcnt(14)
  ds_read_b128 v[228:231], v26 offset:4608
  s_waitcnt lgkmcnt(14)
  ds_read_b128 v[236:239], v25 offset:5120
  s_waitcnt lgkmcnt(14)
  ds_read_b128 v[240:243], v26 offset:5120
  s_waitcnt lgkmcnt(14)
  ds_read_b128 v[248:251], v25 offset:5632
  s_waitcnt lgkmcnt(14)
  ds_read_b128 v[252:255], v26 offset:5632
  v_perm_b32 v112, v32, v32, v28
  v_perm_b32 v113, v32, v32, v29
  v_perm_b32 v114, v33, v33, v28
  v_perm_b32 v115, v33, v33, v29
  v_perm_b32 v124, v34, v34, v28
  v_perm_b32 v125, v34, v34, v29
  v_perm_b32 v126, v35, v35, v28
  v_perm_b32 v127, v35, v35, v29
  v_perm_b32 v136, v36, v36, v28
  v_perm_b32 v137, v36, v36, v29
  v_perm_b32 v138, v37, v37, v28
  v_perm_b32 v139, v37, v37, v29
  v_perm_b32 v148, v38, v38, v28
  v_perm_b32 v149, v38, v38, v29
  v_perm_b32 v150, v39, v39, v28
  v_perm_b32 v151, v39, v39, v29
  v_perm_b32 v160, v40, v40, v28
  v_perm_b32 v161, v40, v40, v29
  v_perm_b32 v162, v41, v41, v28
  v_perm_b32 v163, v41, v41, v29
  v_perm_b32 v172, v42, v42, v28
  v_perm_b32 v173, v42, v42, v29
  v_perm_b32 v174, v43, v43, v28
  v_perm_b32 v175, v43, v43, v29
  v_perm_b32 v184, v44, v44, v28
  v_perm_b32 v185, v44, v44, v29
  v_perm_b32 v186, v45, v45, v28
  v_perm_b32 v187, v45, v45, v29
  v_perm_b32 v196, v46, v46, v28
  v_perm_b32 v197, v46, v46, v29
  v_perm_b32 v198, v47, v47, v28
  v_perm_b32 v199, v47, v47, v29
  v_perm_b32 v208, v48, v48, v28
  v_perm_b32 v209, v48, v48, v29
  v_perm_b32 v210, v49, v49, v28
  v_perm_b32 v211, v49, v49, v29
  v_perm_b32 v220, v50, v50, v28
  v_perm_b32 v221, v50, v50, v29
  v_perm_b32 v222, v51, v51, v28
  v_perm_b32 v223, v51, v51, v29
  v_perm_b32 v232, v52, v52, v28
  v_perm_b32 v233, v52, v52, v29
  v_perm_b32 v234, v53, v53, v28
  v_perm_b32 v235, v53, v53, v29
  v_perm_b32 v244, v54, v54, v28
  v_perm_b32 v245, v54, v54, v29
  v_perm_b32 v246, v55, v55, v28
  v_perm_b32 v247, v55, v55, v29
  s_add_u32 m0, s56, 0
  s_add_u32 s59, s41, s55
  buffer_load_dwordx4 v13, s[24:27], s41 offen lds
  s_add_u32 m0, s56, 1024
  s_cmp_ge_u32 s59, s42
  s_cselect_b32 s59, 0, s59
  buffer_load_dwordx4 v13, s[28:31], s41 offen lds
  s_add_u32 m0, s56, 2048
  s_nop 0
  buffer_load_dwordx4 v13, s[32:35], s41 offen lds
  s_mov_b32 s41, s59
  s_add_u32 m0, s56, 12288
  s_add_u32 s59, s41, s55
  buffer_load_dwordx4 v13, s[24:27], s41 offen lds
  s_add_u32 m0, s56, 13312
  s_cmp_ge_u32 s59, s42
  s_cselect_b32 s59, 0, s59
  buffer_load_dwordx4 v13, s[28:31], s41 offen lds
  s_add_u32 m0, s56, 14336
  s_nop 0
  buffer_load_dwordx4 v13, s[32:35], s41 offen lds
  s_mov_b32 s41, s59
  v_lshlrev_b32 v64, 17, v63
  v_lshlrev_b32 v65, 2, v63
  v_add_u32 v66, 102400, v65
  v_add_u32 v65, 36864, v65
  v_add_u32 v76, 0x86000000, v64
  v_add_u32 v77, 0x86010000, v64
  v_mul_f32 v76, s37, v76
  v_mul_f32 v77, s37, v77
  v_fmaak_f32 v78, v76, v76, 0x409d30fc
  v_fmaak_f32 v79, v77, v77, 0x409d30fc
  v_mul_f32 v78, v76, v78
  v_mul_f32 v79, v77, v79
  v_exp_f32 v78, -v78
  v_exp_f32 v79, -v79
  v_fma_f32 v78, v78, s36, s36
  v_fma_f32 v79, v79, s36, s36
  v_rcp_f32 v78, v78
  v_rcp_f32 v79, v79
  v_mul_f32 v76, v76, v78
  v_mul_f32 v77, v77, v79
  v_cvt_pk_bf16_f32 v76, v76, v77
  s_waitcnt lgkmcnt(14)
  ds_write_b32 v66, v76 offset:3072
  v_add_u32 v68, 0x88000000, v64
  v_add_u32 v69, 0x88010000, v64
  v_mul_f32 v68, s37, v68
  v_mul_f32 v69, s37, v69
  v_fmaak_f32 v70, v68, v68, 0x409d30fc
  v_fmaak_f32 v71, v69, v69, 0x409d30fc
  v_mul_f32 v70, v68, v70
  v_mul_f32 v71, v69, v71
  v_exp_f32 v70, -v70
  v_exp_f32 v71, -v71
  v_fma_f32 v70, v70, s36, s36
  v_fma_f32 v71, v71, s36, s36
  v_rcp_f32 v70, v70
  v_rcp_f32 v71, v71
  v_mul_f32 v68, v68, v70
  v_mul_f32 v69, v69, v71
  v_cvt_pk_bf16_f32 v68, v68, v69
  s_waitcnt lgkmcnt(14)
  ds_write_b32 v66, v68 offset:4096
  v_add_u32 v14, s43, v1
  v_add_u32 v15, s44, v1
  v_add_u32 v0, s45, v1
  v_add_u32 v3, s46, v1
  v_add_u32 v12, s47, v1
  s_waitcnt lgkmcnt(0)
  s_barrier
  ds_read_b64 v[16:17], v14 offset:0
  ds_read_b64 v[18:19], v14 offset:8
  ds_read_b64 v[20:21], v15 offset:0
  ds_read_b64 v[22:23], v15 offset:8
  ds_read_b64 v[24:25], v0 offset:0
  ds_read_b64 v[26:27], v0 offset:8
  ds_read_b64 v[28:29], v14 offset:312
  ds_read_b64 v[30:31], v14 offset:320
  ds_read_b64 v[32:33], v15 offset:312
  ds_read_b64 v[34:35], v15 offset:320
  ds_read_b64 v[36:37], v0 offset:312
  ds_read_b64 v[38:39], v0 offset:320
  s_waitcnt lgkmcnt(10)
  v_mfma_f32_16x16x32_bf16 v[64:67], v[112:115], v[16:19], 0
  ds_read_b64 v[40:41], v14 offset:624
  ds_read_b64 v[42:43], v14 offset:632
  ds_read_b64 v[44:45], v15 offset:624
  ds_read_b64 v[46:47], v15 offset:632
  ds_read_b64 v[48:49], v0 offset:624
  s_waitcnt lgkmcnt(14)
  ds_read_b64 v[50:51], v0 offset:632
  s_waitcnt lgkmcnt(10)
  v_mfma_f32_16x16x32_bf16 v[68:71], v[124:127], v[28:31], 0
  v_smfmac_f32_16x16x64_bf16 v[64:67], v[116:119], v[20:27], v7
  ds_read_b64 v[16:17], v14 offset:936
  ds_read_b64 v[18:19], v14 offset:944
  ds_read_b64 v[20:21], v15 offset:936
  ds_read_b64 v[22:23], v15 offset:944
  ds_read_b64 v[24:25], v0 offset:936
  s_waitcnt lgkmcnt(14)
  ds_read_b64 v[26:27], v0 offset:944
  s_waitcnt lgkmcnt(10)
  v_mfma_f32_16x16x32_bf16 v[72:75], v[136:139], v[40:43], 0
  v_smfmac_f32_16x16x64_bf16 v[68:71], v[128:131], v[32:39], v7
  ds_read_b64 v[28:29], v14 offset:1248
  ds_read_b64 v[30:31], v14 offset:1256
  ds_read_b64 v[32:33], v15 offset:1248
  ds_read_b64 v[34:35], v15 offset:1256
  ds_read_b64 v[36:37], v0 offset:1248
  s_waitcnt lgkmcnt(14)
  ds_read_b64 v[38:39], v0 offset:1256
  s_waitcnt lgkmcnt(10)
  v_mfma_f32_16x16x32_bf16 v[76:79], v[148:151], v[16:19], 0
  v_smfmac_f32_16x16x64_bf16 v[72:75], v[140:143], v[44:51], v7
  ds_read_b64 v[40:41], v14 offset:1560
  ds_read_b64 v[42:43], v14 offset:1568
  ds_read_b64 v[44:45], v15 offset:1560
  ds_read_b64 v[46:47], v15 offset:1568
  ds_read_b64 v[48:49], v0 offset:1560
  s_waitcnt lgkmcnt(14)
  ds_read_b64 v[50:51], v0 offset:1568
  s_waitcnt lgkmcnt(10)
  v_mfma_f32_16x16x32_bf16 v[80:83], v[160:163], v[28:31], 0
  v_smfmac_f32_16x16x64_bf16 v[76:79], v[152:155], v[20:27], v7
  ds_read_b64 v[16:17], v14 offset:1872
  ds_read_b64 v[18:19], v14 offset:1880
  ds_read_b64 v[20:21], v15 offset:1872
  ds_read_b64 v[22:23], v15 offset:1880
  ds_read_b64 v[24:25], v0 offset:1872
  s_waitcnt lgkmcnt(14)
  ds_read_b64 v[26:27], v0 offset:1880
  s_waitcnt lgkmcnt(10)
  v_mfma_f32_16x16x32_bf16 v[84:87], v[172:175], v[40:43], 0
  v_smfmac_f32_16x16x64_bf16 v[80:83], v[164:167], v[32:39], v7
  ds_read_b64 v[28:29], v14 offset:2184
  ds_read_b64 v[30:31], v14 offset:2192
  ds_read_b64 v[32:33], v15 offset:2184
  ds_read_b64 v[34:35], v15 offset:2192
  ds_read_b64 v[36:37], v0 offset:2184
  s_waitcnt lgkmcnt(14)
  ds_read_b64 v[38:39], v0 offset:2192
  s_waitcnt lgkmcnt(10)
  v_mfma_f32_16x16x32_bf16 v[88:91], v[184:187], v[16:19], 0
  v_smfmac_f32_16x16x64_bf16 v[84:87], v[176:179], v[44:51], v7
  ds_read_b64 v[40:41], v14 offset:2496
  ds_read_b64 v[42:43], v14 offset:2504
  ds_read_b64 v[44:45], v15 offset:2496
  ds_read_b64 v[46:47], v15 offset:2504
  ds_read_b64 v[48:49], v0 offset:2496
  s_waitcnt lgkmcnt(14)
  ds_read_b64 v[50:51], v0 offset:2504
  s_waitcnt lgkmcnt(10)
  v_mfma_f32_16x16x32_bf16 v[92:95], v[196:199], v[28:31], 0
  v_smfmac_f32_16x16x64_bf16 v[88:91], v[188:191], v[20:27], v7
  ds_read_b64 v[16:17], v14 offset:2808
  ds_read_b64 v[18:19], v14 offset:2816
  ds_read_b64 v[20:21], v15 offset:2808
  ds_read_b64 v[22:23], v15 offset:2816
  ds_read_b64 v[24:25], v0 offset:2808
  s_waitcnt lgkmcnt(14)
  ds_read_b64 v[26:27], v0 offset:2816
  s_waitcnt lgkmcnt(10)
  v_mfma_f32_16x16x32_bf16 v[96:99], v[208:211], v[40:43], 0
  v_smfmac_f32_16x16x64_bf16 v[92:95], v[200:203], v[32:39], v7
  ds_read_b64 v[28:29], v14 offset:3120
  ds_read_b64 v[30:31], v14 offset:3128
  ds_read_b64 v[32:33], v15 offset:3120
  ds_read_b64 v[34:35], v15 offset:3128
  ds_read_b64 v[36:37], v0 offset:3120
  s_waitcnt lgkmcnt(14)
  ds_read_b64 v[38:39], v0 offset:3128
  s_waitcnt lgkmcnt(10)
  v_mfma_f32_16x16x32_bf16 v[100:103], v[220:223], v[16:19], 0
  v_smfmac_f32_16x16x64_bf16 v[96:99], v[212:215], v[44:51], v7
  ds_read_b64 v[40:41], v14 offset:3432
  ds_read_b64 v[42:43], v14 offset:3440
  ds_read_b64 v[44:45], v15 offset:3432
  ds_read_b64 v[46:47], v15 offset:3440
  ds_read_b64 v[48:49], v0 offset:3432
  s_waitcnt lgkmcnt(14)
  ds_read_b64 v[50:51], v0 offset:3440
  s_waitcnt lgkmcnt(10)
  v_mfma_f32_16x16x32_bf16 v[104:107], v[232:235], v[28:31], 0
  v_smfmac_f32_16x16x64_bf16 v[100:103], v[224:227], v[20:27], v7
  s_waitcnt lgkmcnt(4)
  v_mfma_f32_16x16x32_bf16 v[108:111], v[244:247], v[40:43], 0
  v_smfmac_f32_16x16x64_bf16 v[104:107], v[236:239], v[32:39], v7
  s_waitcnt lgkmcnt(0)
  v_smfmac_f32_16x16x64_bf16 v[108:111], v[248:251], v[44:51], v7
  s_barrier
  ds_read_b64 v[16:17], v3 offset:0
  ds_read_b64 v[18:19], v3 offset:8
  ds_read_b64 v[20:21], v12 offset:0
  ds_read_b64 v[22:23], v12 offset:8
  ds_read_b64 v[24:25], v3 offset:312
  ds_read_b64 v[26:27], v3 offset:320
  ds_read_b64 v[28:29], v12 offset:312
  ds_read_b64 v[30:31], v12 offset:320
  ds_read_b64 v[32:33], v3 offset:624
  ds_read_b64 v[34:35], v3 offset:632
  ds_read_b64 v[36:37], v12 offset:624
  ds_read_b64 v[38:39], v12 offset:632
  s_waitcnt lgkmcnt(8)
  v_smfmac_f32_16x16x64_bf16 v[64:67], v[120:123], v[16:23], v7
  ds_read_b64 v[40:41], v3 offset:936
  ds_read_b64 v[42:43], v3 offset:944
  ds_read_b64 v[44:45], v12 offset:936
  ds_read_b64 v[46:47], v12 offset:944
  s_waitcnt lgkmcnt(8)
  v_smfmac_f32_16x16x64_bf16 v[68:71], v[132:135], v[24:31], v7
  ds_read_b64 v[16:17], v3 offset:1248
  ds_read_b64 v[18:19], v3 offset:1256
  ds_read_b64 v[20:21], v12 offset:1248
  ds_read_b64 v[22:23], v12 offset:1256
  v_add_f32 v8, v64, v65
  v_mul_f32 v9, v64, v64
  v_add_f32 v10, v66, v67
  v_mul_f32 v11, v66, v66
  v_fmac_f32 v9, v65, v65
  v_fmac_f32 v11, v67, v67
  s_waitcnt lgkmcnt(8)
  v_smfmac_f32_16x16x64_bf16 v[72:75], v[144:147], v[32:39], v7
  ds_read_b64 v[24:25], v3 offset:1560
  ds_read_b64 v[26:27], v3 offset:1568
  ds_read_b64 v[28:29], v12 offset:1560
  ds_read_b64 v[30:31], v12 offset:1568
  v_add_f32 v8, v8, v68
  v_add_f32 v10, v10, v70
  v_add_f32 v8, v8, v69
  v_add_f32 v10, v10, v71
  v_fmac_f32 v9, v68, v68
  v_fmac_f32 v11, v70, v70
  v_fmac_f32 v9, v69, v69
  v_fmac_f32 v11, v71, v71
  s_waitcnt lgkmcnt(8)
  v_smfmac_f32_16x16x64_bf16 v[76:79], v[156:159], v[40:47], v7
  ds_read_b64 v[32:33], v3 offset:1872
  ds_read_b64 v[34:35], v3 offset:1880
  ds_read_b64 v[36:37], v12 offset:1872
  ds_read_b64 v[38:39], v12 offset:1880
  v_add_f32 v8, v8, v72
  v_add_f32 v10, v10, v74
  v_add_f32 v8, v8, v73
  v_add_f32 v10, v10, v75
  v_fmac_f32 v9, v72, v72
  v_fmac_f32 v11, v74, v74
  v_fmac_f32 v9, v73, v73
  v_fmac_f32 v11, v75, v75
  s_waitcnt lgkmcnt(8)
  v_smfmac_f32_16x16x64_bf16 v[80:83], v[168:171], v[16:23], v7
  ds_read_b64 v[40:41], v3 offset:2184
  ds_read_b64 v[42:43], v3 offset:2192
  ds_read_b64 v[44:45], v12 offset:2184
  ds_read_b64 v[46:47], v12 offset:2192
  v_add_f32 v8, v8, v76
  v_add_f32 v10, v10, v78
  v_add_f32 v8, v8, v77
  v_add_f32 v10, v10, v79
  v_fmac_f32 v9, v76, v76
  v_fmac_f32 v11, v78, v78
  v_fmac_f32 v9, v77, v77
  v_fmac_f32 v11, v79, v79
  s_waitcnt lgkmcnt(8)
  v_smfmac_f32_16x16x64_bf16 v[84:87], v[180:183], v[24:31], v7
  ds_read_b64 v[16:17], v3 offset:2496
  ds_read_b64 v[18:19], v3 offset:2504
  ds_read_b64 v[20:21], v12 offset:2496
  ds_read_b64 v[22:23], v12 offset:2504
  v_add_f32 v8, v8, v80
  v_add_f32 v10, v10, v82
  v_add_f32 v8, v8, v81
  v_add_f32 v10, v10, v83
  v_fmac_f32 v9, v80, v80
  v_fmac_f32 v11, v82, v82
  v_fmac_f32 v9, v81, v81
  v_fmac_f32 v11, v83, v83
  s_waitcnt lgkmcnt(8)
  v_smfmac_f32_16x16x64_bf16 v[88:91], v[192:195], v[32:39], v7
  ds_read_b64 v[24:25], v3 offset:2808
  ds_read_b64 v[26:27], v3 offset:2816
  ds_read_b64 v[28:29], v12 offset:2808
  ds_read_b64 v[30:31], v12 offset:2816
  v_add_f32 v8, v8, v84
  v_add_f32 v10, v10, v86
  v_add_f32 v8, v8, v85
  v_add_f32 v10, v10, v87
  v_fmac_f32 v9, v84, v84
  v_fmac_f32 v11, v86, v86
  v_fmac_f32 v9, v85, v85
  v_fmac_f32 v11, v87, v87
  s_waitcnt lgkmcnt(8)
  v_smfmac_f32_16x16x64_bf16 v[92:95], v[204:207], v[40:47], v7
  ds_read_b64 v[32:33], v3 offset:3120
  ds_read_b64 v[34:35], v3 offset:3128
  ds_read_b64 v[36:37], v12 offset:3120
  ds_read_b64 v[38:39], v12 offset:3128
  v_add_f32 v8, v8, v88
  v_add_f32 v10, v10, v90
  v_add_f32 v8, v8, v89
  v_add_f32 v10, v10, v91
  v_fmac_f32 v9, v88, v88
  v_fmac_f32 v11, v90, v90
  v_fmac_f32 v9, v89, v89
  v_fmac_f32 v11, v91, v91
  s_waitcnt lgkmcnt(8)
  v_smfmac_f32_16x16x64_bf16 v[96:99], v[216:219], v[16:23], v7
  ds_read_b64 v[40:41], v3 offset:3432
  ds_read_b64 v[42:43], v3 offset:3440
  ds_read_b64 v[44:45], v12 offset:3432
  ds_read_b64 v[46:47], v12 offset:3440
  v_add_f32 v8, v8, v92
  v_add_f32 v10, v10, v94
  v_add_f32 v8, v8, v93
  v_add_f32 v10, v10, v95
  v_fmac_f32 v9, v92, v92
  v_fmac_f32 v11, v94, v94
  v_fmac_f32 v9, v93, v93
  v_fmac_f32 v11, v95, v95
  s_waitcnt lgkmcnt(8)
  v_smfmac_f32_16x16x64_bf16 v[100:103], v[228:231], v[24:31], v7
  v_add_f32 v8, v8, v96
  v_add_f32 v10, v10, v98
  v_add_f32 v8, v8, v97
  v_add_f32 v10, v10, v99
  v_fmac_f32 v9, v96, v96
  v_fmac_f32 v11, v98, v98
  v_fmac_f32 v9, v97, v97
  v_fmac_f32 v11, v99, v99
  s_waitcnt lgkmcnt(4)
  v_smfmac_f32_16x16x64_bf16 v[104:107], v[240:243], v[32:39], v7
  v_add_f32 v8, v8, v100
  v_add_f32 v10, v10, v102
  v_add_f32 v8, v8, v101
  v_add_f32 v10, v10, v103
  v_fmac_f32 v9, v100, v100
  v_fmac_f32 v11, v102, v102
  v_fmac_f32 v9, v101, v101
  v_fmac_f32 v11, v103, v103
  s_waitcnt lgkmcnt(0)
  v_smfmac_f32_16x16x64_bf16 v[108:111], v[252:255], v[40:47], v7
  v_add_f32 v8, v8, v104
  v_add_f32 v10, v10, v106
  v_add_f32 v8, v8, v105
  v_add_f32 v10, v10, v107
  v_fmac_f32 v9, v104, v104
  v_fmac_f32 v11, v106, v106
  v_fmac_f32 v9, v105, v105
  v_fmac_f32 v11, v107, v107
  s_lshl_b32 s49, s15, 10
  v_mbcnt_lo_u32_b32 v63, -1, 0
  v_mbcnt_hi_u32_b32 v63, -1, v63
  v_lshlrev_b32 v63, 4, v63
  v_add_u32 v14, s49, v63
  v_add_f32 v8, v8, v108
  v_add_f32 v10, v10, v110
  v_add_f32 v8, v8, v109
  v_add_f32 v10, v10, v111
  v_fmac_f32 v9, v108, v108
  v_fmac_f32 v11, v110, v110
  v_fmac_f32 v9, v109, v109
  v_fmac_f32 v11, v111, v111
  ds_write_b128 v14, v[8:11] offset:24576
  s_mov_b32 s49, s43
  s_mov_b32 s50, s44
  s_mov_b32 s43, s45
  s_mov_b32 s44, s46
  s_mov_b32 s45, s47
  s_mov_b32 s46, s48
  s_mov_b32 s47, s49
  s_mov_b32 s48, s50
  s_waitcnt lgkmcnt(0)
  s_barrier
  ds_read_b128 v[16:19], v63 offset:24576
  ds_read_b128 v[20:23], v63 offset:25600
  ds_read_b128 v[24:27], v63 offset:26624
  ds_read_b128 v[28:31], v63 offset:27648
  v_add_u32 v14, s43, v1
  v_add_u32 v15, s44, v1
  v_add_u32 v0, s45, v1
  v_mbcnt_lo_u32_b32 v12, -1, 0
  v_mbcnt_hi_u32_b32 v12, -1, v12
  v_lshlrev_b32 v12, 4, v12
  v_add_u32 v12, s3, v12
  s_waitcnt lgkmcnt(2)
  v_add_f32 v16, v16, v20
  v_add_f32 v17, v17, v21
  v_add_f32 v18, v18, v22
  v_add_f32 v19, v19, v23
  s_waitcnt lgkmcnt(0)
  v_add_f32 v24, v24, v28
  v_add_f32 v25, v25, v29
  v_add_f32 v26, v26, v30
  v_add_f32 v27, v27, v31
  v_add_f32 v16, v16, v24
  v_add_f32 v17, v17, v25
  v_add_f32 v18, v18, v26
  v_add_f32 v19, v19, v27
  v_mul_f32 v9, s58, v16
  v_mul_f32 v11, s58, v18
  v_mul_f32 v17, s58, v17
  v_mul_f32 v19, s58, v19
  v_mul_f32 v16, v9, v9
  v_mul_f32 v18, v11, v11
  v_sub_f32 v17, v17, v16
  v_sub_f32 v19, v19, v18
  v_cmp_u_f32 vcc, v17, v19
  v_max_f32 v17, 0, v17
  v_max_f32 v19, 0, v19
  s_or_b64 s[70:71], s[70:71], vcc
  v_add_f32 v17, 0x3727c5ac, v17
  v_add_f32 v19, 0x3727c5ac, v19
  v_rsq_f32 v17, v17
  v_rsq_f32 v19, v19
  v_mul_f32 v8, s38, v17
  v_mul_f32 v10, s38, v19
  v_mul_f32 v20, v9, v17
  v_mul_f32 v21, v11, v19
  v_min_f32 v16, v17, v19
  v_max_f32 v20, |v20|, |v21|
  v_cmp_lt_f32 vcc, 0x42800000, v20
  s_or_b64 s[70:71], s[70:71], vcc
  v_cmp_gt_f32 vcc, 0x3b800000, v16
  s_or_b64 s[70:71], s[70:71], vcc
  v_mul_f32 v9, -v9, v8
  v_mul_f32 v11, -v11, v10
  s_mov_b32 s49, s38
  s_mov_b32 s38, s39
  s_mov_b32 s39, s49
  v_pk_fma_f32 v[64:65], v[64:65], v[8:9], v[8:9] op_sel:[0,0,1] op_sel_hi:[1,0,1]
  v_pk_fma_f32 v[66:67], v[66:67], v[10:11], v[10:11] op_sel:[0,0,1] op_sel_hi:[1,0,1]
  v_pk_fma_f32 v[68:69], v[68:69], v[8:9], v[8:9] op_sel:[0,0,1] op_sel_hi:[1,0,1]
  v_pk_fma_f32 v[70:71], v[70:71], v[10:11], v[10:11] op_sel:[0,0,1] op_sel_hi:[1,0,1]
  v_pk_fma_f32 v[72:73], v[72:73], v[8:9], v[8:9] op_sel:[0,0,1] op_sel_hi:[1,0,1]
  v_pk_fma_f32 v[74:75], v[74:75], v[10:11], v[10:11] op_sel:[0,0,1] op_sel_hi:[1,0,1]
  v_pk_fma_f32 v[76:77], v[76:77], v[8:9], v[8:9] op_sel:[0,0,1] op_sel_hi:[1,0,1]
  v_pk_fma_f32 v[78:79], v[78:79], v[10:11], v[10:11] op_sel:[0,0,1] op_sel_hi:[1,0,1]
  v_cvt_pk_bf16_f32 v40, v66, v67
  v_cvt_pk_bf16_f32 v41, v70, v71
  v_cvt_pk_bf16_f32 v42, v74, v75
  v_cvt_pk_bf16_f32 v43, v78, v79
  ds_write_b128 v12, v[40:43] offset:1024
  v_cvt_pk_bf16_f32 v64, v64, v65
  v_cvt_pk_bf16_f32 v65, v68, v69
  v_cvt_pk_bf16_f32 v66, v72, v73
  v_cvt_pk_bf16_f32 v67, v76, v77
  ds_write_b128 v12, v[64:67] offset:0
  v_pk_fma_f32 v[80:81], v[80:81], v[8:9], v[8:9] op_sel:[0,0,1] op_sel_hi:[1,0,1]
  v_pk_fma_f32 v[82:83], v[82:83], v[10:11], v[10:11] op_sel:[0,0,1] op_sel_hi:[1,0,1]
  v_pk_fma_f32 v[84:85], v[84:85], v[8:9], v[8:9] op_sel:[0,0,1] op_sel_hi:[1,0,1]
  v_pk_fma_f32 v[86:87], v[86:87], v[10:11], v[10:11] op_sel:[0,0,1] op_sel_hi:[1,0,1]
  v_pk_fma_f32 v[88:89], v[88:89], v[8:9], v[8:9] op_sel:[0,0,1] op_sel_hi:[1,0,1]
  v_pk_fma_f32 v[90:91], v[90:91], v[10:11], v[10:11] op_sel:[0,0,1] op_sel_hi:[1,0,1]
  v_pk_fma_f32 v[92:93], v[92:93], v[8:9], v[8:9] op_sel:[0,0,1] op_sel_hi:[1,0,1]
  v_pk_fma_f32 v[94:95], v[94:95], v[10:11], v[10:11] op_sel:[0,0,1] op_sel_hi:[1,0,1]
  v_cvt_pk_bf16_f32 v40, v82, v83
  v_cvt_pk_bf16_f32 v41, v86, v87
  v_cvt_pk_bf16_f32 v42, v90, v91
  v_cvt_pk_bf16_f32 v43, v94, v95
  ds_write_b128 v12, v[40:43] offset:3072
  v_cvt_pk_bf16_f32 v80, v80, v81
  v_cvt_pk_bf16_f32 v81, v84, v85
  v_cvt_pk_bf16_f32 v82, v88, v89
  v_cvt_pk_bf16_f32 v83, v92, v93
  ds_write_b128 v12, v[80:83] offset:2048
  v_pk_fma_f32 v[96:97], v[96:97], v[8:9], v[8:9] op_sel:[0,0,1] op_sel_hi:[1,0,1]
  v_pk_fma_f32 v[98:99], v[98:99], v[10:11], v[10:11] op_sel:[0,0,1] op_sel_hi:[1,0,1]
  v_pk_fma_f32 v[100:101], v[100:101], v[8:9], v[8:9] op_sel:[0,0,1] op_sel_hi:[1,0,1]
  v_pk_fma_f32 v[102:103], v[102:103], v[10:11], v[10:11] op_sel:[0,0,1] op_sel_hi:[1,0,1]
  v_pk_fma_f32 v[104:105], v[104:105], v[8:9], v[8:9] op_sel:[0,0,1] op_sel_hi:[1,0,1]
  v_pk_fma_f32 v[106:107], v[106:107], v[10:11], v[10:11] op_sel:[0,0,1] op_sel_hi:[1,0,1]
  v_pk_fma_f32 v[108:109], v[108:109], v[8:9], v[8:9] op_sel:[0,0,1] op_sel_hi:[1,0,1]
  v_pk_fma_f32 v[110:111], v[110:111], v[10:11], v[10:11] op_sel:[0,0,1] op_sel_hi:[1,0,1]
  v_cvt_pk_bf16_f32 v40, v98, v99
  v_cvt_pk_bf16_f32 v41, v102, v103
  v_cvt_pk_bf16_f32 v42, v106, v107
  v_cvt_pk_bf16_f32 v43, v110, v111
  ds_write_b128 v12, v[40:43] offset:5120
  v_cvt_pk_bf16_f32 v96, v96, v97
  v_cvt_pk_bf16_f32 v97, v100, v101
  v_cvt_pk_bf16_f32 v98, v104, v105
  v_cvt_pk_bf16_f32 v99, v108, v109
  ds_write_b128 v12, v[96:99] offset:4096
  s_waitcnt vmcnt(0)
  s_waitcnt lgkmcnt(0)
  s_barrier
  ds_read_b64 v[32:33], v14 offset:0
  ds_read_b64 v[34:35], v14 offset:8
  ds_read_b64 v[36:37], v15 offset:0
  ds_read_b64 v[38:39], v15 offset:8
  ds_read_b64 v[40:41], v0 offset:0
  ds_read_b64 v[42:43], v0 offset:8
  ds_read_b64 v[44:45], v14 offset:312
  ds_read_b64 v[46:47], v14 offset:320
  ds_read_b64 v[48:49], v15 offset:312
  ds_read_b64 v[50:51], v15 offset:320
  ds_read_b64 v[52:53], v0 offset:312
  ds_read_b64 v[54:55], v0 offset:320
  ds_read_b64 v[16:17], v14 offset:624
  ds_read_b64 v[18:19], v14 offset:632
  ds_read_b64 v[20:21], v15 offset:624
  s_waitcnt lgkmcnt(14)
  ds_read_b64 v[22:23], v15 offset:632
  s_waitcnt lgkmcnt(14)
  ds_read_b64 v[24:25], v0 offset:624
  s_waitcnt lgkmcnt(14)
  ds_read_b64 v[26:27], v0 offset:632
  v_mfma_f32_16x16x32_bf16 v[64:67], v[112:115], v[32:35], 0
  s_waitcnt lgkmcnt(12)
  v_smfmac_f32_16x16x64_bf16 v[64:67], v[116:119], v[36:43], v7
  ds_read_b64 v[32:33], v14 offset:936
  ds_read_b64 v[34:35], v14 offset:944
  ds_read_b64 v[36:37], v15 offset:936
  s_waitcnt lgkmcnt(14)
  ds_read_b64 v[38:39], v15 offset:944
  s_waitcnt lgkmcnt(14)
  ds_read_b64 v[40:41], v0 offset:936
  s_waitcnt lgkmcnt(14)
  ds_read_b64 v[42:43], v0 offset:944
  v_mfma_f32_16x16x32_bf16 v[68:71], v[124:127], v[44:47], 0
  s_waitcnt lgkmcnt(12)
  v_smfmac_f32_16x16x64_bf16 v[68:71], v[128:131], v[48:55], v7
  ds_read_b64 v[44:45], v14 offset:1248
  ds_read_b64 v[46:47], v14 offset:1256
  ds_read_b64 v[48:49], v15 offset:1248
  s_waitcnt lgkmcnt(14)
  ds_read_b64 v[50:51], v15 offset:1256
  s_waitcnt lgkmcnt(14)
  ds_read_b64 v[52:53], v0 offset:1248
  s_waitcnt lgkmcnt(14)
  ds_read_b64 v[54:55], v0 offset:1256
  v_mfma_f32_16x16x32_bf16 v[72:75], v[136:139], v[16:19], 0
  s_waitcnt lgkmcnt(12)
  v_smfmac_f32_16x16x64_bf16 v[72:75], v[140:143], v[20:27], v7
  ds_read_b64 v[16:17], v14 offset:1560
  ds_read_b64 v[18:19], v14 offset:1568
  ds_read_b64 v[20:21], v15 offset:1560
  s_waitcnt lgkmcnt(14)
  ds_read_b64 v[22:23], v15 offset:1568
  s_waitcnt lgkmcnt(14)
  ds_read_b64 v[24:25], v0 offset:1560
  s_waitcnt lgkmcnt(14)
  ds_read_b64 v[26:27], v0 offset:1568
  v_mfma_f32_16x16x32_bf16 v[76:79], v[148:151], v[32:35], 0
  s_waitcnt lgkmcnt(12)
  v_smfmac_f32_16x16x64_bf16 v[76:79], v[152:155], v[36:43], v7
  s_waitcnt lgkmcnt(10)
  v_mfma_f32_16x16x32_bf16 v[80:83], v[160:163], v[44:47], 0
  s_waitcnt lgkmcnt(6)
  v_smfmac_f32_16x16x64_bf16 v[80:83], v[164:167], v[48:55], v7
  s_waitcnt lgkmcnt(4)
  v_mfma_f32_16x16x32_bf16 v[84:87], v[172:175], v[16:19], 0
  s_waitcnt lgkmcnt(0)
  v_smfmac_f32_16x16x64_bf16 v[84:87], v[176:179], v[20:27], v7
  s_setprio 1
L_ploop:
  v_add_u32 v3, s46, v1
  v_add_u32 v12, s47, v1
  ds_read_b64 v[16:17], v3 offset:0
  ds_read_b64 v[18:19], v3 offset:8
  ds_read_b64 v[20:21], v12 offset:0
  ds_read_b64 v[22:23], v12 offset:8
  s_add_u32 m0, s56, 24576
  s_add_u32 s59, s41, s55
  buffer_load_dwordx4 v13, s[24:27], s41 offen lds
  ds_read_b64 v[24:25], v3 offset:312
  ds_read_b64 v[26:27], v3 offset:320
  ds_read_b64 v[28:29], v12 offset:312
  ds_read_b64 v[30:31], v12 offset:320
  s_add_u32 m0, s56, 25600
  s_cmp_ge_u32 s59, s42
  s_cselect_b32 s59, 0, s59
  buffer_load_dwordx4 v13, s[28:31], s41 offen lds
  s_setprio 3
  s_waitcnt lgkmcnt(4)
  v_smfmac_f32_16x16x64_bf16 v[64:67], v[120:123], v[16:23], v7
  s_setprio 1
  ds_read_b64 v[16:17], v14 offset:1872
  ds_read_b64 v[18:19], v14 offset:1880
  ds_read_b64 v[20:21], v14 offset:2184
  ds_read_b64 v[22:23], v14 offset:2192
  s_add_u32 m0, s56, 26624
  s_nop 0
  buffer_load_dwordx4 v13, s[32:35], s41 offen lds
  s_mov_b32 s41, s59
  s_add_u32 s53, s53, 4
  s_mul_i32 s19, s54, s53
  s_add_u32 s19, s16, s19
  s_cmp_lt_u32 s53, 38
  s_cselect_b32 s19, s19, 0x1000
  s_cmp_lt_u32 s19, 512
  s_cselect_b32 s22, 98304, 0
  s_cselect_b32 s19, s19, 0
  s_mul_i32 s19, s19, 98304
  s_add_u32 s20, s4, s19
  s_addc_u32 s21, s5, 0
  v_add_u32 v11, 3072, v2
  buffer_load_dwordx4 v[44:47], v11, s[20:23], 0 offen offset:0
  s_setprio 3
  s_waitcnt lgkmcnt(4)
  v_smfmac_f32_16x16x64_bf16 v[68:71], v[132:135], v[24:31], v7
  s_setprio 1
  ds_read_b64 v[24:25], v15 offset:1872
  ds_read_b64 v[26:27], v15 offset:1880
  ds_read_b64 v[28:29], v0 offset:1872
  ds_read_b64 v[30:31], v0 offset:1880
  buffer_load_dwordx4 v[48:51], v11, s[20:23], 0 offen offset:64
  buffer_load_dwordx4 v[52:55], v11, s[20:23], 0 offen offset:128
  v_add_f32 v8, v64, v65
  v_mul_f32 v9, v64, v64
  v_add_f32 v10, v66, v67
  v_mul_f32 v11, v66, v66
  s_setprio 3
  v_fmac_f32 v9, v65, v65
  v_fmac_f32 v11, v67, v67
  s_waitcnt lgkmcnt(6)
  v_mfma_f32_16x16x32_bf16 v[88:91], v[184:187], v[16:19], 0
  s_waitcnt lgkmcnt(4)
  v_mfma_f32_16x16x32_bf16 v[92:95], v[196:199], v[20:23], 0
  s_setprio 1
  ds_read_b64 v[16:17], v3 offset:624
  ds_read_b64 v[18:19], v3 offset:632
  ds_read_b64 v[20:21], v12 offset:624
  ds_read_b64 v[22:23], v12 offset:632
  buffer_load_dwordx4 v[40:43], v2, s[20:23], 0 offen offset:128
  v_add_f32 v8, v8, v68
  v_add_f32 v10, v10, v70
  v_add_f32 v8, v8, v69
  v_add_f32 v10, v10, v71
  s_setprio 3
  s_waitcnt lgkmcnt(4)
  v_smfmac_f32_16x16x64_bf16 v[88:91], v[188:191], v[24:31], v7
  s_setprio 1
  ds_read_b64 v[24:25], v15 offset:2184
  ds_read_b64 v[26:27], v15 offset:2192
  ds_read_b64 v[28:29], v0 offset:2184
  ds_read_b64 v[30:31], v0 offset:2192
  s_setprio 3
  v_fmac_f32 v9, v68, v68
  v_fmac_f32 v11, v70, v70
  v_fmac_f32 v9, v69, v69
  v_fmac_f32 v11, v71, v71
  s_waitcnt lgkmcnt(4)
  v_smfmac_f32_16x16x64_bf16 v[72:75], v[144:147], v[16:23], v7
  s_setprio 1
  ds_read_b64 v[16:17], v3 offset:936
  ds_read_b64 v[18:19], v3 offset:944
  ds_read_b64 v[20:21], v12 offset:936
  ds_read_b64 v[22:23], v12 offset:944
  s_waitcnt vmcnt(7)
  s_barrier
  s_add_u32 m0, s56, 0
  s_add_u32 s59, s41, s55
  buffer_load_dwordx4 v13, s[24:27], s41 offen lds
  s_setprio 3
  s_waitcnt lgkmcnt(4)
  v_smfmac_f32_16x16x64_bf16 v[92:95], v[200:203], v[24:31], v7
  s_setprio 1
  ds_read_b64 v[24:25], v14 offset:2496
  ds_read_b64 v[26:27], v14 offset:2504
  ds_read_b64 v[28:29], v14 offset:2808
  ds_read_b64 v[30:31], v14 offset:2816
  s_add_u32 m0, s56, 1024
  s_cmp_ge_u32 s59, s42
  s_cselect_b32 s59, 0, s59
  buffer_load_dwordx4 v13, s[28:31], s41 offen lds
  s_add_u32 m0, s56, 2048
  s_nop 0
  buffer_load_dwordx4 v13, s[32:35], s41 offen lds
  s_mov_b32 s41, s59
  buffer_load_dwordx4 v[32:35], v2, s[20:23], 0 offen offset:0
  v_add_f32 v8, v8, v72
  v_add_f32 v10, v10, v74
  v_add_f32 v8, v8, v73
  v_add_f32 v10, v10, v75
  s_setprio 3
  v_fmac_f32 v9, v72, v72
  v_fmac_f32 v11, v74, v74
  v_fmac_f32 v9, v73, v73
  v_fmac_f32 v11, v75, v75
  s_waitcnt lgkmcnt(4)
  v_smfmac_f32_16x16x64_bf16 v[76:79], v[156:159], v[16:23], v7
  s_setprio 1
  ds_read_b64 v[16:17], v15 offset:2496
  ds_read_b64 v[18:19], v15 offset:2504
  ds_read_b64 v[20:21], v0 offset:2496
  ds_read_b64 v[22:23], v0 offset:2504
  buffer_load_dwordx4 v[36:39], v2, s[20:23], 0 offen offset:64
  s_setprio 3
  s_waitcnt lgkmcnt(6)
  v_mfma_f32_16x16x32_bf16 v[96:99], v[208:211], v[24:27], 0
  s_waitcnt lgkmcnt(4)
  v_mfma_f32_16x16x32_bf16 v[100:103], v[220:223], v[28:31], 0
  s_setprio 1
  ds_read_b64 v[24:25], v3 offset:1248
  ds_read_b64 v[26:27], v3 offset:1256
  ds_read_b64 v[28:29], v12 offset:1248
  ds_read_b64 v[30:31], v12 offset:1256
  s_mov_b32 exec_lo, 0xffffff
  s_mov_b32 exec_hi, 0xffffff
  buffer_load_dwordx4 v[56:59], v4, s[20:23], 0 offen offset:0
  s_mov_b32 exec_hi, 0
  buffer_load_dwordx4 v[60:63], v4, s[20:23], 0 offen offset:128
  s_mov_b64 exec, -1
  v_add_f32 v8, v8, v76
  v_add_f32 v10, v10, v78
  v_add_f32 v8, v8, v77
  v_add_f32 v10, v10, v79
  s_setprio 3
  v_fmac_f32 v9, v76, v76
  v_fmac_f32 v11, v78, v78
  v_fmac_f32 v9, v77, v77
  v_fmac_f32 v11, v79, v79
  s_waitcnt lgkmcnt(4)
  v_smfmac_f32_16x16x64_bf16 v[96:99], v[212:215], v[16:23], v7
  s_setprio 1
  ds_read_b64 v[16:17], v15 offset:2808
  ds_read_b64 v[18:19], v15 offset:2816
  ds_read_b64 v[20:21], v0 offset:2808
  ds_read_b64 v[22:23], v0 offset:2816
  s_setprio 3
  s_waitcnt lgkmcnt(4)
  v_smfmac_f32_16x16x64_bf16 v[80:83], v[168:171], v[24:31], v7
  s_setprio 1
  ds_read_b64 v[24:25], v3 offset:1560
  ds_read_b64 v[26:27], v3 offset:1568
  ds_read_b64 v[28:29], v12 offset:1560
  ds_read_b64 v[30:31], v12 offset:1568
  s_setprio 3
  s_waitcnt lgkmcnt(4)
  v_smfmac_f32_16x16x64_bf16 v[100:103], v[224:227], v[16:23], v7
  s_setprio 1
  ds_read_b64 v[16:17], v14 offset:3120
  ds_read_b64 v[18:19], v14 offset:3128
  ds_read_b64 v[20:21], v14 offset:3432
  ds_read_b64 v[22:23], v14 offset:3440
  v_add_f32 v8, v8, v80
  v_add_f32 v10, v10, v82
  v_add_f32 v8, v8, v81
  v_add_f32 v10, v10, v83
  s_setprio 3
  v_fmac_f32 v9, v80, v80
  v_fmac_f32 v11, v82, v82
  v_fmac_f32 v9, v81, v81
  v_fmac_f32 v11, v83, v83
  s_waitcnt lgkmcnt(4)
  v_smfmac_f32_16x16x64_bf16 v[84:87], v[180:183], v[24:31], v7
  s_setprio 1
  ds_read_b64 v[24:25], v15 offset:3120
  ds_read_b64 v[26:27], v15 offset:3128
  ds_read_b64 v[28:29], v0 offset:3120
  ds_read_b64 v[30:31], v0 offset:3128
  s_setprio 3
  s_waitcnt lgkmcnt(6)
  v_mfma_f32_16x16x32_bf16 v[104:107], v[232:235], v[16:19], 0
  s_waitcnt lgkmcnt(4)
  v_mfma_f32_16x16x32_bf16 v[108:111], v[244:247], v[20:23], 0
  s_setprio 1
  ds_read_b64 v[16:17], v3 offset:1872
  ds_read_b64 v[18:19], v3 offset:1880
  ds_read_b64 v[20:21], v12 offset:1872
  ds_read_b64 v[22:23], v12 offset:1880
  v_add_f32 v8, v8, v84
  v_add_f32 v10, v10, v86
  v_add_f32 v8, v8, v85
  v_add_f32 v10, v10, v87
  s_setprio 3
  v_fmac_f32 v9, v84, v84
  v_fmac_f32 v11, v86, v86
  v_fmac_f32 v9, v85, v85
  v_fmac_f32 v11, v87, v87
  s_waitcnt lgkmcnt(4)
  v_smfmac_f32_16x16x64_bf16 v[104:107], v[236:239], v[24:31], v7
  s_setprio 1
  ds_read_b64 v[24:25], v15 offset:3432
  ds_read_b64 v[26:27], v15 offset:3440
  ds_read_b64 v[28:29], v0 offset:3432
  ds_read_b64 v[30:31], v0 offset:3440
  s_setprio 3
  s_waitcnt lgkmcnt(4)
  v_smfmac_f32_16x16x64_bf16 v[88:91], v[192:195], v[16:23], v7
  s_setprio 1
  ds_read_b64 v[16:17], v3 offset:2184
  ds_read_b64 v[18:19], v3 offset:2192
  ds_read_b64 v[20:21], v12 offset:2184
  ds_read_b64 v[22:23], v12 offset:2192
  s_waitcnt vmcnt(11)
  s_barrier
  s_add_u32 m0, s56, 12288
  s_add_u32 s59, s41, s55
  buffer_load_dwordx4 v13, s[24:27], s41 offen lds
  s_setprio 3
  s_waitcnt lgkmcnt(4)
  v_smfmac_f32_16x16x64_bf16 v[108:111], v[248:251], v[24:31], v7
  s_setprio 1
  ds_read_b64 v[24:25], v3 offset:2496
  ds_read_b64 v[26:27], v3 offset:2504
  ds_read_b64 v[28:29], v12 offset:2496
  ds_read_b64 v[30:31], v12 offset:2504
  v_add_f32 v8, v8, v88
  v_add_f32 v10, v10, v90
  v_add_f32 v8, v8, v89
  s_add_u32 m0, s56, 13312
  s_cmp_ge_u32 s59, s42
  s_cselect_b32 s59, 0, s59
  buffer_load_dwordx4 v13, s[28:31], s41 offen lds
  v_add_f32 v10, v10, v91
  s_setprio 3
  v_fmac_f32 v9, v88, v88
  v_fmac_f32 v11, v90, v90
  v_fmac_f32 v9, v89, v89
  v_fmac_f32 v11, v91, v91
  s_waitcnt lgkmcnt(4)
  v_smfmac_f32_16x16x64_bf16 v[92:95], v[204:207], v[16:23], v7
  s_setprio 1
  ds_read_b64 v[16:17], v3 offset:2808
  ds_read_b64 v[18:19], v3 offset:2816
  s_add_u32 m0, s56, 14336
  s_nop 0
  buffer_load_dwordx4 v13, s[32:35], s41 offen lds
  s_mov_b32 s41, s59
  ds_read_b64 v[20:21], v12 offset:2808
  ds_read_b64 v[22:23], v12 offset:2816
  s_setprio 3
  s_waitcnt lgkmcnt(4)
  v_smfmac_f32_16x16x64_bf16 v[96:99], v[216:219], v[24:31], v7
  s_setprio 1
  ds_read_b64 v[24:25], v3 offset:3120
  ds_read_b64 v[26:27], v3 offset:3128
  ds_read_b64 v[28:29], v12 offset:3120
  ds_read_b64 v[30:31], v12 offset:3128
  v_add_f32 v8, v8, v92
  v_add_f32 v10, v10, v94
  v_add_f32 v8, v8, v93
  v_add_f32 v10, v10, v95
  s_setprio 3
  v_fmac_f32 v9, v92, v92
  v_fmac_f32 v11, v94, v94
  v_fmac_f32 v9, v93, v93
  v_fmac_f32 v11, v95, v95
  s_waitcnt lgkmcnt(4)
  v_smfmac_f32_16x16x64_bf16 v[100:103], v[228:231], v[16:23], v7
  s_setprio 1
  ds_read_b64 v[16:17], v3 offset:3432
  ds_read_b64 v[18:19], v3 offset:3440
  ds_read_b64 v[20:21], v12 offset:3432
  ds_read_b64 v[22:23], v12 offset:3440
  v_add_f32 v8, v8, v96
  v_add_f32 v10, v10, v98
  v_add_f32 v8, v8, v97
  v_add_f32 v10, v10, v99
  s_setprio 3
  v_fmac_f32 v9, v96, v96
  v_fmac_f32 v11, v98, v98
  v_fmac_f32 v9, v97, v97
  v_fmac_f32 v11, v99, v99
  s_waitcnt lgkmcnt(4)
  v_smfmac_f32_16x16x64_bf16 v[104:107], v[240:243], v[24:31], v7
  s_setprio 1
  v_add_f32 v8, v8, v100
  v_add_f32 v10, v10, v102
  v_add_f32 v8, v8, v101
  v_add_f32 v10, v10, v103
  s_setprio 3
  v_fmac_f32 v9, v100, v100
  v_fmac_f32 v11, v102, v102
  v_fmac_f32 v9, v101, v101
  v_fmac_f32 v11, v103, v103
  s_waitcnt lgkmcnt(0)
  v_smfmac_f32_16x16x64_bf16 v[108:111], v[252:255], v[16:23], v7
  s_setprio 1
  v_add_f32 v8, v8, v104
  v_add_f32 v10, v10, v106
  v_add_f32 v8, v8, v105
  v_add_f32 v10, v10, v107
  s_setprio 3
  v_fmac_f32 v9, v104, v104
  v_fmac_f32 v11, v106, v106
  v_fmac_f32 v9, v105, v105
  v_fmac_f32 v11, v107, v107
  s_setprio 1
  v_mbcnt_lo_u32_b32 v12, -1, 0
  v_mbcnt_hi_u32_b32 v12, -1, v12
  v_lshlrev_b32 v12, 4, v12
  v_add_u32 v14, 137472, v12
  v_add_u32 v12, s3, v12
  v_add_f32 v8, v8, v108
  v_add_f32 v10, v10, v110
  v_add_f32 v8, v8, v109
  v_add_f32 v10, v10, v111
  s_setprio 3
  v_fmac_f32 v9, v108, v108
  v_fmac_f32 v11, v110, v110
  v_fmac_f32 v9, v109, v109
  v_fmac_f32 v11, v111, v111
  s_setprio 1
  ds_write_b128 v12, v[8:11] offset:4096
  s_cmp_ge_u32 s15, 2
  s_cselect_b32 s18, s43, s48
  s_and_b32 s50, s15, 1
  s_mul_i32 s50, s50, 152
  s_add_u32 s18, s18, s50
  s_mov_b32 s49, s43
  s_mov_b32 s50, s44
  s_mov_b32 s43, s45
  s_mov_b32 s44, s46
  s_mov_b32 s45, s47
  s_mov_b32 s46, s48
  s_mov_b32 s47, s49
  s_mov_b32 s48, s50
  s_waitcnt vmcnt(7)
  s_waitcnt lgkmcnt(0)
  s_barrier
  s_cmp_eq_u32 s52, 7
  s_cbranch_scc1 L_plast
  s_add_u32 s52, s52, 1
  ds_read_b128 v[16:19], v14 offset:4096
  ds_read_b128 v[20:23], v14 offset:10240
  ds_read_b128 v[24:27], v14 offset:16384
  ds_read_b128 v[28:31], v14 offset:22528
  s_add_u32 m0, s56, 24576
  s_add_u32 s59, s41, s55
  buffer_load_dwordx4 v13, s[24:27], s41 offen lds
  s_waitcnt lgkmcnt(2)
  v_add_f32 v16, v16, v20
  v_add_f32 v17, v17, v21
  s_add_u32 s49, s18, 9984
  v_add_u32 v3, s49, v5
  ds_write2_b32 v3, v40, v41 offset0:0 offset1:78
  v_add_f32 v18, v18, v22
  v_add_f32 v19, v19, v23
  s_waitcnt lgkmcnt(1)
  v_add_f32 v24, v24, v28
  v_add_f32 v25, v25, v29
  v_add_f32 v26, v26, v30
  s_add_u32 m0, s56, 25600
  s_cmp_ge_u32 s59, s42
  s_cselect_b32 s59, 0, s59
  buffer_load_dwordx4 v13, s[28:31], s41 offen lds
  v_add_f32 v27, v27, v31
  v_add_f32 v16, v16, v24
  ds_write2_b32 v3, v42, v43 offset0:156 offset1:234
  v_add_f32 v17, v17, v25
  v_add_f32 v18, v18, v26
  v_add_f32 v19, v19, v27
  s_setprio 3
  v_mul_f32 v9, s58, v16
  v_mul_f32 v11, s58, v18
  v_mul_f32 v17, s58, v17
  s_add_u32 m0, s56, 26624
  s_nop 0
  buffer_load_dwordx4 v13, s[32:35], s41 offen lds
  s_mov_b32 s41, s59
  v_mul_f32 v19, s58, v19
  v_mul_f32 v16, v9, v9
  v_mul_f32 v18, v11, v11
  v_sub_f32 v17, v17, v16
  v_sub_f32 v19, v19, v18
  v_cmp_u_f32 vcc, v17, v19
  v_max_f32 v17, 0, v17
  v_max_f32 v19, 0, v19
  s_or_b64 s[70:71], s[70:71], vcc
  v_add_f32 v17, 0x3727c5ac, v17
  v_add_f32 v19, 0x3727c5ac, v19
  v_rsq_f32 v17, v17
  v_rsq_f32 v19, v19
  v_mul_f32 v8, s38, v17
  v_mul_f32 v10, s38, v19
  v_mul_f32 v20, v9, v17
  v_mul_f32 v21, v11, v19
  v_min_f32 v16, v17, v19
  v_max_f32 v20, |v20|, |v21|
  v_cmp_lt_f32 vcc, 0x42800000, v20
  s_or_b64 s[70:71], s[70:71], vcc
  v_cmp_gt_f32 vcc, 0x3b800000, v16
  s_or_b64 s[70:71], s[70:71], vcc
  v_mul_f32 v9, -v9, v8
  v_mul_f32 v11, -v11, v10
  s_setprio 1
  s_mov_b32 s49, s38
  s_mov_b32 s38, s39
  s_mov_b32 s39, s49
  v_add_u32 v14, s43, v1
  v_add_u32 v15, s44, v1
  v_add_u32 v0, s45, v1
  ds_read_b64 v[16:17], v14 offset:0
  ds_read_b64 v[18:19], v14 offset:8
  ds_read_b64 v[20:21], v14 offset:312
  ds_read_b64 v[22:23], v14 offset:320
  ds_read_b64 v[24:25], v15 offset:0
  ds_read_b64 v[26:27], v15 offset:8
  ds_read_b64 v[28:29], v0 offset:0
  ds_read_b64 v[30:31], v0 offset:8
  s_setprio 3
  v_fma_f32 v64, v64, v8, v9
  v_fma_f32 v65, v65, v8, v9
  v_fma_f32 v66, v66, v10, v11
  v_fma_f32 v67, v67, v10, v11
  v_fma_f32 v68, v68, v8, v9
  v_fma_f32 v69, v69, v8, v9
  v_fma_f32 v70, v70, v10, v11
  v_fma_f32 v71, v71, v10, v11
  v_fma_f32 v72, v72, v8, v9
  v_fma_f32 v73, v73, v8, v9
  v_fma_f32 v74, v74, v10, v11
  v_fma_f32 v75, v75, v10, v11
  v_fma_f32 v76, v76, v8, v9
  v_fma_f32 v77, v77, v8, v9
  v_fma_f32 v78, v78, v10, v11
  v_fma_f32 v79, v79, v10, v11
  s_setprio 1
  v_cvt_pk_bf16_f32 v40, v66, v67
  v_cvt_pk_bf16_f32 v41, v70, v71
  ds_write2_b32 v3, v52, v53 offset0:16 offset1:94
  v_cvt_pk_bf16_f32 v42, v74, v75
  v_cvt_pk_bf16_f32 v43, v78, v79
  ds_write_b128 v12, v[40:43] offset:1024
  v_cvt_pk_bf16_f32 v64, v64, v65
  v_cvt_pk_bf16_f32 v65, v68, v69
  v_cvt_pk_bf16_f32 v66, v72, v73
  v_cvt_pk_bf16_f32 v67, v76, v77
  ds_write_b128 v12, v[64:67] offset:0
  s_waitcnt vmcnt(3)
  s_barrier
  s_add_u32 m0, s56, 0
  s_add_u32 s59, s41, s55
  buffer_load_dwordx4 v13, s[24:27], s41 offen lds
  s_setprio 3
  s_waitcnt lgkmcnt(9)
  v_mfma_f32_16x16x32_bf16 v[64:67], v[112:115], v[16:19], 0
  s_waitcnt lgkmcnt(7)
  v_mfma_f32_16x16x32_bf16 v[68:71], v[124:127], v[20:23], 0
  s_setprio 1
  ds_read_b64 v[16:17], v15 offset:312
  ds_read_b64 v[18:19], v15 offset:320
  ds_read_b64 v[20:21], v0 offset:312
  ds_read_b64 v[22:23], v0 offset:320
  s_setprio 3
  v_fma_f32 v80, v80, v8, v9
  s_add_u32 m0, s56, 1024
  s_cmp_ge_u32 s59, s42
  s_cselect_b32 s59, 0, s59
  buffer_load_dwordx4 v13, s[28:31], s41 offen lds
  v_fma_f32 v81, v81, v8, v9
  v_fma_f32 v82, v82, v10, v11
  v_fma_f32 v83, v83, v10, v11
  s_waitcnt lgkmcnt(7)
  v_smfmac_f32_16x16x64_bf16 v[64:67], v[116:119], v[24:31], v7
  s_setprio 1
  ds_read_b64 v[24:25], v14 offset:624
  ds_read_b64 v[26:27], v14 offset:632
  ds_read_b64 v[28:29], v14 offset:936
  ds_read_b64 v[30:31], v14 offset:944
  s_setprio 3
  s_add_u32 m0, s56, 2048
  s_nop 0
  buffer_load_dwordx4 v13, s[32:35], s41 offen lds
  s_mov_b32 s41, s59
  v_fma_f32 v84, v84, v8, v9
  v_fma_f32 v85, v85, v8, v9
  v_fma_f32 v86, v86, v10, v11
  v_fma_f32 v87, v87, v10, v11
  s_waitcnt lgkmcnt(4)
  v_smfmac_f32_16x16x64_bf16 v[68:71], v[128:131], v[16:23], v7
  s_setprio 1
  ds_read_b64 v[16:17], v15 offset:624
  ds_read_b64 v[18:19], v15 offset:632
  ds_read_b64 v[20:21], v0 offset:624
  ds_read_b64 v[22:23], v0 offset:632
  s_setprio 3
  v_fma_f32 v88, v88, v8, v9
  v_fma_f32 v89, v89, v8, v9
  v_fma_f32 v90, v90, v10, v11
  v_fma_f32 v91, v91, v10, v11
  s_waitcnt lgkmcnt(6)
  v_mfma_f32_16x16x32_bf16 v[72:75], v[136:139], v[24:27], 0
  s_waitcnt lgkmcnt(4)
  v_mfma_f32_16x16x32_bf16 v[76:79], v[148:151], v[28:31], 0
  s_setprio 1
  ds_read_b64 v[24:25], v15 offset:936
  ds_read_b64 v[26:27], v15 offset:944
  ds_read_b64 v[28:29], v0 offset:936
  ds_read_b64 v[30:31], v0 offset:944
  ds_write2_b32 v3, v54, v55 offset0:172 offset1:250
  v_mul_f32 v92, v92, v8
  v_mul_f32 v93, v93, v8
  v_mul_f32 v94, v94, v10
  s_add_u32 s49, s18, 9984
  v_add_u32 v3, s49, v6
  s_mov_b32 exec_lo, 0xffffff
  s_mov_b32 exec_hi, 0
  ds_write2_b32 v3, v60, v61 offset0:0 offset1:78
  s_mov_b64 exec, -1
  v_mul_f32 v95, v95, v10
  v_add_f32 v92, v92, v9
  v_add_f32 v93, v93, v9
  s_mov_b32 exec_lo, 0xffffff
  s_mov_b32 exec_hi, 0
  ds_write2_b32 v3, v62, v63 offset0:156 offset1:234
  s_mov_b64 exec, -1
  v_add_f32 v94, v94, v11
  v_add_f32 v95, v95, v11
  v_add_u32 v3, s18, v5
  ds_write2_b32 v3, v32, v33 offset0:0 offset1:78
  v_cvt_pk_bf16_f32 v40, v82, v83
  v_cvt_pk_bf16_f32 v41, v86, v87
  v_cvt_pk_bf16_f32 v42, v90, v91
  ds_write2_b32 v3, v34, v35 offset0:156 offset1:234
  v_cvt_pk_bf16_f32 v43, v94, v95
  ds_write_b128 v12, v[40:43] offset:3072
  v_cvt_pk_bf16_f32 v80, v80, v81
  v_cvt_pk_bf16_f32 v81, v84, v85
  ds_write2_b32 v3, v44, v45 offset0:16 offset1:94
  v_cvt_pk_bf16_f32 v82, v88, v89
  v_cvt_pk_bf16_f32 v83, v92, v93
  s_waitcnt lgkmcnt(14)
  ds_write_b128 v12, v[80:83] offset:2048
  s_waitcnt vmcnt(3)
  s_barrier
  s_add_u32 m0, s56, 12288
  s_add_u32 s59, s41, s55
  buffer_load_dwordx4 v13, s[24:27], s41 offen lds
  s_setprio 3
  s_waitcnt lgkmcnt(12)
  v_smfmac_f32_16x16x64_bf16 v[72:75], v[140:143], v[16:23], v7
  s_setprio 1
  ds_read_b64 v[16:17], v14 offset:1248
  ds_read_b64 v[18:19], v14 offset:1256
  ds_read_b64 v[20:21], v14 offset:1560
  s_waitcnt lgkmcnt(14)
  ds_read_b64 v[22:23], v14 offset:1568
  s_setprio 3
  s_waitcnt lgkmcnt(12)
  v_smfmac_f32_16x16x64_bf16 v[76:79], v[152:155], v[24:31], v7
  s_setprio 1
  s_add_u32 m0, s56, 13312
  s_cmp_ge_u32 s59, s42
  s_cselect_b32 s59, 0, s59
  buffer_load_dwordx4 v13, s[28:31], s41 offen lds
  ds_read_b64 v[24:25], v15 offset:1248
  ds_read_b64 v[26:27], v15 offset:1256
  ds_read_b64 v[28:29], v0 offset:1248
  s_waitcnt lgkmcnt(14)
  ds_read_b64 v[30:31], v0 offset:1256
  s_setprio 3
  v_fma_f32 v96, v96, v8, v9
  v_fma_f32 v97, v97, v8, v9
  v_fma_f32 v98, v98, v10, v11
  v_fma_f32 v99, v99, v10, v11
  s_waitcnt lgkmcnt(6)
  v_mfma_f32_16x16x32_bf16 v[80:83], v[160:163], v[16:19], 0
  s_add_u32 m0, s56, 14336
  s_nop 0
  buffer_load_dwordx4 v13, s[32:35], s41 offen lds
  s_mov_b32 s41, s59
  s_waitcnt lgkmcnt(4)
  v_mfma_f32_16x16x32_bf16 v[84:87], v[172:175], v[20:23], 0
  s_setprio 1
  ds_read_b64 v[16:17], v15 offset:1560
  ds_read_b64 v[18:19], v15 offset:1568
  ds_read_b64 v[20:21], v0 offset:1560
  ds_read_b64 v[22:23], v0 offset:1568
  s_setprio 3
  v_fma_f32 v100, v100, v8, v9
  v_fma_f32 v101, v101, v8, v9
  v_fma_f32 v102, v102, v10, v11
  v_fma_f32 v103, v103, v10, v11
  s_waitcnt lgkmcnt(4)
  v_smfmac_f32_16x16x64_bf16 v[80:83], v[164:167], v[24:31], v7
  v_fma_f32 v104, v104, v8, v9
  v_fma_f32 v105, v105, v8, v9
  v_fma_f32 v106, v106, v10, v11
  v_fma_f32 v107, v107, v10, v11
  s_waitcnt lgkmcnt(0)
  v_smfmac_f32_16x16x64_bf16 v[84:87], v[176:179], v[16:23], v7
  s_setprio 1
  ds_write2_b32 v3, v46, v47 offset0:172 offset1:250
  v_mul_f32 v108, v108, v8
  v_mul_f32 v109, v109, v8
  v_add_u32 v3, s18, v6
  s_mov_b32 exec_lo, 0xffffff
  s_mov_b32 exec_hi, 0xffffff
  ds_write2_b32 v3, v56, v57 offset0:0 offset1:78
  s_mov_b64 exec, -1
  v_mul_f32 v110, v110, v10
  v_mul_f32 v111, v111, v10
  v_add_f32 v108, v108, v9
  s_mov_b32 exec_lo, 0xffffff
  s_mov_b32 exec_hi, 0xffffff
  ds_write2_b32 v3, v58, v59 offset0:156 offset1:234
  s_mov_b64 exec, -1
  v_add_f32 v109, v109, v9
  v_add_f32 v110, v110, v11
  s_add_u32 s49, s18, 4992
  v_add_u32 v3, s49, v5
  ds_write2_b32 v3, v36, v37 offset0:0 offset1:78
  v_add_f32 v111, v111, v11
  v_cvt_pk_bf16_f32 v40, v98, v99
  ds_write2_b32 v3, v38, v39 offset0:156 offset1:234
  v_cvt_pk_bf16_f32 v41, v102, v103
  v_cvt_pk_bf16_f32 v42, v106, v107
  v_cvt_pk_bf16_f32 v43, v110, v111
  ds_write_b128 v12, v[40:43] offset:5120
  ds_write2_b32 v3, v48, v49 offset0:16 offset1:94
  v_cvt_pk_bf16_f32 v96, v96, v97
  v_cvt_pk_bf16_f32 v97, v100, v101
  ds_write2_b32 v3, v50, v51 offset0:172 offset1:250
  v_cvt_pk_bf16_f32 v98, v104, v105
  v_cvt_pk_bf16_f32 v99, v108, v109
  ds_write_b128 v12, v[96:99] offset:4096
  s_waitcnt vmcnt(3)
  s_waitcnt lgkmcnt(0)
  s_barrier
  s_branch L_ploop
L_plast:
  ds_read_b128 v[16:19], v14 offset:4096
  ds_read_b128 v[20:23], v14 offset:10240
  ds_read_b128 v[24:27], v14 offset:16384
  ds_read_b128 v[28:31], v14 offset:22528
  s_add_u32 m0, s56, 24576
  s_add_u32 s59, s41, s55
  buffer_load_dwordx4 v13, s[24:27], s41 offen lds
  s_mov_b32 s20, s8
  s_mov_b32 s21, s9
  s_mov_b32 s22, 73728
  v_mbcnt_lo_u32_b32 v15, -1, 0
  v_mbcnt_hi_u32_b32 v15, -1, v15
  v_lshlrev_b32 v15, 4, v15
  s_lshl_b32 s18, s15, 10
  s_add_u32 s19, s18, 0
  s_add_u32 m0, s56, 25600
  s_cmp_ge_u32 s59, s42
  s_cselect_b32 s59, 0, s59
  buffer_load_dwordx4 v13, s[28:31], s41 offen lds
  s_add_u32 m0, s56, 26624
  s_nop 0
  buffer_load_dwordx4 v13, s[32:35], s41 offen lds
  s_mov_b32 s41, s59
  buffer_load_dwordx4 v[112:115], v15, s[20:23], s19 offen
  s_waitcnt lgkmcnt(2)
  v_add_f32 v16, v16, v20
  v_add_f32 v17, v17, v21
  s_add_u32 s19, s18, 4096
  buffer_load_dwordx4 v[116:119], v15, s[20:23], s19 offen
  v_add_f32 v18, v18, v22
  v_add_f32 v19, v19, v23
  s_add_u32 s19, s18, 8192
  buffer_load_dwordx4 v[120:123], v15, s[20:23], s19 offen
  s_waitcnt lgkmcnt(0)
  v_add_f32 v24, v24, v28
  v_add_f32 v25, v25, v29
  s_add_u32 s19, s18, 12288
  buffer_load_dwordx4 v[124:127], v15, s[20:23], s19 offen
  v_add_f32 v26, v26, v30
  v_add_f32 v27, v27, v31
  s_add_u32 s19, s18, 16384
  buffer_load_dwordx4 v[128:131], v15, s[20:23], s19 offen
  v_add_f32 v16, v16, v24
  v_add_f32 v17, v17, v25
  v_add_f32 v18, v18, v26
  s_add_u32 s19, s18, 20480
  buffer_load_dwordx4 v[132:135], v15, s[20:23], s19 offen
  v_add_f32 v19, v19, v27
  s_setprio 3
  v_mul_f32 v9, s58, v16
  v_mul_f32 v11, s58, v18
  v_mul_f32 v17, s58, v17
  v_mul_f32 v19, s58, v19
  v_mul_f32 v16, v9, v9
  v_mul_f32 v18, v11, v11
  v_sub_f32 v17, v17, v16
  v_sub_f32 v19, v19, v18
  v_cmp_u_f32 vcc, v17, v19
  v_max_f32 v17, 0, v17
  v_max_f32 v19, 0, v19
  s_or_b64 s[70:71], s[70:71], vcc
  v_add_f32 v17, 0x3727c5ac, v17
  v_add_f32 v19, 0x3727c5ac, v19
  v_rsq_f32 v17, v17
  v_rsq_f32 v19, v19
  v_mul_f32 v8, s38, v17
  v_mul_f32 v10, s38, v19
  v_mul_f32 v20, v9, v17
  v_mul_f32 v21, v11, v19
  v_min_f32 v16, v17, v19
  v_max_f32 v20, |v20|, |v21|
  v_cmp_lt_f32 vcc, 0x42800000, v20
  s_or_b64 s[70:71], s[70:71], vcc
  v_cmp_gt_f32 vcc, 0x3b800000, v16
  s_or_b64 s[70:71], s[70:71], vcc
  v_mul_f32 v9, -v9, v8
  v_mul_f32 v11, -v11, v10
  s_setprio 1
  s_mov_b32 s49, s38
  s_mov_b32 s38, s39
  s_mov_b32 s39, s49
  s_setprio 3
  v_fma_f32 v64, v64, v8, v9
  v_fma_f32 v65, v65, v8, v9
  v_fma_f32 v66, v66, v10, v11
  v_fma_f32 v67, v67, v10, v11
  v_fma_f32 v68, v68, v8, v9
  v_fma_f32 v69, v69, v8, v9
  v_fma_f32 v70, v70, v10, v11
  v_fma_f32 v71, v71, v10, v11
  v_fma_f32 v72, v72, v8, v9
  v_fma_f32 v73, v73, v8, v9
  v_fma_f32 v74, v74, v10, v11
  v_fma_f32 v75, v75, v10, v11
  v_fma_f32 v76, v76, v8, v9
  v_fma_f32 v77, v77, v8, v9
  v_fma_f32 v78, v78, v10, v11
  v_fma_f32 v79, v79, v10, v11
  s_setprio 1
  v_cvt_pk_bf16_f32 v40, v66, v67
  s_add_u32 s19, s18, 24576
  buffer_load_dwordx4 v[136:139], v15, s[20:23], s19 offen
  v_cvt_pk_bf16_f32 v41, v70, v71
  v_cvt_pk_bf16_f32 v42, v74, v75
  s_add_u32 s19, s18, 28672
  buffer_load_dwordx4 v[140:143], v15, s[20:23], s19 offen
  v_cvt_pk_bf16_f32 v43, v78, v79
  ds_write_b128 v12, v[40:43] offset:1024
  v_cvt_pk_bf16_f32 v64, v64, v65
  s_add_u32 s19, s18, 32768
  buffer_load_dwordx4 v[144:147], v15, s[20:23], s19 offen
  v_cvt_pk_bf16_f32 v65, v68, v69
  v_cvt_pk_bf16_f32 v66, v72, v73
  v_cvt_pk_bf16_f32 v67, v76, v77
  ds_write_b128 v12, v[64:67] offset:0
  s_waitcnt vmcnt(12)
  s_barrier
  s_add_u32 m0, s56, 0
  s_add_u32 s59, s41, s55
  buffer_load_dwordx4 v13, s[24:27], s41 offen lds
  s_setprio 3
  v_fma_f32 v80, v80, v8, v9
  v_fma_f32 v81, v81, v8, v9
  v_fma_f32 v82, v82, v10, v11
  v_fma_f32 v83, v83, v10, v11
  v_fma_f32 v84, v84, v8, v9
  v_fma_f32 v85, v85, v8, v9
  v_fma_f32 v86, v86, v10, v11
  v_fma_f32 v87, v87, v10, v11
  v_fma_f32 v88, v88, v8, v9
  s_add_u32 m0, s56, 1024
  s_cmp_ge_u32 s59, s42
  s_cselect_b32 s59, 0, s59
  buffer_load_dwordx4 v13, s[28:31], s41 offen lds
  v_fma_f32 v89, v89, v8, v9
  v_fma_f32 v90, v90, v10, v11
  v_fma_f32 v91, v91, v10, v11
  s_setprio 1
  s_add_u32 s19, s18, 36864
  s_add_u32 m0, s56, 2048
  s_nop 0
  buffer_load_dwordx4 v13, s[32:35], s41 offen lds
  s_mov_b32 s41, s59
  buffer_load_dwordx4 v[148:151], v15, s[20:23], s19 offen
  v_mul_f32 v92, v92, v8
  s_add_u32 s19, s18, 40960
  buffer_load_dwordx4 v[152:155], v15, s[20:23], s19 offen
  v_mul_f32 v93, v93, v8
  v_mul_f32 v94, v94, v10
  s_add_u32 s19, s18, 45056
  buffer_load_dwordx4 v[156:159], v15, s[20:23], s19 offen
  v_mul_f32 v95, v95, v10
  v_add_f32 v92, v92, v9
  s_add_u32 s19, s18, 49152
  buffer_load_dwordx4 v[160:163], v15, s[20:23], s19 offen
  v_add_f32 v93, v93, v9
  v_add_f32 v94, v94, v11
  s_add_u32 s19, s18, 53248
  buffer_load_dwordx4 v[164:167], v15, s[20:23], s19 offen
  v_add_f32 v95, v95, v11
  s_add_u32 s19, s18, 57344
  buffer_load_dwordx4 v[168:171], v15, s[20:23], s19 offen
  v_cvt_pk_bf16_f32 v40, v82, v83
  v_cvt_pk_bf16_f32 v41, v86, v87
  s_add_u32 s19, s18, 61440
  buffer_load_dwordx4 v[172:175], v15, s[20:23], s19 offen
  v_cvt_pk_bf16_f32 v42, v90, v91
  v_cvt_pk_bf16_f32 v43, v94, v95
  ds_write_b128 v12, v[40:43] offset:3072
  s_add_u32 s19, s18, 65536
  buffer_load_dwordx4 v[176:179], v15, s[20:23], s19 offen
  v_cvt_pk_bf16_f32 v80, v80, v81
  v_cvt_pk_bf16_f32 v81, v84, v85
  s_add_u32 s19, s18, 69632
  buffer_load_dwordx4 v[180:183], v15, s[20:23], s19 offen
  v_cvt_pk_bf16_f32 v82, v88, v89
  v_cvt_pk_bf16_f32 v83, v92, v93
  ds_write_b128 v12, v[80:83] offset:2048
  s_waitcnt vmcnt(21)
  s_barrier
  s_add_u32 m0, s56, 12288
  s_add_u32 s59, s41, s55
  buffer_load_dwordx4 v13, s[24:27], s41 offen lds
  s_setprio 3
  v_fma_f32 v96, v96, v8, v9
  v_fma_f32 v97, v97, v8, v9
  v_fma_f32 v98, v98, v10, v11
  v_fma_f32 v99, v99, v10, v11
  v_fma_f32 v100, v100, v8, v9
  v_fma_f32 v101, v101, v8, v9
  v_fma_f32 v102, v102, v10, v11
  v_fma_f32 v103, v103, v10, v11
  v_fma_f32 v104, v104, v8, v9
  s_add_u32 m0, s56, 13312
  s_cmp_ge_u32 s59, s42
  s_cselect_b32 s59, 0, s59
  buffer_load_dwordx4 v13, s[28:31], s41 offen lds
  v_fma_f32 v105, v105, v8, v9
  v_fma_f32 v106, v106, v10, v11
  v_fma_f32 v107, v107, v10, v11
  s_setprio 1
  v_mul_f32 v108, v108, v8
  v_mul_f32 v109, v109, v8
  v_mul_f32 v110, v110, v10
  v_mul_f32 v111, v111, v10
  v_add_f32 v108, v108, v9
  v_add_f32 v109, v109, v9
  s_add_u32 m0, s56, 14336
  s_nop 0
  buffer_load_dwordx4 v13, s[32:35], s41 offen lds
  s_mov_b32 s41, s59
  v_add_f32 v110, v110, v11
  v_add_f32 v111, v111, v11
  v_cvt_pk_bf16_f32 v40, v98, v99
  v_cvt_pk_bf16_f32 v41, v102, v103
  v_cvt_pk_bf16_f32 v42, v106, v107
  v_cvt_pk_bf16_f32 v43, v110, v111
  ds_write_b128 v12, v[40:43] offset:5120
  v_cvt_pk_bf16_f32 v96, v96, v97
  v_cvt_pk_bf16_f32 v97, v100, v101
  v_cvt_pk_bf16_f32 v98, v104, v105
  v_cvt_pk_bf16_f32 v99, v108, v109
  ds_write_b128 v12, v[96:99] offset:4096
  s_waitcnt vmcnt(3)
  s_waitcnt lgkmcnt(0)
  s_barrier
  s_add_u32 m0, s56, 24576
  s_add_u32 s59, s41, s55
  buffer_load_dwordx4 v13, s[24:27], s41 offen lds
  v_and_b32 v64, 0x7fff7fff, v112
  v_and_b32 v65, 0x7fff7fff, v113
  v_and_b32 v114, 0x7fff7fff, v114
  v_pk_max_u16 v64, v64, v114
  v_and_b32 v115, 0x7fff7fff, v115
  v_pk_max_u16 v65, v65, v115
  v_and_b32 v116, 0x7fff7fff, v116
  v_pk_max_u16 v64, v64, v116
  v_and_b32 v117, 0x7fff7fff, v117
  v_pk_max_u16 v65, v65, v117
  s_add_u32 m0, s56, 25600
  s_cmp_ge_u32 s59, s42
  s_cselect_b32 s59, 0, s59
  buffer_load_dwordx4 v13, s[28:31], s41 offen lds
  v_and_b32 v118, 0x7fff7fff, v118
  v_pk_max_u16 v64, v64, v118
  v_and_b32 v119, 0x7fff7fff, v119
  v_pk_max_u16 v65, v65, v119
  v_and_b32 v120, 0x7fff7fff, v120
  v_pk_max_u16 v64, v64, v120
  v_and_b32 v121, 0x7fff7fff, v121
  v_pk_max_u16 v65, v65, v121
  v_and_b32 v122, 0x7fff7fff, v122
  v_pk_max_u16 v64, v64, v122
  s_add_u32 m0, s56, 26624
  s_nop 0
  buffer_load_dwordx4 v13, s[32:35], s41 offen lds
  s_mov_b32 s41, s59
  v_and_b32 v123, 0x7fff7fff, v123
  v_pk_max_u16 v65, v65, v123
  v_and_b32 v124, 0x7fff7fff, v124
  v_pk_max_u16 v64, v64, v124
  v_and_b32 v125, 0x7fff7fff, v125
  v_pk_max_u16 v65, v65, v125
  v_and_b32 v126, 0x7fff7fff, v126
  v_pk_max_u16 v64, v64, v126
  v_and_b32 v127, 0x7fff7fff, v127
  s_waitcnt vmcnt(3)
  s_barrier
  s_add_u32 m0, s56, 0
  s_add_u32 s59, s41, s55
  buffer_load_dwordx4 v13, s[24:27], s41 offen lds
  v_pk_max_u16 v65, v65, v127
  v_and_b32 v128, 0x7fff7fff, v128
  v_pk_max_u16 v64, v64, v128
  v_and_b32 v129, 0x7fff7fff, v129
  v_pk_max_u16 v65, v65, v129
  v_and_b32 v130, 0x7fff7fff, v130
  v_pk_max_u16 v64, v64, v130
  v_and_b32 v131, 0x7fff7fff, v131
  v_pk_max_u16 v65, v65, v131
  v_and_b32 v132, 0x7fff7fff, v132
  s_add_u32 m0, s56, 1024
  s_cmp_ge_u32 s59, s42
  s_cselect_b32 s59, 0, s59
  buffer_load_dwordx4 v13, s[28:31], s41 offen lds
  v_pk_max_u16 v64, v64, v132
  v_and_b32 v133, 0x7fff7fff, v133
  v_pk_max_u16 v65, v65, v133
  v_and_b32 v134, 0x7fff7fff, v134
  v_pk_max_u16 v64, v64, v134
  v_and_b32 v135, 0x7fff7fff, v135
  v_pk_max_u16 v65, v65, v135
  v_and_b32 v136, 0x7fff7fff, v136
  v_pk_max_u16 v64, v64, v136
  v_and_b32 v137, 0x7fff7fff, v137
  s_add_u32 m0, s56, 2048
  s_nop 0
  buffer_load_dwordx4 v13, s[32:35], s41 offen lds
  s_mov_b32 s41, s59
  v_pk_max_u16 v65, v65, v137
  v_and_b32 v138, 0x7fff7fff, v138
  v_pk_max_u16 v64, v64, v138
  v_and_b32 v139, 0x7fff7fff, v139
  v_pk_max_u16 v65, v65, v139
  v_and_b32 v140, 0x7fff7fff, v140
  v_pk_max_u16 v64, v64, v140
  v_and_b32 v141, 0x7fff7fff, v141
  v_pk_max_u16 v65, v65, v141
  s_waitcnt vmcnt(3)
  s_barrier
  s_add_u32 m0, s56, 12288
  s_add_u32 s59, s41, s55
  buffer_load_dwordx4 v13, s[24:27], s41 offen lds
  v_and_b32 v142, 0x7fff7fff, v142
  v_pk_max_u16 v64, v64, v142
  v_and_b32 v143, 0x7fff7fff, v143
  v_pk_max_u16 v65, v65, v143
  v_and_b32 v144, 0x7fff7fff, v144
  v_pk_max_u16 v64, v64, v144
  v_and_b32 v145, 0x7fff7fff, v145
  v_pk_max_u16 v65, v65, v145
  v_and_b32 v146, 0x7fff7fff, v146
  v_pk_max_u16 v64, v64, v146
  s_add_u32 m0, s56, 13312
  s_cmp_ge_u32 s59, s42
  s_cselect_b32 s59, 0, s59
  buffer_load_dwordx4 v13, s[28:31], s41 offen lds
  v_and_b32 v147, 0x7fff7fff, v147
  v_pk_max_u16 v65, v65, v147
  v_and_b32 v148, 0x7fff7fff, v148
  v_pk_max_u16 v64, v64, v148
  v_and_b32 v149, 0x7fff7fff, v149
  v_pk_max_u16 v65, v65, v149
  v_and_b32 v150, 0x7fff7fff, v150
  v_pk_max_u16 v64, v64, v150
  v_and_b32 v151, 0x7fff7fff, v151
  v_pk_max_u16 v65, v65, v151
  s_add_u32 m0, s56, 14336
  s_nop 0
  buffer_load_dwordx4 v13, s[32:35], s41 offen lds
  s_mov_b32 s41, s59
  v_and_b32 v152, 0x7fff7fff, v152
  v_pk_max_u16 v64, v64, v152
  v_and_b32 v153, 0x7fff7fff, v153
  v_pk_max_u16 v65, v65, v153
  v_and_b32 v154, 0x7fff7fff, v154
  v_pk_max_u16 v64, v64, v154
  v_and_b32 v155, 0x7fff7fff, v155
  v_pk_max_u16 v65, v65, v155
  v_and_b32 v156, 0x7fff7fff, v156
  s_waitcnt vmcnt(3)
  s_barrier
  s_add_u32 m0, s56, 24576
  s_add_u32 s59, s41, s55
  buffer_load_dwordx4 v13, s[24:27], s41 offen lds
  s_add_u32 m0, s56, 25600
  s_cmp_ge_u32 s59, s42
  s_cselect_b32 s59, 0, s59
  buffer_load_dwordx4 v13, s[28:31], s41 offen lds
  s_add_u32 m0, s56, 26624
  s_nop 0
  buffer_load_dwordx4 v13, s[32:35], s41 offen lds
  s_mov_b32 s41, s59
  s_add_u32 m0, s56, 41984
  s_add_u32 s59, s41, s55
  buffer_load_dwordx4 v13, s[24:27], s41 offen lds
  s_add_u32 m0, s56, 43008
  s_cmp_ge_u32 s59, s42
  s_cselect_b32 s59, 0, s59
  buffer_load_dwordx4 v13, s[28:31], s41 offen lds
  s_add_u32 m0, s56, 44032
  s_nop 0
  buffer_load_dwordx4 v13, s[32:35], s41 offen lds
  s_mov_b32 s41, s59
  s_add_u32 m0, s56, 54272
  s_add_u32 s59, s41, s55
  buffer_load_dwordx4 v13, s[24:27], s41 offen lds
  v_pk_max_u16 v64, v64, v156
  v_and_b32 v157, 0x7fff7fff, v157
  v_pk_max_u16 v65, v65, v157
  v_and_b32 v158, 0x7fff7fff, v158
  v_pk_max_u16 v64, v64, v158
  v_and_b32 v159, 0x7fff7fff, v159
  v_pk_max_u16 v65, v65, v159
  v_and_b32 v160, 0x7fff7fff, v160
  v_pk_max_u16 v64, v64, v160
  v_and_b32 v161, 0x7fff7fff, v161
  s_add_u32 m0, s56, 55296
  s_cmp_ge_u32 s59, s42
  s_cselect_b32 s59, 0, s59
  buffer_load_dwordx4 v13, s[28:31], s41 offen lds
  v_pk_max_u16 v65, v65, v161
  v_and_b32 v162, 0x7fff7fff, v162
  v_pk_max_u16 v64, v64, v162
  v_and_b32 v163, 0x7fff7fff, v163
  v_pk_max_u16 v65, v65, v163
  v_and_b32 v164, 0x7fff7fff, v164
  v_pk_max_u16 v64, v64, v164
  v_and_b32 v165, 0x7fff7fff, v165
  v_pk_max_u16 v65, v65, v165
  v_and_b32 v166, 0x7fff7fff, v166
  s_add_u32 m0, s56, 56320
  s_nop 0
  buffer_load_dwordx4 v13, s[32:35], s41 offen lds
  s_mov_b32 s41, s59
  v_pk_max_u16 v64, v64, v166
  v_and_b32 v167, 0x7fff7fff, v167
  v_pk_max_u16 v65, v65, v167
  v_and_b32 v168, 0x7fff7fff, v168
  v_pk_max_u16 v64, v64, v168
  v_and_b32 v169, 0x7fff7fff, v169
  v_pk_max_u16 v65, v65, v169
  v_and_b32 v170, 0x7fff7fff, v170
  v_pk_max_u16 v64, v64, v170
  s_waitcnt vmcnt(9)
  s_barrier
  s_add_u32 m0, s56, 66560
  s_add_u32 s59, s41, s55
  buffer_load_dwordx4 v13, s[24:27], s41 offen lds
  s_add_u32 m0, s56, 67584
  s_cmp_ge_u32 s59, s42
  s_cselect_b32 s59, 0, s59
  buffer_load_dwordx4 v13, s[28:31], s41 offen lds
  s_add_u32 m0, s56, 68608
  s_nop 0
  buffer_load_dwordx4 v13, s[32:35], s41 offen lds
  s_mov_b32 s41, s59
  s_add_u32 m0, s56, 78848
  s_add_u32 s59, s41, s55
  buffer_load_dwordx4 v13, s[24:27], s41 offen lds
  s_add_u32 m0, s56, 79872
  s_cmp_ge_u32 s59, s42
  s_cselect_b32 s59, 0, s59
  buffer_load_dwordx4 v13, s[28:31], s41 offen lds
  s_add_u32 m0, s56, 80896
  s_nop 0
  buffer_load_dwordx4 v13, s[32:35], s41 offen lds
  s_mov_b32 s41, s59
  s_add_u32 m0, s56, 107520
  s_add_u32 s59, s41, s55
  buffer_load_dwordx4 v13, s[24:27], s41 offen lds
  v_and_b32 v171, 0x7fff7fff, v171
  v_pk_max_u16 v65, v65, v171
  v_and_b32 v172, 0x7fff7fff, v172
  v_pk_max_u16 v64, v64, v172
  v_and_b32 v173, 0x7fff7fff, v173
  v_pk_max_u16 v65, v65, v173
  v_and_b32 v174, 0x7fff7fff, v174
  v_pk_max_u16 v64, v64, v174
  v_and_b32 v175, 0x7fff7fff, v175
  v_pk_max_u16 v65, v65, v175
  s_add_u32 m0, s56, 108544
  s_cmp_ge_u32 s59, s42
  s_cselect_b32 s59, 0, s59
  buffer_load_dwordx4 v13, s[28:31], s41 offen lds
  v_and_b32 v176, 0x7fff7fff, v176
  v_pk_max_u16 v64, v64, v176
  v_and_b32 v177, 0x7fff7fff, v177
  v_pk_max_u16 v65, v65, v177
  v_and_b32 v178, 0x7fff7fff, v178
  v_pk_max_u16 v64, v64, v178
  v_and_b32 v179, 0x7fff7fff, v179
  v_pk_max_u16 v65, v65, v179
  v_and_b32 v180, 0x7fff7fff, v180
  v_pk_max_u16 v64, v64, v180
  s_add_u32 m0, s56, 109568
  s_nop 0
  buffer_load_dwordx4 v13, s[32:35], s41 offen lds
  s_mov_b32 s41, s59
  v_and_b32 v181, 0x7fff7fff, v181
  v_pk_max_u16 v65, v65, v181
  v_and_b32 v182, 0x7fff7fff, v182
  v_pk_max_u16 v64, v64, v182
  v_and_b32 v183, 0x7fff7fff, v183
  v_pk_max_u16 v65, v65, v183
  s_waitcnt vmcnt(15)
  s_barrier
  s_add_u32 m0, s56, 119808
  s_add_u32 s59, s41, s55
  buffer_load_dwordx4 v13, s[24:27], s41 offen lds
  s_add_u32 m0, s56, 120832
  s_cmp_ge_u32 s59, s42
  s_cselect_b32 s59, 0, s59
  buffer_load_dwordx4 v13, s[28:31], s41 offen lds
  s_add_u32 m0, s56, 121856
  s_nop 0
  buffer_load_dwordx4 v13, s[32:35], s41 offen lds
  s_mov_b32 s41, s59
  s_add_u32 m0, s56, 132096
  s_add_u32 s59, s41, s55
  buffer_load_dwordx4 v13, s[24:27], s41 offen lds
  s_add_u32 m0, s56, 133120
  s_cmp_ge_u32 s59, s42
  s_cselect_b32 s59, 0, s59
  buffer_load_dwordx4 v13, s[28:31], s41 offen lds
  s_add_u32 m0, s56, 134144
  s_nop 0
  buffer_load_dwordx4 v13, s[32:35], s41 offen lds
  s_mov_b32 s41, s59
  s_add_u32 m0, s56, 144384
  s_add_u32 s59, s41, s55
  buffer_load_dwordx4 v13, s[24:27], s41 offen lds
  v_pk_max_u16 v64, v64, v65
  v_lshrrev_b32 v65, 16, v64
  v_and_b32 v64, 0xffff, v64
  v_max_u32 v64, v64, v65
  s_nop 1
  v_max_u32_dpp v64, v64, v64 row_shr:1
  s_nop 1
  v_max_u32_dpp v64, v64, v64 row_shr:2
  s_nop 1
  v_max_u32_dpp v64, v64, v64 row_shr:4
  s_add_u32 m0, s56, 145408
  s_cmp_ge_u32 s59, s42
  s_cselect_b32 s59, 0, s59
  buffer_load_dwordx4 v13, s[28:31], s41 offen lds
  s_nop 1
  v_max_u32_dpp v64, v64, v64 row_shr:8
  s_nop 1
  v_max_u32_dpp v64, v64, v64 row_bcast:15 row_mask:0xa
  s_nop 1
  v_max_u32_dpp v64, v64, v64 row_bcast:31 row_mask:0xc
  s_nop 1
  v_readlane_b32 s51, v64, 63
  s_lshl_b32 s50, s15, 2
  s_add_u32 s50, s50, 101888
  s_add_u32 m0, s56, 146432
  s_nop 0
  buffer_load_dwordx4 v13, s[32:35], s41 offen lds
  s_mov_b32 s41, s59
  s_nop 1
  s_cmp_lg_u64 s[70:71], 0
  s_cselect_b32 s51, 0x7fff, s51
  v_mov_b32 v64, s51
  v_mov_b32 v65, s50
  ds_write_b32 v65, v64
  s_waitcnt vmcnt(21)
  s_waitcnt lgkmcnt(0)
  s_barrier
  v_mov_b32 v68, 101888
  ds_read_b128 v[64:67], v68
  s_waitcnt lgkmcnt(0)
  v_max_u32 v64, v64, v65
  v_max3_u32 v64, v64, v66, v67
  s_nop 1
  v_readfirstlane_b32 s51, v64
  s_nop 3
  s_lshr_b32 s51, s51, 7
  s_add_u32 s51, s51, 8
  s_max_u32 s51, s51, 20
  s_sub_u32 s51, s51, 20
  s_cmp_gt_u32 s51, 117
  s_cselect_b32 s51, 127, s51
  s_sub_u32 s50, 113, s51
  s_cmp_le_u32 s50, 7
  s_cselect_b32 s51, 113, s51
  s_lshl_b32 s51, s51, 23
  s_waitcnt vmcnt(0)
  s_barrier
  s_cmp_eq_u32 s51, s65
  s_cbranch_scc1 L_exit
L_redo:
  s_mov_b32 s65, s51
  s_setprio 0
  v_mbcnt_lo_u32_b32 v0, -1, 0
  v_mbcnt_hi_u32_b32 v0, -1, v0
  v_mov_b32 v253, 0x8000
  s_waitcnt vmcnt(0) lgkmcnt(0)
  s_barrier
  s_branch L_again
L_exit:
  s_endpgm
L_main:
  s_barrier
  ds_read_b64_tr_b16 v[16:17], v1 offset:6144
  ds_read_b64_tr_b16 v[18:19], v1 offset:6400
  ds_read_b64_tr_b16 v[20:21], v1 offset:7168
  ds_read_b64_tr_b16 v[22:23], v1 offset:7424
  ds_read_b64_tr_b16 v[24:25], v1 offset:8192
  ds_read_b64_tr_b16 v[26:27], v1 offset:8448
  ds_read_b64_tr_b16 v[28:29], v1 offset:9216
  ds_read_b64_tr_b16 v[30:31], v1 offset:9472
  ds_read_b128 v[112:115], v3 offset:0
  ds_read_b128 v[116:119], v3 offset:4096
  ds_read_b128 v[120:123], v3 offset:8192
  ds_read_b128 v[124:127], v3 offset:12288
  ds_read_b128 v[128:131], v3 offset:16384
  ds_read_b128 v[132:135], v3 offset:20480
  s_waitcnt lgkmcnt(5)
  v_mfma_f32_32x32x16_bf16 v[80:95], v[16:19], v[112:115], 0
  s_waitcnt lgkmcnt(4)
  ds_read_b64_tr_b16 v[32:33], v1 offset:10240
  ds_read_b64_tr_b16 v[34:35], v1 offset:10496
  v_add_u32 v6, s43, v4
  v_mfma_f32_32x32x16_bf16 v[80:95], v[20:23], v[116:119], v[80:95]
  s_waitcnt lgkmcnt(5)
  ds_read_b64_tr_b16 v[36:37], v1 offset:11264
  ds_read_b64_tr_b16 v[38:39], v1 offset:11520
  s_mov_b32 s49, s43
  s_mov_b32 s43, s44
  s_mov_b32 s44, s45
  s_mov_b32 s45, s49
  v_mfma_f32_32x32x16_bf16 v[80:95], v[24:27], v[120:123], v[80:95]
  s_waitcnt lgkmcnt(0)
  s_barrier
  ds_read_b64_tr_b16 v[16:17], v1 offset:18432
  ds_read_b64_tr_b16 v[18:19], v1 offset:18688
  v_mfma_f32_32x32x16_bf16 v[80:95], v[28:31], v[124:127], v[80:95]
  ds_read_b64_tr_b16 v[20:21], v1 offset:19456
  ds_read_b64_tr_b16 v[22:23], v1 offset:19712
  v_mfma_f32_32x32x16_bf16 v[80:95], v[32:35], v[128:131], v[80:95]
  ds_read_b64_tr_b16 v[24:25], v1 offset:20480
  ds_read_b64_tr_b16 v[26:27], v1 offset:20736
  v_mfma_f32_32x32x16_bf16 v[80:95], v[36:39], v[132:135], v[80:95]
  s_waitcnt lgkmcnt(4)
  ds_read_b64_tr_b16 v[28:29], v1 offset:21504
  ds_read_b64_tr_b16 v[30:31], v1 offset:21760
  v_mfma_f32_32x32x16_bf16 v[48:63], v[16:19], v[112:115], 0
  s_waitcnt lgkmcnt(4)
  ds_read_b64_tr_b16 v[32:33], v1 offset:22528
  ds_read_b64_tr_b16 v[34:35], v1 offset:22784
  s_nop 4
  v_cvt_pk_bf16_f32 v80, v80, v81
  v_lshlrev_b32_sdwa v81, 1, v80 dst_sel:DWORD dst_unused:UNUSED_PAD src0_sel:DWORD src1_sel:WORD_1
  v_lshlrev_b32_sdwa v80, 1, v80 dst_sel:DWORD dst_unused:UNUSED_PAD src0_sel:DWORD src1_sel:WORD_0
  v_mul_f32 v92, s37, v92
  v_mul_f32 v94, s37, v94
  v_mul_f32 v93, s37, v93
  v_cvt_pk_bf16_f32 v82, v82, v83
  v_lshlrev_b32_sdwa v83, 1, v82 dst_sel:DWORD dst_unused:UNUSED_PAD src0_sel:DWORD src1_sel:WORD_1
  v_lshlrev_b32_sdwa v82, 1, v82 dst_sel:DWORD dst_unused:UNUSED_PAD src0_sel:DWORD src1_sel:WORD_0
  v_mul_f32 v95, s37, v95
  v_cvt_pk_f16_f32 v8, v92, v93
  v_cvt_pk_f16_f32 v10, v94, v95
  v_mfma_f32_32x32x16_bf16 v[48:63], v[20:23], v[116:119], v[48:63]
  s_waitcnt lgkmcnt(4)
  ds_read_b64_tr_b16 v[36:37], v1 offset:23552
  ds_read_b64_tr_b16 v[38:39], v1 offset:23808
  ds_read_u16_d16_hi v81, v81 offset:36864
  ds_read_u16_d16 v80, v80 offset:36864
  ds_read_u16_d16_hi v83, v83 offset:36864
  v_cvt_pk_bf16_f32 v84, v84, v85
  v_lshlrev_b32_sdwa v85, 1, v84 dst_sel:DWORD dst_unused:UNUSED_PAD src0_sel:DWORD src1_sel:WORD_1
  v_lshlrev_b32_sdwa v84, 1, v84 dst_sel:DWORD dst_unused:UNUSED_PAD src0_sel:DWORD src1_sel:WORD_0
  v_pk_fma_f16 v9, v8, v8, s56
  v_pk_fma_f16 v11, v10, v10, s56
  v_pk_mul_f16 v9, v8, v9 neg_lo:[0,1] neg_hi:[0,1]
  v_cvt_pk_bf16_f32 v86, v86, v87
  v_pk_mul_f16 v11, v10, v11 neg_lo:[0,1] neg_hi:[0,1]
  v_mfma_f32_32x32x16_bf16 v[48:63], v[24:27], v[120:123], v[48:63]
  s_waitcnt lgkmcnt(3)
  s_barrier
  ds_read_b64_tr_b16 v[16:17], v7 offset:24576
  ds_read_b64_tr_b16 v[18:19], v7 offset:26112
  ds_read_u16_d16 v82, v82 offset:36864
  ds_read_u16_d16_hi v85, v85 offset:36864
  ds_read_u16_d16 v84, v84 offset:36864
  v_lshlrev_b32_sdwa v87, 1, v86 dst_sel:DWORD dst_unused:UNUSED_PAD src0_sel:DWORD src1_sel:WORD_1
  v_lshlrev_b32_sdwa v86, 1, v86 dst_sel:DWORD dst_unused:UNUSED_PAD src0_sel:DWORD src1_sel:WORD_0
  v_exp_f16 v8, v9
  v_cvt_pk_bf16_f32 v88, v88, v89
  v_exp_f16 v10, v11
  v_lshlrev_b32_sdwa v89, 1, v88 dst_sel:DWORD dst_unused:UNUSED_PAD src0_sel:DWORD src1_sel:WORD_1
  v_mfma_f32_32x32x16_bf16 v[48:63], v[28:31], v[124:127], v[48:63]
  s_waitcnt lgkmcnt(6)
  ds_read_b64_tr_b16 v[20:21], v7 offset:24640
  ds_read_b64_tr_b16 v[22:23], v7 offset:26176
  ds_read_u16_d16_hi v87, v87 offset:36864
  ds_read_u16_d16 v86, v86 offset:36864
  ds_read_u16_d16_hi v89, v89 offset:36864
  v_lshlrev_b32_sdwa v88, 1, v88 dst_sel:DWORD dst_unused:UNUSED_PAD src0_sel:DWORD src1_sel:WORD_0
  v_exp_f16_sdwa v8, v9 dst_sel:WORD_1 dst_unused:UNUSED_PRESERVE src0_sel:WORD_1
  v_cvt_pk_bf16_f32 v90, v90, v91
  v_or_b32 v80, v80, v81
  v_lshlrev_b32_sdwa v91, 1, v90 dst_sel:DWORD dst_unused:UNUSED_PAD src0_sel:DWORD src1_sel:WORD_1
  v_lshlrev_b32_sdwa v90, 1, v90 dst_sel:DWORD dst_unused:UNUSED_PAD src0_sel:DWORD src1_sel:WORD_0
  v_exp_f16_sdwa v10, v11 dst_sel:WORD_1 dst_unused:UNUSED_PRESERVE src0_sel:WORD_1
  v_mfma_f32_32x32x16_bf16 v[48:63], v[32:35], v[128:131], v[48:63]
  s_waitcnt lgkmcnt(5)
  ds_read_b64_tr_b16 v[24:25], v7 offset:27648
  ds_read_b64_tr_b16 v[26:27], v7 offset:29184
  ds_read_u16_d16 v88, v88 offset:36864
  ds_read_u16_d16_hi v91, v91 offset:36864
  ds_read_u16_d16 v90, v90 offset:36864
  v_pk_fma_f16 v8, v8, s57, s57
  v_or_b32 v81, v82, v83
  v_pk_fma_f16 v10, v10, s57, s57
  v_rcp_f16 v9, v8
  v_add_u32 v0, 0, v6
  v_or_b32 v82, v84, v85
  v_rcp_f16 v11, v10
  v_mfma_f32_32x32x16_bf16 v[48:63], v[36:39], v[132:135], v[48:63]
  s_waitcnt lgkmcnt(2)
  ds_read_b64_tr_b16 v[28:29], v7 offset:27712
  ds_read_b64_tr_b16 v[30:31], v7 offset:29248
  ds_read2_b32 v[40:41], v0 offset0:0 offset1:78
  ds_read2_b32 v[42:43], v0 offset0:156 offset1:234
  v_add_u32 v0, 2496, v6
  v_rcp_f16_sdwa v9, v8 dst_sel:WORD_1 dst_unused:UNUSED_PRESERVE src0_sel:WORD_1
  v_or_b32 v83, v86, v87
  v_rcp_f16_sdwa v11, v10 dst_sel:WORD_1 dst_unused:UNUSED_PRESERVE src0_sel:WORD_1
  v_or_b32 v88, v88, v89
  v_mfma_f32_32x32x16_bf16 v[160:175], v[16:19], v[80:83], 0
  ds_read_b64_tr_b16 v[32:33], v7 offset:24704
  ds_read_b64_tr_b16 v[34:35], v7 offset:26240
  ds_read2_b32 v[44:45], v0 offset0:0 offset1:78
  ds_read2_b32 v[46:47], v0 offset0:156 offset1:234
  v_fma_mix_f32 v92, v92, v9, 0 op_sel_hi:[0,1,0]
  v_fma_mix_f32 v94, v94, v11, 0 op_sel_hi:[0,1,0]
  v_fma_mix_f32 v93, v93, v9, 0 op_sel:[0,1,0] op_sel_hi:[0,1,0]
  v_fma_mix_f32 v95, v95, v11, 0 op_sel:[0,1,0] op_sel_hi:[0,1,0]
  s_waitcnt lgkmcnt(0)
  v_smfmac_f32_32x32x32_bf16 v[160:175], v[12:15], v[40:47], v5
  v_or_b32 v89, v90, v91
  v_add_u32 v0, 4992, v6
  v_cvt_pk_bf16_f32 v90, v92, v93
  ds_read2_b32 v[40:41], v0 offset0:0 offset1:78
  ds_read2_b32 v[42:43], v0 offset0:156 offset1:234
  v_add_u32 v0, 7488, v6
  v_mfma_f32_32x32x16_bf16 v[176:191], v[20:23], v[80:83], 0
  ds_read_b64_tr_b16 v[36:37], v7 offset:27776
  ds_read_b64_tr_b16 v[38:39], v7 offset:29312
  ds_read2_b32 v[44:45], v0 offset0:0 offset1:78
  ds_read2_b32 v[46:47], v0 offset0:156 offset1:234
  v_cvt_pk_bf16_f32 v91, v94, v95
  v_cvt_pk_bf16_f32 v48, v48, v49
  v_lshlrev_b32_sdwa v49, 1, v48 dst_sel:DWORD dst_unused:UNUSED_PAD src0_sel:DWORD src1_sel:WORD_1
  v_mfma_f32_32x32x16_bf16 v[160:175], v[24:27], v[88:91], v[160:175]
  ds_read_b64_tr_b16 v[16:17], v1 offset:30720
  ds_read_b64_tr_b16 v[18:19], v1 offset:30976
  ds_read_u16_d16_hi v49, v49 offset:36864
  v_lshlrev_b32_sdwa v48, 1, v48 dst_sel:DWORD dst_unused:UNUSED_PAD src0_sel:DWORD src1_sel:WORD_0
  v_mul_f32 v60, s37, v60
  v_mul_f32 v62, s37, v62
  v_mul_f32 v61, s37, v61
  v_cvt_pk_bf16_f32 v50, v50, v51
  v_mfma_f32_32x32x16_bf16 v[176:191], v[28:31], v[88:91], v[176:191]
  s_waitcnt lgkmcnt(3)
  ds_read_b64_tr_b16 v[20:21], v1 offset:31744
  ds_read_b64_tr_b16 v[22:23], v1 offset:32000
  ds_read_u16_d16 v48, v48 offset:36864
  v_lshlrev_b32_sdwa v51, 1, v50 dst_sel:DWORD dst_unused:UNUSED_PAD src0_sel:DWORD src1_sel:WORD_1
  v_lshlrev_b32_sdwa v50, 1, v50 dst_sel:DWORD dst_unused:UNUSED_PAD src0_sel:DWORD src1_sel:WORD_0
  v_mul_f32 v63, s37, v63
  v_cvt_pk_f16_f32 v8, v60, v61
  v_smfmac_f32_32x32x32_bf16 v[176:191], v[12:15], v[40:47], v5
  ds_read_u16_d16_hi v51, v51 offset:36864
  ds_read_u16_d16 v50, v50 offset:36864
  v_cvt_pk_f16_f32 v10, v62, v63
  v_cvt_pk_bf16_f32 v52, v52, v53
  v_add_u32 v0, 9984, v6
  v_lshlrev_b32_sdwa v53, 1, v52 dst_sel:DWORD dst_unused:UNUSED_PAD src0_sel:DWORD src1_sel:WORD_1
  v_mfma_f32_32x32x16_bf16 v[192:207], v[32:35], v[80:83], 0
  ds_read_b64_tr_b16 v[24:25], v1 offset:32768
  ds_read_b64_tr_b16 v[26:27], v1 offset:33024
  ds_read_u16_d16_hi v53, v53 offset:36864
  ds_read2_b32 v[40:41], v0 offset0:0 offset1:78
  ds_read2_b32 v[42:43], v0 offset0:156 offset1:234
  v_lshlrev_b32_sdwa v52, 1, v52 dst_sel:DWORD dst_unused:UNUSED_PAD src0_sel:DWORD src1_sel:WORD_0
  v_pk_fma_f16 v9, v8, v8, s56
  v_pk_fma_f16 v11, v10, v10, s56
  v_mfma_f32_32x32x16_bf16 v[192:207], v[36:39], v[88:91], v[192:207]
  s_waitcnt lgkmcnt(11)
  ds_read_b64_tr_b16 v[28:29], v1 offset:33792
  ds_read_b64_tr_b16 v[30:31], v1 offset:34048
  ds_read_u16_d16 v52, v52 offset:36864
  v_add_u32 v0, 12480, v6
  v_pk_mul_f16 v9, v8, v9 neg_lo:[0,1] neg_hi:[0,1]
  v_cvt_pk_bf16_f32 v54, v54, v55
  v_pk_mul_f16 v11, v10, v11 neg_lo:[0,1] neg_hi:[0,1]
  v_mfma_f32_32x32x16_bf16 v[80:95], v[16:19], v[112:115], 0
  s_waitcnt lgkmcnt(11)
  ds_read_b64_tr_b16 v[32:33], v1 offset:34816
  ds_read_b64_tr_b16 v[34:35], v1 offset:35072
  ds_read2_b32 v[44:45], v0 offset0:0 offset1:78
  ds_read2_b32 v[46:47], v0 offset0:156 offset1:234
  v_lshlrev_b32_sdwa v55, 1, v54 dst_sel:DWORD dst_unused:UNUSED_PAD src0_sel:DWORD src1_sel:WORD_1
  v_lshlrev_b32_sdwa v54, 1, v54 dst_sel:DWORD dst_unused:UNUSED_PAD src0_sel:DWORD src1_sel:WORD_0
  v_exp_f16 v8, v9
  v_mfma_f32_32x32x16_bf16 v[80:95], v[20:23], v[116:119], v[80:95]
  s_waitcnt lgkmcnt(10)
  ds_read_b64_tr_b16 v[36:37], v1 offset:35840
  ds_read_b64_tr_b16 v[38:39], v1 offset:36096
  ds_read_u16_d16_hi v55, v55 offset:36864
  v_cvt_pk_bf16_f32 v56, v56, v57
  v_exp_f16 v10, v11
  v_lshlrev_b32_sdwa v57, 1, v56 dst_sel:DWORD dst_unused:UNUSED_PAD src0_sel:DWORD src1_sel:WORD_1
  v_mfma_f32_32x32x16_bf16 v[80:95], v[24:27], v[120:123], v[80:95]
  s_waitcnt lgkmcnt(1)
  s_barrier
  ds_read_b64_tr_b16 v[16:17], v7 offset:0
  ds_read_b64_tr_b16 v[18:19], v7 offset:1536
  ds_read_u16_d16 v54, v54 offset:36864
  v_lshlrev_b32_sdwa v56, 1, v56 dst_sel:DWORD dst_unused:UNUSED_PAD src0_sel:DWORD src1_sel:WORD_0
  v_exp_f16_sdwa v8, v9 dst_sel:WORD_1 dst_unused:UNUSED_PRESERVE src0_sel:WORD_1
  v_smfmac_f32_32x32x32_bf16 v[192:207], v[12:15], v[40:47], v5
  ds_read_u16_d16_hi v57, v57 offset:36864
  ds_read_u16_d16 v56, v56 offset:36864
  v_cvt_pk_bf16_f32 v58, v58, v59
  v_or_b32 v48, v48, v49
  v_lshlrev_b32_sdwa v59, 1, v58 dst_sel:DWORD dst_unused:UNUSED_PAD src0_sel:DWORD src1_sel:WORD_1
  v_lshlrev_b32_sdwa v58, 1, v58 dst_sel:DWORD dst_unused:UNUSED_PAD src0_sel:DWORD src1_sel:WORD_0
  v_mfma_f32_32x32x16_bf16 v[80:95], v[28:31], v[124:127], v[80:95]
  ds_read_b64_tr_b16 v[20:21], v7 offset:64
  ds_read_b64_tr_b16 v[22:23], v7 offset:1600
  ds_read_u16_d16_hi v59, v59 offset:36864
  v_exp_f16_sdwa v10, v11 dst_sel:WORD_1 dst_unused:UNUSED_PRESERVE src0_sel:WORD_1
  v_pk_fma_f16 v8, v8, s57, s57
  v_or_b32 v49, v50, v51
  v_pk_fma_f16 v10, v10, s57, s57
  v_mfma_f32_32x32x16_bf16 v[80:95], v[32:35], v[128:131], v[80:95]
  ds_read_b64_tr_b16 v[24:25], v7 offset:3072
  ds_read_b64_tr_b16 v[26:27], v7 offset:4608
  ds_read_u16_d16 v58, v58 offset:36864
  v_rcp_f16 v9, v8
  v_or_b32 v50, v52, v53
  v_rcp_f16 v11, v10
  v_mfma_f32_32x32x16_bf16 v[80:95], v[36:39], v[132:135], v[80:95]
  s_waitcnt lgkmcnt(6)
  ds_read_b64_tr_b16 v[28:29], v7 offset:3136
  ds_read_b64_tr_b16 v[30:31], v7 offset:4672
  v_rcp_f16_sdwa v9, v8 dst_sel:WORD_1 dst_unused:UNUSED_PRESERVE src0_sel:WORD_1
  v_or_b32 v51, v54, v55
  v_rcp_f16_sdwa v11, v10 dst_sel:WORD_1 dst_unused:UNUSED_PRESERVE src0_sel:WORD_1
  v_or_b32 v56, v56, v57
  v_mfma_f32_32x32x16_bf16 v[160:175], v[16:19], v[48:51], v[160:175]
  s_waitcnt lgkmcnt(2)
  ds_read_b64_tr_b16 v[32:33], v7 offset:128
  ds_read_b64_tr_b16 v[34:35], v7 offset:1664
  v_fma_mix_f32 v60, v60, v9, 0 op_sel_hi:[0,1,0]
  v_fma_mix_f32 v62, v62, v11, 0 op_sel_hi:[0,1,0]
  v_fma_mix_f32 v61, v61, v9, 0 op_sel:[0,1,0] op_sel_hi:[0,1,0]
  v_fma_mix_f32 v63, v63, v11, 0 op_sel:[0,1,0] op_sel_hi:[0,1,0]
  v_or_b32 v57, v58, v59
  v_cvt_pk_bf16_f32 v58, v60, v61
  v_mfma_f32_32x32x16_bf16 v[176:191], v[20:23], v[48:51], v[176:191]
  ds_read_b64_tr_b16 v[36:37], v7 offset:3200
  ds_read_b64_tr_b16 v[38:39], v7 offset:4736
  v_cvt_pk_bf16_f32 v59, v62, v63
  v_cvt_pk_bf16_f32 v80, v80, v81
  v_lshlrev_b32_sdwa v81, 1, v80 dst_sel:DWORD dst_unused:UNUSED_PAD src0_sel:DWORD src1_sel:WORD_1
  v_lshlrev_b32_sdwa v80, 1, v80 dst_sel:DWORD dst_unused:UNUSED_PAD src0_sel:DWORD src1_sel:WORD_0
  v_mul_f32 v92, s37, v92
  v_mul_f32 v94, s37, v94
  v_mfma_f32_32x32x16_bf16 v[160:175], v[24:27], v[56:59], v[160:175]
  s_waitcnt lgkmcnt(4)
  ds_read_b64_tr_b16 v[16:17], v1 offset:6144
  ds_read_b64_tr_b16 v[18:19], v1 offset:6400
  ds_read_u16_d16_hi v81, v81 offset:36864
  ds_read_u16_d16 v80, v80 offset:36864
  v_mul_f32 v93, s37, v93
  v_cvt_pk_bf16_f32 v82, v82, v83
  v_lshlrev_b32_sdwa v83, 1, v82 dst_sel:DWORD dst_unused:UNUSED_PAD src0_sel:DWORD src1_sel:WORD_1
  v_lshlrev_b32_sdwa v82, 1, v82 dst_sel:DWORD dst_unused:UNUSED_PAD src0_sel:DWORD src1_sel:WORD_0
  v_mfma_f32_32x32x16_bf16 v[176:191], v[28:31], v[56:59], v[176:191]
  s_waitcnt lgkmcnt(6)
  ds_read_b64_tr_b16 v[20:21], v1 offset:7168
  ds_read_b64_tr_b16 v[22:23], v1 offset:7424
  ds_read_u16_d16_hi v83, v83 offset:36864
  ds_read_u16_d16 v82, v82 offset:36864
  v_mul_f32 v95, s37, v95
  v_cvt_pk_f16_f32 v8, v92, v93
  v_cvt_pk_f16_f32 v10, v94, v95
  v_cvt_pk_bf16_f32 v84, v84, v85
  v_mfma_f32_32x32x16_bf16 v[192:207], v[32:35], v[48:51], v[192:207]
  s_waitcnt lgkmcnt(8)
  ds_read_b64_tr_b16 v[24:25], v1 offset:8192
  ds_read_b64_tr_b16 v[26:27], v1 offset:8448
  v_lshlrev_b32_sdwa v85, 1, v84 dst_sel:DWORD dst_unused:UNUSED_PAD src0_sel:DWORD src1_sel:WORD_1
  v_lshlrev_b32_sdwa v84, 1, v84 dst_sel:DWORD dst_unused:UNUSED_PAD src0_sel:DWORD src1_sel:WORD_0
  v_pk_fma_f16 v9, v8, v8, s56
  v_pk_fma_f16 v11, v10, v10, s56
  v_pk_mul_f16 v9, v8, v9 neg_lo:[0,1] neg_hi:[0,1]
  v_cvt_pk_bf16_f32 v86, v86, v87
  v_mfma_f32_32x32x16_bf16 v[192:207], v[36:39], v[56:59], v[192:207]
  s_waitcnt lgkmcnt(8)
  ds_read_b64_tr_b16 v[28:29], v1 offset:9216
  ds_read_b64_tr_b16 v[30:31], v1 offset:9472
  ds_read_u16_d16_hi v85, v85 offset:36864
  ds_read_u16_d16 v84, v84 offset:36864
  v_pk_mul_f16 v11, v10, v11 neg_lo:[0,1] neg_hi:[0,1]
  v_lshlrev_b32_sdwa v87, 1, v86 dst_sel:DWORD dst_unused:UNUSED_PAD src0_sel:DWORD src1_sel:WORD_1
  v_lshlrev_b32_sdwa v86, 1, v86 dst_sel:DWORD dst_unused:UNUSED_PAD src0_sel:DWORD src1_sel:WORD_0
  v_mfma_f32_32x32x16_bf16 v[48:63], v[16:19], v[112:115], 0
  s_waitcnt lgkmcnt(8)
  ds_read_b64_tr_b16 v[32:33], v1 offset:10240
  ds_read_b64_tr_b16 v[34:35], v1 offset:10496
  ds_read_u16_d16_hi v87, v87 offset:36864
  ds_read_u16_d16 v86, v86 offset:36864
  v_exp_f16 v8, v9
  v_cvt_pk_bf16_f32 v88, v88, v89
  v_exp_f16 v10, v11
  v_mfma_f32_32x32x16_bf16 v[48:63], v[20:23], v[116:119], v[48:63]
  s_waitcnt lgkmcnt(8)
  ds_read_b64_tr_b16 v[36:37], v1 offset:11264
  ds_read_b64_tr_b16 v[38:39], v1 offset:11520
  v_lshlrev_b32_sdwa v89, 1, v88 dst_sel:DWORD dst_unused:UNUSED_PAD src0_sel:DWORD src1_sel:WORD_1
  v_lshlrev_b32_sdwa v88, 1, v88 dst_sel:DWORD dst_unused:UNUSED_PAD src0_sel:DWORD src1_sel:WORD_0
  v_exp_f16_sdwa v8, v9 dst_sel:WORD_1 dst_unused:UNUSED_PRESERVE src0_sel:WORD_1
  v_cvt_pk_bf16_f32 v90, v90, v91
  v_mfma_f32_32x32x16_bf16 v[48:63], v[24:27], v[120:123], v[48:63]
  s_waitcnt lgkmcnt(0)
  s_barrier
  ds_read_b64_tr_b16 v[16:17], v7 offset:12288
  ds_read_b64_tr_b16 v[18:19], v7 offset:13824
  ds_read_u16_d16_hi v89, v89 offset:36864
  ds_read_u16_d16 v88, v88 offset:36864
  v_or_b32 v80, v80, v81
  v_lshlrev_b32_sdwa v91, 1, v90 dst_sel:DWORD dst_unused:UNUSED_PAD src0_sel:DWORD src1_sel:WORD_1
  v_lshlrev_b32_sdwa v90, 1, v90 dst_sel:DWORD dst_unused:UNUSED_PAD src0_sel:DWORD src1_sel:WORD_0
  v_mfma_f32_32x32x16_bf16 v[48:63], v[28:31], v[124:127], v[48:63]
  ds_read_b64_tr_b16 v[20:21], v7 offset:12352
  ds_read_b64_tr_b16 v[22:23], v7 offset:13888
  ds_read_u16_d16_hi v91, v91 offset:36864
  ds_read_u16_d16 v90, v90 offset:36864
  v_exp_f16_sdwa v10, v11 dst_sel:WORD_1 dst_unused:UNUSED_PRESERVE src0_sel:WORD_1
  v_pk_fma_f16 v8, v8, s57, s57
  v_or_b32 v81, v82, v83
  v_mfma_f32_32x32x16_bf16 v[48:63], v[32:35], v[128:131], v[48:63]
  ds_read_b64_tr_b16 v[24:25], v7 offset:15360
  ds_read_b64_tr_b16 v[26:27], v7 offset:16896
  v_pk_fma_f16 v10, v10, s57, s57
  v_rcp_f16 v9, v8
  v_or_b32 v82, v84, v85
  v_rcp_f16 v11, v10
  v_mfma_f32_32x32x16_bf16 v[48:63], v[36:39], v[132:135], v[48:63]
  s_waitcnt lgkmcnt(6)
  ds_read_b64_tr_b16 v[28:29], v7 offset:15424
  ds_read_b64_tr_b16 v[30:31], v7 offset:16960
  v_rcp_f16_sdwa v9, v8 dst_sel:WORD_1 dst_unused:UNUSED_PRESERVE src0_sel:WORD_1
  v_or_b32 v83, v86, v87
  v_rcp_f16_sdwa v11, v10 dst_sel:WORD_1 dst_unused:UNUSED_PRESERVE src0_sel:WORD_1
  v_or_b32 v88, v88, v89
  v_mfma_f32_32x32x16_bf16 v[160:175], v[16:19], v[80:83], v[160:175]
  s_waitcnt lgkmcnt(4)
  ds_read_b64_tr_b16 v[32:33], v7 offset:12416
  ds_read_b64_tr_b16 v[34:35], v7 offset:13952
  v_fma_mix_f32 v92, v92, v9, 0 op_sel_hi:[0,1,0]
  v_fma_mix_f32 v94, v94, v11, 0 op_sel_hi:[0,1,0]
  v_fma_mix_f32 v93, v93, v9, 0 op_sel:[0,1,0] op_sel_hi:[0,1,0]
  v_fma_mix_f32 v95, v95, v11, 0 op_sel:[0,1,0] op_sel_hi:[0,1,0]
  v_or_b32 v89, v90, v91
  v_cvt_pk_bf16_f32 v90, v92, v93
  v_mfma_f32_32x32x16_bf16 v[176:191], v[20:23], v[80:83], v[176:191]
  s_waitcnt lgkmcnt(4)
  ds_read_b64_tr_b16 v[36:37], v7 offset:15488
  ds_read_b64_tr_b16 v[38:39], v7 offset:17024
  v_cvt_pk_bf16_f32 v91, v94, v95
  v_cvt_pk_bf16_f32 v48, v48, v49
  v_lshlrev_b32_sdwa v49, 1, v48 dst_sel:DWORD dst_unused:UNUSED_PAD src0_sel:DWORD src1_sel:WORD_1
  v_lshlrev_b32_sdwa v48, 1, v48 dst_sel:DWORD dst_unused:UNUSED_PAD src0_sel:DWORD src1_sel:WORD_0
  v_mul_f32 v60, s37, v60
  v_mul_f32 v62, s37, v62
  v_mfma_f32_32x32x16_bf16 v[160:175], v[24:27], v[88:91], v[160:175]
  s_waitcnt lgkmcnt(4)
  ds_read_b64_tr_b16 v[16:17], v1 offset:18432
  ds_read_b64_tr_b16 v[18:19], v1 offset:18688
  ds_read_u16_d16_hi v49, v49 offset:36864
  ds_read_u16_d16 v48, v48 offset:36864
  v_mul_f32 v61, s37, v61
  v_cvt_pk_bf16_f32 v50, v50, v51
  v_lshlrev_b32_sdwa v51, 1, v50 dst_sel:DWORD dst_unused:UNUSED_PAD src0_sel:DWORD src1_sel:WORD_1
  v_lshlrev_b32_sdwa v50, 1, v50 dst_sel:DWORD dst_unused:UNUSED_PAD src0_sel:DWORD src1_sel:WORD_0
  v_mfma_f32_32x32x16_bf16 v[176:191], v[28:31], v[88:91], v[176:191]
  s_waitcnt lgkmcnt(6)
  ds_read_b64_tr_b16 v[20:21], v1 offset:19456
  ds_read_b64_tr_b16 v[22:23], v1 offset:19712
  ds_read_u16_d16_hi v51, v51 offset:36864
  ds_read_u16_d16 v50, v50 offset:36864
  v_mul_f32 v63, s37, v63
  v_cvt_pk_f16_f32 v8, v60, v61
  v_cvt_pk_f16_f32 v10, v62, v63
  v_cvt_pk_bf16_f32 v52, v52, v53
  v_mfma_f32_32x32x16_bf16 v[192:207], v[32:35], v[80:83], v[192:207]
  s_waitcnt lgkmcnt(8)
  ds_read_b64_tr_b16 v[24:25], v1 offset:20480
  ds_read_b64_tr_b16 v[26:27], v1 offset:20736
  v_lshlrev_b32_sdwa v53, 1, v52 dst_sel:DWORD dst_unused:UNUSED_PAD src0_sel:DWORD src1_sel:WORD_1
  v_lshlrev_b32_sdwa v52, 1, v52 dst_sel:DWORD dst_unused:UNUSED_PAD src0_sel:DWORD src1_sel:WORD_0
  v_pk_fma_f16 v9, v8, v8, s56
  v_pk_fma_f16 v11, v10, v10, s56
  v_pk_mul_f16 v9, v8, v9 neg_lo:[0,1] neg_hi:[0,1]
  v_cvt_pk_bf16_f32 v54, v54, v55
  v_mfma_f32_32x32x16_bf16 v[192:207], v[36:39], v[88:91], v[192:207]
  s_waitcnt lgkmcnt(8)
  ds_read_b64_tr_b16 v[28:29], v1 offset:21504
  ds_read_b64_tr_b16 v[30:31], v1 offset:21760
  ds_read_u16_d16_hi v53, v53 offset:36864
  ds_read_u16_d16 v52, v52 offset:36864
  v_pk_mul_f16 v11, v10, v11 neg_lo:[0,1] neg_hi:[0,1]
  v_lshlrev_b32_sdwa v55, 1, v54 dst_sel:DWORD dst_unused:UNUSED_PAD src0_sel:DWORD src1_sel:WORD_1
  v_lshlrev_b32_sdwa v54, 1, v54 dst_sel:DWORD dst_unused:UNUSED_PAD src0_sel:DWORD src1_sel:WORD_0
  v_mfma_f32_32x32x16_bf16 v[80:95], v[16:19], v[112:115], 0
  s_waitcnt lgkmcnt(8)
  ds_read_b64_tr_b16 v[32:33], v1 offset:22528
  ds_read_b64_tr_b16 v[34:35], v1 offset:22784
  ds_read_u16_d16_hi v55, v55 offset:36864
  ds_read_u16_d16 v54, v54 offset:36864
  v_exp_f16 v8, v9
  v_cvt_pk_bf16_f32 v56, v56, v57
  v_exp_f16 v10, v11
  v_mfma_f32_32x32x16_bf16 v[80:95], v[20:23], v[116:119], v[80:95]
  s_waitcnt lgkmcnt(8)
  ds_read_b64_tr_b16 v[36:37], v1 offset:23552
  ds_read_b64_tr_b16 v[38:39], v1 offset:23808
  v_lshlrev_b32_sdwa v57, 1, v56 dst_sel:DWORD dst_unused:UNUSED_PAD src0_sel:DWORD src1_sel:WORD_1
  v_lshlrev_b32_sdwa v56, 1, v56 dst_sel:DWORD dst_unused:UNUSED_PAD src0_sel:DWORD src1_sel:WORD_0
  v_exp_f16_sdwa v8, v9 dst_sel:WORD_1 dst_unused:UNUSED_PRESERVE src0_sel:WORD_1
  v_cvt_pk_bf16_f32 v58, v58, v59
  v_mfma_f32_32x32x16_bf16 v[80:95], v[24:27], v[120:123], v[80:95]
  s_waitcnt lgkmcnt(0)
  s_barrier
  ds_read_b64_tr_b16 v[16:17], v7 offset:24576
  ds_read_b64_tr_b16 v[18:19], v7 offset:26112
  ds_read_u16_d16_hi v57, v57 offset:36864
  ds_read_u16_d16 v56, v56 offset:36864
  v_or_b32 v48, v48, v49
  v_lshlrev_b32_sdwa v59, 1, v58 dst_sel:DWORD dst_unused:UNUSED_PAD src0_sel:DWORD src1_sel:WORD_1
  v_lshlrev_b32_sdwa v58, 1, v58 dst_sel:DWORD dst_unused:UNUSED_PAD src0_sel:DWORD src1_sel:WORD_0
  v_mfma_f32_32x32x16_bf16 v[80:95], v[28:31], v[124:127], v[80:95]
  ds_read_b64_tr_b16 v[20:21], v7 offset:24640
  ds_read_b64_tr_b16 v[22:23], v7 offset:26176
  ds_read_u16_d16_hi v59, v59 offset:36864
  ds_read_u16_d16 v58, v58 offset:36864
  v_exp_f16_sdwa v10, v11 dst_sel:WORD_1 dst_unused:UNUSED_PRESERVE src0_sel:WORD_1
  v_pk_fma_f16 v8, v8, s57, s57
  v_or_b32 v49, v50, v51
  v_mfma_f32_32x32x16_bf16 v[80:95], v[32:35], v[128:131], v[80:95]
  ds_read_b64_tr_b16 v[24:25], v7 offset:27648
  ds_read_b64_tr_b16 v[26:27], v7 offset:29184
  v_pk_fma_f16 v10, v10, s57, s57
  v_rcp_f16 v9, v8
  v_or_b32 v50, v52, v53
  v_rcp_f16 v11, v10
  v_mfma_f32_32x32x16_bf16 v[80:95], v[36:39], v[132:135], v[80:95]
  s_waitcnt lgkmcnt(6)
  ds_read_b64_tr_b16 v[28:29], v7 offset:27712
  ds_read_b64_tr_b16 v[30:31], v7 offset:29248
  v_rcp_f16_sdwa v9, v8 dst_sel:WORD_1 dst_unused:UNUSED_PRESERVE src0_sel:WORD_1
  v_or_b32 v51, v54, v55
  v_rcp_f16_sdwa v11, v10 dst_sel:WORD_1 dst_unused:UNUSED_PRESERVE src0_sel:WORD_1
  v_or_b32 v56, v56, v57
  v_mfma_f32_32x32x16_bf16 v[160:175], v[16:19], v[48:51], v[160:175]
  s_waitcnt lgkmcnt(4)
  ds_read_b64_tr_b16 v[32:33], v7 offset:24704
  ds_read_b64_tr_b16 v[34:35], v7 offset:26240
  v_fma_mix_f32 v60, v60, v9, 0 op_sel_hi:[0,1,0]
  v_fma_mix_f32 v62, v62, v11, 0 op_sel_hi:[0,1,0]
  v_fma_mix_f32 v61, v61, v9, 0 op_sel:[0,1,0] op_sel_hi:[0,1,0]
  v_fma_mix_f32 v63, v63, v11, 0 op_sel:[0,1,0] op_sel_hi:[0,1,0]
  v_or_b32 v57, v58, v59
  v_cvt_pk_bf16_f32 v58, v60, v61
  v_mfma_f32_32x32x16_bf16 v[176:191], v[20:23], v[48:51], v[176:191]
  s_waitcnt lgkmcnt(4)
  ds_read_b64_tr_b16 v[36:37], v7 offset:27776
  ds_read_b64_tr_b16 v[38:39], v7 offset:29312
  v_cvt_pk_bf16_f32 v59, v62, v63
  v_cvt_pk_bf16_f32 v80, v80, v81
  v_lshlrev_b32_sdwa v81, 1, v80 dst_sel:DWORD dst_unused:UNUSED_PAD src0_sel:DWORD src1_sel:WORD_1
  v_lshlrev_b32_sdwa v80, 1, v80 dst_sel:DWORD dst_unused:UNUSED_PAD src0_sel:DWORD src1_sel:WORD_0
  v_mul_f32 v92, s37, v92
  v_mul_f32 v94, s37, v94
  v_mfma_f32_32x32x16_bf16 v[160:175], v[24:27], v[56:59], v[160:175]
  s_waitcnt lgkmcnt(4)
  ds_read_b64_tr_b16 v[16:17], v1 offset:30720
  ds_read_b64_tr_b16 v[18:19], v1 offset:30976
  ds_read_u16_d16_hi v81, v81 offset:36864
  ds_read_u16_d16 v80, v80 offset:36864
  v_mul_f32 v93, s37, v93
  v_cvt_pk_bf16_f32 v82, v82, v83
  v_lshlrev_b32_sdwa v83, 1, v82 dst_sel:DWORD dst_unused:UNUSED_PAD src0_sel:DWORD src1_sel:WORD_1
  v_lshlrev_b32_sdwa v82, 1, v82 dst_sel:DWORD dst_unused:UNUSED_PAD src0_sel:DWORD src1_sel:WORD_0
  v_mfma_f32_32x32x16_bf16 v[176:191], v[28:31], v[56:59], v[176:191]
  s_waitcnt lgkmcnt(6)
  ds_read_b64_tr_b16 v[20:21], v1 offset:31744
  ds_read_b64_tr_b16 v[22:23], v1 offset:32000
  ds_read_u16_d16_hi v83, v83 offset:36864
  ds_read_u16_d16 v82, v82 offset:36864
  v_mul_f32 v95, s37, v95
  v_cvt_pk_f16_f32 v8, v92, v93
  v_cvt_pk_f16_f32 v10, v94, v95
  v_cvt_pk_bf16_f32 v84, v84, v85
  v_mfma_f32_32x32x16_bf16 v[192:207], v[32:35], v[48:51], v[192:207]
  s_waitcnt lgkmcnt(8)
  ds_read_b64_tr_b16 v[24:25], v1 offset:32768
  ds_read_b64_tr_b16 v[26:27], v1 offset:33024
  v_lshlrev_b32_sdwa v85, 1, v84 dst_sel:DWORD dst_unused:UNUSED_PAD src0_sel:DWORD src1_sel:WORD_1
  v_lshlrev_b32_sdwa v84, 1, v84 dst_sel:DWORD dst_unused:UNUSED_PAD src0_sel:DWORD src1_sel:WORD_0
  v_pk_fma_f16 v9, v8, v8, s56
  v_pk_fma_f16 v11, v10, v10, s56
  v_pk_mul_f16 v9, v8, v9 neg_lo:[0,1] neg_hi:[0,1]
  v_cvt_pk_bf16_f32 v86, v86, v87
  v_mfma_f32_32x32x16_bf16 v[192:207], v[36:39], v[56:59], v[192:207]
  s_waitcnt lgkmcnt(8)
  ds_read_b64_tr_b16 v[28:29], v1 offset:33792
  ds_read_b64_tr_b16 v[30:31], v1 offset:34048
  ds_read_u16_d16_hi v85, v85 offset:36864
  ds_read_u16_d16 v84, v84 offset:36864
  v_pk_mul_f16 v11, v10, v11 neg_lo:[0,1] neg_hi:[0,1]
  v_lshlrev_b32_sdwa v87, 1, v86 dst_sel:DWORD dst_unused:UNUSED_PAD src0_sel:DWORD src1_sel:WORD_1
  v_lshlrev_b32_sdwa v86, 1, v86 dst_sel:DWORD dst_unused:UNUSED_PAD src0_sel:DWORD src1_sel:WORD_0
  v_mfma_f32_32x32x16_bf16 v[48:63], v[16:19], v[112:115], 0
  s_waitcnt lgkmcnt(8)
  ds_read_b64_tr_b16 v[32:33], v1 offset:34816
  ds_read_b64_tr_b16 v[34:35], v1 offset:35072
  ds_read_u16_d16_hi v87, v87 offset:36864
  ds_read_u16_d16 v86, v86 offset:36864
  v_exp_f16 v8, v9
  v_cvt_pk_bf16_f32 v88, v88, v89
  v_exp_f16 v10, v11
  v_mfma_f32_32x32x16_bf16 v[48:63], v[20:23], v[116:119], v[48:63]
  s_waitcnt lgkmcnt(8)
  ds_read_b64_tr_b16 v[36:37], v1 offset:35840
  ds_read_b64_tr_b16 v[38:39], v1 offset:36096
  v_lshlrev_b32_sdwa v89, 1, v88 dst_sel:DWORD dst_unused:UNUSED_PAD src0_sel:DWORD src1_sel:WORD_1
  v_lshlrev_b32_sdwa v88, 1, v88 dst_sel:DWORD dst_unused:UNUSED_PAD src0_sel:DWORD src1_sel:WORD_0
  v_exp_f16_sdwa v8, v9 dst_sel:WORD_1 dst_unused:UNUSED_PRESERVE src0_sel:WORD_1
  v_cvt_pk_bf16_f32 v90, v90, v91
  v_mfma_f32_32x32x16_bf16 v[48:63], v[24:27], v[120:123], v[48:63]
  s_waitcnt lgkmcnt(0)
  s_barrier
  ds_read_b64_tr_b16 v[16:17], v7 offset:0
  ds_read_b64_tr_b16 v[18:19], v7 offset:1536
  ds_read_u16_d16_hi v89, v89 offset:36864
  ds_read_u16_d16 v88, v88 offset:36864
  v_or_b32 v80, v80, v81
  v_lshlrev_b32_sdwa v91, 1, v90 dst_sel:DWORD dst_unused:UNUSED_PAD src0_sel:DWORD src1_sel:WORD_1
  v_lshlrev_b32_sdwa v90, 1, v90 dst_sel:DWORD dst_unused:UNUSED_PAD src0_sel:DWORD src1_sel:WORD_0
  v_mfma_f32_32x32x16_bf16 v[48:63], v[28:31], v[124:127], v[48:63]
  ds_read_b64_tr_b16 v[20:21], v7 offset:64
  ds_read_b64_tr_b16 v[22:23], v7 offset:1600
  ds_read_u16_d16_hi v91, v91 offset:36864
  ds_read_u16_d16 v90, v90 offset:36864
  v_exp_f16_sdwa v10, v11 dst_sel:WORD_1 dst_unused:UNUSED_PRESERVE src0_sel:WORD_1
  v_pk_fma_f16 v8, v8, s57, s57
  v_or_b32 v81, v82, v83
  v_mfma_f32_32x32x16_bf16 v[48:63], v[32:35], v[128:131], v[48:63]
  ds_read_b64_tr_b16 v[24:25], v7 offset:3072
  ds_read_b64_tr_b16 v[26:27], v7 offset:4608
  v_pk_fma_f16 v10, v10, s57, s57
  v_rcp_f16 v9, v8
  v_or_b32 v82, v84, v85
  v_rcp_f16 v11, v10
  v_mfma_f32_32x32x16_bf16 v[48:63], v[36:39], v[132:135], v[48:63]
  s_waitcnt lgkmcnt(6)
  ds_read_b64_tr_b16 v[28:29], v7 offset:3136
  ds_read_b64_tr_b16 v[30:31], v7 offset:4672
  v_rcp_f16_sdwa v9, v8 dst_sel:WORD_1 dst_unused:UNUSED_PRESERVE src0_sel:WORD_1
  v_or_b32 v83, v86, v87
  v_rcp_f16_sdwa v11, v10 dst_sel:WORD_1 dst_unused:UNUSED_PRESERVE src0_sel:WORD_1
  v_or_b32 v88, v88, v89
  v_mfma_f32_32x32x16_bf16 v[160:175], v[16:19], v[80:83], v[160:175]
  s_waitcnt lgkmcnt(6)
  ds_read_b64_tr_b16 v[32:33], v7 offset:128
  ds_read_b64_tr_b16 v[34:35], v7 offset:1664
  ds_read_b128 v[136:139], v3 offset:0
  ds_read_b128 v[140:143], v3 offset:4096
  v_fma_mix_f32 v92, v92, v9, 0 op_sel_hi:[0,1,0]
  v_fma_mix_f32 v94, v94, v11, 0 op_sel_hi:[0,1,0]
  v_mfma_f32_32x32x16_bf16 v[176:191], v[20:23], v[80:83], v[176:191]
  s_waitcnt lgkmcnt(6)
  ds_read_b64_tr_b16 v[36:37], v7 offset:3200
  ds_read_b64_tr_b16 v[38:39], v7 offset:4736
  ds_read_b128 v[144:147], v3 offset:8192
  ds_read_b128 v[148:151], v3 offset:12288
  v_fma_mix_f32 v93, v93, v9, 0 op_sel:[0,1,0] op_sel_hi:[0,1,0]
  v_fma_mix_f32 v95, v95, v11, 0 op_sel:[0,1,0] op_sel_hi:[0,1,0]
  v_or_b32 v89, v90, v91
  v_add_u32 v6, s43, v4
  v_cvt_pk_bf16_f32 v90, v92, v93
  v_cvt_pk_bf16_f32 v91, v94, v95
  s_nop 1
  v_mfma_f32_32x32x16_bf16 v[160:175], v[24:27], v[88:91], v[160:175]
  s_waitcnt lgkmcnt(8)
  ds_read_b64_tr_b16 v[16:17], v1 offset:6144
  ds_read_b64_tr_b16 v[18:19], v1 offset:6400
  ds_read_b128 v[152:155], v3 offset:16384
  ds_read_b128 v[156:159], v3 offset:20480
  v_mfma_f32_32x32x16_bf16 v[176:191], v[28:31], v[88:91], v[176:191]
  s_waitcnt lgkmcnt(10)
  ds_read_b64_tr_b16 v[20:21], v1 offset:7168
  ds_read_b64_tr_b16 v[22:23], v1 offset:7424
  s_mov_b32 s49, s43
  s_mov_b32 s43, s44
  s_mov_b32 s44, s45
  s_mov_b32 s45, s49
  v_mfma_f32_32x32x16_bf16 v[192:207], v[32:35], v[80:83], v[192:207]
  s_waitcnt lgkmcnt(8)
  ds_read_b64_tr_b16 v[24:25], v1 offset:8192
  ds_read_b64_tr_b16 v[26:27], v1 offset:8448
  v_cvt_pk_bf16_f32 v48, v48, v49
  v_lshlrev_b32_sdwa v49, 1, v48 dst_sel:DWORD dst_unused:UNUSED_PAD src0_sel:DWORD src1_sel:WORD_1
  v_mfma_f32_32x32x16_bf16 v[192:207], v[36:39], v[88:91], v[192:207]
  s_waitcnt lgkmcnt(6)
  ds_read_b64_tr_b16 v[28:29], v1 offset:9216
  ds_read_b64_tr_b16 v[30:31], v1 offset:9472
  ds_read_u16_d16_hi v49, v49 offset:36864
  v_lshlrev_b32_sdwa v48, 1, v48 dst_sel:DWORD dst_unused:UNUSED_PAD src0_sel:DWORD src1_sel:WORD_0
  v_mul_f32 v60, s37, v60
  v_mfma_f32_32x32x16_bf16 v[80:95], v[16:19], v[112:115], 0
  ds_read_b64_tr_b16 v[32:33], v1 offset:10240
  ds_read_u16_d16 v48, v48 offset:36864
  v_mul_f32 v62, s37, v62
  v_mul_f32 v61, s37, v61
  v_cvt_pk_bf16_f32 v50, v50, v51
  v_lshlrev_b32_sdwa v51, 1, v50 dst_sel:DWORD dst_unused:UNUSED_PAD src0_sel:DWORD src1_sel:WORD_1
  v_mfma_f32_32x32x16_bf16 v[96:111], v[16:19], v[136:139], 0
  s_waitcnt lgkmcnt(7)
  ds_read_b64_tr_b16 v[34:35], v1 offset:10496
  ds_read_u16_d16_hi v51, v51 offset:36864
  v_lshlrev_b32_sdwa v50, 1, v50 dst_sel:DWORD dst_unused:UNUSED_PAD src0_sel:DWORD src1_sel:WORD_0
  v_mul_f32 v63, s37, v63
  v_cvt_pk_f16_f32 v8, v60, v61
  v_cvt_pk_f16_f32 v10, v62, v63
  v_mfma_f32_32x32x16_bf16 v[80:95], v[20:23], v[116:119], v[80:95]
  ds_read_b64_tr_b16 v[36:37], v1 offset:11264
  ds_read_u16_d16 v50, v50 offset:36864
  v_cvt_pk_bf16_f32 v52, v52, v53
  v_lshlrev_b32_sdwa v53, 1, v52 dst_sel:DWORD dst_unused:UNUSED_PAD src0_sel:DWORD src1_sel:WORD_1
  v_lshlrev_b32_sdwa v52, 1, v52 dst_sel:DWORD dst_unused:UNUSED_PAD src0_sel:DWORD src1_sel:WORD_0
  v_pk_fma_f16 v9, v8, v8, s56
  v_mfma_f32_32x32x16_bf16 v[96:111], v[20:23], v[140:143], v[96:111]
  s_waitcnt lgkmcnt(9)
  ds_read_b64_tr_b16 v[38:39], v1 offset:11520
  ds_read_u16_d16_hi v53, v53 offset:36864
  ds_read_u16_d16 v52, v52 offset:36864
  v_pk_fma_f16 v11, v10, v10, s56
  v_pk_mul_f16 v9, v8, v9 neg_lo:[0,1] neg_hi:[0,1]
  v_cvt_pk_bf16_f32 v54, v54, v55
  v_mfma_f32_32x32x16_bf16 v[80:95], v[24:27], v[120:123], v[80:95]
  v_pk_mul_f16 v11, v10, v11 neg_lo:[0,1] neg_hi:[0,1]
  v_lshlrev_b32_sdwa v55, 1, v54 dst_sel:DWORD dst_unused:UNUSED_PAD src0_sel:DWORD src1_sel:WORD_1
  v_lshlrev_b32_sdwa v54, 1, v54 dst_sel:DWORD dst_unused:UNUSED_PAD src0_sel:DWORD src1_sel:WORD_0
  v_exp_f16 v8, v9
  v_cvt_pk_bf16_f32 v56, v56, v57
  v_mfma_f32_32x32x16_bf16 v[96:111], v[24:27], v[144:147], v[96:111]
  s_waitcnt lgkmcnt(10)
  ds_read_u16_d16_hi v55, v55 offset:36864
  ds_read_u16_d16 v54, v54 offset:36864
  v_exp_f16 v10, v11
  v_lshlrev_b32_sdwa v57, 1, v56 dst_sel:DWORD dst_unused:UNUSED_PAD src0_sel:DWORD src1_sel:WORD_1
  v_mfma_f32_32x32x16_bf16 v[80:95], v[28:31], v[124:127], v[80:95]
  s_waitcnt lgkmcnt(4)
  s_barrier
  ds_read_b64_tr_b16 v[16:17], v7 offset:12288
  ds_read_b64_tr_b16 v[18:19], v7 offset:13824
  ds_read_u16_d16_hi v57, v57 offset:36864
  v_lshlrev_b32_sdwa v56, 1, v56 dst_sel:DWORD dst_unused:UNUSED_PAD src0_sel:DWORD src1_sel:WORD_0
  v_exp_f16_sdwa v8, v9 dst_sel:WORD_1 dst_unused:UNUSED_PRESERVE src0_sel:WORD_1
  v_mfma_f32_32x32x16_bf16 v[96:111], v[28:31], v[148:151], v[96:111]
  ds_read_b64_tr_b16 v[20:21], v7 offset:12352
  ds_read_b64_tr_b16 v[22:23], v7 offset:13888
  ds_read_u16_d16 v56, v56 offset:36864
  v_cvt_pk_bf16_f32 v58, v58, v59
  v_or_b32 v48, v48, v49
  v_mfma_f32_32x32x16_bf16 v[80:95], v[32:35], v[128:131], v[80:95]
  ds_read_b64_tr_b16 v[24:25], v7 offset:15360
  v_lshlrev_b32_sdwa v59, 1, v58 dst_sel:DWORD dst_unused:UNUSED_PAD src0_sel:DWORD src1_sel:WORD_1
  v_lshlrev_b32_sdwa v58, 1, v58 dst_sel:DWORD dst_unused:UNUSED_PAD src0_sel:DWORD src1_sel:WORD_0
  v_exp_f16_sdwa v10, v11 dst_sel:WORD_1 dst_unused:UNUSED_PRESERVE src0_sel:WORD_1
  v_pk_fma_f16 v8, v8, s57, s57
  v_mfma_f32_32x32x16_bf16 v[96:111], v[32:35], v[152:155], v[96:111]
  ds_read_b64_tr_b16 v[26:27], v7 offset:16896
  ds_read_u16_d16_hi v59, v59 offset:36864
  ds_read_u16_d16 v58, v58 offset:36864
  v_or_b32 v49, v50, v51
  v_pk_fma_f16 v10, v10, s57, s57
  v_rcp_f16 v9, v8
  v_mfma_f32_32x32x16_bf16 v[80:95], v[36:39], v[132:135], v[80:95]
  s_waitcnt lgkmcnt(12)
  ds_read_b64_tr_b16 v[28:29], v7 offset:15424
  v_or_b32 v50, v52, v53
  v_rcp_f16 v11, v10
  v_rcp_f16_sdwa v9, v8 dst_sel:WORD_1 dst_unused:UNUSED_PRESERVE src0_sel:WORD_1
  v_mfma_f32_32x32x16_bf16 v[96:111], v[36:39], v[156:159], v[96:111]
  s_waitcnt lgkmcnt(5)
  ds_read_b64_tr_b16 v[30:31], v7 offset:16960
  v_or_b32 v51, v54, v55
  v_rcp_f16_sdwa v11, v10 dst_sel:WORD_1 dst_unused:UNUSED_PRESERVE src0_sel:WORD_1
  v_or_b32 v56, v56, v57
  v_mfma_f32_32x32x16_bf16 v[160:175], v[16:19], v[48:51], v[160:175]
  s_waitcnt lgkmcnt(2)
  ds_read_b64_tr_b16 v[32:33], v7 offset:12416
  ds_read_b64_tr_b16 v[34:35], v7 offset:13952
  v_fma_mix_f32 v60, v60, v9, 0 op_sel_hi:[0,1,0]
  v_fma_mix_f32 v62, v62, v11, 0 op_sel_hi:[0,1,0]
  v_fma_mix_f32 v61, v61, v9, 0 op_sel:[0,1,0] op_sel_hi:[0,1,0]
  v_cvt_pk_bf16_f32 v80, v80, v81
  v_fma_mix_f32 v63, v63, v11, 0 op_sel:[0,1,0] op_sel_hi:[0,1,0]
  v_or_b32 v57, v58, v59
  v_lshlrev_b32_sdwa v81, 1, v80 dst_sel:DWORD dst_unused:UNUSED_PAD src0_sel:DWORD src1_sel:WORD_1
  v_lshlrev_b32_sdwa v80, 1, v80 dst_sel:DWORD dst_unused:UNUSED_PAD src0_sel:DWORD src1_sel:WORD_0
  v_mfma_f32_32x32x16_bf16 v[176:191], v[20:23], v[48:51], v[176:191]
  ds_read_b64_tr_b16 v[36:37], v7 offset:15488
  ds_read_b64_tr_b16 v[38:39], v7 offset:17024
  ds_read_u16_d16_hi v81, v81 offset:36864
  v_cvt_pk_bf16_f32 v58, v60, v61
  v_cvt_pk_bf16_f32 v96, v96, v97
  v_cvt_pk_bf16_f32 v59, v62, v63
  v_mul_f32 v92, s37, v92
  v_mul_f32 v108, s37, v108
  v_mul_f32 v93, s37, v93
  v_mfma_f32_32x32x16_bf16 v[160:175], v[24:27], v[56:59], v[160:175]
  s_waitcnt lgkmcnt(5)
  ds_read_b64_tr_b16 v[16:17], v1 offset:18432
  ds_read_b64_tr_b16 v[18:19], v1 offset:18688
  ds_read_u16_d16 v80, v80 offset:36864
  v_mul_f32 v109, s37, v109
  v_lshlrev_b32_sdwa v97, 1, v96 dst_sel:DWORD dst_unused:UNUSED_PAD src0_sel:DWORD src1_sel:WORD_1
  v_lshlrev_b32_sdwa v96, 1, v96 dst_sel:DWORD dst_unused:UNUSED_PAD src0_sel:DWORD src1_sel:WORD_0
  v_cvt_pk_f16_f32 v8, v92, v93
  v_cvt_pk_f16_f32 v10, v108, v109
  v_pk_fma_f16 v9, v8, v8, s56
  v_pk_fma_f16 v11, v10, v10, s56
  v_mfma_f32_32x32x16_bf16 v[176:191], v[28:31], v[56:59], v[176:191]
  s_waitcnt lgkmcnt(6)
  ds_read_b64_tr_b16 v[20:21], v1 offset:19456
  ds_read_b64_tr_b16 v[22:23], v1 offset:19712
  ds_read_u16_d16_hi v97, v97 offset:36864
  v_cvt_pk_bf16_f32 v82, v82, v83
  v_pk_mul_f16 v9, v8, v9 neg_lo:[0,1] neg_hi:[0,1]
  v_lshlrev_b32_sdwa v83, 1, v82 dst_sel:DWORD dst_unused:UNUSED_PAD src0_sel:DWORD src1_sel:WORD_1
  v_lshlrev_b32_sdwa v82, 1, v82 dst_sel:DWORD dst_unused:UNUSED_PAD src0_sel:DWORD src1_sel:WORD_0
  v_pk_mul_f16 v11, v10, v11 neg_lo:[0,1] neg_hi:[0,1]
  v_exp_f16 v8, v9
  v_mfma_f32_32x32x16_bf16 v[192:207], v[32:35], v[48:51], v[192:207]
  s_waitcnt lgkmcnt(3)
  ds_read_b64_tr_b16 v[24:25], v1 offset:20480
  ds_read_b64_tr_b16 v[26:27], v1 offset:20736
  ds_read_u16_d16 v96, v96 offset:36864
  v_exp_f16 v10, v11
  v_cvt_pk_bf16_f32 v98, v98, v99
  v_or_b32 v80, v80, v81
  v_lshlrev_b32_sdwa v99, 1, v98 dst_sel:DWORD dst_unused:UNUSED_PAD src0_sel:DWORD src1_sel:WORD_1
  v_lshlrev_b32_sdwa v98, 1, v98 dst_sel:DWORD dst_unused:UNUSED_PAD src0_sel:DWORD src1_sel:WORD_0
  v_mfma_f32_32x32x16_bf16 v[192:207], v[36:39], v[56:59], v[192:207]
  s_waitcnt lgkmcnt(0)
  ds_read_b64_tr_b16 v[28:29], v1 offset:21504
  ds_read_b64_tr_b16 v[30:31], v1 offset:21760
  ds_read_u16_d16_hi v83, v83 offset:36864
  v_exp_f16_sdwa v8, v9 dst_sel:WORD_1 dst_unused:UNUSED_PRESERVE src0_sel:WORD_1
  v_exp_f16_sdwa v10, v11 dst_sel:WORD_1 dst_unused:UNUSED_PRESERVE src0_sel:WORD_1
  v_cvt_pk_bf16_f32 v84, v84, v85
  v_or_b32 v96, v96, v97
  v_mfma_f32_32x32x16_bf16 v[48:63], v[16:19], v[112:115], 0
  ds_read_b64_tr_b16 v[32:33], v1 offset:22528
  ds_read_u16_d16 v82, v82 offset:36864
  ds_read_u16_d16_hi v99, v99 offset:36864
  v_lshlrev_b32_sdwa v85, 1, v84 dst_sel:DWORD dst_unused:UNUSED_PAD src0_sel:DWORD src1_sel:WORD_1
  v_lshlrev_b32_sdwa v84, 1, v84 dst_sel:DWORD dst_unused:UNUSED_PAD src0_sel:DWORD src1_sel:WORD_0
  v_pk_fma_f16 v8, v8, s57, s57
  v_pk_fma_f16 v10, v10, s57, s57
  v_rcp_f16 v9, v8
  v_cvt_pk_bf16_f32 v100, v100, v101
  v_mfma_f32_32x32x16_bf16 v[64:79], v[16:19], v[136:139], 0
  s_waitcnt lgkmcnt(1)
  ds_read_b64_tr_b16 v[34:35], v1 offset:22784
  ds_read_u16_d16 v98, v98 offset:36864
  ds_read_u16_d16_hi v85, v85 offset:36864
  v_rcp_f16 v11, v10
  v_or_b32 v81, v82, v83
  v_lshlrev_b32_sdwa v101, 1, v100 dst_sel:DWORD dst_unused:UNUSED_PAD src0_sel:DWORD src1_sel:WORD_1
  v_lshlrev_b32_sdwa v100, 1, v100 dst_sel:DWORD dst_unused:UNUSED_PAD src0_sel:DWORD src1_sel:WORD_0
  v_rcp_f16_sdwa v9, v8 dst_sel:WORD_1 dst_unused:UNUSED_PRESERVE src0_sel:WORD_1
  v_mfma_f32_32x32x16_bf16 v[48:63], v[20:23], v[116:119], v[48:63]
  s_waitcnt lgkmcnt(1)
  ds_read_b64_tr_b16 v[36:37], v1 offset:23552
  ds_read_u16_d16 v84, v84 offset:36864
  ds_read_u16_d16_hi v101, v101 offset:36864
  v_rcp_f16_sdwa v11, v10 dst_sel:WORD_1 dst_unused:UNUSED_PRESERVE src0_sel:WORD_1
  v_cvt_pk_bf16_f32 v86, v86, v87
  v_or_b32 v97, v98, v99
  v_lshlrev_b32_sdwa v87, 1, v86 dst_sel:DWORD dst_unused:UNUSED_PAD src0_sel:DWORD src1_sel:WORD_1
  v_mfma_f32_32x32x16_bf16 v[64:79], v[20:23], v[140:143], v[64:79]
  s_waitcnt lgkmcnt(1)
  ds_read_b64_tr_b16 v[38:39], v1 offset:23808
  ds_read_u16_d16 v100, v100 offset:36864
  ds_read_u16_d16_hi v87, v87 offset:36864
  v_lshlrev_b32_sdwa v86, 1, v86 dst_sel:DWORD dst_unused:UNUSED_PAD src0_sel:DWORD src1_sel:WORD_0
  v_fma_mix_f32 v92, v92, v9, 0 op_sel_hi:[0,1,0]
  v_fma_mix_f32 v108, v108, v11, 0 op_sel_hi:[0,1,0]
  v_fma_mix_f32 v93, v93, v9, 0 op_sel:[0,1,0] op_sel_hi:[0,1,0]
  v_cvt_pk_bf16_f32 v102, v102, v103
  v_fma_mix_f32 v109, v109, v11, 0 op_sel:[0,1,0] op_sel_hi:[0,1,0]
  v_or_b32 v82, v84, v85
  v_mfma_f32_32x32x16_bf16 v[48:63], v[24:27], v[120:123], v[48:63]
  s_waitcnt lgkmcnt(1)
  ds_read_u16_d16 v86, v86 offset:36864
  v_lshlrev_b32_sdwa v103, 1, v102 dst_sel:DWORD dst_unused:UNUSED_PAD src0_sel:DWORD src1_sel:WORD_1
  v_lshlrev_b32_sdwa v102, 1, v102 dst_sel:DWORD dst_unused:UNUSED_PAD src0_sel:DWORD src1_sel:WORD_0
  v_mul_f32 v94, s37, v94
  v_mul_f32 v110, s37, v110
  v_cvt_pk_bf16_f32 v88, v88, v89
  v_mul_f32 v95, s37, v95
  v_or_b32 v98, v100, v101
  v_lshlrev_b32_sdwa v89, 1, v88 dst_sel:DWORD dst_unused:UNUSED_PAD src0_sel:DWORD src1_sel:WORD_1
  v_mfma_f32_32x32x16_bf16 v[64:79], v[24:27], v[144:147], v[64:79]
  s_waitcnt lgkmcnt(0)
  ds_read_u16_d16_hi v103, v103 offset:36864
  ds_read_u16_d16 v102, v102 offset:36864
  ds_read_u16_d16_hi v89, v89 offset:36864
  v_lshlrev_b32_sdwa v88, 1, v88 dst_sel:DWORD dst_unused:UNUSED_PAD src0_sel:DWORD src1_sel:WORD_0
  v_mul_f32 v111, s37, v111
  v_cvt_pk_f16_f32 v8, v94, v95
  v_cvt_pk_f16_f32 v10, v110, v111
  v_cvt_pk_bf16_f32 v104, v104, v105
  v_pk_fma_f16 v9, v8, v8, s56
  v_or_b32 v83, v86, v87
  v_mfma_f32_32x32x16_bf16 v[48:63], v[28:31], v[124:127], v[48:63]
  s_barrier
  ds_read_b64_tr_b16 v[16:17], v7 offset:24576
  ds_read_b64_tr_b16 v[18:19], v7 offset:26112
  ds_read_u16_d16 v88, v88 offset:36864
  v_lshlrev_b32_sdwa v105, 1, v104 dst_sel:DWORD dst_unused:UNUSED_PAD src0_sel:DWORD src1_sel:WORD_1
  v_lshlrev_b32_sdwa v104, 1, v104 dst_sel:DWORD dst_unused:UNUSED_PAD src0_sel:DWORD src1_sel:WORD_0
  v_pk_fma_f16 v11, v10, v10, s56
  v_pk_mul_f16 v9, v8, v9 neg_lo:[0,1] neg_hi:[0,1]
  v_pk_mul_f16 v11, v10, v11 neg_lo:[0,1] neg_hi:[0,1]
  v_mfma_f32_32x32x16_bf16 v[64:79], v[28:31], v[148:151], v[64:79]
  s_waitcnt lgkmcnt(4)
  ds_read_b64_tr_b16 v[20:21], v7 offset:24640
  ds_read_b64_tr_b16 v[22:23], v7 offset:26176
  ds_read_u16_d16_hi v105, v105 offset:36864
  v_exp_f16 v8, v9
  v_cvt_pk_bf16_f32 v90, v90, v91
  v_or_b32 v99, v102, v103
  v_lshlrev_b32_sdwa v91, 1, v90 dst_sel:DWORD dst_unused:UNUSED_PAD src0_sel:DWORD src1_sel:WORD_1
  v_lshlrev_b32_sdwa v90, 1, v90 dst_sel:DWORD dst_unused:UNUSED_PAD src0_sel:DWORD src1_sel:WORD_0
  v_exp_f16 v10, v11
  v_mfma_f32_32x32x16_bf16 v[48:63], v[32:35], v[128:131], v[48:63]
  s_waitcnt lgkmcnt(3)
  ds_read_b64_tr_b16 v[24:25], v7 offset:27648
  ds_read_u16_d16 v104, v104 offset:36864
  ds_read_u16_d16_hi v91, v91 offset:36864
  v_exp_f16_sdwa v8, v9 dst_sel:WORD_1 dst_unused:UNUSED_PRESERVE src0_sel:WORD_1
  v_add_u32 v0, 0, v6
  v_cvt_pk_bf16_f32 v106, v106, v107
  v_or_b32 v88, v88, v89
  v_mfma_f32_32x32x16_bf16 v[64:79], v[32:35], v[152:155], v[64:79]
  ds_read_b64_tr_b16 v[26:27], v7 offset:29184
  ds_read_u16_d16 v90, v90 offset:36864
  ds_read2_b32 v[40:41], v0 offset0:0 offset1:78
  ds_read2_b32 v[42:43], v0 offset0:156 offset1:234
  v_lshlrev_b32_sdwa v107, 1, v106 dst_sel:DWORD dst_unused:UNUSED_PAD src0_sel:DWORD src1_sel:WORD_1
  v_lshlrev_b32_sdwa v106, 1, v106 dst_sel:DWORD dst_unused:UNUSED_PAD src0_sel:DWORD src1_sel:WORD_0
  v_exp_f16_sdwa v10, v11 dst_sel:WORD_1 dst_unused:UNUSED_PRESERVE src0_sel:WORD_1
  v_add_u32 v0, 2496, v6
  v_pk_fma_f16 v8, v8, s57, s57
  v_mfma_f32_32x32x16_bf16 v[48:63], v[36:39], v[132:135], v[48:63]
  s_waitcnt lgkmcnt(5)
  ds_read_b64_tr_b16 v[28:29], v7 offset:27712
  ds_read_u16_d16_hi v107, v107 offset:36864
  ds_read_u16_d16 v106, v106 offset:36864
  ds_read2_b32 v[44:45], v0 offset0:0 offset1:78
  ds_read2_b32 v[46:47], v0 offset0:156 offset1:234
  v_pk_fma_f16 v10, v10, s57, s57
  v_rcp_f16 v9, v8
  v_or_b32 v104, v104, v105
  v_mfma_f32_32x32x16_bf16 v[64:79], v[36:39], v[156:159], v[64:79]
  s_waitcnt lgkmcnt(7)
  ds_read_b64_tr_b16 v[30:31], v7 offset:29248
  v_rcp_f16 v11, v10
  v_rcp_f16_sdwa v9, v8 dst_sel:WORD_1 dst_unused:UNUSED_PRESERVE src0_sel:WORD_1
  v_or_b32 v89, v90, v91
  v_cvt_pk_bf16_f32 v90, v92, v93
  v_rcp_f16_sdwa v11, v10 dst_sel:WORD_1 dst_unused:UNUSED_PRESERVE src0_sel:WORD_1
  v_fma_mix_f32 v94, v94, v9, 0 op_sel_hi:[0,1,0]
  v_mfma_f32_32x32x16_bf16 v[160:175], v[16:19], v[80:83], v[160:175]
  s_waitcnt lgkmcnt(3)
  ds_read_b64_tr_b16 v[32:33], v7 offset:24704
  v_fma_mix_f32 v110, v110, v11, 0 op_sel_hi:[0,1,0]
  v_or_b32 v105, v106, v107
  v_cvt_pk_bf16_f32 v106, v108, v109
  v_fma_mix_f32 v95, v95, v9, 0 op_sel:[0,1,0] op_sel_hi:[0,1,0]
  v_fma_mix_f32 v111, v111, v11, 0 op_sel:[0,1,0] op_sel_hi:[0,1,0]
  v_cvt_pk_bf16_f32 v91, v94, v95
  v_mfma_f32_32x32x16_bf16 v[208:223], v[16:19], v[96:99], 0
  s_waitcnt lgkmcnt(2)
  ds_read_b64_tr_b16 v[34:35], v7 offset:26240
  v_cvt_pk_bf16_f32 v107, v110, v111
  v_cvt_pk_bf16_f32 v48, v48, v49
  v_lshlrev_b32_sdwa v49, 1, v48 dst_sel:DWORD dst_unused:UNUSED_PAD src0_sel:DWORD src1_sel:WORD_1
  v_lshlrev_b32_sdwa v48, 1, v48 dst_sel:DWORD dst_unused:UNUSED_PAD src0_sel:DWORD src1_sel:WORD_0
  v_mul_f32 v60, s37, v60
  v_smfmac_f32_32x32x32_bf16 v[208:223], v[12:15], v[40:47], v5
  ds_read_u16_d16_hi v49, v49 offset:36864
  ds_read_u16_d16 v48, v48 offset:36864
  v_add_u32 v0, 4992, v6
  v_mul_f32 v76, s37, v76
  v_mul_f32 v61, s37, v61
  ds_read2_b32 v[40:41], v0 offset0:0 offset1:78
  ds_read2_b32 v[42:43], v0 offset0:156 offset1:234
  v_add_u32 v0, 7488, v6
  v_mfma_f32_32x32x16_bf16 v[176:191], v[20:23], v[80:83], v[176:191]
  ds_read_b64_tr_b16 v[36:37], v7 offset:27776
  ds_read2_b32 v[44:45], v0 offset0:0 offset1:78
  ds_read2_b32 v[46:47], v0 offset0:156 offset1:234
  v_mul_f32 v77, s37, v77
  v_cvt_pk_bf16_f32 v64, v64, v65
  v_mfma_f32_32x32x16_bf16 v[224:239], v[20:23], v[96:99], 0
  ds_read_b64_tr_b16 v[38:39], v7 offset:29312
  v_lshlrev_b32_sdwa v65, 1, v64 dst_sel:DWORD dst_unused:UNUSED_PAD src0_sel:DWORD src1_sel:WORD_1
  v_lshlrev_b32_sdwa v64, 1, v64 dst_sel:DWORD dst_unused:UNUSED_PAD src0_sel:DWORD src1_sel:WORD_0
  v_cvt_pk_f16_f32 v8, v60, v61
  v_cvt_pk_f16_f32 v10, v76, v77
  v_pk_fma_f16 v9, v8, v8, s56
  v_pk_fma_f16 v11, v10, v10, s56
  v_mfma_f32_32x32x16_bf16 v[160:175], v[24:27], v[88:91], v[160:175]
  ds_read_b64_tr_b16 v[16:17], v1 offset:30720
  ds_read_u16_d16_hi v65, v65 offset:36864
  ds_read_u16_d16 v64, v64 offset:36864
  v_cvt_pk_bf16_f32 v50, v50, v51
  v_pk_mul_f16 v9, v8, v9 neg_lo:[0,1] neg_hi:[0,1]
  v_lshlrev_b32_sdwa v51, 1, v50 dst_sel:DWORD dst_unused:UNUSED_PAD src0_sel:DWORD src1_sel:WORD_1
  v_mfma_f32_32x32x16_bf16 v[208:223], v[24:27], v[104:107], v[208:223]
  s_waitcnt lgkmcnt(13)
  ds_read_b64_tr_b16 v[18:19], v1 offset:30976
  ds_read_u16_d16_hi v51, v51 offset:36864
  v_lshlrev_b32_sdwa v50, 1, v50 dst_sel:DWORD dst_unused:UNUSED_PAD src0_sel:DWORD src1_sel:WORD_0
  v_pk_mul_f16 v11, v10, v11 neg_lo:[0,1] neg_hi:[0,1]
  v_exp_f16 v8, v9
  v_exp_f16 v10, v11
  v_mfma_f32_32x32x16_bf16 v[176:191], v[28:31], v[88:91], v[176:191]
  s_waitcnt lgkmcnt(11)
  ds_read_b64_tr_b16 v[20:21], v1 offset:31744
  ds_read_u16_d16 v50, v50 offset:36864
  v_cvt_pk_bf16_f32 v66, v66, v67
  v_or_b32 v48, v48, v49
  v_lshlrev_b32_sdwa v67, 1, v66 dst_sel:DWORD dst_unused:UNUSED_PAD src0_sel:DWORD src1_sel:WORD_1
  v_lshlrev_b32_sdwa v66, 1, v66 dst_sel:DWORD dst_unused:UNUSED_PAD src0_sel:DWORD src1_sel:WORD_0
  v_mfma_f32_32x32x16_bf16 v[224:239], v[28:31], v[104:107], v[224:239]
  s_waitcnt lgkmcnt(8)
  ds_read_b64_tr_b16 v[22:23], v1 offset:32000
  ds_read_u16_d16_hi v67, v67 offset:36864
  ds_read_u16_d16 v66, v66 offset:36864
  v_exp_f16_sdwa v8, v9 dst_sel:WORD_1 dst_unused:UNUSED_PRESERVE src0_sel:WORD_1
  v_exp_f16_sdwa v10, v11 dst_sel:WORD_1 dst_unused:UNUSED_PRESERVE src0_sel:WORD_1
  v_smfmac_f32_32x32x32_bf16 v[224:239], v[12:15], v[40:47], v5
  s_waitcnt lgkmcnt(7)
  v_cvt_pk_bf16_f32 v52, v52, v53
  v_or_b32 v64, v64, v65
  v_lshlrev_b32_sdwa v53, 1, v52 dst_sel:DWORD dst_unused:UNUSED_PAD src0_sel:DWORD src1_sel:WORD_1
  v_lshlrev_b32_sdwa v52, 1, v52 dst_sel:DWORD dst_unused:UNUSED_PAD src0_sel:DWORD src1_sel:WORD_0
  v_pk_fma_f16 v8, v8, s57, s57
  v_mfma_f32_32x32x16_bf16 v[192:207], v[32:35], v[80:83], v[192:207]
  ds_read_b64_tr_b16 v[24:25], v1 offset:32768
  ds_read_u16_d16_hi v53, v53 offset:36864
  ds_read_u16_d16 v52, v52 offset:36864
  v_add_u32 v0, 9984, v6
  v_pk_fma_f16 v10, v10, s57, s57
  v_rcp_f16 v9, v8
  v_mfma_f32_32x32x16_bf16 v[240:255], v[32:35], v[96:99], 0
  ds_read_b64_tr_b16 v[26:27], v1 offset:33024
  ds_read2_b32 v[40:41], v0 offset0:0 offset1:78
  ds_read2_b32 v[42:43], v0 offset0:156 offset1:234
  v_add_u32 v0, 12480, v6
  v_cvt_pk_bf16_f32 v68, v68, v69
  v_rcp_f16 v11, v10
  v_mfma_f32_32x32x16_bf16 v[192:207], v[36:39], v[88:91], v[192:207]
  s_waitcnt lgkmcnt(9)
  ds_read_b64_tr_b16 v[28:29], v1 offset:33792
  ds_read2_b32 v[44:45], v0 offset0:0 offset1:78
  ds_read2_b32 v[46:47], v0 offset0:156 offset1:234
  v_or_b32 v49, v50, v51
  v_lshlrev_b32_sdwa v69, 1, v68 dst_sel:DWORD dst_unused:UNUSED_PAD src0_sel:DWORD src1_sel:WORD_1
  v_lshlrev_b32_sdwa v68, 1, v68 dst_sel:DWORD dst_unused:UNUSED_PAD src0_sel:DWORD src1_sel:WORD_0
  v_mfma_f32_32x32x16_bf16 v[240:255], v[36:39], v[104:107], v[240:255]
  ds_read_b64_tr_b16 v[30:31], v1 offset:34048
  ds_read_u16_d16_hi v69, v69 offset:36864
  ds_read_u16_d16 v68, v68 offset:36864
  v_rcp_f16_sdwa v9, v8 dst_sel:WORD_1 dst_unused:UNUSED_PRESERVE src0_sel:WORD_1
  v_rcp_f16_sdwa v11, v10 dst_sel:WORD_1 dst_unused:UNUSED_PRESERVE src0_sel:WORD_1
  v_mfma_f32_32x32x16_bf16 v[80:95], v[16:19], v[112:115], 0
  s_waitcnt lgkmcnt(12)
  ds_read_b64_tr_b16 v[32:33], v1 offset:34816
  v_cvt_pk_bf16_f32 v54, v54, v55
  v_or_b32 v65, v66, v67
  v_lshlrev_b32_sdwa v55, 1, v54 dst_sel:DWORD dst_unused:UNUSED_PAD src0_sel:DWORD src1_sel:WORD_1
  v_lshlrev_b32_sdwa v54, 1, v54 dst_sel:DWORD dst_unused:UNUSED_PAD src0_sel:DWORD src1_sel:WORD_0
  v_fma_mix_f32 v60, v60, v9, 0 op_sel_hi:[0,1,0]
  v_mfma_f32_32x32x16_bf16 v[96:111], v[16:19], v[136:139], 0
  s_waitcnt lgkmcnt(12)
  ds_read_b64_tr_b16 v[34:35], v1 offset:35072
  ds_read_u16_d16_hi v55, v55 offset:36864
  ds_read_u16_d16 v54, v54 offset:36864
  v_fma_mix_f32 v76, v76, v11, 0 op_sel_hi:[0,1,0]
  v_fma_mix_f32 v61, v61, v9, 0 op_sel:[0,1,0] op_sel_hi:[0,1,0]
  v_cvt_pk_bf16_f32 v70, v70, v71
  v_fma_mix_f32 v77, v77, v11, 0 op_sel:[0,1,0] op_sel_hi:[0,1,0]
  v_mfma_f32_32x32x16_bf16 v[80:95], v[20:23], v[116:119], v[80:95]
  s_waitcnt lgkmcnt(13)
  ds_read_b64_tr_b16 v[36:37], v1 offset:35840
  v_or_b32 v50, v52, v53
  v_lshlrev_b32_sdwa v71, 1, v70 dst_sel:DWORD dst_unused:UNUSED_PAD src0_sel:DWORD src1_sel:WORD_1
  v_lshlrev_b32_sdwa v70, 1, v70 dst_sel:DWORD dst_unused:UNUSED_PAD src0_sel:DWORD src1_sel:WORD_0
  v_mul_f32 v62, s37, v62
  v_mul_f32 v78, s37, v78
  v_cvt_pk_bf16_f32 v56, v56, v57
  v_mfma_f32_32x32x16_bf16 v[96:111], v[20:23], v[140:143], v[96:111]
  s_waitcnt lgkmcnt(5)
  ds_read_b64_tr_b16 v[38:39], v1 offset:36096
  ds_read_u16_d16_hi v71, v71 offset:36864
  ds_read_u16_d16 v70, v70 offset:36864
  v_mul_f32 v63, s37, v63
  v_or_b32 v66, v68, v69
  v_lshlrev_b32_sdwa v57, 1, v56 dst_sel:DWORD dst_unused:UNUSED_PAD src0_sel:DWORD src1_sel:WORD_1
  v_mfma_f32_32x32x16_bf16 v[80:95], v[24:27], v[120:123], v[80:95]
  ds_read_u16_d16_hi v57, v57 offset:36864
  v_lshlrev_b32_sdwa v56, 1, v56 dst_sel:DWORD dst_unused:UNUSED_PAD src0_sel:DWORD src1_sel:WORD_0
  v_mul_f32 v79, s37, v79
  v_cvt_pk_f16_f32 v8, v62, v63
  v_cvt_pk_f16_f32 v10, v78, v79
  v_cvt_pk_bf16_f32 v72, v72, v73
  v_pk_fma_f16 v9, v8, v8, s56
  v_mfma_f32_32x32x16_bf16 v[96:111], v[24:27], v[144:147], v[96:111]
  s_waitcnt lgkmcnt(5)
  ds_read_u16_d16 v56, v56 offset:36864
  v_or_b32 v51, v54, v55
  v_lshlrev_b32_sdwa v73, 1, v72 dst_sel:DWORD dst_unused:UNUSED_PAD src0_sel:DWORD src1_sel:WORD_1
  v_lshlrev_b32_sdwa v72, 1, v72 dst_sel:DWORD dst_unused:UNUSED_PAD src0_sel:DWORD src1_sel:WORD_0
  v_pk_fma_f16 v11, v10, v10, s56
  v_pk_mul_f16 v9, v8, v9 neg_lo:[0,1] neg_hi:[0,1]
  v_pk_mul_f16 v11, v10, v11 neg_lo:[0,1] neg_hi:[0,1]
  v_smfmac_f32_32x32x32_bf16 v[240:255], v[12:15], v[40:47], v5
  s_waitcnt lgkmcnt(4)
  s_barrier
  ds_read_b64_tr_b16 v[16:17], v7 offset:0
  ds_read_b64_tr_b16 v[18:19], v7 offset:1536
  ds_read_u16_d16_hi v73, v73 offset:36864
  v_exp_f16 v8, v9
  v_mfma_f32_32x32x16_bf16 v[80:95], v[28:31], v[124:127], v[80:95]
  s_waitcnt lgkmcnt(5)
  ds_read_b64_tr_b16 v[20:21], v7 offset:64
  ds_read_u16_d16 v72, v72 offset:36864
  v_cvt_pk_bf16_f32 v58, v58, v59
  v_or_b32 v67, v70, v71
  v_lshlrev_b32_sdwa v59, 1, v58 dst_sel:DWORD dst_unused:UNUSED_PAD src0_sel:DWORD src1_sel:WORD_1
  v_lshlrev_b32_sdwa v58, 1, v58 dst_sel:DWORD dst_unused:UNUSED_PAD src0_sel:DWORD src1_sel:WORD_0
  v_mfma_f32_32x32x16_bf16 v[96:111], v[28:31], v[148:151], v[96:111]
  ds_read_b64_tr_b16 v[22:23], v7 offset:1600
  ds_read_u16_d16_hi v59, v59 offset:36864
  ds_read_u16_d16 v58, v58 offset:36864
  v_exp_f16 v10, v11
  v_exp_f16_sdwa v8, v9 dst_sel:WORD_1 dst_unused:UNUSED_PRESERVE src0_sel:WORD_1
  v_mfma_f32_32x32x16_bf16 v[80:95], v[32:35], v[128:131], v[80:95]
  s_waitcnt lgkmcnt(8)
  ds_read_b64_tr_b16 v[24:25], v7 offset:3072
  v_cvt_pk_bf16_f32 v74, v74, v75
  v_or_b32 v56, v56, v57
  v_lshlrev_b32_sdwa v75, 1, v74 dst_sel:DWORD dst_unused:UNUSED_PAD src0_sel:DWORD src1_sel:WORD_1
  v_lshlrev_b32_sdwa v74, 1, v74 dst_sel:DWORD dst_unused:UNUSED_PAD src0_sel:DWORD src1_sel:WORD_0
  v_exp_f16_sdwa v10, v11 dst_sel:WORD_1 dst_unused:UNUSED_PRESERVE src0_sel:WORD_1
  v_mfma_f32_32x32x16_bf16 v[96:111], v[32:35], v[152:155], v[96:111]
  ds_read_b64_tr_b16 v[26:27], v7 offset:4608
  ds_read_u16_d16_hi v75, v75 offset:36864
  ds_read_u16_d16 v74, v74 offset:36864
  v_pk_fma_f16 v8, v8, s57, s57
  v_pk_fma_f16 v10, v10, s57, s57
  v_rcp_f16 v9, v8
  v_mfma_f32_32x32x16_bf16 v[80:95], v[36:39], v[132:135], v[80:95]
  s_waitcnt lgkmcnt(7)
  ds_read_b64_tr_b16 v[28:29], v7 offset:3136
  v_or_b32 v72, v72, v73
  v_rcp_f16 v11, v10
  v_rcp_f16_sdwa v9, v8 dst_sel:WORD_1 dst_unused:UNUSED_PRESERVE src0_sel:WORD_1
  v_mfma_f32_32x32x16_bf16 v[96:111], v[36:39], v[156:159], v[96:111]
  s_waitcnt lgkmcnt(5)
  ds_read_b64_tr_b16 v[30:31], v7 offset:4672
  v_or_b32 v57, v58, v59
  v_cvt_pk_bf16_f32 v58, v60, v61
  v_rcp_f16_sdwa v11, v10 dst_sel:WORD_1 dst_unused:UNUSED_PRESERVE src0_sel:WORD_1
  v_fma_mix_f32 v62, v62, v9, 0 op_sel_hi:[0,1,0]
L_mloop:
  v_mfma_f32_32x32x16_bf16 v[160:175], v[16:19], v[48:51], v[160:175]
  s_waitcnt lgkmcnt(2)
  ds_read_b64_tr_b16 v[32:33], v7 offset:128
  v_fma_mix_f32 v78, v78, v11, 0 op_sel_hi:[0,1,0]
  v_or_b32 v73, v74, v75
  v_cvt_pk_bf16_f32 v74, v76, v77
  v_fma_mix_f32 v63, v63, v9, 0 op_sel:[0,1,0] op_sel_hi:[0,1,0]
  v_fma_mix_f32 v79, v79, v11, 0 op_sel:[0,1,0] op_sel_hi:[0,1,0]
  v_cvt_pk_bf16_f32 v59, v62, v63
  v_mfma_f32_32x32x16_bf16 v[208:223], v[16:19], v[64:67], v[208:223]
  ds_read_b64_tr_b16 v[34:35], v7 offset:1664
  v_cvt_pk_bf16_f32 v75, v78, v79
  v_cvt_pk_bf16_f32 v80, v80, v81
  v_lshlrev_b32_sdwa v81, 1, v80 dst_sel:DWORD dst_unused:UNUSED_PAD src0_sel:DWORD src1_sel:WORD_1
  v_lshlrev_b32_sdwa v80, 1, v80 dst_sel:DWORD dst_unused:UNUSED_PAD src0_sel:DWORD src1_sel:WORD_0
  v_mul_f32 v92, s37, v92
  v_mul_f32 v108, s37, v108
  v_mfma_f32_32x32x16_bf16 v[176:191], v[20:23], v[48:51], v[176:191]
  ds_read_b64_tr_b16 v[36:37], v7 offset:3200
  ds_read_u16_d16_hi v81, v81 offset:36864
  ds_read_u16_d16 v80, v80 offset:36864
  v_mul_f32 v93, s37, v93
  v_mul_f32 v109, s37, v109
  v_cvt_pk_bf16_f32 v96, v96, v97
  v_lshlrev_b32_sdwa v97, 1, v96 dst_sel:DWORD dst_unused:UNUSED_PAD src0_sel:DWORD src1_sel:WORD_1
  v_mfma_f32_32x32x16_bf16 v[224:239], v[20:23], v[64:67], v[224:239]
  ds_read_b64_tr_b16 v[38:39], v7 offset:4736
  ds_read_u16_d16_hi v97, v97 offset:36864
  v_lshlrev_b32_sdwa v96, 1, v96 dst_sel:DWORD dst_unused:UNUSED_PAD src0_sel:DWORD src1_sel:WORD_0
  v_cvt_pk_f16_f32 v8, v92, v93
  v_cvt_pk_f16_f32 v10, v108, v109
  v_pk_fma_f16 v9, v8, v8, s56
  v_pk_fma_f16 v11, v10, v10, s56
  v_mfma_f32_32x32x16_bf16 v[160:175], v[24:27], v[56:59], v[160:175]
  ds_read_b64_tr_b16 v[16:17], v1 offset:6144
  ds_read_u16_d16 v96, v96 offset:36864
  v_cvt_pk_bf16_f32 v82, v82, v83
  v_pk_mul_f16 v9, v8, v9 neg_lo:[0,1] neg_hi:[0,1]
  v_lshlrev_b32_sdwa v83, 1, v82 dst_sel:DWORD dst_unused:UNUSED_PAD src0_sel:DWORD src1_sel:WORD_1
  v_lshlrev_b32_sdwa v82, 1, v82 dst_sel:DWORD dst_unused:UNUSED_PAD src0_sel:DWORD src1_sel:WORD_0
  v_pk_mul_f16 v11, v10, v11 neg_lo:[0,1] neg_hi:[0,1]
  v_mfma_f32_32x32x16_bf16 v[208:223], v[24:27], v[72:75], v[208:223]
  s_waitcnt lgkmcnt(9)
  ds_read_b64_tr_b16 v[18:19], v1 offset:6400
  ds_read_u16_d16_hi v83, v83 offset:36864
  ds_read_u16_d16 v82, v82 offset:36864
  v_exp_f16 v8, v9
  v_exp_f16 v10, v11
  v_mfma_f32_32x32x16_bf16 v[176:191], v[28:31], v[56:59], v[176:191]
  s_waitcnt lgkmcnt(7)
  ds_read_b64_tr_b16 v[20:21], v1 offset:7168
  v_cvt_pk_bf16_f32 v98, v98, v99
  v_or_b32 v80, v80, v81
  v_lshlrev_b32_sdwa v99, 1, v98 dst_sel:DWORD dst_unused:UNUSED_PAD src0_sel:DWORD src1_sel:WORD_1
  v_lshlrev_b32_sdwa v98, 1, v98 dst_sel:DWORD dst_unused:UNUSED_PAD src0_sel:DWORD src1_sel:WORD_0
  v_exp_f16_sdwa v8, v9 dst_sel:WORD_1 dst_unused:UNUSED_PRESERVE src0_sel:WORD_1
  v_mfma_f32_32x32x16_bf16 v[224:239], v[28:31], v[72:75], v[224:239]
  ds_read_b64_tr_b16 v[22:23], v1 offset:7424
  ds_read_u16_d16_hi v99, v99 offset:36864
  ds_read_u16_d16 v98, v98 offset:36864
  v_exp_f16_sdwa v10, v11 dst_sel:WORD_1 dst_unused:UNUSED_PRESERVE src0_sel:WORD_1
  v_cvt_pk_bf16_f32 v84, v84, v85
  v_mfma_f32_32x32x16_bf16 v[192:207], v[32:35], v[48:51], v[192:207]
  s_waitcnt lgkmcnt(7)
  ds_read_b64_tr_b16 v[24:25], v1 offset:8192
  v_or_b32 v96, v96, v97
  v_lshlrev_b32_sdwa v85, 1, v84 dst_sel:DWORD dst_unused:UNUSED_PAD src0_sel:DWORD src1_sel:WORD_1
  v_lshlrev_b32_sdwa v84, 1, v84 dst_sel:DWORD dst_unused:UNUSED_PAD src0_sel:DWORD src1_sel:WORD_0
  v_pk_fma_f16 v8, v8, s57, s57
  v_pk_fma_f16 v10, v10, s57, s57
  v_rcp_f16 v9, v8
  v_mfma_f32_32x32x16_bf16 v[240:255], v[32:35], v[64:67], v[240:255]
  ds_read_b64_tr_b16 v[26:27], v1 offset:8448
  ds_read_u16_d16_hi v85, v85 offset:36864
  ds_read_u16_d16 v84, v84 offset:36864
  v_cvt_pk_bf16_f32 v100, v100, v101
  v_rcp_f16 v11, v10
  v_mfma_f32_32x32x16_bf16 v[192:207], v[36:39], v[56:59], v[192:207]
  s_waitcnt lgkmcnt(8)
  ds_read_b64_tr_b16 v[28:29], v1 offset:9216
  v_or_b32 v81, v82, v83
  v_lshlrev_b32_sdwa v101, 1, v100 dst_sel:DWORD dst_unused:UNUSED_PAD src0_sel:DWORD src1_sel:WORD_1
  v_lshlrev_b32_sdwa v100, 1, v100 dst_sel:DWORD dst_unused:UNUSED_PAD src0_sel:DWORD src1_sel:WORD_0
  v_rcp_f16_sdwa v9, v8 dst_sel:WORD_1 dst_unused:UNUSED_PRESERVE src0_sel:WORD_1
  v_rcp_f16_sdwa v11, v10 dst_sel:WORD_1 dst_unused:UNUSED_PRESERVE src0_sel:WORD_1
  v_mfma_f32_32x32x16_bf16 v[240:255], v[36:39], v[72:75], v[240:255]
  s_waitcnt lgkmcnt(5)
  ds_read_b64_tr_b16 v[30:31], v1 offset:9472
  ds_read_u16_d16_hi v101, v101 offset:36864
  ds_read_u16_d16 v100, v100 offset:36864
  v_cvt_pk_bf16_f32 v86, v86, v87
  v_or_b32 v97, v98, v99
  v_mfma_f32_32x32x16_bf16 v[48:63], v[16:19], v[112:115], 0
  ds_read_b64_tr_b16 v[32:33], v1 offset:10240
  v_lshlrev_b32_sdwa v87, 1, v86 dst_sel:DWORD dst_unused:UNUSED_PAD src0_sel:DWORD src1_sel:WORD_1
  v_lshlrev_b32_sdwa v86, 1, v86 dst_sel:DWORD dst_unused:UNUSED_PAD src0_sel:DWORD src1_sel:WORD_0
  v_fma_mix_f32 v92, v92, v9, 0 op_sel_hi:[0,1,0]
  v_fma_mix_f32 v108, v108, v11, 0 op_sel_hi:[0,1,0]
  v_fma_mix_f32 v93, v93, v9, 0 op_sel:[0,1,0] op_sel_hi:[0,1,0]
  v_cvt_pk_bf16_f32 v102, v102, v103
  v_mfma_f32_32x32x16_bf16 v[64:79], v[16:19], v[136:139], 0
  s_waitcnt lgkmcnt(5)
  ds_read_b64_tr_b16 v[34:35], v1 offset:10496
  ds_read_u16_d16_hi v87, v87 offset:36864
  ds_read_u16_d16 v86, v86 offset:36864
  v_fma_mix_f32 v109, v109, v11, 0 op_sel:[0,1,0] op_sel_hi:[0,1,0]
  v_or_b32 v82, v84, v85
  v_lshlrev_b32_sdwa v103, 1, v102 dst_sel:DWORD dst_unused:UNUSED_PAD src0_sel:DWORD src1_sel:WORD_1
  v_lshlrev_b32_sdwa v102, 1, v102 dst_sel:DWORD dst_unused:UNUSED_PAD src0_sel:DWORD src1_sel:WORD_0
  v_mfma_f32_32x32x16_bf16 v[48:63], v[20:23], v[116:119], v[48:63]
  ds_read_b64_tr_b16 v[36:37], v1 offset:11264
  ds_read_u16_d16_hi v103, v103 offset:36864
  ds_read_u16_d16 v102, v102 offset:36864
  v_mul_f32 v94, s37, v94
  v_mul_f32 v110, s37, v110
  v_cvt_pk_bf16_f32 v88, v88, v89
  v_mul_f32 v95, s37, v95
  v_mfma_f32_32x32x16_bf16 v[64:79], v[20:23], v[140:143], v[64:79]
  s_waitcnt lgkmcnt(7)
  ds_read_b64_tr_b16 v[38:39], v1 offset:11520
  v_or_b32 v98, v100, v101
  v_lshlrev_b32_sdwa v89, 1, v88 dst_sel:DWORD dst_unused:UNUSED_PAD src0_sel:DWORD src1_sel:WORD_1
  v_lshlrev_b32_sdwa v88, 1, v88 dst_sel:DWORD dst_unused:UNUSED_PAD src0_sel:DWORD src1_sel:WORD_0
  v_mul_f32 v111, s37, v111
  v_cvt_pk_f16_f32 v8, v94, v95
  v_cvt_pk_f16_f32 v10, v110, v111
  v_mfma_f32_32x32x16_bf16 v[48:63], v[24:27], v[120:123], v[48:63]
  s_waitcnt lgkmcnt(4)
  ds_read_u16_d16_hi v89, v89 offset:36864
  ds_read_u16_d16 v88, v88 offset:36864
  v_cvt_pk_bf16_f32 v104, v104, v105
  v_pk_fma_f16 v9, v8, v8, s56
  v_or_b32 v83, v86, v87
  v_lshlrev_b32_sdwa v105, 1, v104 dst_sel:DWORD dst_unused:UNUSED_PAD src0_sel:DWORD src1_sel:WORD_1
  v_lshlrev_b32_sdwa v104, 1, v104 dst_sel:DWORD dst_unused:UNUSED_PAD src0_sel:DWORD src1_sel:WORD_0
  v_mfma_f32_32x32x16_bf16 v[64:79], v[24:27], v[144:147], v[64:79]
  ds_read_u16_d16_hi v105, v105 offset:36864
  ds_read_u16_d16 v104, v104 offset:36864
  v_pk_fma_f16 v11, v10, v10, s56
  v_pk_mul_f16 v9, v8, v9 neg_lo:[0,1] neg_hi:[0,1]
  v_pk_mul_f16 v11, v10, v11 neg_lo:[0,1] neg_hi:[0,1]
  v_exp_f16 v8, v9
  v_mfma_f32_32x32x16_bf16 v[48:63], v[28:31], v[124:127], v[48:63]
  s_waitcnt lgkmcnt(4)
  s_barrier
  ds_read_b64_tr_b16 v[16:17], v7 offset:12288
  ds_read_b64_tr_b16 v[18:19], v7 offset:13824
  v_cvt_pk_bf16_f32 v90, v90, v91
  v_or_b32 v99, v102, v103
  v_lshlrev_b32_sdwa v91, 1, v90 dst_sel:DWORD dst_unused:UNUSED_PAD src0_sel:DWORD src1_sel:WORD_1
  v_mfma_f32_32x32x16_bf16 v[64:79], v[28:31], v[148:151], v[64:79]
  ds_read_b64_tr_b16 v[20:21], v7 offset:12352
  ds_read_b64_tr_b16 v[22:23], v7 offset:13888
  ds_read_u16_d16_hi v91, v91 offset:36864
  v_lshlrev_b32_sdwa v90, 1, v90 dst_sel:DWORD dst_unused:UNUSED_PAD src0_sel:DWORD src1_sel:WORD_0
  v_exp_f16 v10, v11
  v_exp_f16_sdwa v8, v9 dst_sel:WORD_1 dst_unused:UNUSED_PRESERVE src0_sel:WORD_1
  v_mfma_f32_32x32x16_bf16 v[48:63], v[32:35], v[128:131], v[48:63]
  s_waitcnt lgkmcnt(7)
  ds_read_b64_tr_b16 v[24:25], v7 offset:15360
  ds_read_u16_d16 v90, v90 offset:36864
  v_cvt_pk_bf16_f32 v106, v106, v107
  v_or_b32 v88, v88, v89
  v_lshlrev_b32_sdwa v107, 1, v106 dst_sel:DWORD dst_unused:UNUSED_PAD src0_sel:DWORD src1_sel:WORD_1
  v_lshlrev_b32_sdwa v106, 1, v106 dst_sel:DWORD dst_unused:UNUSED_PAD src0_sel:DWORD src1_sel:WORD_0
  v_mfma_f32_32x32x16_bf16 v[64:79], v[32:35], v[152:155], v[64:79]
  ds_read_b64_tr_b16 v[26:27], v7 offset:16896
  ds_read_u16_d16_hi v107, v107 offset:36864
  ds_read_u16_d16 v106, v106 offset:36864
  v_exp_f16_sdwa v10, v11 dst_sel:WORD_1 dst_unused:UNUSED_PRESERVE src0_sel:WORD_1
  v_pk_fma_f16 v8, v8, s57, s57
  v_pk_fma_f16 v10, v10, s57, s57
  v_mfma_f32_32x32x16_bf16 v[48:63], v[36:39], v[132:135], v[48:63]
  s_waitcnt lgkmcnt(10)
  ds_read_b64_tr_b16 v[28:29], v7 offset:15424
  v_rcp_f16 v9, v8
  v_or_b32 v104, v104, v105
  v_rcp_f16 v11, v10
  v_rcp_f16_sdwa v9, v8 dst_sel:WORD_1 dst_unused:UNUSED_PRESERVE src0_sel:WORD_1
  v_mfma_f32_32x32x16_bf16 v[64:79], v[36:39], v[156:159], v[64:79]
  s_waitcnt lgkmcnt(4)
  ds_read_b64_tr_b16 v[30:31], v7 offset:16960
  v_or_b32 v89, v90, v91
  v_cvt_pk_bf16_f32 v90, v92, v93
  v_rcp_f16_sdwa v11, v10 dst_sel:WORD_1 dst_unused:UNUSED_PRESERVE src0_sel:WORD_1
  v_fma_mix_f32 v94, v94, v9, 0 op_sel_hi:[0,1,0]
  v_mfma_f32_32x32x16_bf16 v[160:175], v[16:19], v[80:83], v[160:175]
  s_waitcnt lgkmcnt(2)
  ds_read_b64_tr_b16 v[32:33], v7 offset:12416
  v_fma_mix_f32 v110, v110, v11, 0 op_sel_hi:[0,1,0]
  v_or_b32 v105, v106, v107
  v_cvt_pk_bf16_f32 v106, v108, v109
  v_fma_mix_f32 v95, v95, v9, 0 op_sel:[0,1,0] op_sel_hi:[0,1,0]
  v_fma_mix_f32 v111, v111, v11, 0 op_sel:[0,1,0] op_sel_hi:[0,1,0]
  v_cvt_pk_bf16_f32 v91, v94, v95
  v_mfma_f32_32x32x16_bf16 v[208:223], v[16:19], v[96:99], v[208:223]
  ds_read_b64_tr_b16 v[34:35], v7 offset:13952
  v_cvt_pk_bf16_f32 v107, v110, v111
  v_cvt_pk_bf16_f32 v48, v48, v49
  v_lshlrev_b32_sdwa v49, 1, v48 dst_sel:DWORD dst_unused:UNUSED_PAD src0_sel:DWORD src1_sel:WORD_1
  v_lshlrev_b32_sdwa v48, 1, v48 dst_sel:DWORD dst_unused:UNUSED_PAD src0_sel:DWORD src1_sel:WORD_0
  v_mul_f32 v60, s37, v60
  v_mul_f32 v76, s37, v76
  v_mfma_f32_32x32x16_bf16 v[176:191], v[20:23], v[80:83], v[176:191]
  ds_read_b64_tr_b16 v[36:37], v7 offset:15488
  ds_read_u16_d16_hi v49, v49 offset:36864
  ds_read_u16_d16 v48, v48 offset:36864
  v_mul_f32 v61, s37, v61
  v_mul_f32 v77, s37, v77
  v_cvt_pk_bf16_f32 v64, v64, v65
  v_lshlrev_b32_sdwa v65, 1, v64 dst_sel:DWORD dst_unused:UNUSED_PAD src0_sel:DWORD src1_sel:WORD_1
  v_mfma_f32_32x32x16_bf16 v[224:239], v[20:23], v[96:99], v[224:239]
  ds_read_b64_tr_b16 v[38:39], v7 offset:17024
  ds_read_u16_d16_hi v65, v65 offset:36864
  v_lshlrev_b32_sdwa v64, 1, v64 dst_sel:DWORD dst_unused:UNUSED_PAD src0_sel:DWORD src1_sel:WORD_0
  v_cvt_pk_f16_f32 v8, v60, v61
  v_cvt_pk_f16_f32 v10, v76, v77
  v_pk_fma_f16 v9, v8, v8, s56
  v_pk_fma_f16 v11, v10, v10, s56
  v_mfma_f32_32x32x16_bf16 v[160:175], v[24:27], v[88:91], v[160:175]
  ds_read_b64_tr_b16 v[16:17], v1 offset:18432
  ds_read_u16_d16 v64, v64 offset:36864
  v_cvt_pk_bf16_f32 v50, v50, v51
  v_pk_mul_f16 v9, v8, v9 neg_lo:[0,1] neg_hi:[0,1]
  v_lshlrev_b32_sdwa v51, 1, v50 dst_sel:DWORD dst_unused:UNUSED_PAD src0_sel:DWORD src1_sel:WORD_1
  v_lshlrev_b32_sdwa v50, 1, v50 dst_sel:DWORD dst_unused:UNUSED_PAD src0_sel:DWORD src1_sel:WORD_0
  v_pk_mul_f16 v11, v10, v11 neg_lo:[0,1] neg_hi:[0,1]
  v_mfma_f32_32x32x16_bf16 v[208:223], v[24:27], v[104:107], v[208:223]
  s_waitcnt lgkmcnt(9)
  ds_read_b64_tr_b16 v[18:19], v1 offset:18688
  ds_read_u16_d16_hi v51, v51 offset:36864
  ds_read_u16_d16 v50, v50 offset:36864
  v_exp_f16 v8, v9
  v_exp_f16 v10, v11
  v_mfma_f32_32x32x16_bf16 v[176:191], v[28:31], v[88:91], v[176:191]
  s_waitcnt lgkmcnt(7)
  ds_read_b64_tr_b16 v[20:21], v1 offset:19456
  v_cvt_pk_bf16_f32 v66, v66, v67
  v_or_b32 v48, v48, v49
  v_lshlrev_b32_sdwa v67, 1, v66 dst_sel:DWORD dst_unused:UNUSED_PAD src0_sel:DWORD src1_sel:WORD_1
  v_lshlrev_b32_sdwa v66, 1, v66 dst_sel:DWORD dst_unused:UNUSED_PAD src0_sel:DWORD src1_sel:WORD_0
  v_exp_f16_sdwa v8, v9 dst_sel:WORD_1 dst_unused:UNUSED_PRESERVE src0_sel:WORD_1
  v_mfma_f32_32x32x16_bf16 v[224:239], v[28:31], v[104:107], v[224:239]
  ds_read_b64_tr_b16 v[22:23], v1 offset:19712
  ds_read_u16_d16_hi v67, v67 offset:36864
  ds_read_u16_d16 v66, v66 offset:36864
  v_exp_f16_sdwa v10, v11 dst_sel:WORD_1 dst_unused:UNUSED_PRESERVE src0_sel:WORD_1
  v_cvt_pk_bf16_f32 v52, v52, v53
  v_mfma_f32_32x32x16_bf16 v[192:207], v[32:35], v[80:83], v[192:207]
  s_waitcnt lgkmcnt(7)
  ds_read_b64_tr_b16 v[24:25], v1 offset:20480
  v_or_b32 v64, v64, v65
  v_lshlrev_b32_sdwa v53, 1, v52 dst_sel:DWORD dst_unused:UNUSED_PAD src0_sel:DWORD src1_sel:WORD_1
  v_lshlrev_b32_sdwa v52, 1, v52 dst_sel:DWORD dst_unused:UNUSED_PAD src0_sel:DWORD src1_sel:WORD_0
  v_pk_fma_f16 v8, v8, s57, s57
  v_pk_fma_f16 v10, v10, s57, s57
  v_rcp_f16 v9, v8
  v_mfma_f32_32x32x16_bf16 v[240:255], v[32:35], v[96:99], v[240:255]
  ds_read_b64_tr_b16 v[26:27], v1 offset:20736
  ds_read_u16_d16_hi v53, v53 offset:36864
  ds_read_u16_d16 v52, v52 offset:36864
  v_cvt_pk_bf16_f32 v68, v68, v69
  v_rcp_f16 v11, v10
  v_mfma_f32_32x32x16_bf16 v[192:207], v[36:39], v[88:91], v[192:207]
  s_waitcnt lgkmcnt(8)
  ds_read_b64_tr_b16 v[28:29], v1 offset:21504
  v_or_b32 v49, v50, v51
  v_lshlrev_b32_sdwa v69, 1, v68 dst_sel:DWORD dst_unused:UNUSED_PAD src0_sel:DWORD src1_sel:WORD_1
  v_lshlrev_b32_sdwa v68, 1, v68 dst_sel:DWORD dst_unused:UNUSED_PAD src0_sel:DWORD src1_sel:WORD_0
  v_rcp_f16_sdwa v9, v8 dst_sel:WORD_1 dst_unused:UNUSED_PRESERVE src0_sel:WORD_1
  v_rcp_f16_sdwa v11, v10 dst_sel:WORD_1 dst_unused:UNUSED_PRESERVE src0_sel:WORD_1
  v_mfma_f32_32x32x16_bf16 v[240:255], v[36:39], v[104:107], v[240:255]
  s_waitcnt lgkmcnt(5)
  ds_read_b64_tr_b16 v[30:31], v1 offset:21760
  ds_read_u16_d16_hi v69, v69 offset:36864
  ds_read_u16_d16 v68, v68 offset:36864
  v_cvt_pk_bf16_f32 v54, v54, v55
  v_or_b32 v65, v66, v67
  v_mfma_f32_32x32x16_bf16 v[80:95], v[16:19], v[112:115], 0
  ds_read_b64_tr_b16 v[32:33], v1 offset:22528
  v_lshlrev_b32_sdwa v55, 1, v54 dst_sel:DWORD dst_unused:UNUSED_PAD src0_sel:DWORD src1_sel:WORD_1
  v_lshlrev_b32_sdwa v54, 1, v54 dst_sel:DWORD dst_unused:UNUSED_PAD src0_sel:DWORD src1_sel:WORD_0
  v_fma_mix_f32 v60, v60, v9, 0 op_sel_hi:[0,1,0]
  v_fma_mix_f32 v76, v76, v11, 0 op_sel_hi:[0,1,0]
  v_fma_mix_f32 v61, v61, v9, 0 op_sel:[0,1,0] op_sel_hi:[0,1,0]
  v_cvt_pk_bf16_f32 v70, v70, v71
  v_mfma_f32_32x32x16_bf16 v[96:111], v[16:19], v[136:139], 0
  s_waitcnt lgkmcnt(5)
  ds_read_b64_tr_b16 v[34:35], v1 offset:22784
  ds_read_u16_d16_hi v55, v55 offset:36864
  ds_read_u16_d16 v54, v54 offset:36864
  v_fma_mix_f32 v77, v77, v11, 0 op_sel:[0,1,0] op_sel_hi:[0,1,0]
  v_or_b32 v50, v52, v53
  v_lshlrev_b32_sdwa v71, 1, v70 dst_sel:DWORD dst_unused:UNUSED_PAD src0_sel:DWORD src1_sel:WORD_1
  v_lshlrev_b32_sdwa v70, 1, v70 dst_sel:DWORD dst_unused:UNUSED_PAD src0_sel:DWORD src1_sel:WORD_0
  v_mfma_f32_32x32x16_bf16 v[80:95], v[20:23], v[116:119], v[80:95]
  ds_read_b64_tr_b16 v[36:37], v1 offset:23552
  ds_read_u16_d16_hi v71, v71 offset:36864
  ds_read_u16_d16 v70, v70 offset:36864
  v_mul_f32 v62, s37, v62
  v_mul_f32 v78, s37, v78
  v_cvt_pk_bf16_f32 v56, v56, v57
  v_mul_f32 v63, s37, v63
  v_mfma_f32_32x32x16_bf16 v[96:111], v[20:23], v[140:143], v[96:111]
  s_waitcnt lgkmcnt(7)
  ds_read_b64_tr_b16 v[38:39], v1 offset:23808
  v_or_b32 v66, v68, v69
  v_lshlrev_b32_sdwa v57, 1, v56 dst_sel:DWORD dst_unused:UNUSED_PAD src0_sel:DWORD src1_sel:WORD_1
  v_lshlrev_b32_sdwa v56, 1, v56 dst_sel:DWORD dst_unused:UNUSED_PAD src0_sel:DWORD src1_sel:WORD_0
  v_mul_f32 v79, s37, v79
  v_cvt_pk_f16_f32 v8, v62, v63
  v_cvt_pk_f16_f32 v10, v78, v79
  v_mfma_f32_32x32x16_bf16 v[80:95], v[24:27], v[120:123], v[80:95]
  s_waitcnt lgkmcnt(4)
  ds_read_u16_d16_hi v57, v57 offset:36864
  ds_read_u16_d16 v56, v56 offset:36864
  v_cvt_pk_bf16_f32 v72, v72, v73
  v_pk_fma_f16 v9, v8, v8, s56
  v_or_b32 v51, v54, v55
  v_lshlrev_b32_sdwa v73, 1, v72 dst_sel:DWORD dst_unused:UNUSED_PAD src0_sel:DWORD src1_sel:WORD_1
  v_lshlrev_b32_sdwa v72, 1, v72 dst_sel:DWORD dst_unused:UNUSED_PAD src0_sel:DWORD src1_sel:WORD_0
  v_mfma_f32_32x32x16_bf16 v[96:111], v[24:27], v[144:147], v[96:111]
  ds_read_u16_d16_hi v73, v73 offset:36864
  ds_read_u16_d16 v72, v72 offset:36864
  v_pk_fma_f16 v11, v10, v10, s56
  v_pk_mul_f16 v9, v8, v9 neg_lo:[0,1] neg_hi:[0,1]
  v_pk_mul_f16 v11, v10, v11 neg_lo:[0,1] neg_hi:[0,1]
  v_exp_f16 v8, v9
  v_mfma_f32_32x32x16_bf16 v[80:95], v[28:31], v[124:127], v[80:95]
  s_waitcnt lgkmcnt(4)
  s_barrier
  ds_read_b64_tr_b16 v[16:17], v7 offset:24576
  ds_read_b64_tr_b16 v[18:19], v7 offset:26112
  v_cvt_pk_bf16_f32 v58, v58, v59
  v_or_b32 v67, v70, v71
  v_lshlrev_b32_sdwa v59, 1, v58 dst_sel:DWORD dst_unused:UNUSED_PAD src0_sel:DWORD src1_sel:WORD_1
  v_mfma_f32_32x32x16_bf16 v[96:111], v[28:31], v[148:151], v[96:111]
  ds_read_b64_tr_b16 v[20:21], v7 offset:24640
  ds_read_b64_tr_b16 v[22:23], v7 offset:26176
  ds_read_u16_d16_hi v59, v59 offset:36864
  v_lshlrev_b32_sdwa v58, 1, v58 dst_sel:DWORD dst_unused:UNUSED_PAD src0_sel:DWORD src1_sel:WORD_0
  v_exp_f16 v10, v11
  v_exp_f16_sdwa v8, v9 dst_sel:WORD_1 dst_unused:UNUSED_PRESERVE src0_sel:WORD_1
  v_mfma_f32_32x32x16_bf16 v[80:95], v[32:35], v[128:131], v[80:95]
  s_waitcnt lgkmcnt(7)
  ds_read_b64_tr_b16 v[24:25], v7 offset:27648
  ds_read_u16_d16 v58, v58 offset:36864
  v_cvt_pk_bf16_f32 v74, v74, v75
  v_or_b32 v56, v56, v57
  v_lshlrev_b32_sdwa v75, 1, v74 dst_sel:DWORD dst_unused:UNUSED_PAD src0_sel:DWORD src1_sel:WORD_1
  v_lshlrev_b32_sdwa v74, 1, v74 dst_sel:DWORD dst_unused:UNUSED_PAD src0_sel:DWORD src1_sel:WORD_0
  v_mfma_f32_32x32x16_bf16 v[96:111], v[32:35], v[152:155], v[96:111]
  ds_read_b64_tr_b16 v[26:27], v7 offset:29184
  ds_read_u16_d16_hi v75, v75 offset:36864
  ds_read_u16_d16 v74, v74 offset:36864
  v_exp_f16_sdwa v10, v11 dst_sel:WORD_1 dst_unused:UNUSED_PRESERVE src0_sel:WORD_1
  v_pk_fma_f16 v8, v8, s57, s57
  v_pk_fma_f16 v10, v10, s57, s57
  v_mfma_f32_32x32x16_bf16 v[80:95], v[36:39], v[132:135], v[80:95]
  s_waitcnt lgkmcnt(10)
  ds_read_b64_tr_b16 v[28:29], v7 offset:27712
  v_rcp_f16 v9, v8
  v_or_b32 v72, v72, v73
  v_rcp_f16 v11, v10
  v_rcp_f16_sdwa v9, v8 dst_sel:WORD_1 dst_unused:UNUSED_PRESERVE src0_sel:WORD_1
  v_mfma_f32_32x32x16_bf16 v[96:111], v[36:39], v[156:159], v[96:111]
  s_waitcnt lgkmcnt(4)
  ds_read_b64_tr_b16 v[30:31], v7 offset:29248
  v_or_b32 v57, v58, v59
  v_cvt_pk_bf16_f32 v58, v60, v61
  v_rcp_f16_sdwa v11, v10 dst_sel:WORD_1 dst_unused:UNUSED_PRESERVE src0_sel:WORD_1
  v_fma_mix_f32 v62, v62, v9, 0 op_sel_hi:[0,1,0]
  s_cmp_eq_u32 s42, 3
  s_cbranch_scc1 L_mtail
  v_mfma_f32_32x32x16_bf16 v[160:175], v[16:19], v[48:51], v[160:175]
  s_waitcnt lgkmcnt(2)
  ds_read_b64_tr_b16 v[32:33], v7 offset:24704
  v_fma_mix_f32 v78, v78, v11, 0 op_sel_hi:[0,1,0]
  v_or_b32 v73, v74, v75
  v_cvt_pk_bf16_f32 v74, v76, v77
  v_fma_mix_f32 v63, v63, v9, 0 op_sel:[0,1,0] op_sel_hi:[0,1,0]
  v_fma_mix_f32 v79, v79, v11, 0 op_sel:[0,1,0] op_sel_hi:[0,1,0]
  v_cvt_pk_bf16_f32 v59, v62, v63
  v_mfma_f32_32x32x16_bf16 v[208:223], v[16:19], v[64:67], v[208:223]
  ds_read_b64_tr_b16 v[34:35], v7 offset:26240
  v_cvt_pk_bf16_f32 v75, v78, v79
  v_cvt_pk_bf16_f32 v80, v80, v81
  v_lshlrev_b32_sdwa v81, 1, v80 dst_sel:DWORD dst_unused:UNUSED_PAD src0_sel:DWORD src1_sel:WORD_1
  v_lshlrev_b32_sdwa v80, 1, v80 dst_sel:DWORD dst_unused:UNUSED_PAD src0_sel:DWORD src1_sel:WORD_0
  v_mul_f32 v92, s37, v92
  v_mul_f32 v108, s37, v108
  v_mfma_f32_32x32x16_bf16 v[176:191], v[20:23], v[48:51], v[176:191]
  ds_read_b64_tr_b16 v[36:37], v7 offset:27776
  ds_read_u16_d16_hi v81, v81 offset:36864
  ds_read_u16_d16 v80, v80 offset:36864
  v_mul_f32 v93, s37, v93
  v_mul_f32 v109, s37, v109
  v_cvt_pk_bf16_f32 v96, v96, v97
  v_lshlrev_b32_sdwa v97, 1, v96 dst_sel:DWORD dst_unused:UNUSED_PAD src0_sel:DWORD src1_sel:WORD_1
  v_mfma_f32_32x32x16_bf16 v[224:239], v[20:23], v[64:67], v[224:239]
  ds_read_b64_tr_b16 v[38:39], v7 offset:29312
  ds_read_u16_d16_hi v97, v97 offset:36864
  v_lshlrev_b32_sdwa v96, 1, v96 dst_sel:DWORD dst_unused:UNUSED_PAD src0_sel:DWORD src1_sel:WORD_0
  v_cvt_pk_f16_f32 v8, v92, v93
  v_cvt_pk_f16_f32 v10, v108, v109
  v_pk_fma_f16 v9, v8, v8, s56
  v_pk_fma_f16 v11, v10, v10, s56
  v_mfma_f32_32x32x16_bf16 v[160:175], v[24:27], v[56:59], v[160:175]
  ds_read_b64_tr_b16 v[16:17], v1 offset:30720
  ds_read_u16_d16 v96, v96 offset:36864
  v_cvt_pk_bf16_f32 v82, v82, v83
  v_pk_mul_f16 v9, v8, v9 neg_lo:[0,1] neg_hi:[0,1]
  v_lshlrev_b32_sdwa v83, 1, v82 dst_sel:DWORD dst_unused:UNUSED_PAD src0_sel:DWORD src1_sel:WORD_1
  v_lshlrev_b32_sdwa v82, 1, v82 dst_sel:DWORD dst_unused:UNUSED_PAD src0_sel:DWORD src1_sel:WORD_0
  v_pk_mul_f16 v11, v10, v11 neg_lo:[0,1] neg_hi:[0,1]
  v_mfma_f32_32x32x16_bf16 v[208:223], v[24:27], v[72:75], v[208:223]
  s_waitcnt lgkmcnt(9)
  ds_read_b64_tr_b16 v[18:19], v1 offset:30976
  ds_read_u16_d16_hi v83, v83 offset:36864
  ds_read_u16_d16 v82, v82 offset:36864
  v_exp_f16 v8, v9
  v_exp_f16 v10, v11
  v_mfma_f32_32x32x16_bf16 v[176:191], v[28:31], v[56:59], v[176:191]
  s_waitcnt lgkmcnt(7)
  ds_read_b64_tr_b16 v[20:21], v1 offset:31744
  v_cvt_pk_bf16_f32 v98, v98, v99
  v_or_b32 v80, v80, v81
  v_lshlrev_b32_sdwa v99, 1, v98 dst_sel:DWORD dst_unused:UNUSED_PAD src0_sel:DWORD src1_sel:WORD_1
  v_lshlrev_b32_sdwa v98, 1, v98 dst_sel:DWORD dst_unused:UNUSED_PAD src0_sel:DWORD src1_sel:WORD_0
  v_exp_f16_sdwa v8, v9 dst_sel:WORD_1 dst_unused:UNUSED_PRESERVE src0_sel:WORD_1
  v_mfma_f32_32x32x16_bf16 v[224:239], v[28:31], v[72:75], v[224:239]
  ds_read_b64_tr_b16 v[22:23], v1 offset:32000
  ds_read_u16_d16_hi v99, v99 offset:36864
  ds_read_u16_d16 v98, v98 offset:36864
  v_exp_f16_sdwa v10, v11 dst_sel:WORD_1 dst_unused:UNUSED_PRESERVE src0_sel:WORD_1
  v_cvt_pk_bf16_f32 v84, v84, v85
  v_mfma_f32_32x32x16_bf16 v[192:207], v[32:35], v[48:51], v[192:207]
  s_waitcnt lgkmcnt(7)
  ds_read_b64_tr_b16 v[24:25], v1 offset:32768
  v_or_b32 v96, v96, v97
  v_lshlrev_b32_sdwa v85, 1, v84 dst_sel:DWORD dst_unused:UNUSED_PAD src0_sel:DWORD src1_sel:WORD_1
  v_lshlrev_b32_sdwa v84, 1, v84 dst_sel:DWORD dst_unused:UNUSED_PAD src0_sel:DWORD src1_sel:WORD_0
  v_pk_fma_f16 v8, v8, s57, s57
  v_pk_fma_f16 v10, v10, s57, s57
  v_rcp_f16 v9, v8
  v_mfma_f32_32x32x16_bf16 v[240:255], v[32:35], v[64:67], v[240:255]
  ds_read_b64_tr_b16 v[26:27], v1 offset:33024
  ds_read_u16_d16_hi v85, v85 offset:36864
  ds_read_u16_d16 v84, v84 offset:36864
  v_cvt_pk_bf16_f32 v100, v100, v101
  v_rcp_f16 v11, v10
  v_mfma_f32_32x32x16_bf16 v[192:207], v[36:39], v[56:59], v[192:207]
  s_waitcnt lgkmcnt(8)
  ds_read_b64_tr_b16 v[28:29], v1 offset:33792
  v_or_b32 v81, v82, v83
  v_lshlrev_b32_sdwa v101, 1, v100 dst_sel:DWORD dst_unused:UNUSED_PAD src0_sel:DWORD src1_sel:WORD_1
  v_lshlrev_b32_sdwa v100, 1, v100 dst_sel:DWORD dst_unused:UNUSED_PAD src0_sel:DWORD src1_sel:WORD_0
  v_rcp_f16_sdwa v9, v8 dst_sel:WORD_1 dst_unused:UNUSED_PRESERVE src0_sel:WORD_1
  v_rcp_f16_sdwa v11, v10 dst_sel:WORD_1 dst_unused:UNUSED_PRESERVE src0_sel:WORD_1
  v_mfma_f32_32x32x16_bf16 v[240:255], v[36:39], v[72:75], v[240:255]
  s_waitcnt lgkmcnt(5)
  ds_read_b64_tr_b16 v[30:31], v1 offset:34048
  ds_read_u16_d16_hi v101, v101 offset:36864
  ds_read_u16_d16 v100, v100 offset:36864
  v_cvt_pk_bf16_f32 v86, v86, v87
  v_or_b32 v97, v98, v99
  v_mfma_f32_32x32x16_bf16 v[48:63], v[16:19], v[112:115], 0
  ds_read_b64_tr_b16 v[32:33], v1 offset:34816
  v_lshlrev_b32_sdwa v87, 1, v86 dst_sel:DWORD dst_unused:UNUSED_PAD src0_sel:DWORD src1_sel:WORD_1
  v_lshlrev_b32_sdwa v86, 1, v86 dst_sel:DWORD dst_unused:UNUSED_PAD src0_sel:DWORD src1_sel:WORD_0
  v_fma_mix_f32 v92, v92, v9, 0 op_sel_hi:[0,1,0]
  v_fma_mix_f32 v108, v108, v11, 0 op_sel_hi:[0,1,0]
  v_fma_mix_f32 v93, v93, v9, 0 op_sel:[0,1,0] op_sel_hi:[0,1,0]
  v_cvt_pk_bf16_f32 v102, v102, v103
  v_mfma_f32_32x32x16_bf16 v[64:79], v[16:19], v[136:139], 0
  s_waitcnt lgkmcnt(5)
  ds_read_b64_tr_b16 v[34:35], v1 offset:35072
  ds_read_u16_d16_hi v87, v87 offset:36864
  ds_read_u16_d16 v86, v86 offset:36864
  v_fma_mix_f32 v109, v109, v11, 0 op_sel:[0,1,0] op_sel_hi:[0,1,0]
  v_or_b32 v82, v84, v85
  v_lshlrev_b32_sdwa v103, 1, v102 dst_sel:DWORD dst_unused:UNUSED_PAD src0_sel:DWORD src1_sel:WORD_1
  v_lshlrev_b32_sdwa v102, 1, v102 dst_sel:DWORD dst_unused:UNUSED_PAD src0_sel:DWORD src1_sel:WORD_0
  v_mfma_f32_32x32x16_bf16 v[48:63], v[20:23], v[116:119], v[48:63]
  ds_read_b64_tr_b16 v[36:37], v1 offset:35840
  ds_read_u16_d16_hi v103, v103 offset:36864
  ds_read_u16_d16 v102, v102 offset:36864
  v_mul_f32 v94, s37, v94
  v_mul_f32 v110, s37, v110
  v_cvt_pk_bf16_f32 v88, v88, v89
  v_mul_f32 v95, s37, v95
  v_mfma_f32_32x32x16_bf16 v[64:79], v[20:23], v[140:143], v[64:79]
  s_waitcnt lgkmcnt(7)
  ds_read_b64_tr_b16 v[38:39], v1 offset:36096
  v_or_b32 v98, v100, v101
  v_lshlrev_b32_sdwa v89, 1, v88 dst_sel:DWORD dst_unused:UNUSED_PAD src0_sel:DWORD src1_sel:WORD_1
  v_lshlrev_b32_sdwa v88, 1, v88 dst_sel:DWORD dst_unused:UNUSED_PAD src0_sel:DWORD src1_sel:WORD_0
  v_mul_f32 v111, s37, v111
  v_cvt_pk_f16_f32 v8, v94, v95
  v_cvt_pk_f16_f32 v10, v110, v111
  v_mfma_f32_32x32x16_bf16 v[48:63], v[24:27], v[120:123], v[48:63]
  s_waitcnt lgkmcnt(4)
  ds_read_u16_d16_hi v89, v89 offset:36864
  ds_read_u16_d16 v88, v88 offset:36864
  v_cvt_pk_bf16_f32 v104, v104, v105
  v_pk_fma_f16 v9, v8, v8, s56
  v_or_b32 v83, v86, v87
  v_lshlrev_b32_sdwa v105, 1, v104 dst_sel:DWORD dst_unused:UNUSED_PAD src0_sel:DWORD src1_sel:WORD_1
  v_lshlrev_b32_sdwa v104, 1, v104 dst_sel:DWORD dst_unused:UNUSED_PAD src0_sel:DWORD src1_sel:WORD_0
  v_mfma_f32_32x32x16_bf16 v[64:79], v[24:27], v[144:147], v[64:79]
  ds_read_u16_d16_hi v105, v105 offset:36864
  ds_read_u16_d16 v104, v104 offset:36864
  v_pk_fma_f16 v11, v10, v10, s56
  v_pk_mul_f16 v9, v8, v9 neg_lo:[0,1] neg_hi:[0,1]
  v_pk_mul_f16 v11, v10, v11 neg_lo:[0,1] neg_hi:[0,1]
  v_exp_f16 v8, v9
  v_mfma_f32_32x32x16_bf16 v[48:63], v[28:31], v[124:127], v[48:63]
  s_waitcnt lgkmcnt(4)
  s_barrier
  ds_read_b64_tr_b16 v[16:17], v7 offset:0
  ds_read_b64_tr_b16 v[18:19], v7 offset:1536
  v_cvt_pk_bf16_f32 v90, v90, v91
  v_or_b32 v99, v102, v103
  v_lshlrev_b32_sdwa v91, 1, v90 dst_sel:DWORD dst_unused:UNUSED_PAD src0_sel:DWORD src1_sel:WORD_1
  v_mfma_f32_32x32x16_bf16 v[64:79], v[28:31], v[148:151], v[64:79]
  ds_read_b64_tr_b16 v[20:21], v7 offset:64
  ds_read_b64_tr_b16 v[22:23], v7 offset:1600
  ds_read_u16_d16_hi v91, v91 offset:36864
  v_lshlrev_b32_sdwa v90, 1, v90 dst_sel:DWORD dst_unused:UNUSED_PAD src0_sel:DWORD src1_sel:WORD_0
  v_exp_f16 v10, v11
  v_exp_f16_sdwa v8, v9 dst_sel:WORD_1 dst_unused:UNUSED_PRESERVE src0_sel:WORD_1
  v_mfma_f32_32x32x16_bf16 v[48:63], v[32:35], v[128:131], v[48:63]
  s_waitcnt lgkmcnt(7)
  ds_read_b64_tr_b16 v[24:25], v7 offset:3072
  ds_read_u16_d16 v90, v90 offset:36864
  v_cvt_pk_bf16_f32 v106, v106, v107
  v_or_b32 v88, v88, v89
  v_lshlrev_b32_sdwa v107, 1, v106 dst_sel:DWORD dst_unused:UNUSED_PAD src0_sel:DWORD src1_sel:WORD_1
  v_lshlrev_b32_sdwa v106, 1, v106 dst_sel:DWORD dst_unused:UNUSED_PAD src0_sel:DWORD src1_sel:WORD_0
  v_mfma_f32_32x32x16_bf16 v[64:79], v[32:35], v[152:155], v[64:79]
  ds_read_b64_tr_b16 v[26:27], v7 offset:4608
  ds_read_u16_d16_hi v107, v107 offset:36864
  ds_read_u16_d16 v106, v106 offset:36864
  v_exp_f16_sdwa v10, v11 dst_sel:WORD_1 dst_unused:UNUSED_PRESERVE src0_sel:WORD_1
  v_pk_fma_f16 v8, v8, s57, s57
  v_pk_fma_f16 v10, v10, s57, s57
  v_mfma_f32_32x32x16_bf16 v[48:63], v[36:39], v[132:135], v[48:63]
  s_waitcnt lgkmcnt(10)
  ds_read_b64_tr_b16 v[28:29], v7 offset:3136
  v_rcp_f16 v9, v8
  v_or_b32 v104, v104, v105
  v_rcp_f16 v11, v10
  v_rcp_f16_sdwa v9, v8 dst_sel:WORD_1 dst_unused:UNUSED_PRESERVE src0_sel:WORD_1
  v_mfma_f32_32x32x16_bf16 v[64:79], v[36:39], v[156:159], v[64:79]
  s_waitcnt lgkmcnt(4)
  ds_read_b64_tr_b16 v[30:31], v7 offset:4672
  v_or_b32 v89, v90, v91
  v_cvt_pk_bf16_f32 v90, v92, v93
  v_rcp_f16_sdwa v11, v10 dst_sel:WORD_1 dst_unused:UNUSED_PRESERVE src0_sel:WORD_1
  v_fma_mix_f32 v94, v94, v9, 0 op_sel_hi:[0,1,0]
  v_mfma_f32_32x32x16_bf16 v[160:175], v[16:19], v[80:83], v[160:175]
  s_waitcnt lgkmcnt(2)
  ds_read_b64_tr_b16 v[32:33], v7 offset:128
  ds_read_b128 v[112:115], v3 offset:0
  ds_read_b128 v[116:119], v3 offset:4096
  v_fma_mix_f32 v110, v110, v11, 0 op_sel_hi:[0,1,0]
  v_or_b32 v105, v106, v107
  v_cvt_pk_bf16_f32 v106, v108, v109
  v_fma_mix_f32 v95, v95, v9, 0 op_sel:[0,1,0] op_sel_hi:[0,1,0]
  v_fma_mix_f32 v111, v111, v11, 0 op_sel:[0,1,0] op_sel_hi:[0,1,0]
  v_mfma_f32_32x32x16_bf16 v[208:223], v[16:19], v[96:99], v[208:223]
  ds_read_b64_tr_b16 v[34:35], v7 offset:1664
  ds_read_b128 v[120:123], v3 offset:8192
  ds_read_b128 v[124:127], v3 offset:12288
  v_cvt_pk_bf16_f32 v91, v94, v95
  v_cvt_pk_bf16_f32 v107, v110, v111
  v_cvt_pk_bf16_f32 v48, v48, v49
  v_lshlrev_b32_sdwa v49, 1, v48 dst_sel:DWORD dst_unused:UNUSED_PAD src0_sel:DWORD src1_sel:WORD_1
  v_mfma_f32_32x32x16_bf16 v[176:191], v[20:23], v[80:83], v[176:191]
  ds_read_b64_tr_b16 v[36:37], v7 offset:3200
  ds_read_u16_d16_hi v49, v49 offset:36864
  ds_read_b128 v[128:131], v3 offset:16384
  ds_read_b128 v[132:135], v3 offset:20480
  v_lshlrev_b32_sdwa v48, 1, v48 dst_sel:DWORD dst_unused:UNUSED_PAD src0_sel:DWORD src1_sel:WORD_0
  v_mul_f32 v60, s37, v60
  v_mul_f32 v76, s37, v76
  v_mfma_f32_32x32x16_bf16 v[224:239], v[20:23], v[96:99], v[224:239]
  ds_read_b64_tr_b16 v[38:39], v7 offset:4736
  ds_read_u16_d16 v48, v48 offset:36864
  v_mul_f32 v61, s37, v61
  v_mul_f32 v77, s37, v77
  v_cvt_pk_bf16_f32 v64, v64, v65
  v_lshlrev_b32_sdwa v65, 1, v64 dst_sel:DWORD dst_unused:UNUSED_PAD src0_sel:DWORD src1_sel:WORD_1
  v_lshlrev_b32_sdwa v64, 1, v64 dst_sel:DWORD dst_unused:UNUSED_PAD src0_sel:DWORD src1_sel:WORD_0
  v_mfma_f32_32x32x16_bf16 v[160:175], v[24:27], v[88:91], v[160:175]
  s_waitcnt lgkmcnt(12)
  ds_read_b64_tr_b16 v[16:17], v1 offset:6144
  ds_read_u16_d16_hi v65, v65 offset:36864
  ds_read_u16_d16 v64, v64 offset:36864
  v_cvt_pk_f16_f32 v8, v60, v61
  v_cvt_pk_f16_f32 v10, v76, v77
  v_pk_fma_f16 v9, v8, v8, s56
  v_pk_fma_f16 v11, v10, v10, s56
  v_mfma_f32_32x32x16_bf16 v[208:223], v[24:27], v[104:107], v[208:223]
  s_waitcnt lgkmcnt(14)
  ds_read_b64_tr_b16 v[18:19], v1 offset:6400
  v_cvt_pk_bf16_f32 v50, v50, v51
  v_pk_mul_f16 v9, v8, v9 neg_lo:[0,1] neg_hi:[0,1]
  v_lshlrev_b32_sdwa v51, 1, v50 dst_sel:DWORD dst_unused:UNUSED_PAD src0_sel:DWORD src1_sel:WORD_1
  v_lshlrev_b32_sdwa v50, 1, v50 dst_sel:DWORD dst_unused:UNUSED_PAD src0_sel:DWORD src1_sel:WORD_0
  v_pk_mul_f16 v11, v10, v11 neg_lo:[0,1] neg_hi:[0,1]
  v_exp_f16 v8, v9
  v_mfma_f32_32x32x16_bf16 v[176:191], v[28:31], v[88:91], v[176:191]
  s_waitcnt lgkmcnt(12)
  ds_read_b64_tr_b16 v[20:21], v1 offset:7168
  ds_read_u16_d16_hi v51, v51 offset:36864
  ds_read_u16_d16 v50, v50 offset:36864
  v_exp_f16 v10, v11
  v_cvt_pk_bf16_f32 v66, v66, v67
  v_mfma_f32_32x32x16_bf16 v[224:239], v[28:31], v[104:107], v[224:239]
  s_waitcnt lgkmcnt(7)
  ds_read_b64_tr_b16 v[22:23], v1 offset:7424
  v_or_b32 v48, v48, v49
  v_lshlrev_b32_sdwa v67, 1, v66 dst_sel:DWORD dst_unused:UNUSED_PAD src0_sel:DWORD src1_sel:WORD_1
  v_lshlrev_b32_sdwa v66, 1, v66 dst_sel:DWORD dst_unused:UNUSED_PAD src0_sel:DWORD src1_sel:WORD_0
  v_exp_f16_sdwa v8, v9 dst_sel:WORD_1 dst_unused:UNUSED_PRESERVE src0_sel:WORD_1
  v_exp_f16_sdwa v10, v11 dst_sel:WORD_1 dst_unused:UNUSED_PRESERVE src0_sel:WORD_1
  v_mfma_f32_32x32x16_bf16 v[192:207], v[32:35], v[80:83], v[192:207]
  s_waitcnt lgkmcnt(5)
  ds_read_b64_tr_b16 v[24:25], v1 offset:8192
  ds_read_u16_d16_hi v67, v67 offset:36864
  ds_read_u16_d16 v66, v66 offset:36864
  v_cvt_pk_bf16_f32 v52, v52, v53
  v_or_b32 v64, v64, v65
  v_lshlrev_b32_sdwa v53, 1, v52 dst_sel:DWORD dst_unused:UNUSED_PAD src0_sel:DWORD src1_sel:WORD_1
  v_mfma_f32_32x32x16_bf16 v[240:255], v[32:35], v[96:99], v[240:255]
  ds_read_b64_tr_b16 v[26:27], v1 offset:8448
  ds_read_u16_d16_hi v53, v53 offset:36864
  v_lshlrev_b32_sdwa v52, 1, v52 dst_sel:DWORD dst_unused:UNUSED_PAD src0_sel:DWORD src1_sel:WORD_0
  v_pk_fma_f16 v8, v8, s57, s57
  v_pk_fma_f16 v10, v10, s57, s57
  v_rcp_f16 v9, v8
  v_mfma_f32_32x32x16_bf16 v[192:207], v[36:39], v[88:91], v[192:207]
  s_waitcnt lgkmcnt(6)
  ds_read_b64_tr_b16 v[28:29], v1 offset:9216
  ds_read_u16_d16 v52, v52 offset:36864
  v_cvt_pk_bf16_f32 v68, v68, v69
  v_rcp_f16 v11, v10
  v_or_b32 v49, v50, v51
  v_lshlrev_b32_sdwa v69, 1, v68 dst_sel:DWORD dst_unused:UNUSED_PAD src0_sel:DWORD src1_sel:WORD_1
  v_mfma_f32_32x32x16_bf16 v[240:255], v[36:39], v[104:107], v[240:255]
  ds_read_b64_tr_b16 v[30:31], v1 offset:9472
  ds_read_u16_d16_hi v69, v69 offset:36864
  v_lshlrev_b32_sdwa v68, 1, v68 dst_sel:DWORD dst_unused:UNUSED_PAD src0_sel:DWORD src1_sel:WORD_0
  v_rcp_f16_sdwa v9, v8 dst_sel:WORD_1 dst_unused:UNUSED_PRESERVE src0_sel:WORD_1
  v_rcp_f16_sdwa v11, v10 dst_sel:WORD_1 dst_unused:UNUSED_PRESERVE src0_sel:WORD_1
  v_mfma_f32_32x32x16_bf16 v[80:95], v[16:19], v[112:115], 0
  s_waitcnt lgkmcnt(6)
  ds_read_b64_tr_b16 v[32:33], v1 offset:10240
  ds_read_u16_d16 v68, v68 offset:36864
  v_cvt_pk_bf16_f32 v54, v54, v55
  v_or_b32 v65, v66, v67
  v_lshlrev_b32_sdwa v55, 1, v54 dst_sel:DWORD dst_unused:UNUSED_PAD src0_sel:DWORD src1_sel:WORD_1
  v_lshlrev_b32_sdwa v54, 1, v54 dst_sel:DWORD dst_unused:UNUSED_PAD src0_sel:DWORD src1_sel:WORD_0
  v_fma_mix_f32 v60, v60, v9, 0 op_sel_hi:[0,1,0]
  v_fma_mix_f32 v76, v76, v11, 0 op_sel_hi:[0,1,0]
  v_mfma_f32_32x32x16_bf16 v[96:111], v[16:19], v[136:139], 0
  s_waitcnt lgkmcnt(4)
  ds_read_b64_tr_b16 v[34:35], v1 offset:10496
  ds_read_u16_d16_hi v55, v55 offset:36864
  ds_read_u16_d16 v54, v54 offset:36864
  v_fma_mix_f32 v61, v61, v9, 0 op_sel:[0,1,0] op_sel_hi:[0,1,0]
  v_cvt_pk_bf16_f32 v70, v70, v71
  v_fma_mix_f32 v77, v77, v11, 0 op_sel:[0,1,0] op_sel_hi:[0,1,0]
  v_or_b32 v50, v52, v53
  v_mfma_f32_32x32x16_bf16 v[80:95], v[20:23], v[116:119], v[80:95]
  ds_read_b64_tr_b16 v[36:37], v1 offset:11264
  v_lshlrev_b32_sdwa v71, 1, v70 dst_sel:DWORD dst_unused:UNUSED_PAD src0_sel:DWORD src1_sel:WORD_1
  v_lshlrev_b32_sdwa v70, 1, v70 dst_sel:DWORD dst_unused:UNUSED_PAD src0_sel:DWORD src1_sel:WORD_0
  v_mul_f32 v62, s37, v62
  v_mul_f32 v78, s37, v78
  v_cvt_pk_bf16_f32 v56, v56, v57
  v_mul_f32 v63, s37, v63
  v_mfma_f32_32x32x16_bf16 v[96:111], v[20:23], v[140:143], v[96:111]
  s_waitcnt lgkmcnt(4)
  ds_read_b64_tr_b16 v[38:39], v1 offset:11520
  ds_read_u16_d16_hi v71, v71 offset:36864
  ds_read_u16_d16 v70, v70 offset:36864
  v_or_b32 v66, v68, v69
  v_lshlrev_b32_sdwa v57, 1, v56 dst_sel:DWORD dst_unused:UNUSED_PAD src0_sel:DWORD src1_sel:WORD_1
  v_lshlrev_b32_sdwa v56, 1, v56 dst_sel:DWORD dst_unused:UNUSED_PAD src0_sel:DWORD src1_sel:WORD_0
  v_mul_f32 v79, s37, v79
  v_mfma_f32_32x32x16_bf16 v[80:95], v[24:27], v[120:123], v[80:95]
  s_waitcnt lgkmcnt(4)
  ds_read_u16_d16_hi v57, v57 offset:36864
  ds_read_u16_d16 v56, v56 offset:36864
  v_cvt_pk_f16_f32 v8, v62, v63
  v_cvt_pk_f16_f32 v10, v78, v79
  v_cvt_pk_bf16_f32 v72, v72, v73
  v_pk_fma_f16 v9, v8, v8, s56
  v_or_b32 v51, v54, v55
  v_mfma_f32_32x32x16_bf16 v[96:111], v[24:27], v[144:147], v[96:111]
  v_lshlrev_b32_sdwa v73, 1, v72 dst_sel:DWORD dst_unused:UNUSED_PAD src0_sel:DWORD src1_sel:WORD_1
  v_lshlrev_b32_sdwa v72, 1, v72 dst_sel:DWORD dst_unused:UNUSED_PAD src0_sel:DWORD src1_sel:WORD_0
  v_pk_fma_f16 v11, v10, v10, s56
  v_pk_mul_f16 v9, v8, v9 neg_lo:[0,1] neg_hi:[0,1]
  v_pk_mul_f16 v11, v10, v11 neg_lo:[0,1] neg_hi:[0,1]
  v_exp_f16 v8, v9
  v_mfma_f32_32x32x16_bf16 v[80:95], v[28:31], v[124:127], v[80:95]
  s_waitcnt lgkmcnt(4)
  s_barrier
  ds_read_b64_tr_b16 v[16:17], v7 offset:12288
  ds_read_b64_tr_b16 v[18:19], v7 offset:13824
  ds_read_u16_d16_hi v73, v73 offset:36864
  v_cvt_pk_bf16_f32 v58, v58, v59
  s_waitcnt lgkmcnt(5)
  v_or_b32 v67, v70, v71
  v_lshlrev_b32_sdwa v59, 1, v58 dst_sel:DWORD dst_unused:UNUSED_PAD src0_sel:DWORD src1_sel:WORD_1
  v_mfma_f32_32x32x16_bf16 v[96:111], v[28:31], v[148:151], v[96:111]
  ds_read_b64_tr_b16 v[20:21], v7 offset:12352
  ds_read_b64_tr_b16 v[22:23], v7 offset:13888
  ds_read_u16_d16 v72, v72 offset:36864
  v_lshlrev_b32_sdwa v58, 1, v58 dst_sel:DWORD dst_unused:UNUSED_PAD src0_sel:DWORD src1_sel:WORD_0
  v_exp_f16 v10, v11
  v_exp_f16_sdwa v8, v9 dst_sel:WORD_1 dst_unused:UNUSED_PRESERVE src0_sel:WORD_1
  v_mfma_f32_32x32x16_bf16 v[80:95], v[32:35], v[128:131], v[80:95]
  s_waitcnt lgkmcnt(6)
  ds_read_b64_tr_b16 v[24:25], v7 offset:15360
  ds_read_u16_d16_hi v59, v59 offset:36864
  ds_read_u16_d16 v58, v58 offset:36864
  v_cvt_pk_bf16_f32 v74, v74, v75
  v_or_b32 v56, v56, v57
  v_lshlrev_b32_sdwa v75, 1, v74 dst_sel:DWORD dst_unused:UNUSED_PAD src0_sel:DWORD src1_sel:WORD_1
  v_mfma_f32_32x32x16_bf16 v[96:111], v[32:35], v[152:155], v[96:111]
  ds_read_b64_tr_b16 v[26:27], v7 offset:16896
  ds_read_u16_d16_hi v75, v75 offset:36864
  v_lshlrev_b32_sdwa v74, 1, v74 dst_sel:DWORD dst_unused:UNUSED_PAD src0_sel:DWORD src1_sel:WORD_0
  v_exp_f16_sdwa v10, v11 dst_sel:WORD_1 dst_unused:UNUSED_PRESERVE src0_sel:WORD_1
  v_pk_fma_f16 v8, v8, s57, s57
  v_pk_fma_f16 v10, v10, s57, s57
  v_mfma_f32_32x32x16_bf16 v[80:95], v[36:39], v[132:135], v[80:95]
  s_waitcnt lgkmcnt(5)
  ds_read_b64_tr_b16 v[28:29], v7 offset:15424
  ds_read_u16_d16 v74, v74 offset:36864
  v_rcp_f16 v9, v8
  v_or_b32 v72, v72, v73
  v_rcp_f16 v11, v10
  v_mfma_f32_32x32x16_bf16 v[96:111], v[36:39], v[156:159], v[96:111]
  s_waitcnt lgkmcnt(4)
  ds_read_b64_tr_b16 v[30:31], v7 offset:16960
  v_rcp_f16_sdwa v9, v8 dst_sel:WORD_1 dst_unused:UNUSED_PRESERVE src0_sel:WORD_1
  v_or_b32 v57, v58, v59
  v_cvt_pk_bf16_f32 v58, v60, v61
  v_rcp_f16_sdwa v11, v10 dst_sel:WORD_1 dst_unused:UNUSED_PRESERVE src0_sel:WORD_1
  v_fma_mix_f32 v62, v62, v9, 0 op_sel_hi:[0,1,0]
  v_mfma_f32_32x32x16_bf16 v[160:175], v[16:19], v[48:51], v[160:175]
  s_waitcnt lgkmcnt(1)
  ds_read_b64_tr_b16 v[32:33], v7 offset:12416
  v_add_u32 v6, s43, v4
  v_fma_mix_f32 v78, v78, v11, 0 op_sel_hi:[0,1,0]
  v_or_b32 v73, v74, v75
  v_cvt_pk_bf16_f32 v74, v76, v77
  v_fma_mix_f32 v63, v63, v9, 0 op_sel:[0,1,0] op_sel_hi:[0,1,0]
  v_fma_mix_f32 v79, v79, v11, 0 op_sel:[0,1,0] op_sel_hi:[0,1,0]
  v_cvt_pk_bf16_f32 v59, v62, v63
  v_cvt_pk_bf16_f32 v75, v78, v79
  v_mfma_f32_32x32x16_bf16 v[208:223], v[16:19], v[64:67], v[208:223]
  ds_read_b64_tr_b16 v[34:35], v7 offset:13952
  s_mov_b32 s49, s43
  s_mov_b32 s43, s44
  s_mov_b32 s44, s45
  s_mov_b32 s45, s49
  v_cvt_pk_bf16_f32 v80, v80, v81
  v_lshlrev_b32_sdwa v81, 1, v80 dst_sel:DWORD dst_unused:UNUSED_PAD src0_sel:DWORD src1_sel:WORD_1
  v_lshlrev_b32_sdwa v80, 1, v80 dst_sel:DWORD dst_unused:UNUSED_PAD src0_sel:DWORD src1_sel:WORD_0
  v_mul_f32 v92, s37, v92
  v_mfma_f32_32x32x16_bf16 v[176:191], v[20:23], v[48:51], v[176:191]
  ds_read_b64_tr_b16 v[36:37], v7 offset:15488
  ds_read_u16_d16_hi v81, v81 offset:36864
  ds_read_u16_d16 v80, v80 offset:36864
  v_mul_f32 v108, s37, v108
  v_mul_f32 v93, s37, v93
  v_mul_f32 v109, s37, v109
  v_cvt_pk_bf16_f32 v96, v96, v97
  v_lshlrev_b32_sdwa v97, 1, v96 dst_sel:DWORD dst_unused:UNUSED_PAD src0_sel:DWORD src1_sel:WORD_1
  v_lshlrev_b32_sdwa v96, 1, v96 dst_sel:DWORD dst_unused:UNUSED_PAD src0_sel:DWORD src1_sel:WORD_0
  v_mfma_f32_32x32x16_bf16 v[224:239], v[20:23], v[64:67], v[224:239]
  ds_read_b64_tr_b16 v[38:39], v7 offset:17024
  ds_read_u16_d16_hi v97, v97 offset:36864
  ds_read_u16_d16 v96, v96 offset:36864
  v_cvt_pk_f16_f32 v8, v92, v93
  v_cvt_pk_f16_f32 v10, v108, v109
  v_pk_fma_f16 v9, v8, v8, s56
  v_pk_fma_f16 v11, v10, v10, s56
  v_cvt_pk_bf16_f32 v82, v82, v83
  v_mfma_f32_32x32x16_bf16 v[160:175], v[24:27], v[56:59], v[160:175]
  ds_read_b64_tr_b16 v[16:17], v1 offset:18432
  v_pk_mul_f16 v9, v8, v9 neg_lo:[0,1] neg_hi:[0,1]
  v_lshlrev_b32_sdwa v83, 1, v82 dst_sel:DWORD dst_unused:UNUSED_PAD src0_sel:DWORD src1_sel:WORD_1
  v_lshlrev_b32_sdwa v82, 1, v82 dst_sel:DWORD dst_unused:UNUSED_PAD src0_sel:DWORD src1_sel:WORD_0
  v_pk_mul_f16 v11, v10, v11 neg_lo:[0,1] neg_hi:[0,1]
  v_exp_f16 v8, v9
  v_mfma_f32_32x32x16_bf16 v[208:223], v[24:27], v[72:75], v[208:223]
  s_waitcnt lgkmcnt(4)
  ds_read_b64_tr_b16 v[18:19], v1 offset:18688
  ds_read_u16_d16_hi v83, v83 offset:36864
  ds_read_u16_d16 v82, v82 offset:36864
  s_nop 0
  v_cvt_pk_bf16_f32 v160, v160, v161
  v_cvt_pk_bf16_f32 v161, v162, v163
  v_cvt_pk_bf16_f32 v162, v164, v165
  v_cvt_pk_bf16_f32 v163, v166, v167
  v_exp_f16 v10, v11
  v_cvt_pk_bf16_f32 v98, v98, v99
  v_or_b32 v80, v80, v81
  v_mfma_f32_32x32x16_bf16 v[176:191], v[28:31], v[56:59], v[176:191]
  ds_read_b64_tr_b16 v[20:21], v1 offset:19456
  v_lshlrev_b32_sdwa v99, 1, v98 dst_sel:DWORD dst_unused:UNUSED_PAD src0_sel:DWORD src1_sel:WORD_1
  v_lshlrev_b32_sdwa v98, 1, v98 dst_sel:DWORD dst_unused:UNUSED_PAD src0_sel:DWORD src1_sel:WORD_0
  v_cvt_pk_bf16_f32 v168, v168, v169
  v_cvt_pk_bf16_f32 v169, v170, v171
  v_cvt_pk_bf16_f32 v170, v172, v173
  v_cvt_pk_bf16_f32 v171, v174, v175
  s_nop 1
  v_permlane16_swap_b32 v160, v168
  v_permlane16_swap_b32 v161, v169
  v_permlane16_swap_b32 v162, v170
  v_permlane16_swap_b32 v163, v171
  v_mfma_f32_32x32x16_bf16 v[224:239], v[28:31], v[72:75], v[224:239]
  ds_read_b64_tr_b16 v[22:23], v1 offset:19712
  ds_read_u16_d16_hi v99, v99 offset:36864
  ds_read_u16_d16 v98, v98 offset:36864
  buffer_store_dwordx4 v[160:163], v2, s[28:31], s40 offen offset:0 sc1
  v_exp_f16_sdwa v8, v9 dst_sel:WORD_1 dst_unused:UNUSED_PRESERVE src0_sel:WORD_1
  v_mfma_f32_32x32x16_bf16 v[192:207], v[32:35], v[48:51], v[192:207]
  s_waitcnt lgkmcnt(8)
  ds_read_b64_tr_b16 v[24:25], v1 offset:20480
  v_exp_f16_sdwa v10, v11 dst_sel:WORD_1 dst_unused:UNUSED_PRESERVE src0_sel:WORD_1
  v_cvt_pk_bf16_f32 v84, v84, v85
  v_or_b32 v96, v96, v97
  v_lshlrev_b32_sdwa v85, 1, v84 dst_sel:DWORD dst_unused:UNUSED_PAD src0_sel:DWORD src1_sel:WORD_1
  v_lshlrev_b32_sdwa v84, 1, v84 dst_sel:DWORD dst_unused:UNUSED_PAD src0_sel:DWORD src1_sel:WORD_0
  v_pk_fma_f16 v8, v8, s57, s57
  v_mfma_f32_32x32x16_bf16 v[240:255], v[32:35], v[64:67], v[240:255]
  ds_read_b64_tr_b16 v[26:27], v1 offset:20736
  ds_read_u16_d16_hi v85, v85 offset:36864
  ds_read_u16_d16 v84, v84 offset:36864
  v_pk_fma_f16 v10, v10, s57, s57
  v_rcp_f16 v9, v8
  v_cvt_pk_bf16_f32 v100, v100, v101
  v_rcp_f16 v11, v10
  v_mfma_f32_32x32x16_bf16 v[192:207], v[36:39], v[56:59], v[192:207]
  s_waitcnt lgkmcnt(8)
  ds_read_b64_tr_b16 v[28:29], v1 offset:21504
  v_or_b32 v81, v82, v83
  v_lshlrev_b32_sdwa v101, 1, v100 dst_sel:DWORD dst_unused:UNUSED_PAD src0_sel:DWORD src1_sel:WORD_1
  v_lshlrev_b32_sdwa v100, 1, v100 dst_sel:DWORD dst_unused:UNUSED_PAD src0_sel:DWORD src1_sel:WORD_0
  v_rcp_f16_sdwa v9, v8 dst_sel:WORD_1 dst_unused:UNUSED_PRESERVE src0_sel:WORD_1
  v_rcp_f16_sdwa v11, v10 dst_sel:WORD_1 dst_unused:UNUSED_PRESERVE src0_sel:WORD_1
  v_mfma_f32_32x32x16_bf16 v[240:255], v[36:39], v[72:75], v[240:255]
  s_waitcnt lgkmcnt(5)
  ds_read_b64_tr_b16 v[30:31], v1 offset:21760
  ds_read_u16_d16_hi v101, v101 offset:36864
  ds_read_u16_d16 v100, v100 offset:36864
  v_cvt_pk_bf16_f32 v86, v86, v87
  v_or_b32 v97, v98, v99
  v_lshlrev_b32_sdwa v87, 1, v86 dst_sel:DWORD dst_unused:UNUSED_PAD src0_sel:DWORD src1_sel:WORD_1
  v_lshlrev_b32_sdwa v86, 1, v86 dst_sel:DWORD dst_unused:UNUSED_PAD src0_sel:DWORD src1_sel:WORD_0
  v_fma_mix_f32 v92, v92, v9, 0 op_sel_hi:[0,1,0]
  v_fma_mix_f32 v108, v108, v11, 0 op_sel_hi:[0,1,0]
  v_mfma_f32_32x32x16_bf16 v[48:63], v[16:19], v[112:115], 0
  ds_read_b64_tr_b16 v[32:33], v1 offset:22528
  ds_read_u16_d16_hi v87, v87 offset:36864
  ds_read_u16_d16 v86, v86 offset:36864
  buffer_store_dwordx4 v[168:171], v2, s[28:31], s40 offen offset:192 sc1
  v_fma_mix_f32 v93, v93, v9, 0 op_sel:[0,1,0] op_sel_hi:[0,1,0]
  v_cvt_pk_bf16_f32 v102, v102, v103
  v_fma_mix_f32 v109, v109, v11, 0 op_sel:[0,1,0] op_sel_hi:[0,1,0]
  v_cvt_pk_bf16_f32 v176, v176, v177
  v_cvt_pk_bf16_f32 v177, v178, v179
  v_mfma_f32_32x32x16_bf16 v[64:79], v[16:19], v[136:139], 0
  s_waitcnt lgkmcnt(7)
  ds_read_b64_tr_b16 v[34:35], v1 offset:22784
  v_cvt_pk_bf16_f32 v178, v180, v181
  v_cvt_pk_bf16_f32 v179, v182, v183
  v_or_b32 v82, v84, v85
  v_lshlrev_b32_sdwa v103, 1, v102 dst_sel:DWORD dst_unused:UNUSED_PAD src0_sel:DWORD src1_sel:WORD_1
  v_lshlrev_b32_sdwa v102, 1, v102 dst_sel:DWORD dst_unused:UNUSED_PAD src0_sel:DWORD src1_sel:WORD_0
  v_cvt_pk_bf16_f32 v184, v184, v185
  v_cvt_pk_bf16_f32 v185, v186, v187
  v_mfma_f32_32x32x16_bf16 v[48:63], v[20:23], v[116:119], v[48:63]
  ds_read_b64_tr_b16 v[36:37], v1 offset:23552
  ds_read_u16_d16_hi v103, v103 offset:36864
  ds_read_u16_d16 v102, v102 offset:36864
  v_cvt_pk_bf16_f32 v186, v188, v189
  v_cvt_pk_bf16_f32 v187, v190, v191
  s_nop 1
  v_permlane16_swap_b32 v176, v184
  v_permlane16_swap_b32 v177, v185
  v_permlane16_swap_b32 v178, v186
  v_permlane16_swap_b32 v179, v187
  v_mfma_f32_32x32x16_bf16 v[64:79], v[20:23], v[140:143], v[64:79]
  s_waitcnt lgkmcnt(7)
  ds_read_b64_tr_b16 v[38:39], v1 offset:23808
  buffer_store_dwordx4 v[176:179], v2, s[28:31], s40 offen offset:64 sc1
  v_mul_f32 v94, s37, v94
  v_mul_f32 v110, s37, v110
  v_cvt_pk_bf16_f32 v88, v88, v89
  v_mul_f32 v95, s37, v95
  v_or_b32 v98, v100, v101
  v_lshlrev_b32_sdwa v89, 1, v88 dst_sel:DWORD dst_unused:UNUSED_PAD src0_sel:DWORD src1_sel:WORD_1
  v_mfma_f32_32x32x16_bf16 v[48:63], v[24:27], v[120:123], v[48:63]
  s_waitcnt lgkmcnt(5)
  ds_read_u16_d16_hi v89, v89 offset:36864
  v_lshlrev_b32_sdwa v88, 1, v88 dst_sel:DWORD dst_unused:UNUSED_PAD src0_sel:DWORD src1_sel:WORD_0
  v_mul_f32 v111, s37, v111
  v_cvt_pk_f16_f32 v8, v94, v95
  v_cvt_pk_f16_f32 v10, v110, v111
  v_cvt_pk_bf16_f32 v104, v104, v105
  v_pk_fma_f16 v9, v8, v8, s56
  v_or_b32 v83, v86, v87
  v_lshlrev_b32_sdwa v105, 1, v104 dst_sel:DWORD dst_unused:UNUSED_PAD src0_sel:DWORD src1_sel:WORD_1
  v_mfma_f32_32x32x16_bf16 v[64:79], v[24:27], v[144:147], v[64:79]
  ds_read_u16_d16 v88, v88 offset:36864
  ds_read_u16_d16_hi v105, v105 offset:36864
  v_lshlrev_b32_sdwa v104, 1, v104 dst_sel:DWORD dst_unused:UNUSED_PAD src0_sel:DWORD src1_sel:WORD_0
  v_pk_fma_f16 v11, v10, v10, s56
  v_pk_mul_f16 v9, v8, v9 neg_lo:[0,1] neg_hi:[0,1]
  v_pk_mul_f16 v11, v10, v11 neg_lo:[0,1] neg_hi:[0,1]
  v_exp_f16 v8, v9
  v_mfma_f32_32x32x16_bf16 v[48:63], v[28:31], v[124:127], v[48:63]
  s_waitcnt lgkmcnt(3)
  s_barrier
  ds_read_b64_tr_b16 v[16:17], v7 offset:24576
  ds_read_b64_tr_b16 v[18:19], v7 offset:26112
  ds_read_u16_d16 v104, v104 offset:36864
  v_cvt_pk_bf16_f32 v90, v90, v91
  v_or_b32 v99, v102, v103
  v_lshlrev_b32_sdwa v91, 1, v90 dst_sel:DWORD dst_unused:UNUSED_PAD src0_sel:DWORD src1_sel:WORD_1
  v_lshlrev_b32_sdwa v90, 1, v90 dst_sel:DWORD dst_unused:UNUSED_PAD src0_sel:DWORD src1_sel:WORD_0
  v_exp_f16 v10, v11
  v_mfma_f32_32x32x16_bf16 v[64:79], v[28:31], v[148:151], v[64:79]
  s_waitcnt lgkmcnt(4)
  ds_read_b64_tr_b16 v[20:21], v7 offset:24640
  ds_read_b64_tr_b16 v[22:23], v7 offset:26176
  ds_read_u16_d16_hi v91, v91 offset:36864
  v_exp_f16_sdwa v8, v9 dst_sel:WORD_1 dst_unused:UNUSED_PRESERVE src0_sel:WORD_1
  v_add_u32 v0, 0, v6
  v_cvt_pk_bf16_f32 v106, v106, v107
  v_or_b32 v88, v88, v89
  v_mfma_f32_32x32x16_bf16 v[48:63], v[32:35], v[128:131], v[48:63]
  ds_read_b64_tr_b16 v[24:25], v7 offset:27648
  ds_read_u16_d16 v90, v90 offset:36864
  buffer_store_dwordx4 v[184:187], v2, s[28:31], s40 offen offset:256 sc1
  ds_read2_b32 v[40:41], v0 offset0:0 offset1:78
  v_lshlrev_b32_sdwa v107, 1, v106 dst_sel:DWORD dst_unused:UNUSED_PAD src0_sel:DWORD src1_sel:WORD_1
  v_lshlrev_b32_sdwa v106, 1, v106 dst_sel:DWORD dst_unused:UNUSED_PAD src0_sel:DWORD src1_sel:WORD_0
  v_exp_f16_sdwa v10, v11 dst_sel:WORD_1 dst_unused:UNUSED_PRESERVE src0_sel:WORD_1
  v_mfma_f32_32x32x16_bf16 v[64:79], v[32:35], v[152:155], v[64:79]
  ds_read_b64_tr_b16 v[26:27], v7 offset:29184
  ds_read_u16_d16_hi v107, v107 offset:36864
  ds_read_u16_d16 v106, v106 offset:36864
  ds_read2_b32 v[42:43], v0 offset0:156 offset1:234
  v_add_u32 v0, 2496, v6
  v_pk_fma_f16 v8, v8, s57, s57
  v_pk_fma_f16 v10, v10, s57, s57
  v_rcp_f16 v9, v8
  v_mfma_f32_32x32x16_bf16 v[48:63], v[36:39], v[132:135], v[48:63]
  s_waitcnt lgkmcnt(5)
  ds_read_b64_tr_b16 v[28:29], v7 offset:27712
  ds_read2_b32 v[44:45], v0 offset0:0 offset1:78
  ds_read2_b32 v[46:47], v0 offset0:156 offset1:234
  v_or_b32 v104, v104, v105
  v_rcp_f16 v11, v10
  v_rcp_f16_sdwa v9, v8 dst_sel:WORD_1 dst_unused:UNUSED_PRESERVE src0_sel:WORD_1
  v_or_b32 v89, v90, v91
  v_mfma_f32_32x32x16_bf16 v[64:79], v[36:39], v[156:159], v[64:79]
  ds_read_b64_tr_b16 v[30:31], v7 offset:29248
  v_cvt_pk_bf16_f32 v90, v92, v93
  v_rcp_f16_sdwa v11, v10 dst_sel:WORD_1 dst_unused:UNUSED_PRESERVE src0_sel:WORD_1
  v_cvt_pk_bf16_f32 v192, v192, v193
  v_cvt_pk_bf16_f32 v193, v194, v195
  v_cvt_pk_bf16_f32 v194, v196, v197
  v_cvt_pk_bf16_f32 v195, v198, v199
  v_fma_mix_f32 v94, v94, v9, 0 op_sel_hi:[0,1,0]
  v_mfma_f32_32x32x16_bf16 v[160:175], v[16:19], v[80:83], 0
  ds_read_b64_tr_b16 v[32:33], v7 offset:24704
  v_cvt_pk_bf16_f32 v200, v200, v201
  v_cvt_pk_bf16_f32 v201, v202, v203
  v_cvt_pk_bf16_f32 v202, v204, v205
  v_cvt_pk_bf16_f32 v203, v206, v207
  s_nop 1
  v_permlane16_swap_b32 v192, v200
  v_permlane16_swap_b32 v193, v201
  v_permlane16_swap_b32 v194, v202
  v_permlane16_swap_b32 v195, v203
  v_mfma_f32_32x32x16_bf16 v[208:223], v[16:19], v[96:99], v[208:223]
  s_waitcnt lgkmcnt(2)
  ds_read_b64_tr_b16 v[34:35], v7 offset:26240
  buffer_store_dwordx4 v[192:195], v2, s[28:31], s40 offen offset:128 sc1
  v_fma_mix_f32 v110, v110, v11, 0 op_sel_hi:[0,1,0]
  v_or_b32 v105, v106, v107
  v_cvt_pk_bf16_f32 v106, v108, v109
  v_smfmac_f32_32x32x32_bf16 v[160:175], v[12:15], v[40:47], v5
  v_fma_mix_f32 v95, v95, v9, 0 op_sel:[0,1,0] op_sel_hi:[0,1,0]
  v_fma_mix_f32 v111, v111, v11, 0 op_sel:[0,1,0] op_sel_hi:[0,1,0]
  v_cvt_pk_bf16_f32 v91, v94, v95
  v_cvt_pk_bf16_f32 v107, v110, v111
  v_cvt_pk_bf16_f32 v48, v48, v49
  v_lshlrev_b32_sdwa v49, 1, v48 dst_sel:DWORD dst_unused:UNUSED_PAD src0_sel:DWORD src1_sel:WORD_1
  v_mfma_f32_32x32x16_bf16 v[176:191], v[20:23], v[80:83], 0
  ds_read_b64_tr_b16 v[36:37], v7 offset:27776
  ds_read_u16_d16_hi v49, v49 offset:36864
  v_lshlrev_b32_sdwa v48, 1, v48 dst_sel:DWORD dst_unused:UNUSED_PAD src0_sel:DWORD src1_sel:WORD_0
  v_mul_f32 v60, s37, v60
  v_add_u32 v0, 4992, v6
  v_mul_f32 v76, s37, v76
  v_mul_f32 v61, s37, v61
  v_mfma_f32_32x32x16_bf16 v[224:239], v[20:23], v[96:99], v[224:239]
  ds_read_b64_tr_b16 v[38:39], v7 offset:29312
  ds_read_u16_d16 v48, v48 offset:36864
  ds_read2_b32 v[40:41], v0 offset0:0 offset1:78
  ds_read2_b32 v[42:43], v0 offset0:156 offset1:234
  v_add_u32 v0, 7488, v6
  v_mul_f32 v77, s37, v77
  v_cvt_pk_bf16_f32 v64, v64, v65
  v_mfma_f32_32x32x16_bf16 v[160:175], v[24:27], v[88:91], v[160:175]
  ds_read_b64_tr_b16 v[16:17], v1 offset:30720
  ds_read2_b32 v[44:45], v0 offset0:0 offset1:78
  ds_read2_b32 v[46:47], v0 offset0:156 offset1:234
  v_lshlrev_b32_sdwa v65, 1, v64 dst_sel:DWORD dst_unused:UNUSED_PAD src0_sel:DWORD src1_sel:WORD_1
  v_lshlrev_b32_sdwa v64, 1, v64 dst_sel:DWORD dst_unused:UNUSED_PAD src0_sel:DWORD src1_sel:WORD_0
  v_cvt_pk_f16_f32 v8, v60, v61
  v_cvt_pk_f16_f32 v10, v76, v77
  v_mfma_f32_32x32x16_bf16 v[208:223], v[24:27], v[104:107], v[208:223]
  s_waitcnt lgkmcnt(11)
  ds_read_b64_tr_b16 v[18:19], v1 offset:30976
  ds_read_u16_d16_hi v65, v65 offset:36864
  ds_read_u16_d16 v64, v64 offset:36864
  v_pk_fma_f16 v9, v8, v8, s56
  v_pk_fma_f16 v11, v10, v10, s56
  v_cvt_pk_bf16_f32 v50, v50, v51
  v_pk_mul_f16 v9, v8, v9 neg_lo:[0,1] neg_hi:[0,1]
  v_mfma_f32_32x32x16_bf16 v[176:191], v[28:31], v[88:91], v[176:191]
  ds_read_b64_tr_b16 v[20:21], v1 offset:31744
  buffer_store_dwordx4 v[200:203], v2, s[28:31], s40 offen offset:320 sc1
  s_add_u32 s40, s40, s41
  v_lshlrev_b32_sdwa v51, 1, v50 dst_sel:DWORD dst_unused:UNUSED_PAD src0_sel:DWORD src1_sel:WORD_1
  v_lshlrev_b32_sdwa v50, 1, v50 dst_sel:DWORD dst_unused:UNUSED_PAD src0_sel:DWORD src1_sel:WORD_0
  v_pk_mul_f16 v11, v10, v11 neg_lo:[0,1] neg_hi:[0,1]
  v_exp_f16 v8, v9
  v_mfma_f32_32x32x16_bf16 v[224:239], v[28:31], v[104:107], v[224:239]
  s_waitcnt lgkmcnt(4)
  ds_read_b64_tr_b16 v[22:23], v1 offset:32000
  ds_read_u16_d16_hi v51, v51 offset:36864
  ds_read_u16_d16 v50, v50 offset:36864
  v_exp_f16 v10, v11
  v_cvt_pk_bf16_f32 v66, v66, v67
  v_smfmac_f32_32x32x32_bf16 v[176:191], v[12:15], v[40:47], v5
  v_or_b32 v48, v48, v49
  v_lshlrev_b32_sdwa v67, 1, v66 dst_sel:DWORD dst_unused:UNUSED_PAD src0_sel:DWORD src1_sel:WORD_1
  v_lshlrev_b32_sdwa v66, 1, v66 dst_sel:DWORD dst_unused:UNUSED_PAD src0_sel:DWORD src1_sel:WORD_0
  v_exp_f16_sdwa v8, v9 dst_sel:WORD_1 dst_unused:UNUSED_PRESERVE src0_sel:WORD_1
  v_exp_f16_sdwa v10, v11 dst_sel:WORD_1 dst_unused:UNUSED_PRESERVE src0_sel:WORD_1
  v_mfma_f32_32x32x16_bf16 v[192:207], v[32:35], v[80:83], 0
  s_waitcnt lgkmcnt(4)
  ds_read_b64_tr_b16 v[24:25], v1 offset:32768
  ds_read_u16_d16_hi v67, v67 offset:36864
  ds_read_u16_d16 v66, v66 offset:36864
  v_cvt_pk_bf16_f32 v52, v52, v53
  v_or_b32 v64, v64, v65
  v_lshlrev_b32_sdwa v53, 1, v52 dst_sel:DWORD dst_unused:UNUSED_PAD src0_sel:DWORD src1_sel:WORD_1
  v_lshlrev_b32_sdwa v52, 1, v52 dst_sel:DWORD dst_unused:UNUSED_PAD src0_sel:DWORD src1_sel:WORD_0
  v_mfma_f32_32x32x16_bf16 v[240:255], v[32:35], v[96:99], v[240:255]
  ds_read_b64_tr_b16 v[26:27], v1 offset:33024
  ds_read_u16_d16_hi v53, v53 offset:36864
  ds_read_u16_d16 v52, v52 offset:36864
  v_pk_fma_f16 v8, v8, s57, s57
  v_add_u32 v0, 9984, v6
  v_pk_fma_f16 v10, v10, s57, s57
  v_rcp_f16 v9, v8
  v_mfma_f32_32x32x16_bf16 v[192:207], v[36:39], v[88:91], v[192:207]
  ds_read_b64_tr_b16 v[28:29], v1 offset:33792
  ds_read2_b32 v[40:41], v0 offset0:0 offset1:78
  ds_read2_b32 v[42:43], v0 offset0:156 offset1:234
  v_add_u32 v0, 12480, v6
  v_cvt_pk_bf16_f32 v68, v68, v69
  v_rcp_f16 v11, v10
  v_mfma_f32_32x32x16_bf16 v[240:255], v[36:39], v[104:107], v[240:255]
  s_waitcnt lgkmcnt(9)
  ds_read_b64_tr_b16 v[30:31], v1 offset:34048
  ds_read2_b32 v[44:45], v0 offset0:0 offset1:78
  ds_read2_b32 v[46:47], v0 offset0:156 offset1:234
  v_or_b32 v49, v50, v51
  v_lshlrev_b32_sdwa v69, 1, v68 dst_sel:DWORD dst_unused:UNUSED_PAD src0_sel:DWORD src1_sel:WORD_1
  v_lshlrev_b32_sdwa v68, 1, v68 dst_sel:DWORD dst_unused:UNUSED_PAD src0_sel:DWORD src1_sel:WORD_0
  v_mfma_f32_32x32x16_bf16 v[80:95], v[16:19], v[112:115], 0
  ds_read_b64_tr_b16 v[32:33], v1 offset:34816
  ds_read_u16_d16_hi v69, v69 offset:36864
  ds_read_u16_d16 v68, v68 offset:36864
  v_rcp_f16_sdwa v9, v8 dst_sel:WORD_1 dst_unused:UNUSED_PRESERVE src0_sel:WORD_1
  v_rcp_f16_sdwa v11, v10 dst_sel:WORD_1 dst_unused:UNUSED_PRESERVE src0_sel:WORD_1
  v_mfma_f32_32x32x16_bf16 v[96:111], v[16:19], v[136:139], 0
  s_waitcnt lgkmcnt(12)
  ds_read_b64_tr_b16 v[34:35], v1 offset:35072
  v_cvt_pk_bf16_f32 v54, v54, v55
  v_or_b32 v65, v66, v67
  v_lshlrev_b32_sdwa v55, 1, v54 dst_sel:DWORD dst_unused:UNUSED_PAD src0_sel:DWORD src1_sel:WORD_1
  v_lshlrev_b32_sdwa v54, 1, v54 dst_sel:DWORD dst_unused:UNUSED_PAD src0_sel:DWORD src1_sel:WORD_0
  v_fma_mix_f32 v60, v60, v9, 0 op_sel_hi:[0,1,0]
  v_fma_mix_f32 v76, v76, v11, 0 op_sel_hi:[0,1,0]
  v_mfma_f32_32x32x16_bf16 v[80:95], v[20:23], v[116:119], v[80:95]
  s_waitcnt lgkmcnt(10)
  ds_read_b64_tr_b16 v[36:37], v1 offset:35840
  ds_read_u16_d16_hi v55, v55 offset:36864
  ds_read_u16_d16 v54, v54 offset:36864
  v_fma_mix_f32 v61, v61, v9, 0 op_sel:[0,1,0] op_sel_hi:[0,1,0]
  v_cvt_pk_bf16_f32 v70, v70, v71
  v_fma_mix_f32 v77, v77, v11, 0 op_sel:[0,1,0] op_sel_hi:[0,1,0]
  v_or_b32 v50, v52, v53
  v_mfma_f32_32x32x16_bf16 v[96:111], v[20:23], v[140:143], v[96:111]
  ds_read_b64_tr_b16 v[38:39], v1 offset:36096
  v_lshlrev_b32_sdwa v71, 1, v70 dst_sel:DWORD dst_unused:UNUSED_PAD src0_sel:DWORD src1_sel:WORD_1
  v_lshlrev_b32_sdwa v70, 1, v70 dst_sel:DWORD dst_unused:UNUSED_PAD src0_sel:DWORD src1_sel:WORD_0
  v_mul_f32 v62, s37, v62
  v_mul_f32 v78, s37, v78
  v_cvt_pk_bf16_f32 v56, v56, v57
  v_mul_f32 v63, s37, v63
  v_mfma_f32_32x32x16_bf16 v[80:95], v[24:27], v[120:123], v[80:95]
  s_waitcnt lgkmcnt(5)
  ds_read_u16_d16_hi v71, v71 offset:36864
  ds_read_u16_d16 v70, v70 offset:36864
  v_or_b32 v66, v68, v69
  v_lshlrev_b32_sdwa v57, 1, v56 dst_sel:DWORD dst_unused:UNUSED_PAD src0_sel:DWORD src1_sel:WORD_1
  v_lshlrev_b32_sdwa v56, 1, v56 dst_sel:DWORD dst_unused:UNUSED_PAD src0_sel:DWORD src1_sel:WORD_0
  v_mul_f32 v79, s37, v79
  v_cvt_pk_f16_f32 v8, v62, v63
  v_cvt_pk_f16_f32 v10, v78, v79
  v_mfma_f32_32x32x16_bf16 v[96:111], v[24:27], v[144:147], v[96:111]
  s_waitcnt lgkmcnt(3)
  ds_read_u16_d16_hi v57, v57 offset:36864
  ds_read_u16_d16 v56, v56 offset:36864
  v_cvt_pk_bf16_f32 v72, v72, v73
  v_pk_fma_f16 v9, v8, v8, s56
  v_or_b32 v51, v54, v55
  v_lshlrev_b32_sdwa v73, 1, v72 dst_sel:DWORD dst_unused:UNUSED_PAD src0_sel:DWORD src1_sel:WORD_1
  v_lshlrev_b32_sdwa v72, 1, v72 dst_sel:DWORD dst_unused:UNUSED_PAD src0_sel:DWORD src1_sel:WORD_0
  v_smfmac_f32_32x32x32_bf16 v[192:207], v[12:15], v[40:47], v5
  s_waitcnt lgkmcnt(4)
  s_barrier
  ds_read_b64_tr_b16 v[16:17], v7 offset:0
  ds_read_b64_tr_b16 v[18:19], v7 offset:1536
  ds_read_u16_d16_hi v73, v73 offset:36864
  v_pk_fma_f16 v11, v10, v10, s56
  v_pk_mul_f16 v9, v8, v9 neg_lo:[0,1] neg_hi:[0,1]
  v_mfma_f32_32x32x16_bf16 v[80:95], v[28:31], v[124:127], v[80:95]
  s_waitcnt lgkmcnt(5)
  ds_read_b64_tr_b16 v[20:21], v7 offset:64
  ds_read_u16_d16 v72, v72 offset:36864
  v_pk_mul_f16 v11, v10, v11 neg_lo:[0,1] neg_hi:[0,1]
  v_exp_f16 v8, v9
  v_cvt_pk_bf16_f32 v58, v58, v59
  v_or_b32 v67, v70, v71
  v_mfma_f32_32x32x16_bf16 v[96:111], v[28:31], v[148:151], v[96:111]
  ds_read_b64_tr_b16 v[22:23], v7 offset:1600
  v_lshlrev_b32_sdwa v59, 1, v58 dst_sel:DWORD dst_unused:UNUSED_PAD src0_sel:DWORD src1_sel:WORD_1
  v_lshlrev_b32_sdwa v58, 1, v58 dst_sel:DWORD dst_unused:UNUSED_PAD src0_sel:DWORD src1_sel:WORD_0
  v_exp_f16 v10, v11
  v_exp_f16_sdwa v8, v9 dst_sel:WORD_1 dst_unused:UNUSED_PRESERVE src0_sel:WORD_1
  v_mfma_f32_32x32x16_bf16 v[80:95], v[32:35], v[128:131], v[80:95]
  s_waitcnt lgkmcnt(6)
  ds_read_b64_tr_b16 v[24:25], v7 offset:3072
  ds_read_u16_d16_hi v59, v59 offset:36864
  ds_read_u16_d16 v58, v58 offset:36864
  v_cvt_pk_bf16_f32 v74, v74, v75
  v_or_b32 v56, v56, v57
  v_lshlrev_b32_sdwa v75, 1, v74 dst_sel:DWORD dst_unused:UNUSED_PAD src0_sel:DWORD src1_sel:WORD_1
  v_lshlrev_b32_sdwa v74, 1, v74 dst_sel:DWORD dst_unused:UNUSED_PAD src0_sel:DWORD src1_sel:WORD_0
  v_mfma_f32_32x32x16_bf16 v[96:111], v[32:35], v[152:155], v[96:111]
  ds_read_b64_tr_b16 v[26:27], v7 offset:4608
  ds_read_u16_d16_hi v75, v75 offset:36864
  ds_read_u16_d16 v74, v74 offset:36864
  v_exp_f16_sdwa v10, v11 dst_sel:WORD_1 dst_unused:UNUSED_PRESERVE src0_sel:WORD_1
  v_pk_fma_f16 v8, v8, s57, s57
  v_pk_fma_f16 v10, v10, s57, s57
  v_mfma_f32_32x32x16_bf16 v[80:95], v[36:39], v[132:135], v[80:95]
  s_waitcnt lgkmcnt(7)
  ds_read_b64_tr_b16 v[28:29], v7 offset:3136
  v_rcp_f16 v9, v8
  v_or_b32 v72, v72, v73
  v_rcp_f16 v11, v10
  v_rcp_f16_sdwa v9, v8 dst_sel:WORD_1 dst_unused:UNUSED_PRESERVE src0_sel:WORD_1
  v_mfma_f32_32x32x16_bf16 v[96:111], v[36:39], v[156:159], v[96:111]
  s_waitcnt lgkmcnt(4)
  ds_read_b64_tr_b16 v[30:31], v7 offset:4672
  v_or_b32 v57, v58, v59
  v_cvt_pk_bf16_f32 v58, v60, v61
  v_rcp_f16_sdwa v11, v10 dst_sel:WORD_1 dst_unused:UNUSED_PRESERVE src0_sel:WORD_1
  v_fma_mix_f32 v62, v62, v9, 0 op_sel_hi:[0,1,0]
  v_mfma_f32_32x32x16_bf16 v[160:175], v[16:19], v[48:51], v[160:175]
  s_waitcnt lgkmcnt(2)
  ds_read_b64_tr_b16 v[32:33], v7 offset:128
  v_fma_mix_f32 v78, v78, v11, 0 op_sel_hi:[0,1,0]
  v_or_b32 v73, v74, v75
  v_cvt_pk_bf16_f32 v74, v76, v77
  v_fma_mix_f32 v63, v63, v9, 0 op_sel:[0,1,0] op_sel_hi:[0,1,0]
  v_fma_mix_f32 v79, v79, v11, 0 op_sel:[0,1,0] op_sel_hi:[0,1,0]
  v_cvt_pk_bf16_f32 v59, v62, v63
  v_mfma_f32_32x32x16_bf16 v[208:223], v[16:19], v[64:67], v[208:223]
  ds_read_b64_tr_b16 v[34:35], v7 offset:1664
  v_cvt_pk_bf16_f32 v75, v78, v79
  v_cvt_pk_bf16_f32 v80, v80, v81
  v_lshlrev_b32_sdwa v81, 1, v80 dst_sel:DWORD dst_unused:UNUSED_PAD src0_sel:DWORD src1_sel:WORD_1
  v_lshlrev_b32_sdwa v80, 1, v80 dst_sel:DWORD dst_unused:UNUSED_PAD src0_sel:DWORD src1_sel:WORD_0
  v_mul_f32 v92, s37, v92
  v_mul_f32 v108, s37, v108
  v_mfma_f32_32x32x16_bf16 v[176:191], v[20:23], v[48:51], v[176:191]
  ds_read_b64_tr_b16 v[36:37], v7 offset:3200
  ds_read_u16_d16_hi v81, v81 offset:36864
  ds_read_u16_d16 v80, v80 offset:36864
  v_mul_f32 v93, s37, v93
  v_mul_f32 v109, s37, v109
  v_cvt_pk_bf16_f32 v96, v96, v97
  v_lshlrev_b32_sdwa v97, 1, v96 dst_sel:DWORD dst_unused:UNUSED_PAD src0_sel:DWORD src1_sel:WORD_1
  v_mfma_f32_32x32x16_bf16 v[224:239], v[20:23], v[64:67], v[224:239]
  ds_read_b64_tr_b16 v[38:39], v7 offset:4736
  ds_read_u16_d16_hi v97, v97 offset:36864
  v_lshlrev_b32_sdwa v96, 1, v96 dst_sel:DWORD dst_unused:UNUSED_PAD src0_sel:DWORD src1_sel:WORD_0
  v_cvt_pk_f16_f32 v8, v92, v93
  v_cvt_pk_f16_f32 v10, v108, v109
  v_pk_fma_f16 v9, v8, v8, s56
  v_pk_fma_f16 v11, v10, v10, s56
  v_mfma_f32_32x32x16_bf16 v[160:175], v[24:27], v[56:59], v[160:175]
  ds_read_b64_tr_b16 v[16:17], v1 offset:6144
  ds_read_u16_d16 v96, v96 offset:36864
  v_cvt_pk_bf16_f32 v82, v82, v83
  v_pk_mul_f16 v9, v8, v9 neg_lo:[0,1] neg_hi:[0,1]
  v_lshlrev_b32_sdwa v83, 1, v82 dst_sel:DWORD dst_unused:UNUSED_PAD src0_sel:DWORD src1_sel:WORD_1
  v_lshlrev_b32_sdwa v82, 1, v82 dst_sel:DWORD dst_unused:UNUSED_PAD src0_sel:DWORD src1_sel:WORD_0
  v_pk_mul_f16 v11, v10, v11 neg_lo:[0,1] neg_hi:[0,1]
  v_mfma_f32_32x32x16_bf16 v[208:223], v[24:27], v[72:75], v[208:223]
  s_waitcnt lgkmcnt(9)
  ds_read_b64_tr_b16 v[18:19], v1 offset:6400
  ds_read_u16_d16_hi v83, v83 offset:36864
  ds_read_u16_d16 v82, v82 offset:36864
  v_exp_f16 v8, v9
  v_exp_f16 v10, v11
  v_mfma_f32_32x32x16_bf16 v[176:191], v[28:31], v[56:59], v[176:191]
  s_waitcnt lgkmcnt(7)
  ds_read_b64_tr_b16 v[20:21], v1 offset:7168
  v_cvt_pk_bf16_f32 v98, v98, v99
  v_or_b32 v80, v80, v81
  v_lshlrev_b32_sdwa v99, 1, v98 dst_sel:DWORD dst_unused:UNUSED_PAD src0_sel:DWORD src1_sel:WORD_1
  v_lshlrev_b32_sdwa v98, 1, v98 dst_sel:DWORD dst_unused:UNUSED_PAD src0_sel:DWORD src1_sel:WORD_0
  v_exp_f16_sdwa v8, v9 dst_sel:WORD_1 dst_unused:UNUSED_PRESERVE src0_sel:WORD_1
  v_mfma_f32_32x32x16_bf16 v[224:239], v[28:31], v[72:75], v[224:239]
  ds_read_b64_tr_b16 v[22:23], v1 offset:7424
  ds_read_u16_d16_hi v99, v99 offset:36864
  ds_read_u16_d16 v98, v98 offset:36864
  v_exp_f16_sdwa v10, v11 dst_sel:WORD_1 dst_unused:UNUSED_PRESERVE src0_sel:WORD_1
  v_cvt_pk_bf16_f32 v84, v84, v85
  v_mfma_f32_32x32x16_bf16 v[192:207], v[32:35], v[48:51], v[192:207]
  s_waitcnt lgkmcnt(7)
  ds_read_b64_tr_b16 v[24:25], v1 offset:8192
  v_or_b32 v96, v96, v97
  v_lshlrev_b32_sdwa v85, 1, v84 dst_sel:DWORD dst_unused:UNUSED_PAD src0_sel:DWORD src1_sel:WORD_1
  v_lshlrev_b32_sdwa v84, 1, v84 dst_sel:DWORD dst_unused:UNUSED_PAD src0_sel:DWORD src1_sel:WORD_0
  v_pk_fma_f16 v8, v8, s57, s57
  v_pk_fma_f16 v10, v10, s57, s57
  v_rcp_f16 v9, v8
  v_mfma_f32_32x32x16_bf16 v[240:255], v[32:35], v[64:67], v[240:255]
  ds_read_b64_tr_b16 v[26:27], v1 offset:8448
  ds_read_u16_d16_hi v85, v85 offset:36864
  ds_read_u16_d16 v84, v84 offset:36864
  v_cvt_pk_bf16_f32 v100, v100, v101
  v_rcp_f16 v11, v10
  v_mfma_f32_32x32x16_bf16 v[192:207], v[36:39], v[56:59], v[192:207]
  s_waitcnt lgkmcnt(8)
  ds_read_b64_tr_b16 v[28:29], v1 offset:9216
  v_or_b32 v81, v82, v83
  v_lshlrev_b32_sdwa v101, 1, v100 dst_sel:DWORD dst_unused:UNUSED_PAD src0_sel:DWORD src1_sel:WORD_1
  v_lshlrev_b32_sdwa v100, 1, v100 dst_sel:DWORD dst_unused:UNUSED_PAD src0_sel:DWORD src1_sel:WORD_0
  v_rcp_f16_sdwa v9, v8 dst_sel:WORD_1 dst_unused:UNUSED_PRESERVE src0_sel:WORD_1
  v_rcp_f16_sdwa v11, v10 dst_sel:WORD_1 dst_unused:UNUSED_PRESERVE src0_sel:WORD_1
  v_mfma_f32_32x32x16_bf16 v[240:255], v[36:39], v[72:75], v[240:255]
  s_waitcnt lgkmcnt(5)
  ds_read_b64_tr_b16 v[30:31], v1 offset:9472
  ds_read_u16_d16_hi v101, v101 offset:36864
  ds_read_u16_d16 v100, v100 offset:36864
  v_cvt_pk_bf16_f32 v86, v86, v87
  v_or_b32 v97, v98, v99
  v_mfma_f32_32x32x16_bf16 v[48:63], v[16:19], v[112:115], 0
  ds_read_b64_tr_b16 v[32:33], v1 offset:10240
  v_lshlrev_b32_sdwa v87, 1, v86 dst_sel:DWORD dst_unused:UNUSED_PAD src0_sel:DWORD src1_sel:WORD_1
  v_lshlrev_b32_sdwa v86, 1, v86 dst_sel:DWORD dst_unused:UNUSED_PAD src0_sel:DWORD src1_sel:WORD_0
  v_fma_mix_f32 v92, v92, v9, 0 op_sel_hi:[0,1,0]
  v_fma_mix_f32 v108, v108, v11, 0 op_sel_hi:[0,1,0]
  v_fma_mix_f32 v93, v93, v9, 0 op_sel:[0,1,0] op_sel_hi:[0,1,0]
  v_cvt_pk_bf16_f32 v102, v102, v103
  v_mfma_f32_32x32x16_bf16 v[64:79], v[16:19], v[136:139], 0
  s_waitcnt lgkmcnt(5)
  ds_read_b64_tr_b16 v[34:35], v1 offset:10496
  ds_read_u16_d16_hi v87, v87 offset:36864
  ds_read_u16_d16 v86, v86 offset:36864
  v_fma_mix_f32 v109, v109, v11, 0 op_sel:[0,1,0] op_sel_hi:[0,1,0]
  v_or_b32 v82, v84, v85
  v_lshlrev_b32_sdwa v103, 1, v102 dst_sel:DWORD dst_unused:UNUSED_PAD src0_sel:DWORD src1_sel:WORD_1
  v_lshlrev_b32_sdwa v102, 1, v102 dst_sel:DWORD dst_unused:UNUSED_PAD src0_sel:DWORD src1_sel:WORD_0
  v_mfma_f32_32x32x16_bf16 v[48:63], v[20:23], v[116:119], v[48:63]
  ds_read_b64_tr_b16 v[36:37], v1 offset:11264
  ds_read_u16_d16_hi v103, v103 offset:36864
  ds_read_u16_d16 v102, v102 offset:36864
  v_mul_f32 v94, s37, v94
  v_mul_f32 v110, s37, v110
  v_cvt_pk_bf16_f32 v88, v88, v89
  v_mul_f32 v95, s37, v95
  v_mfma_f32_32x32x16_bf16 v[64:79], v[20:23], v[140:143], v[64:79]
  s_waitcnt lgkmcnt(7)
  ds_read_b64_tr_b16 v[38:39], v1 offset:11520
  v_or_b32 v98, v100, v101
  v_lshlrev_b32_sdwa v89, 1, v88 dst_sel:DWORD dst_unused:UNUSED_PAD src0_sel:DWORD src1_sel:WORD_1
  v_lshlrev_b32_sdwa v88, 1, v88 dst_sel:DWORD dst_unused:UNUSED_PAD src0_sel:DWORD src1_sel:WORD_0
  v_mul_f32 v111, s37, v111
  v_cvt_pk_f16_f32 v8, v94, v95
  v_cvt_pk_f16_f32 v10, v110, v111
  v_mfma_f32_32x32x16_bf16 v[48:63], v[24:27], v[120:123], v[48:63]
  s_waitcnt lgkmcnt(4)
  ds_read_u16_d16_hi v89, v89 offset:36864
  ds_read_u16_d16 v88, v88 offset:36864
  v_cvt_pk_bf16_f32 v104, v104, v105
  v_pk_fma_f16 v9, v8, v8, s56
  v_or_b32 v83, v86, v87
  v_lshlrev_b32_sdwa v105, 1, v104 dst_sel:DWORD dst_unused:UNUSED_PAD src0_sel:DWORD src1_sel:WORD_1
  v_lshlrev_b32_sdwa v104, 1, v104 dst_sel:DWORD dst_unused:UNUSED_PAD src0_sel:DWORD src1_sel:WORD_0
  v_mfma_f32_32x32x16_bf16 v[64:79], v[24:27], v[144:147], v[64:79]
  ds_read_u16_d16_hi v105, v105 offset:36864
  ds_read_u16_d16 v104, v104 offset:36864
  v_pk_fma_f16 v11, v10, v10, s56
  v_pk_mul_f16 v9, v8, v9 neg_lo:[0,1] neg_hi:[0,1]
  v_pk_mul_f16 v11, v10, v11 neg_lo:[0,1] neg_hi:[0,1]
  v_exp_f16 v8, v9
  v_mfma_f32_32x32x16_bf16 v[48:63], v[28:31], v[124:127], v[48:63]
  s_waitcnt lgkmcnt(4)
  s_barrier
  ds_read_b64_tr_b16 v[16:17], v7 offset:12288
  ds_read_b64_tr_b16 v[18:19], v7 offset:13824
  v_cvt_pk_bf16_f32 v90, v90, v91
  v_or_b32 v99, v102, v103
  v_lshlrev_b32_sdwa v91, 1, v90 dst_sel:DWORD dst_unused:UNUSED_PAD src0_sel:DWORD src1_sel:WORD_1
  v_mfma_f32_32x32x16_bf16 v[64:79], v[28:31], v[148:151], v[64:79]
  ds_read_b64_tr_b16 v[20:21], v7 offset:12352
  ds_read_b64_tr_b16 v[22:23], v7 offset:13888
  ds_read_u16_d16_hi v91, v91 offset:36864
  v_lshlrev_b32_sdwa v90, 1, v90 dst_sel:DWORD dst_unused:UNUSED_PAD src0_sel:DWORD src1_sel:WORD_0
  v_exp_f16 v10, v11
  v_exp_f16_sdwa v8, v9 dst_sel:WORD_1 dst_unused:UNUSED_PRESERVE src0_sel:WORD_1
  v_mfma_f32_32x32x16_bf16 v[48:63], v[32:35], v[128:131], v[48:63]
  s_waitcnt lgkmcnt(7)
  ds_read_b64_tr_b16 v[24:25], v7 offset:15360
  ds_read_u16_d16 v90, v90 offset:36864
  v_cvt_pk_bf16_f32 v106, v106, v107
  v_or_b32 v88, v88, v89
  v_lshlrev_b32_sdwa v107, 1, v106 dst_sel:DWORD dst_unused:UNUSED_PAD src0_sel:DWORD src1_sel:WORD_1
  v_lshlrev_b32_sdwa v106, 1, v106 dst_sel:DWORD dst_unused:UNUSED_PAD src0_sel:DWORD src1_sel:WORD_0
  v_mfma_f32_32x32x16_bf16 v[64:79], v[32:35], v[152:155], v[64:79]
  ds_read_b64_tr_b16 v[26:27], v7 offset:16896
  ds_read_u16_d16_hi v107, v107 offset:36864
  ds_read_u16_d16 v106, v106 offset:36864
  v_exp_f16_sdwa v10, v11 dst_sel:WORD_1 dst_unused:UNUSED_PRESERVE src0_sel:WORD_1
  v_pk_fma_f16 v8, v8, s57, s57
  v_pk_fma_f16 v10, v10, s57, s57
  v_mfma_f32_32x32x16_bf16 v[48:63], v[36:39], v[132:135], v[48:63]
  s_waitcnt lgkmcnt(10)
  ds_read_b64_tr_b16 v[28:29], v7 offset:15424
  v_rcp_f16 v9, v8
  v_or_b32 v104, v104, v105
  v_rcp_f16 v11, v10
  v_rcp_f16_sdwa v9, v8 dst_sel:WORD_1 dst_unused:UNUSED_PRESERVE src0_sel:WORD_1
  v_mfma_f32_32x32x16_bf16 v[64:79], v[36:39], v[156:159], v[64:79]
  s_waitcnt lgkmcnt(4)
  ds_read_b64_tr_b16 v[30:31], v7 offset:16960
  v_or_b32 v89, v90, v91
  v_cvt_pk_bf16_f32 v90, v92, v93
  v_rcp_f16_sdwa v11, v10 dst_sel:WORD_1 dst_unused:UNUSED_PRESERVE src0_sel:WORD_1
  v_fma_mix_f32 v94, v94, v9, 0 op_sel_hi:[0,1,0]
  v_mfma_f32_32x32x16_bf16 v[160:175], v[16:19], v[80:83], v[160:175]
  s_waitcnt lgkmcnt(2)
  ds_read_b64_tr_b16 v[32:33], v7 offset:12416
  v_fma_mix_f32 v110, v110, v11, 0 op_sel_hi:[0,1,0]
  v_or_b32 v105, v106, v107
  v_cvt_pk_bf16_f32 v106, v108, v109
  v_fma_mix_f32 v95, v95, v9, 0 op_sel:[0,1,0] op_sel_hi:[0,1,0]
  v_fma_mix_f32 v111, v111, v11, 0 op_sel:[0,1,0] op_sel_hi:[0,1,0]
  v_cvt_pk_bf16_f32 v91, v94, v95
  v_mfma_f32_32x32x16_bf16 v[208:223], v[16:19], v[96:99], v[208:223]
  ds_read_b64_tr_b16 v[34:35], v7 offset:13952
  v_cvt_pk_bf16_f32 v107, v110, v111
  v_cvt_pk_bf16_f32 v48, v48, v49
  v_lshlrev_b32_sdwa v49, 1, v48 dst_sel:DWORD dst_unused:UNUSED_PAD src0_sel:DWORD src1_sel:WORD_1
  v_lshlrev_b32_sdwa v48, 1, v48 dst_sel:DWORD dst_unused:UNUSED_PAD src0_sel:DWORD src1_sel:WORD_0
  v_mul_f32 v60, s37, v60
  v_mul_f32 v76, s37, v76
  v_mfma_f32_32x32x16_bf16 v[176:191], v[20:23], v[80:83], v[176:191]
  ds_read_b64_tr_b16 v[36:37], v7 offset:15488
  ds_read_u16_d16_hi v49, v49 offset:36864
  ds_read_u16_d16 v48, v48 offset:36864
  v_mul_f32 v61, s37, v61
  v_mul_f32 v77, s37, v77
  v_cvt_pk_bf16_f32 v64, v64, v65
  v_lshlrev_b32_sdwa v65, 1, v64 dst_sel:DWORD dst_unused:UNUSED_PAD src0_sel:DWORD src1_sel:WORD_1
  v_mfma_f32_32x32x16_bf16 v[224:239], v[20:23], v[96:99], v[224:239]
  ds_read_b64_tr_b16 v[38:39], v7 offset:17024
  ds_read_u16_d16_hi v65, v65 offset:36864
  v_lshlrev_b32_sdwa v64, 1, v64 dst_sel:DWORD dst_unused:UNUSED_PAD src0_sel:DWORD src1_sel:WORD_0
  v_cvt_pk_f16_f32 v8, v60, v61
  v_cvt_pk_f16_f32 v10, v76, v77
  v_pk_fma_f16 v9, v8, v8, s56
  v_pk_fma_f16 v11, v10, v10, s56
  v_mfma_f32_32x32x16_bf16 v[160:175], v[24:27], v[88:91], v[160:175]
  ds_read_b64_tr_b16 v[16:17], v1 offset:18432
  ds_read_u16_d16 v64, v64 offset:36864
  v_cvt_pk_bf16_f32 v50, v50, v51
  v_pk_mul_f16 v9, v8, v9 neg_lo:[0,1] neg_hi:[0,1]
  v_lshlrev_b32_sdwa v51, 1, v50 dst_sel:DWORD dst_unused:UNUSED_PAD src0_sel:DWORD src1_sel:WORD_1
  v_lshlrev_b32_sdwa v50, 1, v50 dst_sel:DWORD dst_unused:UNUSED_PAD src0_sel:DWORD src1_sel:WORD_0
  v_pk_mul_f16 v11, v10, v11 neg_lo:[0,1] neg_hi:[0,1]
  v_mfma_f32_32x32x16_bf16 v[208:223], v[24:27], v[104:107], v[208:223]
  s_waitcnt lgkmcnt(9)
  ds_read_b64_tr_b16 v[18:19], v1 offset:18688
  ds_read_u16_d16_hi v51, v51 offset:36864
  ds_read_u16_d16 v50, v50 offset:36864
  v_exp_f16 v8, v9
  v_exp_f16 v10, v11
  v_mfma_f32_32x32x16_bf16 v[176:191], v[28:31], v[88:91], v[176:191]
  s_waitcnt lgkmcnt(7)
  ds_read_b64_tr_b16 v[20:21], v1 offset:19456
  v_cvt_pk_bf16_f32 v66, v66, v67
  v_or_b32 v48, v48, v49
  v_lshlrev_b32_sdwa v67, 1, v66 dst_sel:DWORD dst_unused:UNUSED_PAD src0_sel:DWORD src1_sel:WORD_1
  v_lshlrev_b32_sdwa v66, 1, v66 dst_sel:DWORD dst_unused:UNUSED_PAD src0_sel:DWORD src1_sel:WORD_0
  v_exp_f16_sdwa v8, v9 dst_sel:WORD_1 dst_unused:UNUSED_PRESERVE src0_sel:WORD_1
  v_mfma_f32_32x32x16_bf16 v[224:239], v[28:31], v[104:107], v[224:239]
  ds_read_b64_tr_b16 v[22:23], v1 offset:19712
  ds_read_u16_d16_hi v67, v67 offset:36864
  ds_read_u16_d16 v66, v66 offset:36864
  v_exp_f16_sdwa v10, v11 dst_sel:WORD_1 dst_unused:UNUSED_PRESERVE src0_sel:WORD_1
  v_cvt_pk_bf16_f32 v52, v52, v53
  v_mfma_f32_32x32x16_bf16 v[192:207], v[32:35], v[80:83], v[192:207]
  s_waitcnt lgkmcnt(7)
  ds_read_b64_tr_b16 v[24:25], v1 offset:20480
  v_or_b32 v64, v64, v65
  v_lshlrev_b32_sdwa v53, 1, v52 dst_sel:DWORD dst_unused:UNUSED_PAD src0_sel:DWORD src1_sel:WORD_1
  v_lshlrev_b32_sdwa v52, 1, v52 dst_sel:DWORD dst_unused:UNUSED_PAD src0_sel:DWORD src1_sel:WORD_0
  v_pk_fma_f16 v8, v8, s57, s57
  v_pk_fma_f16 v10, v10, s57, s57
  v_rcp_f16 v9, v8
  v_mfma_f32_32x32x16_bf16 v[240:255], v[32:35], v[96:99], v[240:255]
  ds_read_b64_tr_b16 v[26:27], v1 offset:20736
  ds_read_u16_d16_hi v53, v53 offset:36864
  ds_read_u16_d16 v52, v52 offset:36864
  v_cvt_pk_bf16_f32 v68, v68, v69
  v_rcp_f16 v11, v10
  v_mfma_f32_32x32x16_bf16 v[192:207], v[36:39], v[88:91], v[192:207]
  s_waitcnt lgkmcnt(8)
  ds_read_b64_tr_b16 v[28:29], v1 offset:21504
  v_or_b32 v49, v50, v51
  v_lshlrev_b32_sdwa v69, 1, v68 dst_sel:DWORD dst_unused:UNUSED_PAD src0_sel:DWORD src1_sel:WORD_1
  v_lshlrev_b32_sdwa v68, 1, v68 dst_sel:DWORD dst_unused:UNUSED_PAD src0_sel:DWORD src1_sel:WORD_0
  v_rcp_f16_sdwa v9, v8 dst_sel:WORD_1 dst_unused:UNUSED_PRESERVE src0_sel:WORD_1
  v_rcp_f16_sdwa v11, v10 dst_sel:WORD_1 dst_unused:UNUSED_PRESERVE src0_sel:WORD_1
  v_mfma_f32_32x32x16_bf16 v[240:255], v[36:39], v[104:107], v[240:255]
  s_waitcnt lgkmcnt(5)
  ds_read_b64_tr_b16 v[30:31], v1 offset:21760
  ds_read_u16_d16_hi v69, v69 offset:36864
  ds_read_u16_d16 v68, v68 offset:36864
  v_cvt_pk_bf16_f32 v54, v54, v55
  v_or_b32 v65, v66, v67
  v_mfma_f32_32x32x16_bf16 v[80:95], v[16:19], v[112:115], 0
  ds_read_b64_tr_b16 v[32:33], v1 offset:22528
  v_lshlrev_b32_sdwa v55, 1, v54 dst_sel:DWORD dst_unused:UNUSED_PAD src0_sel:DWORD src1_sel:WORD_1
  v_lshlrev_b32_sdwa v54, 1, v54 dst_sel:DWORD dst_unused:UNUSED_PAD src0_sel:DWORD src1_sel:WORD_0
  v_fma_mix_f32 v60, v60, v9, 0 op_sel_hi:[0,1,0]
  v_fma_mix_f32 v76, v76, v11, 0 op_sel_hi:[0,1,0]
  v_fma_mix_f32 v61, v61, v9, 0 op_sel:[0,1,0] op_sel_hi:[0,1,0]
  v_cvt_pk_bf16_f32 v70, v70, v71
  v_mfma_f32_32x32x16_bf16 v[96:111], v[16:19], v[136:139], 0
  s_waitcnt lgkmcnt(5)
  ds_read_b64_tr_b16 v[34:35], v1 offset:22784
  ds_read_u16_d16_hi v55, v55 offset:36864
  ds_read_u16_d16 v54, v54 offset:36864
  v_fma_mix_f32 v77, v77, v11, 0 op_sel:[0,1,0] op_sel_hi:[0,1,0]
  v_or_b32 v50, v52, v53
  v_lshlrev_b32_sdwa v71, 1, v70 dst_sel:DWORD dst_unused:UNUSED_PAD src0_sel:DWORD src1_sel:WORD_1
  v_lshlrev_b32_sdwa v70, 1, v70 dst_sel:DWORD dst_unused:UNUSED_PAD src0_sel:DWORD src1_sel:WORD_0
  v_mfma_f32_32x32x16_bf16 v[80:95], v[20:23], v[116:119], v[80:95]
  ds_read_b64_tr_b16 v[36:37], v1 offset:23552
  ds_read_u16_d16_hi v71, v71 offset:36864
  ds_read_u16_d16 v70, v70 offset:36864
  v_mul_f32 v62, s37, v62
  v_mul_f32 v78, s37, v78
  v_cvt_pk_bf16_f32 v56, v56, v57
  v_mul_f32 v63, s37, v63
  v_mfma_f32_32x32x16_bf16 v[96:111], v[20:23], v[140:143], v[96:111]
  s_waitcnt lgkmcnt(7)
  ds_read_b64_tr_b16 v[38:39], v1 offset:23808
  v_or_b32 v66, v68, v69
  v_lshlrev_b32_sdwa v57, 1, v56 dst_sel:DWORD dst_unused:UNUSED_PAD src0_sel:DWORD src1_sel:WORD_1
  v_lshlrev_b32_sdwa v56, 1, v56 dst_sel:DWORD dst_unused:UNUSED_PAD src0_sel:DWORD src1_sel:WORD_0
  v_mul_f32 v79, s37, v79
  v_cvt_pk_f16_f32 v8, v62, v63
  v_cvt_pk_f16_f32 v10, v78, v79
  v_mfma_f32_32x32x16_bf16 v[80:95], v[24:27], v[120:123], v[80:95]
  s_waitcnt lgkmcnt(4)
  ds_read_u16_d16_hi v57, v57 offset:36864
  ds_read_u16_d16 v56, v56 offset:36864
  v_cvt_pk_bf16_f32 v72, v72, v73
  v_pk_fma_f16 v9, v8, v8, s56
  v_or_b32 v51, v54, v55
  v_lshlrev_b32_sdwa v73, 1, v72 dst_sel:DWORD dst_unused:UNUSED_PAD src0_sel:DWORD src1_sel:WORD_1
  v_lshlrev_b32_sdwa v72, 1, v72 dst_sel:DWORD dst_unused:UNUSED_PAD src0_sel:DWORD src1_sel:WORD_0
  v_mfma_f32_32x32x16_bf16 v[96:111], v[24:27], v[144:147], v[96:111]
  ds_read_u16_d16_hi v73, v73 offset:36864
  ds_read_u16_d16 v72, v72 offset:36864
  v_pk_fma_f16 v11, v10, v10, s56
  v_pk_mul_f16 v9, v8, v9 neg_lo:[0,1] neg_hi:[0,1]
  v_pk_mul_f16 v11, v10, v11 neg_lo:[0,1] neg_hi:[0,1]
  v_exp_f16 v8, v9
  v_mfma_f32_32x32x16_bf16 v[80:95], v[28:31], v[124:127], v[80:95]
  s_waitcnt lgkmcnt(4)
  s_barrier
  ds_read_b64_tr_b16 v[16:17], v7 offset:24576
  ds_read_b64_tr_b16 v[18:19], v7 offset:26112
  v_cvt_pk_bf16_f32 v58, v58, v59
  v_or_b32 v67, v70, v71
  v_lshlrev_b32_sdwa v59, 1, v58 dst_sel:DWORD dst_unused:UNUSED_PAD src0_sel:DWORD src1_sel:WORD_1
  v_mfma_f32_32x32x16_bf16 v[96:111], v[28:31], v[148:151], v[96:111]
  ds_read_b64_tr_b16 v[20:21], v7 offset:24640
  ds_read_b64_tr_b16 v[22:23], v7 offset:26176
  ds_read_u16_d16_hi v59, v59 offset:36864
  v_lshlrev_b32_sdwa v58, 1, v58 dst_sel:DWORD dst_unused:UNUSED_PAD src0_sel:DWORD src1_sel:WORD_0
  v_exp_f16 v10, v11
  v_exp_f16_sdwa v8, v9 dst_sel:WORD_1 dst_unused:UNUSED_PRESERVE src0_sel:WORD_1
  v_mfma_f32_32x32x16_bf16 v[80:95], v[32:35], v[128:131], v[80:95]
  s_waitcnt lgkmcnt(7)
  ds_read_b64_tr_b16 v[24:25], v7 offset:27648
  ds_read_u16_d16 v58, v58 offset:36864
  v_cvt_pk_bf16_f32 v74, v74, v75
  v_or_b32 v56, v56, v57
  v_lshlrev_b32_sdwa v75, 1, v74 dst_sel:DWORD dst_unused:UNUSED_PAD src0_sel:DWORD src1_sel:WORD_1
  v_lshlrev_b32_sdwa v74, 1, v74 dst_sel:DWORD dst_unused:UNUSED_PAD src0_sel:DWORD src1_sel:WORD_0
  v_mfma_f32_32x32x16_bf16 v[96:111], v[32:35], v[152:155], v[96:111]
  ds_read_b64_tr_b16 v[26:27], v7 offset:29184
  ds_read_u16_d16_hi v75, v75 offset:36864
  ds_read_u16_d16 v74, v74 offset:36864
  v_exp_f16_sdwa v10, v11 dst_sel:WORD_1 dst_unused:UNUSED_PRESERVE src0_sel:WORD_1
  v_pk_fma_f16 v8, v8, s57, s57
  v_pk_fma_f16 v10, v10, s57, s57
  v_mfma_f32_32x32x16_bf16 v[80:95], v[36:39], v[132:135], v[80:95]
  s_waitcnt lgkmcnt(10)
  ds_read_b64_tr_b16 v[28:29], v7 offset:27712
  v_rcp_f16 v9, v8
  v_or_b32 v72, v72, v73
  v_rcp_f16 v11, v10
  v_rcp_f16_sdwa v9, v8 dst_sel:WORD_1 dst_unused:UNUSED_PRESERVE src0_sel:WORD_1
  v_mfma_f32_32x32x16_bf16 v[96:111], v[36:39], v[156:159], v[96:111]
  s_waitcnt lgkmcnt(4)
  ds_read_b64_tr_b16 v[30:31], v7 offset:29248
  v_or_b32 v57, v58, v59
  v_cvt_pk_bf16_f32 v58, v60, v61
  v_rcp_f16_sdwa v11, v10 dst_sel:WORD_1 dst_unused:UNUSED_PRESERVE src0_sel:WORD_1
  v_fma_mix_f32 v62, v62, v9, 0 op_sel_hi:[0,1,0]
  v_mfma_f32_32x32x16_bf16 v[160:175], v[16:19], v[48:51], v[160:175]
  s_waitcnt lgkmcnt(2)
  ds_read_b64_tr_b16 v[32:33], v7 offset:24704
  v_fma_mix_f32 v78, v78, v11, 0 op_sel_hi:[0,1,0]
  v_or_b32 v73, v74, v75
  v_cvt_pk_bf16_f32 v74, v76, v77
  v_fma_mix_f32 v63, v63, v9, 0 op_sel:[0,1,0] op_sel_hi:[0,1,0]
  v_fma_mix_f32 v79, v79, v11, 0 op_sel:[0,1,0] op_sel_hi:[0,1,0]
  v_cvt_pk_bf16_f32 v59, v62, v63
  v_mfma_f32_32x32x16_bf16 v[208:223], v[16:19], v[64:67], v[208:223]
  ds_read_b64_tr_b16 v[34:35], v7 offset:26240
  v_cvt_pk_bf16_f32 v75, v78, v79
  v_cvt_pk_bf16_f32 v80, v80, v81
  v_lshlrev_b32_sdwa v81, 1, v80 dst_sel:DWORD dst_unused:UNUSED_PAD src0_sel:DWORD src1_sel:WORD_1
  v_lshlrev_b32_sdwa v80, 1, v80 dst_sel:DWORD dst_unused:UNUSED_PAD src0_sel:DWORD src1_sel:WORD_0
  v_mul_f32 v92, s37, v92
  v_mul_f32 v108, s37, v108
  v_mfma_f32_32x32x16_bf16 v[176:191], v[20:23], v[48:51], v[176:191]
  ds_read_b64_tr_b16 v[36:37], v7 offset:27776
  ds_read_u16_d16_hi v81, v81 offset:36864
  ds_read_u16_d16 v80, v80 offset:36864
  v_mul_f32 v93, s37, v93
  v_mul_f32 v109, s37, v109
  v_cvt_pk_bf16_f32 v96, v96, v97
  v_lshlrev_b32_sdwa v97, 1, v96 dst_sel:DWORD dst_unused:UNUSED_PAD src0_sel:DWORD src1_sel:WORD_1
  v_mfma_f32_32x32x16_bf16 v[224:239], v[20:23], v[64:67], v[224:239]
  ds_read_b64_tr_b16 v[38:39], v7 offset:29312
  ds_read_u16_d16_hi v97, v97 offset:36864
  v_lshlrev_b32_sdwa v96, 1, v96 dst_sel:DWORD dst_unused:UNUSED_PAD src0_sel:DWORD src1_sel:WORD_0
  v_cvt_pk_f16_f32 v8, v92, v93
  v_cvt_pk_f16_f32 v10, v108, v109
  v_pk_fma_f16 v9, v8, v8, s56
  v_pk_fma_f16 v11, v10, v10, s56
  v_mfma_f32_32x32x16_bf16 v[160:175], v[24:27], v[56:59], v[160:175]
  ds_read_b64_tr_b16 v[16:17], v1 offset:30720
  ds_read_u16_d16 v96, v96 offset:36864
  v_cvt_pk_bf16_f32 v82, v82, v83
  v_pk_mul_f16 v9, v8, v9 neg_lo:[0,1] neg_hi:[0,1]
  v_lshlrev_b32_sdwa v83, 1, v82 dst_sel:DWORD dst_unused:UNUSED_PAD src0_sel:DWORD src1_sel:WORD_1
  v_lshlrev_b32_sdwa v82, 1, v82 dst_sel:DWORD dst_unused:UNUSED_PAD src0_sel:DWORD src1_sel:WORD_0
  v_pk_mul_f16 v11, v10, v11 neg_lo:[0,1] neg_hi:[0,1]
  v_mfma_f32_32x32x16_bf16 v[208:223], v[24:27], v[72:75], v[208:223]
  s_waitcnt lgkmcnt(9)
  ds_read_b64_tr_b16 v[18:19], v1 offset:30976
  ds_read_u16_d16_hi v83, v83 offset:36864
  ds_read_u16_d16 v82, v82 offset:36864
  v_exp_f16 v8, v9
  v_exp_f16 v10, v11
  v_mfma_f32_32x32x16_bf16 v[176:191], v[28:31], v[56:59], v[176:191]
  s_waitcnt lgkmcnt(7)
  ds_read_b64_tr_b16 v[20:21], v1 offset:31744
  v_cvt_pk_bf16_f32 v98, v98, v99
  v_or_b32 v80, v80, v81
  v_lshlrev_b32_sdwa v99, 1, v98 dst_sel:DWORD dst_unused:UNUSED_PAD src0_sel:DWORD src1_sel:WORD_1
  v_lshlrev_b32_sdwa v98, 1, v98 dst_sel:DWORD dst_unused:UNUSED_PAD src0_sel:DWORD src1_sel:WORD_0
  v_exp_f16_sdwa v8, v9 dst_sel:WORD_1 dst_unused:UNUSED_PRESERVE src0_sel:WORD_1
  v_mfma_f32_32x32x16_bf16 v[224:239], v[28:31], v[72:75], v[224:239]
  ds_read_b64_tr_b16 v[22:23], v1 offset:32000
  ds_read_u16_d16_hi v99, v99 offset:36864
  ds_read_u16_d16 v98, v98 offset:36864
  v_exp_f16_sdwa v10, v11 dst_sel:WORD_1 dst_unused:UNUSED_PRESERVE src0_sel:WORD_1
  v_cvt_pk_bf16_f32 v84, v84, v85
  v_mfma_f32_32x32x16_bf16 v[192:207], v[32:35], v[48:51], v[192:207]
  s_waitcnt lgkmcnt(7)
  ds_read_b64_tr_b16 v[24:25], v1 offset:32768
  v_or_b32 v96, v96, v97
  v_lshlrev_b32_sdwa v85, 1, v84 dst_sel:DWORD dst_unused:UNUSED_PAD src0_sel:DWORD src1_sel:WORD_1
  v_lshlrev_b32_sdwa v84, 1, v84 dst_sel:DWORD dst_unused:UNUSED_PAD src0_sel:DWORD src1_sel:WORD_0
  v_pk_fma_f16 v8, v8, s57, s57
  v_pk_fma_f16 v10, v10, s57, s57
  v_rcp_f16 v9, v8
  v_mfma_f32_32x32x16_bf16 v[240:255], v[32:35], v[64:67], v[240:255]
  ds_read_b64_tr_b16 v[26:27], v1 offset:33024
  ds_read_u16_d16_hi v85, v85 offset:36864
  ds_read_u16_d16 v84, v84 offset:36864
  v_cvt_pk_bf16_f32 v100, v100, v101
  v_rcp_f16 v11, v10
  v_mfma_f32_32x32x16_bf16 v[192:207], v[36:39], v[56:59], v[192:207]
  s_waitcnt lgkmcnt(8)
  ds_read_b64_tr_b16 v[28:29], v1 offset:33792
  v_or_b32 v81, v82, v83
  v_lshlrev_b32_sdwa v101, 1, v100 dst_sel:DWORD dst_unused:UNUSED_PAD src0_sel:DWORD src1_sel:WORD_1
  v_lshlrev_b32_sdwa v100, 1, v100 dst_sel:DWORD dst_unused:UNUSED_PAD src0_sel:DWORD src1_sel:WORD_0
  v_rcp_f16_sdwa v9, v8 dst_sel:WORD_1 dst_unused:UNUSED_PRESERVE src0_sel:WORD_1
  v_rcp_f16_sdwa v11, v10 dst_sel:WORD_1 dst_unused:UNUSED_PRESERVE src0_sel:WORD_1
  v_mfma_f32_32x32x16_bf16 v[240:255], v[36:39], v[72:75], v[240:255]
  s_waitcnt lgkmcnt(5)
  ds_read_b64_tr_b16 v[30:31], v1 offset:34048
  ds_read_u16_d16_hi v101, v101 offset:36864
  ds_read_u16_d16 v100, v100 offset:36864
  v_cvt_pk_bf16_f32 v86, v86, v87
  v_or_b32 v97, v98, v99
  v_mfma_f32_32x32x16_bf16 v[48:63], v[16:19], v[112:115], 0
  ds_read_b64_tr_b16 v[32:33], v1 offset:34816
  v_lshlrev_b32_sdwa v87, 1, v86 dst_sel:DWORD dst_unused:UNUSED_PAD src0_sel:DWORD src1_sel:WORD_1
  v_lshlrev_b32_sdwa v86, 1, v86 dst_sel:DWORD dst_unused:UNUSED_PAD src0_sel:DWORD src1_sel:WORD_0
  v_fma_mix_f32 v92, v92, v9, 0 op_sel_hi:[0,1,0]
  v_fma_mix_f32 v108, v108, v11, 0 op_sel_hi:[0,1,0]
  v_fma_mix_f32 v93, v93, v9, 0 op_sel:[0,1,0] op_sel_hi:[0,1,0]
  v_cvt_pk_bf16_f32 v102, v102, v103
  v_mfma_f32_32x32x16_bf16 v[64:79], v[16:19], v[136:139], 0
  s_waitcnt lgkmcnt(5)
  ds_read_b64_tr_b16 v[34:35], v1 offset:35072
  ds_read_u16_d16_hi v87, v87 offset:36864
  ds_read_u16_d16 v86, v86 offset:36864
  v_fma_mix_f32 v109, v109, v11, 0 op_sel:[0,1,0] op_sel_hi:[0,1,0]
  v_or_b32 v82, v84, v85
  v_lshlrev_b32_sdwa v103, 1, v102 dst_sel:DWORD dst_unused:UNUSED_PAD src0_sel:DWORD src1_sel:WORD_1
  v_lshlrev_b32_sdwa v102, 1, v102 dst_sel:DWORD dst_unused:UNUSED_PAD src0_sel:DWORD src1_sel:WORD_0
  v_mfma_f32_32x32x16_bf16 v[48:63], v[20:23], v[116:119], v[48:63]
  ds_read_b64_tr_b16 v[36:37], v1 offset:35840
  ds_read_u16_d16_hi v103, v103 offset:36864
  ds_read_u16_d16 v102, v102 offset:36864
  v_mul_f32 v94, s37, v94
  v_mul_f32 v110, s37, v110
  v_cvt_pk_bf16_f32 v88, v88, v89
  v_mul_f32 v95, s37, v95
  v_mfma_f32_32x32x16_bf16 v[64:79], v[20:23], v[140:143], v[64:79]
  s_waitcnt lgkmcnt(7)
  ds_read_b64_tr_b16 v[38:39], v1 offset:36096
  v_or_b32 v98, v100, v101
  v_lshlrev_b32_sdwa v89, 1, v88 dst_sel:DWORD dst_unused:UNUSED_PAD src0_sel:DWORD src1_sel:WORD_1
  v_lshlrev_b32_sdwa v88, 1, v88 dst_sel:DWORD dst_unused:UNUSED_PAD src0_sel:DWORD src1_sel:WORD_0
  v_mul_f32 v111, s37, v111
  v_cvt_pk_f16_f32 v8, v94, v95
  v_cvt_pk_f16_f32 v10, v110, v111
  v_mfma_f32_32x32x16_bf16 v[48:63], v[24:27], v[120:123], v[48:63]
  s_waitcnt lgkmcnt(4)
  ds_read_u16_d16_hi v89, v89 offset:36864
  ds_read_u16_d16 v88, v88 offset:36864
  v_cvt_pk_bf16_f32 v104, v104, v105
  v_pk_fma_f16 v9, v8, v8, s56
  v_or_b32 v83, v86, v87
  v_lshlrev_b32_sdwa v105, 1, v104 dst_sel:DWORD dst_unused:UNUSED_PAD src0_sel:DWORD src1_sel:WORD_1
  v_lshlrev_b32_sdwa v104, 1, v104 dst_sel:DWORD dst_unused:UNUSED_PAD src0_sel:DWORD src1_sel:WORD_0
  v_mfma_f32_32x32x16_bf16 v[64:79], v[24:27], v[144:147], v[64:79]
  ds_read_u16_d16_hi v105, v105 offset:36864
  ds_read_u16_d16 v104, v104 offset:36864
  v_pk_fma_f16 v11, v10, v10, s56
  v_pk_mul_f16 v9, v8, v9 neg_lo:[0,1] neg_hi:[0,1]
  v_pk_mul_f16 v11, v10, v11 neg_lo:[0,1] neg_hi:[0,1]
  v_exp_f16 v8, v9
  v_mfma_f32_32x32x16_bf16 v[48:63], v[28:31], v[124:127], v[48:63]
  s_waitcnt lgkmcnt(4)
  s_barrier
  ds_read_b64_tr_b16 v[16:17], v7 offset:0
  ds_read_b64_tr_b16 v[18:19], v7 offset:1536
  v_cvt_pk_bf16_f32 v90, v90, v91
  v_or_b32 v99, v102, v103
  v_lshlrev_b32_sdwa v91, 1, v90 dst_sel:DWORD dst_unused:UNUSED_PAD src0_sel:DWORD src1_sel:WORD_1
  v_mfma_f32_32x32x16_bf16 v[64:79], v[28:31], v[148:151], v[64:79]
  ds_read_b64_tr_b16 v[20:21], v7 offset:64
  ds_read_b64_tr_b16 v[22:23], v7 offset:1600
  ds_read_u16_d16_hi v91, v91 offset:36864
  v_lshlrev_b32_sdwa v90, 1, v90 dst_sel:DWORD dst_unused:UNUSED_PAD src0_sel:DWORD src1_sel:WORD_0
  v_exp_f16 v10, v11
  v_exp_f16_sdwa v8, v9 dst_sel:WORD_1 dst_unused:UNUSED_PRESERVE src0_sel:WORD_1
  v_mfma_f32_32x32x16_bf16 v[48:63], v[32:35], v[128:131], v[48:63]
  s_waitcnt lgkmcnt(7)
  ds_read_b64_tr_b16 v[24:25], v7 offset:3072
  ds_read_u16_d16 v90, v90 offset:36864
  v_cvt_pk_bf16_f32 v106, v106, v107
  v_or_b32 v88, v88, v89
  v_lshlrev_b32_sdwa v107, 1, v106 dst_sel:DWORD dst_unused:UNUSED_PAD src0_sel:DWORD src1_sel:WORD_1
  v_lshlrev_b32_sdwa v106, 1, v106 dst_sel:DWORD dst_unused:UNUSED_PAD src0_sel:DWORD src1_sel:WORD_0
  v_mfma_f32_32x32x16_bf16 v[64:79], v[32:35], v[152:155], v[64:79]
  ds_read_b64_tr_b16 v[26:27], v7 offset:4608
  ds_read_u16_d16_hi v107, v107 offset:36864
  ds_read_u16_d16 v106, v106 offset:36864
  v_exp_f16_sdwa v10, v11 dst_sel:WORD_1 dst_unused:UNUSED_PRESERVE src0_sel:WORD_1
  v_pk_fma_f16 v8, v8, s57, s57
  v_pk_fma_f16 v10, v10, s57, s57
  v_mfma_f32_32x32x16_bf16 v[48:63], v[36:39], v[132:135], v[48:63]
  s_waitcnt lgkmcnt(10)
  ds_read_b64_tr_b16 v[28:29], v7 offset:3136
  v_rcp_f16 v9, v8
  v_or_b32 v104, v104, v105
  v_rcp_f16 v11, v10
  v_rcp_f16_sdwa v9, v8 dst_sel:WORD_1 dst_unused:UNUSED_PRESERVE src0_sel:WORD_1
  v_mfma_f32_32x32x16_bf16 v[64:79], v[36:39], v[156:159], v[64:79]
  s_waitcnt lgkmcnt(4)
  ds_read_b64_tr_b16 v[30:31], v7 offset:4672
  v_or_b32 v89, v90, v91
  v_cvt_pk_bf16_f32 v90, v92, v93
  v_rcp_f16_sdwa v11, v10 dst_sel:WORD_1 dst_unused:UNUSED_PRESERVE src0_sel:WORD_1
  v_fma_mix_f32 v94, v94, v9, 0 op_sel_hi:[0,1,0]
  v_mfma_f32_32x32x16_bf16 v[160:175], v[16:19], v[80:83], v[160:175]
  s_waitcnt lgkmcnt(2)
  ds_read_b64_tr_b16 v[32:33], v7 offset:128
  ds_read_b128 v[136:139], v3 offset:0
  ds_read_b128 v[140:143], v3 offset:4096
  v_fma_mix_f32 v110, v110, v11, 0 op_sel_hi:[0,1,0]
  v_or_b32 v105, v106, v107
  v_cvt_pk_bf16_f32 v106, v108, v109
  v_fma_mix_f32 v95, v95, v9, 0 op_sel:[0,1,0] op_sel_hi:[0,1,0]
  v_fma_mix_f32 v111, v111, v11, 0 op_sel:[0,1,0] op_sel_hi:[0,1,0]
  v_mfma_f32_32x32x16_bf16 v[208:223], v[16:19], v[96:99], v[208:223]
  ds_read_b64_tr_b16 v[34:35], v7 offset:1664
  ds_read_b128 v[144:147], v3 offset:8192
  ds_read_b128 v[148:151], v3 offset:12288
  v_cvt_pk_bf16_f32 v91, v94, v95
  v_cvt_pk_bf16_f32 v107, v110, v111
  v_cvt_pk_bf16_f32 v48, v48, v49
  v_lshlrev_b32_sdwa v49, 1, v48 dst_sel:DWORD dst_unused:UNUSED_PAD src0_sel:DWORD src1_sel:WORD_1
  v_mfma_f32_32x32x16_bf16 v[176:191], v[20:23], v[80:83], v[176:191]
  ds_read_b64_tr_b16 v[36:37], v7 offset:3200
  ds_read_u16_d16_hi v49, v49 offset:36864
  ds_read_b128 v[152:155], v3 offset:16384
  ds_read_b128 v[156:159], v3 offset:20480
  v_lshlrev_b32_sdwa v48, 1, v48 dst_sel:DWORD dst_unused:UNUSED_PAD src0_sel:DWORD src1_sel:WORD_0
  v_mul_f32 v60, s37, v60
  v_mul_f32 v76, s37, v76
  v_mfma_f32_32x32x16_bf16 v[224:239], v[20:23], v[96:99], v[224:239]
  ds_read_b64_tr_b16 v[38:39], v7 offset:4736
  ds_read_u16_d16 v48, v48 offset:36864
  v_mul_f32 v61, s37, v61
  v_mul_f32 v77, s37, v77
  v_cvt_pk_bf16_f32 v64, v64, v65
  v_lshlrev_b32_sdwa v65, 1, v64 dst_sel:DWORD dst_unused:UNUSED_PAD src0_sel:DWORD src1_sel:WORD_1
  v_lshlrev_b32_sdwa v64, 1, v64 dst_sel:DWORD dst_unused:UNUSED_PAD src0_sel:DWORD src1_sel:WORD_0
  v_mfma_f32_32x32x16_bf16 v[160:175], v[24:27], v[88:91], v[160:175]
  s_waitcnt lgkmcnt(12)
  ds_read_b64_tr_b16 v[16:17], v1 offset:6144
  ds_read_u16_d16_hi v65, v65 offset:36864
  ds_read_u16_d16 v64, v64 offset:36864
  v_cvt_pk_f16_f32 v8, v60, v61
  v_cvt_pk_f16_f32 v10, v76, v77
  v_pk_fma_f16 v9, v8, v8, s56
  v_pk_fma_f16 v11, v10, v10, s56
  v_mfma_f32_32x32x16_bf16 v[208:223], v[24:27], v[104:107], v[208:223]
  s_waitcnt lgkmcnt(14)
  ds_read_b64_tr_b16 v[18:19], v1 offset:6400
  v_cvt_pk_bf16_f32 v50, v50, v51
  v_pk_mul_f16 v9, v8, v9 neg_lo:[0,1] neg_hi:[0,1]
  v_lshlrev_b32_sdwa v51, 1, v50 dst_sel:DWORD dst_unused:UNUSED_PAD src0_sel:DWORD src1_sel:WORD_1
  v_lshlrev_b32_sdwa v50, 1, v50 dst_sel:DWORD dst_unused:UNUSED_PAD src0_sel:DWORD src1_sel:WORD_0
  v_pk_mul_f16 v11, v10, v11 neg_lo:[0,1] neg_hi:[0,1]
  v_exp_f16 v8, v9
  v_mfma_f32_32x32x16_bf16 v[176:191], v[28:31], v[88:91], v[176:191]
  s_waitcnt lgkmcnt(12)
  ds_read_b64_tr_b16 v[20:21], v1 offset:7168
  ds_read_u16_d16_hi v51, v51 offset:36864
  ds_read_u16_d16 v50, v50 offset:36864
  v_exp_f16 v10, v11
  v_cvt_pk_bf16_f32 v66, v66, v67
  v_mfma_f32_32x32x16_bf16 v[224:239], v[28:31], v[104:107], v[224:239]
  s_waitcnt lgkmcnt(7)
  ds_read_b64_tr_b16 v[22:23], v1 offset:7424
  v_or_b32 v48, v48, v49
  v_lshlrev_b32_sdwa v67, 1, v66 dst_sel:DWORD dst_unused:UNUSED_PAD src0_sel:DWORD src1_sel:WORD_1
  v_lshlrev_b32_sdwa v66, 1, v66 dst_sel:DWORD dst_unused:UNUSED_PAD src0_sel:DWORD src1_sel:WORD_0
  v_exp_f16_sdwa v8, v9 dst_sel:WORD_1 dst_unused:UNUSED_PRESERVE src0_sel:WORD_1
  v_exp_f16_sdwa v10, v11 dst_sel:WORD_1 dst_unused:UNUSED_PRESERVE src0_sel:WORD_1
  v_mfma_f32_32x32x16_bf16 v[192:207], v[32:35], v[80:83], v[192:207]
  s_waitcnt lgkmcnt(5)
  ds_read_b64_tr_b16 v[24:25], v1 offset:8192
  ds_read_u16_d16_hi v67, v67 offset:36864
  ds_read_u16_d16 v66, v66 offset:36864
  v_cvt_pk_bf16_f32 v52, v52, v53
  v_or_b32 v64, v64, v65
  v_lshlrev_b32_sdwa v53, 1, v52 dst_sel:DWORD dst_unused:UNUSED_PAD src0_sel:DWORD src1_sel:WORD_1
  v_mfma_f32_32x32x16_bf16 v[240:255], v[32:35], v[96:99], v[240:255]
  ds_read_b64_tr_b16 v[26:27], v1 offset:8448
  ds_read_u16_d16_hi v53, v53 offset:36864
  v_lshlrev_b32_sdwa v52, 1, v52 dst_sel:DWORD dst_unused:UNUSED_PAD src0_sel:DWORD src1_sel:WORD_0
  v_pk_fma_f16 v8, v8, s57, s57
  v_pk_fma_f16 v10, v10, s57, s57
  v_rcp_f16 v9, v8
  v_mfma_f32_32x32x16_bf16 v[192:207], v[36:39], v[88:91], v[192:207]
  s_waitcnt lgkmcnt(6)
  ds_read_b64_tr_b16 v[28:29], v1 offset:9216
  ds_read_u16_d16 v52, v52 offset:36864
  v_cvt_pk_bf16_f32 v68, v68, v69
  v_rcp_f16 v11, v10
  v_or_b32 v49, v50, v51
  v_lshlrev_b32_sdwa v69, 1, v68 dst_sel:DWORD dst_unused:UNUSED_PAD src0_sel:DWORD src1_sel:WORD_1
  v_mfma_f32_32x32x16_bf16 v[240:255], v[36:39], v[104:107], v[240:255]
  ds_read_b64_tr_b16 v[30:31], v1 offset:9472
  ds_read_u16_d16_hi v69, v69 offset:36864
  v_lshlrev_b32_sdwa v68, 1, v68 dst_sel:DWORD dst_unused:UNUSED_PAD src0_sel:DWORD src1_sel:WORD_0
  v_rcp_f16_sdwa v9, v8 dst_sel:WORD_1 dst_unused:UNUSED_PRESERVE src0_sel:WORD_1
  v_rcp_f16_sdwa v11, v10 dst_sel:WORD_1 dst_unused:UNUSED_PRESERVE src0_sel:WORD_1
  v_mfma_f32_32x32x16_bf16 v[80:95], v[16:19], v[112:115], 0
  s_waitcnt lgkmcnt(6)
  ds_read_b64_tr_b16 v[32:33], v1 offset:10240
  ds_read_u16_d16 v68, v68 offset:36864
  v_cvt_pk_bf16_f32 v54, v54, v55
  v_or_b32 v65, v66, v67
  v_lshlrev_b32_sdwa v55, 1, v54 dst_sel:DWORD dst_unused:UNUSED_PAD src0_sel:DWORD src1_sel:WORD_1
  v_lshlrev_b32_sdwa v54, 1, v54 dst_sel:DWORD dst_unused:UNUSED_PAD src0_sel:DWORD src1_sel:WORD_0
  v_fma_mix_f32 v60, v60, v9, 0 op_sel_hi:[0,1,0]
  v_fma_mix_f32 v76, v76, v11, 0 op_sel_hi:[0,1,0]
  v_mfma_f32_32x32x16_bf16 v[96:111], v[16:19], v[136:139], 0
  s_waitcnt lgkmcnt(4)
  ds_read_b64_tr_b16 v[34:35], v1 offset:10496
  ds_read_u16_d16_hi v55, v55 offset:36864
  ds_read_u16_d16 v54, v54 offset:36864
  v_fma_mix_f32 v61, v61, v9, 0 op_sel:[0,1,0] op_sel_hi:[0,1,0]
  v_cvt_pk_bf16_f32 v70, v70, v71
  v_fma_mix_f32 v77, v77, v11, 0 op_sel:[0,1,0] op_sel_hi:[0,1,0]
  v_or_b32 v50, v52, v53
  v_mfma_f32_32x32x16_bf16 v[80:95], v[20:23], v[116:119], v[80:95]
  ds_read_b64_tr_b16 v[36:37], v1 offset:11264
  v_lshlrev_b32_sdwa v71, 1, v70 dst_sel:DWORD dst_unused:UNUSED_PAD src0_sel:DWORD src1_sel:WORD_1
  v_lshlrev_b32_sdwa v70, 1, v70 dst_sel:DWORD dst_unused:UNUSED_PAD src0_sel:DWORD src1_sel:WORD_0
  v_mul_f32 v62, s37, v62
  v_mul_f32 v78, s37, v78
  v_cvt_pk_bf16_f32 v56, v56, v57
  v_mul_f32 v63, s37, v63
  v_mfma_f32_32x32x16_bf16 v[96:111], v[20:23], v[140:143], v[96:111]
  s_waitcnt lgkmcnt(4)
  ds_read_b64_tr_b16 v[38:39], v1 offset:11520
  ds_read_u16_d16_hi v71, v71 offset:36864
  ds_read_u16_d16 v70, v70 offset:36864
  v_or_b32 v66, v68, v69
  v_lshlrev_b32_sdwa v57, 1, v56 dst_sel:DWORD dst_unused:UNUSED_PAD src0_sel:DWORD src1_sel:WORD_1
  v_lshlrev_b32_sdwa v56, 1, v56 dst_sel:DWORD dst_unused:UNUSED_PAD src0_sel:DWORD src1_sel:WORD_0
  v_mul_f32 v79, s37, v79
  v_mfma_f32_32x32x16_bf16 v[80:95], v[24:27], v[120:123], v[80:95]
  s_waitcnt lgkmcnt(4)
  ds_read_u16_d16_hi v57, v57 offset:36864
  ds_read_u16_d16 v56, v56 offset:36864
  v_cvt_pk_f16_f32 v8, v62, v63
  v_cvt_pk_f16_f32 v10, v78, v79
  v_cvt_pk_bf16_f32 v72, v72, v73
  v_pk_fma_f16 v9, v8, v8, s56
  v_or_b32 v51, v54, v55
  v_mfma_f32_32x32x16_bf16 v[96:111], v[24:27], v[144:147], v[96:111]
  v_lshlrev_b32_sdwa v73, 1, v72 dst_sel:DWORD dst_unused:UNUSED_PAD src0_sel:DWORD src1_sel:WORD_1
  v_lshlrev_b32_sdwa v72, 1, v72 dst_sel:DWORD dst_unused:UNUSED_PAD src0_sel:DWORD src1_sel:WORD_0
  v_pk_fma_f16 v11, v10, v10, s56
  v_pk_mul_f16 v9, v8, v9 neg_lo:[0,1] neg_hi:[0,1]
  v_pk_mul_f16 v11, v10, v11 neg_lo:[0,1] neg_hi:[0,1]
  v_exp_f16 v8, v9
  v_mfma_f32_32x32x16_bf16 v[80:95], v[28:31], v[124:127], v[80:95]
  s_waitcnt lgkmcnt(4)
  s_barrier
  ds_read_b64_tr_b16 v[16:17], v7 offset:12288
  ds_read_b64_tr_b16 v[18:19], v7 offset:13824
  ds_read_u16_d16_hi v73, v73 offset:36864
  v_cvt_pk_bf16_f32 v58, v58, v59
  s_waitcnt lgkmcnt(5)
  v_or_b32 v67, v70, v71
  v_lshlrev_b32_sdwa v59, 1, v58 dst_sel:DWORD dst_unused:UNUSED_PAD src0_sel:DWORD src1_sel:WORD_1
  v_mfma_f32_32x32x16_bf16 v[96:111], v[28:31], v[148:151], v[96:111]
  ds_read_b64_tr_b16 v[20:21], v7 offset:12352
  ds_read_b64_tr_b16 v[22:23], v7 offset:13888
  ds_read_u16_d16 v72, v72 offset:36864
  v_lshlrev_b32_sdwa v58, 1, v58 dst_sel:DWORD dst_unused:UNUSED_PAD src0_sel:DWORD src1_sel:WORD_0
  v_exp_f16 v10, v11
  v_exp_f16_sdwa v8, v9 dst_sel:WORD_1 dst_unused:UNUSED_PRESERVE src0_sel:WORD_1
  v_mfma_f32_32x32x16_bf16 v[80:95], v[32:35], v[128:131], v[80:95]
  s_waitcnt lgkmcnt(6)
  ds_read_b64_tr_b16 v[24:25], v7 offset:15360
  ds_read_u16_d16_hi v59, v59 offset:36864
  ds_read_u16_d16 v58, v58 offset:36864
  v_cvt_pk_bf16_f32 v74, v74, v75
  v_or_b32 v56, v56, v57
  v_lshlrev_b32_sdwa v75, 1, v74 dst_sel:DWORD dst_unused:UNUSED_PAD src0_sel:DWORD src1_sel:WORD_1
  v_mfma_f32_32x32x16_bf16 v[96:111], v[32:35], v[152:155], v[96:111]
  ds_read_b64_tr_b16 v[26:27], v7 offset:16896
  ds_read_u16_d16_hi v75, v75 offset:36864
  v_lshlrev_b32_sdwa v74, 1, v74 dst_sel:DWORD dst_unused:UNUSED_PAD src0_sel:DWORD src1_sel:WORD_0
  v_exp_f16_sdwa v10, v11 dst_sel:WORD_1 dst_unused:UNUSED_PRESERVE src0_sel:WORD_1
  v_pk_fma_f16 v8, v8, s57, s57
  v_pk_fma_f16 v10, v10, s57, s57
  v_mfma_f32_32x32x16_bf16 v[80:95], v[36:39], v[132:135], v[80:95]
  s_waitcnt lgkmcnt(5)
  ds_read_b64_tr_b16 v[28:29], v7 offset:15424
  ds_read_u16_d16 v74, v74 offset:36864
  v_rcp_f16 v9, v8
  v_or_b32 v72, v72, v73
  v_rcp_f16 v11, v10
  v_mfma_f32_32x32x16_bf16 v[96:111], v[36:39], v[156:159], v[96:111]
  s_waitcnt lgkmcnt(4)
  ds_read_b64_tr_b16 v[30:31], v7 offset:16960
  v_rcp_f16_sdwa v9, v8 dst_sel:WORD_1 dst_unused:UNUSED_PRESERVE src0_sel:WORD_1
  v_or_b32 v57, v58, v59
  v_cvt_pk_bf16_f32 v58, v60, v61
  v_rcp_f16_sdwa v11, v10 dst_sel:WORD_1 dst_unused:UNUSED_PRESERVE src0_sel:WORD_1
  v_fma_mix_f32 v62, v62, v9, 0 op_sel_hi:[0,1,0]
  v_mfma_f32_32x32x16_bf16 v[160:175], v[16:19], v[48:51], v[160:175]
  s_waitcnt lgkmcnt(1)
  ds_read_b64_tr_b16 v[32:33], v7 offset:12416
  v_add_u32 v6, s43, v4
  v_fma_mix_f32 v78, v78, v11, 0 op_sel_hi:[0,1,0]
  v_or_b32 v73, v74, v75
  v_cvt_pk_bf16_f32 v74, v76, v77
  v_fma_mix_f32 v63, v63, v9, 0 op_sel:[0,1,0] op_sel_hi:[0,1,0]
  v_fma_mix_f32 v79, v79, v11, 0 op_sel:[0,1,0] op_sel_hi:[0,1,0]
  v_cvt_pk_bf16_f32 v59, v62, v63
  v_cvt_pk_bf16_f32 v75, v78, v79
  v_mfma_f32_32x32x16_bf16 v[208:223], v[16:19], v[64:67], v[208:223]
  ds_read_b64_tr_b16 v[34:35], v7 offset:13952
  s_mov_b32 s49, s43
  s_mov_b32 s43, s44
  s_mov_b32 s44, s45
  s_mov_b32 s45, s49
  v_cvt_pk_bf16_f32 v80, v80, v81
  v_lshlrev_b32_sdwa v81, 1, v80 dst_sel:DWORD dst_unused:UNUSED_PAD src0_sel:DWORD src1_sel:WORD_1
  v_lshlrev_b32_sdwa v80, 1, v80 dst_sel:DWORD dst_unused:UNUSED_PAD src0_sel:DWORD src1_sel:WORD_0
  v_mul_f32 v92, s37, v92
  v_mfma_f32_32x32x16_bf16 v[176:191], v[20:23], v[48:51], v[176:191]
  ds_read_b64_tr_b16 v[36:37], v7 offset:15488
  ds_read_u16_d16_hi v81, v81 offset:36864
  ds_read_u16_d16 v80, v80 offset:36864
  v_mul_f32 v108, s37, v108
  v_mul_f32 v93, s37, v93
  v_mul_f32 v109, s37, v109
  v_cvt_pk_bf16_f32 v96, v96, v97
  v_lshlrev_b32_sdwa v97, 1, v96 dst_sel:DWORD dst_unused:UNUSED_PAD src0_sel:DWORD src1_sel:WORD_1
  v_lshlrev_b32_sdwa v96, 1, v96 dst_sel:DWORD dst_unused:UNUSED_PAD src0_sel:DWORD src1_sel:WORD_0
  v_mfma_f32_32x32x16_bf16 v[224:239], v[20:23], v[64:67], v[224:239]
  ds_read_b64_tr_b16 v[38:39], v7 offset:17024
  ds_read_u16_d16_hi v97, v97 offset:36864
  ds_read_u16_d16 v96, v96 offset:36864
  v_cvt_pk_f16_f32 v8, v92, v93
  v_cvt_pk_f16_f32 v10, v108, v109
  v_pk_fma_f16 v9, v8, v8, s56
  v_pk_fma_f16 v11, v10, v10, s56
  v_cvt_pk_bf16_f32 v82, v82, v83
  v_mfma_f32_32x32x16_bf16 v[160:175], v[24:27], v[56:59], v[160:175]
  ds_read_b64_tr_b16 v[16:17], v1 offset:18432
  v_pk_mul_f16 v9, v8, v9 neg_lo:[0,1] neg_hi:[0,1]
  v_lshlrev_b32_sdwa v83, 1, v82 dst_sel:DWORD dst_unused:UNUSED_PAD src0_sel:DWORD src1_sel:WORD_1
  v_lshlrev_b32_sdwa v82, 1, v82 dst_sel:DWORD dst_unused:UNUSED_PAD src0_sel:DWORD src1_sel:WORD_0
  v_pk_mul_f16 v11, v10, v11 neg_lo:[0,1] neg_hi:[0,1]
  v_exp_f16 v8, v9
  v_mfma_f32_32x32x16_bf16 v[208:223], v[24:27], v[72:75], v[208:223]
  s_waitcnt lgkmcnt(4)
  ds_read_b64_tr_b16 v[18:19], v1 offset:18688
  ds_read_u16_d16_hi v83, v83 offset:36864
  ds_read_u16_d16 v82, v82 offset:36864
  s_nop 7
  v_cvt_pk_bf16_f32 v208, v208, v209
  v_cvt_pk_bf16_f32 v209, v210, v211
  v_cvt_pk_bf16_f32 v210, v212, v213
  v_cvt_pk_bf16_f32 v211, v214, v215
  v_exp_f16 v10, v11
  v_cvt_pk_bf16_f32 v98, v98, v99
  v_or_b32 v80, v80, v81
  v_mfma_f32_32x32x16_bf16 v[176:191], v[28:31], v[56:59], v[176:191]
  ds_read_b64_tr_b16 v[20:21], v1 offset:19456
  v_lshlrev_b32_sdwa v99, 1, v98 dst_sel:DWORD dst_unused:UNUSED_PAD src0_sel:DWORD src1_sel:WORD_1
  v_lshlrev_b32_sdwa v98, 1, v98 dst_sel:DWORD dst_unused:UNUSED_PAD src0_sel:DWORD src1_sel:WORD_0
  v_cvt_pk_bf16_f32 v216, v216, v217
  v_cvt_pk_bf16_f32 v217, v218, v219
  v_cvt_pk_bf16_f32 v218, v220, v221
  v_cvt_pk_bf16_f32 v219, v222, v223
  s_nop 1
  v_permlane16_swap_b32 v208, v216
  v_permlane16_swap_b32 v209, v217
  v_permlane16_swap_b32 v210, v218
  v_permlane16_swap_b32 v211, v219
  v_mfma_f32_32x32x16_bf16 v[224:239], v[28:31], v[72:75], v[224:239]
  ds_read_b64_tr_b16 v[22:23], v1 offset:19712
  ds_read_u16_d16_hi v99, v99 offset:36864
  ds_read_u16_d16 v98, v98 offset:36864
  buffer_store_dwordx4 v[208:211], v2, s[28:31], s40 offen offset:0 sc1
  v_exp_f16_sdwa v8, v9 dst_sel:WORD_1 dst_unused:UNUSED_PRESERVE src0_sel:WORD_1
  v_mfma_f32_32x32x16_bf16 v[192:207], v[32:35], v[48:51], v[192:207]
  s_waitcnt lgkmcnt(8)
  ds_read_b64_tr_b16 v[24:25], v1 offset:20480
  v_exp_f16_sdwa v10, v11 dst_sel:WORD_1 dst_unused:UNUSED_PRESERVE src0_sel:WORD_1
  v_cvt_pk_bf16_f32 v84, v84, v85
  v_or_b32 v96, v96, v97
  v_lshlrev_b32_sdwa v85, 1, v84 dst_sel:DWORD dst_unused:UNUSED_PAD src0_sel:DWORD src1_sel:WORD_1
  v_lshlrev_b32_sdwa v84, 1, v84 dst_sel:DWORD dst_unused:UNUSED_PAD src0_sel:DWORD src1_sel:WORD_0
  v_pk_fma_f16 v8, v8, s57, s57
  v_mfma_f32_32x32x16_bf16 v[240:255], v[32:35], v[64:67], v[240:255]
  ds_read_b64_tr_b16 v[26:27], v1 offset:20736
  ds_read_u16_d16_hi v85, v85 offset:36864
  ds_read_u16_d16 v84, v84 offset:36864
  v_pk_fma_f16 v10, v10, s57, s57
  v_rcp_f16 v9, v8
  v_cvt_pk_bf16_f32 v100, v100, v101
  v_rcp_f16 v11, v10
  v_mfma_f32_32x32x16_bf16 v[192:207], v[36:39], v[56:59], v[192:207]
  s_waitcnt lgkmcnt(8)
  ds_read_b64_tr_b16 v[28:29], v1 offset:21504
  v_or_b32 v81, v82, v83
  v_lshlrev_b32_sdwa v101, 1, v100 dst_sel:DWORD dst_unused:UNUSED_PAD src0_sel:DWORD src1_sel:WORD_1
  v_lshlrev_b32_sdwa v100, 1, v100 dst_sel:DWORD dst_unused:UNUSED_PAD src0_sel:DWORD src1_sel:WORD_0
  v_rcp_f16_sdwa v9, v8 dst_sel:WORD_1 dst_unused:UNUSED_PRESERVE src0_sel:WORD_1
  v_rcp_f16_sdwa v11, v10 dst_sel:WORD_1 dst_unused:UNUSED_PRESERVE src0_sel:WORD_1
  v_mfma_f32_32x32x16_bf16 v[240:255], v[36:39], v[72:75], v[240:255]
  s_waitcnt lgkmcnt(5)
  ds_read_b64_tr_b16 v[30:31], v1 offset:21760
  ds_read_u16_d16_hi v101, v101 offset:36864
  ds_read_u16_d16 v100, v100 offset:36864
  v_cvt_pk_bf16_f32 v86, v86, v87
  v_or_b32 v97, v98, v99
  v_lshlrev_b32_sdwa v87, 1, v86 dst_sel:DWORD dst_unused:UNUSED_PAD src0_sel:DWORD src1_sel:WORD_1
  v_lshlrev_b32_sdwa v86, 1, v86 dst_sel:DWORD dst_unused:UNUSED_PAD src0_sel:DWORD src1_sel:WORD_0
  v_fma_mix_f32 v92, v92, v9, 0 op_sel_hi:[0,1,0]
  v_fma_mix_f32 v108, v108, v11, 0 op_sel_hi:[0,1,0]
  v_mfma_f32_32x32x16_bf16 v[48:63], v[16:19], v[112:115], 0
  ds_read_b64_tr_b16 v[32:33], v1 offset:22528
  ds_read_u16_d16_hi v87, v87 offset:36864
  ds_read_u16_d16 v86, v86 offset:36864
  buffer_store_dwordx4 v[216:219], v2, s[28:31], s40 offen offset:192 sc1
  v_fma_mix_f32 v93, v93, v9, 0 op_sel:[0,1,0] op_sel_hi:[0,1,0]
  v_cvt_pk_bf16_f32 v102, v102, v103
  v_fma_mix_f32 v109, v109, v11, 0 op_sel:[0,1,0] op_sel_hi:[0,1,0]
  v_cvt_pk_bf16_f32 v224, v224, v225
  v_cvt_pk_bf16_f32 v225, v226, v227
  v_mfma_f32_32x32x16_bf16 v[64:79], v[16:19], v[136:139], 0
  s_waitcnt lgkmcnt(7)
  ds_read_b64_tr_b16 v[34:35], v1 offset:22784
  v_cvt_pk_bf16_f32 v226, v228, v229
  v_cvt_pk_bf16_f32 v227, v230, v231
  v_or_b32 v82, v84, v85
  v_lshlrev_b32_sdwa v103, 1, v102 dst_sel:DWORD dst_unused:UNUSED_PAD src0_sel:DWORD src1_sel:WORD_1
  v_lshlrev_b32_sdwa v102, 1, v102 dst_sel:DWORD dst_unused:UNUSED_PAD src0_sel:DWORD src1_sel:WORD_0
  v_cvt_pk_bf16_f32 v232, v232, v233
  v_cvt_pk_bf16_f32 v233, v234, v235
  v_mfma_f32_32x32x16_bf16 v[48:63], v[20:23], v[116:119], v[48:63]
  ds_read_b64_tr_b16 v[36:37], v1 offset:23552
  ds_read_u16_d16_hi v103, v103 offset:36864
  ds_read_u16_d16 v102, v102 offset:36864
  v_cvt_pk_bf16_f32 v234, v236, v237
  v_cvt_pk_bf16_f32 v235, v238, v239
  s_nop 1
  v_permlane16_swap_b32 v224, v232
  v_permlane16_swap_b32 v225, v233
  v_permlane16_swap_b32 v226, v234
  v_permlane16_swap_b32 v227, v235
  v_mfma_f32_32x32x16_bf16 v[64:79], v[20:23], v[140:143], v[64:79]
  s_waitcnt lgkmcnt(7)
  ds_read_b64_tr_b16 v[38:39], v1 offset:23808
  buffer_store_dwordx4 v[224:227], v2, s[28:31], s40 offen offset:64 sc1
  v_mul_f32 v94, s37, v94
  v_mul_f32 v110, s37, v110
  v_cvt_pk_bf16_f32 v88, v88, v89
  v_mul_f32 v95, s37, v95
  v_or_b32 v98, v100, v101
  v_lshlrev_b32_sdwa v89, 1, v88 dst_sel:DWORD dst_unused:UNUSED_PAD src0_sel:DWORD src1_sel:WORD_1
  v_mfma_f32_32x32x16_bf16 v[48:63], v[24:27], v[120:123], v[48:63]
  s_waitcnt lgkmcnt(5)
  ds_read_u16_d16_hi v89, v89 offset:36864
  v_lshlrev_b32_sdwa v88, 1, v88 dst_sel:DWORD dst_unused:UNUSED_PAD src0_sel:DWORD src1_sel:WORD_0
  v_mul_f32 v111, s37, v111
  v_cvt_pk_f16_f32 v8, v94, v95
  v_cvt_pk_f16_f32 v10, v110, v111
  v_cvt_pk_bf16_f32 v104, v104, v105
  v_pk_fma_f16 v9, v8, v8, s56
  v_or_b32 v83, v86, v87
  v_lshlrev_b32_sdwa v105, 1, v104 dst_sel:DWORD dst_unused:UNUSED_PAD src0_sel:DWORD src1_sel:WORD_1
  v_mfma_f32_32x32x16_bf16 v[64:79], v[24:27], v[144:147], v[64:79]
  ds_read_u16_d16 v88, v88 offset:36864
  ds_read_u16_d16_hi v105, v105 offset:36864
  v_lshlrev_b32_sdwa v104, 1, v104 dst_sel:DWORD dst_unused:UNUSED_PAD src0_sel:DWORD src1_sel:WORD_0
  v_pk_fma_f16 v11, v10, v10, s56
  v_pk_mul_f16 v9, v8, v9 neg_lo:[0,1] neg_hi:[0,1]
  v_pk_mul_f16 v11, v10, v11 neg_lo:[0,1] neg_hi:[0,1]
  v_exp_f16 v8, v9
  v_mfma_f32_32x32x16_bf16 v[48:63], v[28:31], v[124:127], v[48:63]
  s_waitcnt lgkmcnt(3)
  s_barrier
  ds_read_b64_tr_b16 v[16:17], v7 offset:24576
  ds_read_b64_tr_b16 v[18:19], v7 offset:26112
  ds_read_u16_d16 v104, v104 offset:36864
  v_cvt_pk_bf16_f32 v90, v90, v91
  v_or_b32 v99, v102, v103
  v_lshlrev_b32_sdwa v91, 1, v90 dst_sel:DWORD dst_unused:UNUSED_PAD src0_sel:DWORD src1_sel:WORD_1
  v_lshlrev_b32_sdwa v90, 1, v90 dst_sel:DWORD dst_unused:UNUSED_PAD src0_sel:DWORD src1_sel:WORD_0
  v_exp_f16 v10, v11
  v_mfma_f32_32x32x16_bf16 v[64:79], v[28:31], v[148:151], v[64:79]
  s_waitcnt lgkmcnt(4)
  ds_read_b64_tr_b16 v[20:21], v7 offset:24640
  ds_read_b64_tr_b16 v[22:23], v7 offset:26176
  ds_read_u16_d16_hi v91, v91 offset:36864
  v_exp_f16_sdwa v8, v9 dst_sel:WORD_1 dst_unused:UNUSED_PRESERVE src0_sel:WORD_1
  v_add_u32 v0, 0, v6
  v_cvt_pk_bf16_f32 v106, v106, v107
  v_or_b32 v88, v88, v89
  v_mfma_f32_32x32x16_bf16 v[48:63], v[32:35], v[128:131], v[48:63]
  ds_read_b64_tr_b16 v[24:25], v7 offset:27648
  ds_read_u16_d16 v90, v90 offset:36864
  buffer_store_dwordx4 v[232:235], v2, s[28:31], s40 offen offset:256 sc1
  ds_read2_b32 v[40:41], v0 offset0:0 offset1:78
  v_lshlrev_b32_sdwa v107, 1, v106 dst_sel:DWORD dst_unused:UNUSED_PAD src0_sel:DWORD src1_sel:WORD_1
  v_lshlrev_b32_sdwa v106, 1, v106 dst_sel:DWORD dst_unused:UNUSED_PAD src0_sel:DWORD src1_sel:WORD_0
  v_exp_f16_sdwa v10, v11 dst_sel:WORD_1 dst_unused:UNUSED_PRESERVE src0_sel:WORD_1
  v_mfma_f32_32x32x16_bf16 v[64:79], v[32:35], v[152:155], v[64:79]
  ds_read_b64_tr_b16 v[26:27], v7 offset:29184
  ds_read_u16_d16_hi v107, v107 offset:36864
  ds_read_u16_d16 v106, v106 offset:36864
  ds_read2_b32 v[42:43], v0 offset0:156 offset1:234
  v_add_u32 v0, 2496, v6
  v_pk_fma_f16 v8, v8, s57, s57
  v_pk_fma_f16 v10, v10, s57, s57
  v_rcp_f16 v9, v8
  v_mfma_f32_32x32x16_bf16 v[48:63], v[36:39], v[132:135], v[48:63]
  s_waitcnt lgkmcnt(5)
  ds_read_b64_tr_b16 v[28:29], v7 offset:27712
  ds_read2_b32 v[44:45], v0 offset0:0 offset1:78
  ds_read2_b32 v[46:47], v0 offset0:156 offset1:234
  v_or_b32 v104, v104, v105
  v_rcp_f16 v11, v10
  v_rcp_f16_sdwa v9, v8 dst_sel:WORD_1 dst_unused:UNUSED_PRESERVE src0_sel:WORD_1
  v_or_b32 v89, v90, v91
  v_mfma_f32_32x32x16_bf16 v[64:79], v[36:39], v[156:159], v[64:79]
  ds_read_b64_tr_b16 v[30:31], v7 offset:29248
  v_cvt_pk_bf16_f32 v90, v92, v93
  v_rcp_f16_sdwa v11, v10 dst_sel:WORD_1 dst_unused:UNUSED_PRESERVE src0_sel:WORD_1
  v_cvt_pk_bf16_f32 v240, v240, v241
  v_cvt_pk_bf16_f32 v241, v242, v243
  v_cvt_pk_bf16_f32 v242, v244, v245
  v_cvt_pk_bf16_f32 v243, v246, v247
  v_fma_mix_f32 v94, v94, v9, 0 op_sel_hi:[0,1,0]
  v_mfma_f32_32x32x16_bf16 v[160:175], v[16:19], v[80:83], v[160:175]
  ds_read_b64_tr_b16 v[32:33], v7 offset:24704
  v_cvt_pk_bf16_f32 v248, v248, v249
  v_cvt_pk_bf16_f32 v249, v250, v251
  v_cvt_pk_bf16_f32 v250, v252, v253
  v_cvt_pk_bf16_f32 v251, v254, v255
  s_nop 1
  v_permlane16_swap_b32 v240, v248
  v_permlane16_swap_b32 v241, v249
  v_permlane16_swap_b32 v242, v250
  v_permlane16_swap_b32 v243, v251
  v_mfma_f32_32x32x16_bf16 v[208:223], v[16:19], v[96:99], 0
  s_waitcnt lgkmcnt(2)
  ds_read_b64_tr_b16 v[34:35], v7 offset:26240
  buffer_store_dwordx4 v[240:243], v2, s[28:31], s40 offen offset:128 sc1
  v_fma_mix_f32 v110, v110, v11, 0 op_sel_hi:[0,1,0]
  v_or_b32 v105, v106, v107
  v_cvt_pk_bf16_f32 v106, v108, v109
  v_smfmac_f32_32x32x32_bf16 v[208:223], v[12:15], v[40:47], v5
  v_fma_mix_f32 v95, v95, v9, 0 op_sel:[0,1,0] op_sel_hi:[0,1,0]
  v_fma_mix_f32 v111, v111, v11, 0 op_sel:[0,1,0] op_sel_hi:[0,1,0]
  v_cvt_pk_bf16_f32 v91, v94, v95
  v_cvt_pk_bf16_f32 v107, v110, v111
  v_cvt_pk_bf16_f32 v48, v48, v49
  v_lshlrev_b32_sdwa v49, 1, v48 dst_sel:DWORD dst_unused:UNUSED_PAD src0_sel:DWORD src1_sel:WORD_1
  v_mfma_f32_32x32x16_bf16 v[176:191], v[20:23], v[80:83], v[176:191]
  ds_read_b64_tr_b16 v[36:37], v7 offset:27776
  ds_read_u16_d16_hi v49, v49 offset:36864
  v_lshlrev_b32_sdwa v48, 1, v48 dst_sel:DWORD dst_unused:UNUSED_PAD src0_sel:DWORD src1_sel:WORD_0
  v_mul_f32 v60, s37, v60
  v_add_u32 v0, 4992, v6
  v_mul_f32 v76, s37, v76
  v_mul_f32 v61, s37, v61
  v_mfma_f32_32x32x16_bf16 v[224:239], v[20:23], v[96:99], 0
  ds_read_b64_tr_b16 v[38:39], v7 offset:29312
  ds_read_u16_d16 v48, v48 offset:36864
  ds_read2_b32 v[40:41], v0 offset0:0 offset1:78
  ds_read2_b32 v[42:43], v0 offset0:156 offset1:234
  v_add_u32 v0, 7488, v6
  v_mul_f32 v77, s37, v77
  v_cvt_pk_bf16_f32 v64, v64, v65
  v_mfma_f32_32x32x16_bf16 v[160:175], v[24:27], v[88:91], v[160:175]
  ds_read_b64_tr_b16 v[16:17], v1 offset:30720
  ds_read2_b32 v[44:45], v0 offset0:0 offset1:78
  ds_read2_b32 v[46:47], v0 offset0:156 offset1:234
  v_lshlrev_b32_sdwa v65, 1, v64 dst_sel:DWORD dst_unused:UNUSED_PAD src0_sel:DWORD src1_sel:WORD_1
  v_lshlrev_b32_sdwa v64, 1, v64 dst_sel:DWORD dst_unused:UNUSED_PAD src0_sel:DWORD src1_sel:WORD_0
  v_cvt_pk_f16_f32 v8, v60, v61
  v_cvt_pk_f16_f32 v10, v76, v77
  v_mfma_f32_32x32x16_bf16 v[208:223], v[24:27], v[104:107], v[208:223]
  s_waitcnt lgkmcnt(11)
  ds_read_b64_tr_b16 v[18:19], v1 offset:30976
  ds_read_u16_d16_hi v65, v65 offset:36864
  ds_read_u16_d16 v64, v64 offset:36864
  v_pk_fma_f16 v9, v8, v8, s56
  v_pk_fma_f16 v11, v10, v10, s56
  v_cvt_pk_bf16_f32 v50, v50, v51
  v_pk_mul_f16 v9, v8, v9 neg_lo:[0,1] neg_hi:[0,1]
  v_mfma_f32_32x32x16_bf16 v[176:191], v[28:31], v[88:91], v[176:191]
  ds_read_b64_tr_b16 v[20:21], v1 offset:31744
  buffer_store_dwordx4 v[248:251], v2, s[28:31], s40 offen offset:320 sc1
  s_add_u32 s40, s40, s41
  v_lshlrev_b32_sdwa v51, 1, v50 dst_sel:DWORD dst_unused:UNUSED_PAD src0_sel:DWORD src1_sel:WORD_1
  v_lshlrev_b32_sdwa v50, 1, v50 dst_sel:DWORD dst_unused:UNUSED_PAD src0_sel:DWORD src1_sel:WORD_0
  v_pk_mul_f16 v11, v10, v11 neg_lo:[0,1] neg_hi:[0,1]
  v_exp_f16 v8, v9
  v_mfma_f32_32x32x16_bf16 v[224:239], v[28:31], v[104:107], v[224:239]
  s_waitcnt lgkmcnt(4)
  ds_read_b64_tr_b16 v[22:23], v1 offset:32000
  ds_read_u16_d16_hi v51, v51 offset:36864
  ds_read_u16_d16 v50, v50 offset:36864
  v_exp_f16 v10, v11
  v_cvt_pk_bf16_f32 v66, v66, v67
  v_smfmac_f32_32x32x32_bf16 v[224:239], v[12:15], v[40:47], v5
  v_or_b32 v48, v48, v49
  v_lshlrev_b32_sdwa v67, 1, v66 dst_sel:DWORD dst_unused:UNUSED_PAD src0_sel:DWORD src1_sel:WORD_1
  v_lshlrev_b32_sdwa v66, 1, v66 dst_sel:DWORD dst_unused:UNUSED_PAD src0_sel:DWORD src1_sel:WORD_0
  v_exp_f16_sdwa v8, v9 dst_sel:WORD_1 dst_unused:UNUSED_PRESERVE src0_sel:WORD_1
  v_exp_f16_sdwa v10, v11 dst_sel:WORD_1 dst_unused:UNUSED_PRESERVE src0_sel:WORD_1
  v_mfma_f32_32x32x16_bf16 v[192:207], v[32:35], v[80:83], v[192:207]
  s_waitcnt lgkmcnt(4)
  ds_read_b64_tr_b16 v[24:25], v1 offset:32768
  ds_read_u16_d16_hi v67, v67 offset:36864
  ds_read_u16_d16 v66, v66 offset:36864
  v_cvt_pk_bf16_f32 v52, v52, v53
  v_or_b32 v64, v64, v65
  v_lshlrev_b32_sdwa v53, 1, v52 dst_sel:DWORD dst_unused:UNUSED_PAD src0_sel:DWORD src1_sel:WORD_1
  v_lshlrev_b32_sdwa v52, 1, v52 dst_sel:DWORD dst_unused:UNUSED_PAD src0_sel:DWORD src1_sel:WORD_0
  v_mfma_f32_32x32x16_bf16 v[240:255], v[32:35], v[96:99], 0
  ds_read_b64_tr_b16 v[26:27], v1 offset:33024
  ds_read_u16_d16_hi v53, v53 offset:36864
  ds_read_u16_d16 v52, v52 offset:36864
  v_pk_fma_f16 v8, v8, s57, s57
  v_add_u32 v0, 9984, v6
  v_pk_fma_f16 v10, v10, s57, s57
  v_rcp_f16 v9, v8
  v_mfma_f32_32x32x16_bf16 v[192:207], v[36:39], v[88:91], v[192:207]
  ds_read_b64_tr_b16 v[28:29], v1 offset:33792
  ds_read2_b32 v[40:41], v0 offset0:0 offset1:78
  ds_read2_b32 v[42:43], v0 offset0:156 offset1:234
  v_add_u32 v0, 12480, v6
  v_cvt_pk_bf16_f32 v68, v68, v69
  v_rcp_f16 v11, v10
  v_mfma_f32_32x32x16_bf16 v[240:255], v[36:39], v[104:107], v[240:255]
  s_waitcnt lgkmcnt(9)
  ds_read_b64_tr_b16 v[30:31], v1 offset:34048
  ds_read2_b32 v[44:45], v0 offset0:0 offset1:78
  ds_read2_b32 v[46:47], v0 offset0:156 offset1:234
  v_or_b32 v49, v50, v51
  v_lshlrev_b32_sdwa v69, 1, v68 dst_sel:DWORD dst_unused:UNUSED_PAD src0_sel:DWORD src1_sel:WORD_1
  v_lshlrev_b32_sdwa v68, 1, v68 dst_sel:DWORD dst_unused:UNUSED_PAD src0_sel:DWORD src1_sel:WORD_0
  v_mfma_f32_32x32x16_bf16 v[80:95], v[16:19], v[112:115], 0
  ds_read_b64_tr_b16 v[32:33], v1 offset:34816
  ds_read_u16_d16_hi v69, v69 offset:36864
  ds_read_u16_d16 v68, v68 offset:36864
  v_rcp_f16_sdwa v9, v8 dst_sel:WORD_1 dst_unused:UNUSED_PRESERVE src0_sel:WORD_1
  v_rcp_f16_sdwa v11, v10 dst_sel:WORD_1 dst_unused:UNUSED_PRESERVE src0_sel:WORD_1
  v_mfma_f32_32x32x16_bf16 v[96:111], v[16:19], v[136:139], 0
  s_waitcnt lgkmcnt(12)
  ds_read_b64_tr_b16 v[34:35], v1 offset:35072
  v_cvt_pk_bf16_f32 v54, v54, v55
  v_or_b32 v65, v66, v67
  v_lshlrev_b32_sdwa v55, 1, v54 dst_sel:DWORD dst_unused:UNUSED_PAD src0_sel:DWORD src1_sel:WORD_1
  v_lshlrev_b32_sdwa v54, 1, v54 dst_sel:DWORD dst_unused:UNUSED_PAD src0_sel:DWORD src1_sel:WORD_0
  v_fma_mix_f32 v60, v60, v9, 0 op_sel_hi:[0,1,0]
  v_fma_mix_f32 v76, v76, v11, 0 op_sel_hi:[0,1,0]
  v_mfma_f32_32x32x16_bf16 v[80:95], v[20:23], v[116:119], v[80:95]
  s_waitcnt lgkmcnt(10)
  ds_read_b64_tr_b16 v[36:37], v1 offset:35840
  ds_read_u16_d16_hi v55, v55 offset:36864
  ds_read_u16_d16 v54, v54 offset:36864
  v_fma_mix_f32 v61, v61, v9, 0 op_sel:[0,1,0] op_sel_hi:[0,1,0]
  v_cvt_pk_bf16_f32 v70, v70, v71
  v_fma_mix_f32 v77, v77, v11, 0 op_sel:[0,1,0] op_sel_hi:[0,1,0]
  v_or_b32 v50, v52, v53
  v_mfma_f32_32x32x16_bf16 v[96:111], v[20:23], v[140:143], v[96:111]
  ds_read_b64_tr_b16 v[38:39], v1 offset:36096
  v_lshlrev_b32_sdwa v71, 1, v70 dst_sel:DWORD dst_unused:UNUSED_PAD src0_sel:DWORD src1_sel:WORD_1
  v_lshlrev_b32_sdwa v70, 1, v70 dst_sel:DWORD dst_unused:UNUSED_PAD src0_sel:DWORD src1_sel:WORD_0
  v_mul_f32 v62, s37, v62
  v_mul_f32 v78, s37, v78
  v_cvt_pk_bf16_f32 v56, v56, v57
  v_mul_f32 v63, s37, v63
  v_mfma_f32_32x32x16_bf16 v[80:95], v[24:27], v[120:123], v[80:95]
  s_waitcnt lgkmcnt(5)
  ds_read_u16_d16_hi v71, v71 offset:36864
  ds_read_u16_d16 v70, v70 offset:36864
  v_or_b32 v66, v68, v69
  v_lshlrev_b32_sdwa v57, 1, v56 dst_sel:DWORD dst_unused:UNUSED_PAD src0_sel:DWORD src1_sel:WORD_1
  v_lshlrev_b32_sdwa v56, 1, v56 dst_sel:DWORD dst_unused:UNUSED_PAD src0_sel:DWORD src1_sel:WORD_0
  v_mul_f32 v79, s37, v79
  v_cvt_pk_f16_f32 v8, v62, v63
  v_cvt_pk_f16_f32 v10, v78, v79
  v_mfma_f32_32x32x16_bf16 v[96:111], v[24:27], v[144:147], v[96:111]
  s_waitcnt lgkmcnt(3)
  ds_read_u16_d16_hi v57, v57 offset:36864
  ds_read_u16_d16 v56, v56 offset:36864
  v_cvt_pk_bf16_f32 v72, v72, v73
  v_pk_fma_f16 v9, v8, v8, s56
  v_or_b32 v51, v54, v55
  v_lshlrev_b32_sdwa v73, 1, v72 dst_sel:DWORD dst_unused:UNUSED_PAD src0_sel:DWORD src1_sel:WORD_1
  v_lshlrev_b32_sdwa v72, 1, v72 dst_sel:DWORD dst_unused:UNUSED_PAD src0_sel:DWORD src1_sel:WORD_0
  v_smfmac_f32_32x32x32_bf16 v[240:255], v[12:15], v[40:47], v5
  s_waitcnt lgkmcnt(4)
  s_barrier
  ds_read_b64_tr_b16 v[16:17], v7 offset:0
  ds_read_b64_tr_b16 v[18:19], v7 offset:1536
  ds_read_u16_d16_hi v73, v73 offset:36864
  v_pk_fma_f16 v11, v10, v10, s56
  v_pk_mul_f16 v9, v8, v9 neg_lo:[0,1] neg_hi:[0,1]
  v_mfma_f32_32x32x16_bf16 v[80:95], v[28:31], v[124:127], v[80:95]
  s_waitcnt lgkmcnt(5)
  ds_read_b64_tr_b16 v[20:21], v7 offset:64
  ds_read_u16_d16 v72, v72 offset:36864
  v_pk_mul_f16 v11, v10, v11 neg_lo:[0,1] neg_hi:[0,1]
  v_exp_f16 v8, v9
  v_cvt_pk_bf16_f32 v58, v58, v59
  v_or_b32 v67, v70, v71
  v_mfma_f32_32x32x16_bf16 v[96:111], v[28:31], v[148:151], v[96:111]
  ds_read_b64_tr_b16 v[22:23], v7 offset:1600
  v_lshlrev_b32_sdwa v59, 1, v58 dst_sel:DWORD dst_unused:UNUSED_PAD src0_sel:DWORD src1_sel:WORD_1
  v_lshlrev_b32_sdwa v58, 1, v58 dst_sel:DWORD dst_unused:UNUSED_PAD src0_sel:DWORD src1_sel:WORD_0
  v_exp_f16 v10, v11
  v_exp_f16_sdwa v8, v9 dst_sel:WORD_1 dst_unused:UNUSED_PRESERVE src0_sel:WORD_1
  v_mfma_f32_32x32x16_bf16 v[80:95], v[32:35], v[128:131], v[80:95]
  s_waitcnt lgkmcnt(6)
  ds_read_b64_tr_b16 v[24:25], v7 offset:3072
  ds_read_u16_d16_hi v59, v59 offset:36864
  ds_read_u16_d16 v58, v58 offset:36864
  v_cvt_pk_bf16_f32 v74, v74, v75
  v_or_b32 v56, v56, v57
  v_lshlrev_b32_sdwa v75, 1, v74 dst_sel:DWORD dst_unused:UNUSED_PAD src0_sel:DWORD src1_sel:WORD_1
  v_lshlrev_b32_sdwa v74, 1, v74 dst_sel:DWORD dst_unused:UNUSED_PAD src0_sel:DWORD src1_sel:WORD_0
  v_mfma_f32_32x32x16_bf16 v[96:111], v[32:35], v[152:155], v[96:111]
  ds_read_b64_tr_b16 v[26:27], v7 offset:4608
  ds_read_u16_d16_hi v75, v75 offset:36864
  ds_read_u16_d16 v74, v74 offset:36864
  v_exp_f16_sdwa v10, v11 dst_sel:WORD_1 dst_unused:UNUSED_PRESERVE src0_sel:WORD_1
  v_pk_fma_f16 v8, v8, s57, s57
  v_pk_fma_f16 v10, v10, s57, s57
  v_mfma_f32_32x32x16_bf16 v[80:95], v[36:39], v[132:135], v[80:95]
  s_waitcnt lgkmcnt(7)
  ds_read_b64_tr_b16 v[28:29], v7 offset:3136
  v_rcp_f16 v9, v8
  v_or_b32 v72, v72, v73
  v_rcp_f16 v11, v10
  v_rcp_f16_sdwa v9, v8 dst_sel:WORD_1 dst_unused:UNUSED_PRESERVE src0_sel:WORD_1
  v_mfma_f32_32x32x16_bf16 v[96:111], v[36:39], v[156:159], v[96:111]
  s_waitcnt lgkmcnt(4)
  ds_read_b64_tr_b16 v[30:31], v7 offset:4672
  v_or_b32 v57, v58, v59
  v_cvt_pk_bf16_f32 v58, v60, v61
  v_rcp_f16_sdwa v11, v10 dst_sel:WORD_1 dst_unused:UNUSED_PRESERVE src0_sel:WORD_1
  v_fma_mix_f32 v62, v62, v9, 0 op_sel_hi:[0,1,0]
  s_add_u32 s42, s42, 1
  s_branch L_mloop
L_mtail:
  v_mfma_f32_32x32x16_bf16 v[160:175], v[16:19], v[48:51], v[160:175]
  s_waitcnt lgkmcnt(2)
  ds_read_b64_tr_b16 v[32:33], v7 offset:24704
  v_fma_mix_f32 v78, v78, v11, 0 op_sel_hi:[0,1,0]
  v_or_b32 v73, v74, v75
  v_cvt_pk_bf16_f32 v74, v76, v77
  v_fma_mix_f32 v63, v63, v9, 0 op_sel:[0,1,0] op_sel_hi:[0,1,0]
  v_fma_mix_f32 v79, v79, v11, 0 op_sel:[0,1,0] op_sel_hi:[0,1,0]
  v_cvt_pk_bf16_f32 v59, v62, v63
  v_mfma_f32_32x32x16_bf16 v[208:223], v[16:19], v[64:67], v[208:223]
  ds_read_b64_tr_b16 v[34:35], v7 offset:26240
  v_cvt_pk_bf16_f32 v75, v78, v79
  v_cvt_pk_bf16_f32 v80, v80, v81
  v_lshlrev_b32_sdwa v81, 1, v80 dst_sel:DWORD dst_unused:UNUSED_PAD src0_sel:DWORD src1_sel:WORD_1
  v_lshlrev_b32_sdwa v80, 1, v80 dst_sel:DWORD dst_unused:UNUSED_PAD src0_sel:DWORD src1_sel:WORD_0
  v_mul_f32 v92, s37, v92
  v_mul_f32 v108, s37, v108
  v_mfma_f32_32x32x16_bf16 v[176:191], v[20:23], v[48:51], v[176:191]
  ds_read_b64_tr_b16 v[36:37], v7 offset:27776
  ds_read_u16_d16_hi v81, v81 offset:36864
  ds_read_u16_d16 v80, v80 offset:36864
  v_mul_f32 v93, s37, v93
  v_mul_f32 v109, s37, v109
  v_cvt_pk_bf16_f32 v96, v96, v97
  v_lshlrev_b32_sdwa v97, 1, v96 dst_sel:DWORD dst_unused:UNUSED_PAD src0_sel:DWORD src1_sel:WORD_1
  v_mfma_f32_32x32x16_bf16 v[224:239], v[20:23], v[64:67], v[224:239]
  ds_read_b64_tr_b16 v[38:39], v7 offset:29312
  ds_read_u16_d16_hi v97, v97 offset:36864
  v_lshlrev_b32_sdwa v96, 1, v96 dst_sel:DWORD dst_unused:UNUSED_PAD src0_sel:DWORD src1_sel:WORD_0
  v_cvt_pk_f16_f32 v8, v92, v93
  v_cvt_pk_f16_f32 v10, v108, v109
  v_pk_fma_f16 v9, v8, v8, s56
  v_pk_fma_f16 v11, v10, v10, s56
  v_mfma_f32_32x32x16_bf16 v[160:175], v[24:27], v[56:59], v[160:175]
  ds_read_b64_tr_b16 v[16:17], v1 offset:30720
  ds_read_u16_d16 v96, v96 offset:36864
  v_cvt_pk_bf16_f32 v82, v82, v83
  v_pk_mul_f16 v9, v8, v9 neg_lo:[0,1] neg_hi:[0,1]
  v_lshlrev_b32_sdwa v83, 1, v82 dst_sel:DWORD dst_unused:UNUSED_PAD src0_sel:DWORD src1_sel:WORD_1
  v_lshlrev_b32_sdwa v82, 1, v82 dst_sel:DWORD dst_unused:UNUSED_PAD src0_sel:DWORD src1_sel:WORD_0
  v_pk_mul_f16 v11, v10, v11 neg_lo:[0,1] neg_hi:[0,1]
  v_mfma_f32_32x32x16_bf16 v[208:223], v[24:27], v[72:75], v[208:223]
  s_waitcnt lgkmcnt(9)
  ds_read_b64_tr_b16 v[18:19], v1 offset:30976
  ds_read_u16_d16_hi v83, v83 offset:36864
  ds_read_u16_d16 v82, v82 offset:36864
  v_exp_f16 v8, v9
  v_exp_f16 v10, v11
  v_mfma_f32_32x32x16_bf16 v[176:191], v[28:31], v[56:59], v[176:191]
  s_waitcnt lgkmcnt(7)
  ds_read_b64_tr_b16 v[20:21], v1 offset:31744
  v_cvt_pk_bf16_f32 v98, v98, v99
  v_or_b32 v80, v80, v81
  v_lshlrev_b32_sdwa v99, 1, v98 dst_sel:DWORD dst_unused:UNUSED_PAD src0_sel:DWORD src1_sel:WORD_1
  v_lshlrev_b32_sdwa v98, 1, v98 dst_sel:DWORD dst_unused:UNUSED_PAD src0_sel:DWORD src1_sel:WORD_0
  v_exp_f16_sdwa v8, v9 dst_sel:WORD_1 dst_unused:UNUSED_PRESERVE src0_sel:WORD_1
  v_mfma_f32_32x32x16_bf16 v[224:239], v[28:31], v[72:75], v[224:239]
  ds_read_b64_tr_b16 v[22:23], v1 offset:32000
  ds_read_u16_d16_hi v99, v99 offset:36864
  ds_read_u16_d16 v98, v98 offset:36864
  v_exp_f16_sdwa v10, v11 dst_sel:WORD_1 dst_unused:UNUSED_PRESERVE src0_sel:WORD_1
  v_cvt_pk_bf16_f32 v84, v84, v85
  v_mfma_f32_32x32x16_bf16 v[192:207], v[32:35], v[48:51], v[192:207]
  s_waitcnt lgkmcnt(7)
  ds_read_b64_tr_b16 v[24:25], v1 offset:32768
  v_or_b32 v96, v96, v97
  v_lshlrev_b32_sdwa v85, 1, v84 dst_sel:DWORD dst_unused:UNUSED_PAD src0_sel:DWORD src1_sel:WORD_1
  v_lshlrev_b32_sdwa v84, 1, v84 dst_sel:DWORD dst_unused:UNUSED_PAD src0_sel:DWORD src1_sel:WORD_0
  v_pk_fma_f16 v8, v8, s57, s57
  v_pk_fma_f16 v10, v10, s57, s57
  v_rcp_f16 v9, v8
  v_mfma_f32_32x32x16_bf16 v[240:255], v[32:35], v[64:67], v[240:255]
  ds_read_b64_tr_b16 v[26:27], v1 offset:33024
  ds_read_u16_d16_hi v85, v85 offset:36864
  ds_read_u16_d16 v84, v84 offset:36864
  v_cvt_pk_bf16_f32 v100, v100, v101
  v_rcp_f16 v11, v10
  v_mfma_f32_32x32x16_bf16 v[192:207], v[36:39], v[56:59], v[192:207]
  s_waitcnt lgkmcnt(8)
  ds_read_b64_tr_b16 v[28:29], v1 offset:33792
  v_or_b32 v81, v82, v83
  v_lshlrev_b32_sdwa v101, 1, v100 dst_sel:DWORD dst_unused:UNUSED_PAD src0_sel:DWORD src1_sel:WORD_1
  v_lshlrev_b32_sdwa v100, 1, v100 dst_sel:DWORD dst_unused:UNUSED_PAD src0_sel:DWORD src1_sel:WORD_0
  v_rcp_f16_sdwa v9, v8 dst_sel:WORD_1 dst_unused:UNUSED_PRESERVE src0_sel:WORD_1
  v_rcp_f16_sdwa v11, v10 dst_sel:WORD_1 dst_unused:UNUSED_PRESERVE src0_sel:WORD_1
  v_mfma_f32_32x32x16_bf16 v[240:255], v[36:39], v[72:75], v[240:255]
  s_waitcnt lgkmcnt(5)
  ds_read_b64_tr_b16 v[30:31], v1 offset:34048
  ds_read_u16_d16_hi v101, v101 offset:36864
  ds_read_u16_d16 v100, v100 offset:36864
  v_cvt_pk_bf16_f32 v86, v86, v87
  v_or_b32 v97, v98, v99
  v_mfma_f32_32x32x16_bf16 v[48:63], v[16:19], v[112:115], 0
  ds_read_b64_tr_b16 v[32:33], v1 offset:34816
  v_lshlrev_b32_sdwa v87, 1, v86 dst_sel:DWORD dst_unused:UNUSED_PAD src0_sel:DWORD src1_sel:WORD_1
  v_lshlrev_b32_sdwa v86, 1, v86 dst_sel:DWORD dst_unused:UNUSED_PAD src0_sel:DWORD src1_sel:WORD_0
  v_fma_mix_f32 v92, v92, v9, 0 op_sel_hi:[0,1,0]
  v_fma_mix_f32 v108, v108, v11, 0 op_sel_hi:[0,1,0]
  v_fma_mix_f32 v93, v93, v9, 0 op_sel:[0,1,0] op_sel_hi:[0,1,0]
  v_cvt_pk_bf16_f32 v102, v102, v103
  v_mfma_f32_32x32x16_bf16 v[64:79], v[16:19], v[136:139], 0
  s_waitcnt lgkmcnt(5)
  ds_read_b64_tr_b16 v[34:35], v1 offset:35072
  ds_read_u16_d16_hi v87, v87 offset:36864
  ds_read_u16_d16 v86, v86 offset:36864
  v_fma_mix_f32 v109, v109, v11, 0 op_sel:[0,1,0] op_sel_hi:[0,1,0]
  v_or_b32 v82, v84, v85
  v_lshlrev_b32_sdwa v103, 1, v102 dst_sel:DWORD dst_unused:UNUSED_PAD src0_sel:DWORD src1_sel:WORD_1
  v_lshlrev_b32_sdwa v102, 1, v102 dst_sel:DWORD dst_unused:UNUSED_PAD src0_sel:DWORD src1_sel:WORD_0
  v_mfma_f32_32x32x16_bf16 v[48:63], v[20:23], v[116:119], v[48:63]
  ds_read_b64_tr_b16 v[36:37], v1 offset:35840
  ds_read_u16_d16_hi v103, v103 offset:36864
  ds_read_u16_d16 v102, v102 offset:36864
  v_mul_f32 v94, s37, v94
  v_mul_f32 v110, s37, v110
  v_cvt_pk_bf16_f32 v88, v88, v89
  v_mul_f32 v95, s37, v95
  v_mfma_f32_32x32x16_bf16 v[64:79], v[20:23], v[140:143], v[64:79]
  s_waitcnt lgkmcnt(7)
  ds_read_b64_tr_b16 v[38:39], v1 offset:36096
  v_or_b32 v98, v100, v101
  v_lshlrev_b32_sdwa v89, 1, v88 dst_sel:DWORD dst_unused:UNUSED_PAD src0_sel:DWORD src1_sel:WORD_1
  v_lshlrev_b32_sdwa v88, 1, v88 dst_sel:DWORD dst_unused:UNUSED_PAD src0_sel:DWORD src1_sel:WORD_0
  v_mul_f32 v111, s37, v111
  v_cvt_pk_f16_f32 v8, v94, v95
  v_cvt_pk_f16_f32 v10, v110, v111
  v_mfma_f32_32x32x16_bf16 v[48:63], v[24:27], v[120:123], v[48:63]
  s_waitcnt lgkmcnt(4)
  ds_read_u16_d16_hi v89, v89 offset:36864
  ds_read_u16_d16 v88, v88 offset:36864
  v_cvt_pk_bf16_f32 v104, v104, v105
  v_pk_fma_f16 v9, v8, v8, s56
  v_or_b32 v83, v86, v87
  v_lshlrev_b32_sdwa v105, 1, v104 dst_sel:DWORD dst_unused:UNUSED_PAD src0_sel:DWORD src1_sel:WORD_1
  v_lshlrev_b32_sdwa v104, 1, v104 dst_sel:DWORD dst_unused:UNUSED_PAD src0_sel:DWORD src1_sel:WORD_0
  v_mfma_f32_32x32x16_bf16 v[64:79], v[24:27], v[144:147], v[64:79]
  ds_read_u16_d16_hi v105, v105 offset:36864
  ds_read_u16_d16 v104, v104 offset:36864
  v_pk_fma_f16 v11, v10, v10, s56
  v_pk_mul_f16 v9, v8, v9 neg_lo:[0,1] neg_hi:[0,1]
  v_pk_mul_f16 v11, v10, v11 neg_lo:[0,1] neg_hi:[0,1]
  v_exp_f16 v8, v9
  v_mfma_f32_32x32x16_bf16 v[48:63], v[28:31], v[124:127], v[48:63]
  s_waitcnt lgkmcnt(4)
  s_barrier
  v_add_u32 v1, 41984, v1
  v_add_u32 v7, 41984, v7
  ds_read_b64_tr_b16 v[16:17], v7 offset:0
  ds_read_b64_tr_b16 v[18:19], v7 offset:1536
  v_cvt_pk_bf16_f32 v90, v90, v91
  v_mfma_f32_32x32x16_bf16 v[64:79], v[28:31], v[148:151], v[64:79]
  ds_read_b64_tr_b16 v[20:21], v7 offset:64
  ds_read_b64_tr_b16 v[22:23], v7 offset:1600
  v_or_b32 v99, v102, v103
  v_lshlrev_b32_sdwa v91, 1, v90 dst_sel:DWORD dst_unused:UNUSED_PAD src0_sel:DWORD src1_sel:WORD_1
  v_lshlrev_b32_sdwa v90, 1, v90 dst_sel:DWORD dst_unused:UNUSED_PAD src0_sel:DWORD src1_sel:WORD_0
  v_exp_f16 v10, v11
  v_mfma_f32_32x32x16_bf16 v[48:63], v[32:35], v[128:131], v[48:63]
  s_waitcnt lgkmcnt(6)
  ds_read_b64_tr_b16 v[24:25], v7 offset:3072
  ds_read_u16_d16_hi v91, v91 offset:36864
  ds_read_u16_d16 v90, v90 offset:36864
  v_exp_f16_sdwa v8, v9 dst_sel:WORD_1 dst_unused:UNUSED_PRESERVE src0_sel:WORD_1
  v_cvt_pk_bf16_f32 v106, v106, v107
  v_or_b32 v88, v88, v89
  v_mfma_f32_32x32x16_bf16 v[64:79], v[32:35], v[152:155], v[64:79]
  ds_read_b64_tr_b16 v[26:27], v7 offset:4608
  v_lshlrev_b32_sdwa v107, 1, v106 dst_sel:DWORD dst_unused:UNUSED_PAD src0_sel:DWORD src1_sel:WORD_1
  v_lshlrev_b32_sdwa v106, 1, v106 dst_sel:DWORD dst_unused:UNUSED_PAD src0_sel:DWORD src1_sel:WORD_0
  v_exp_f16_sdwa v10, v11 dst_sel:WORD_1 dst_unused:UNUSED_PRESERVE src0_sel:WORD_1
  v_pk_fma_f16 v8, v8, s57, s57
  v_pk_fma_f16 v10, v10, s57, s57
  v_mfma_f32_32x32x16_bf16 v[48:63], v[36:39], v[132:135], v[48:63]
  s_waitcnt lgkmcnt(8)
  ds_read_b64_tr_b16 v[28:29], v7 offset:3136
  ds_read_u16_d16_hi v107, v107 offset:36864
  ds_read_u16_d16 v106, v106 offset:36864
  v_rcp_f16 v9, v8
  v_or_b32 v104, v104, v105
  v_rcp_f16 v11, v10
  v_mfma_f32_32x32x16_bf16 v[64:79], v[36:39], v[156:159], v[64:79]
  s_waitcnt lgkmcnt(4)
  ds_read_b64_tr_b16 v[30:31], v7 offset:4672
  v_rcp_f16_sdwa v9, v8 dst_sel:WORD_1 dst_unused:UNUSED_PRESERVE src0_sel:WORD_1
  v_or_b32 v89, v90, v91
  v_cvt_pk_bf16_f32 v90, v92, v93
  v_rcp_f16_sdwa v11, v10 dst_sel:WORD_1 dst_unused:UNUSED_PRESERVE src0_sel:WORD_1
  v_fma_mix_f32 v94, v94, v9, 0 op_sel_hi:[0,1,0]
  v_mfma_f32_32x32x16_bf16 v[160:175], v[16:19], v[80:83], v[160:175]
  s_waitcnt lgkmcnt(1)
  ds_read_b64_tr_b16 v[32:33], v7 offset:128
  v_fma_mix_f32 v110, v110, v11, 0 op_sel_hi:[0,1,0]
  v_or_b32 v105, v106, v107
  v_cvt_pk_bf16_f32 v106, v108, v109
  v_fma_mix_f32 v95, v95, v9, 0 op_sel:[0,1,0] op_sel_hi:[0,1,0]
  v_fma_mix_f32 v111, v111, v11, 0 op_sel:[0,1,0] op_sel_hi:[0,1,0]
  v_cvt_pk_bf16_f32 v91, v94, v95
  v_cvt_pk_bf16_f32 v107, v110, v111
  v_cvt_pk_bf16_f32 v48, v48, v49
  v_lshlrev_b32_sdwa v49, 1, v48 dst_sel:DWORD dst_unused:UNUSED_PAD src0_sel:DWORD src1_sel:WORD_1
  v_mfma_f32_32x32x16_bf16 v[208:223], v[16:19], v[96:99], v[208:223]
  ds_read_b64_tr_b16 v[34:35], v7 offset:1664
  ds_read_u16_d16_hi v49, v49 offset:36864
  v_lshlrev_b32_sdwa v48, 1, v48 dst_sel:DWORD dst_unused:UNUSED_PAD src0_sel:DWORD src1_sel:WORD_0
  v_mul_f32 v60, s37, v60
  v_mul_f32 v76, s37, v76
  v_mul_f32 v61, s37, v61
  v_mul_f32 v77, s37, v77
  v_cvt_pk_bf16_f32 v64, v64, v65
  v_lshlrev_b32_sdwa v65, 1, v64 dst_sel:DWORD dst_unused:UNUSED_PAD src0_sel:DWORD src1_sel:WORD_1
  v_mfma_f32_32x32x16_bf16 v[176:191], v[20:23], v[80:83], v[176:191]
  ds_read_b64_tr_b16 v[36:37], v7 offset:3200
  ds_read_u16_d16 v48, v48 offset:36864
  ds_read_u16_d16_hi v65, v65 offset:36864
  v_lshlrev_b32_sdwa v64, 1, v64 dst_sel:DWORD dst_unused:UNUSED_PAD src0_sel:DWORD src1_sel:WORD_0
  v_cvt_pk_f16_f32 v8, v60, v61
  v_cvt_pk_f16_f32 v10, v76, v77
  v_pk_fma_f16 v9, v8, v8, s56
  v_pk_fma_f16 v11, v10, v10, s56
  v_cvt_pk_bf16_f32 v50, v50, v51
  v_mfma_f32_32x32x16_bf16 v[224:239], v[20:23], v[96:99], v[224:239]
  ds_read_b64_tr_b16 v[38:39], v7 offset:4736
  ds_read_u16_d16 v64, v64 offset:36864
  v_pk_mul_f16 v9, v8, v9 neg_lo:[0,1] neg_hi:[0,1]
  v_lshlrev_b32_sdwa v51, 1, v50 dst_sel:DWORD dst_unused:UNUSED_PAD src0_sel:DWORD src1_sel:WORD_1
  v_lshlrev_b32_sdwa v50, 1, v50 dst_sel:DWORD dst_unused:UNUSED_PAD src0_sel:DWORD src1_sel:WORD_0
  v_pk_mul_f16 v11, v10, v11 neg_lo:[0,1] neg_hi:[0,1]
  v_exp_f16 v8, v9
  v_exp_f16 v10, v11
  v_mfma_f32_32x32x16_bf16 v[160:175], v[24:27], v[88:91], v[160:175]
  s_waitcnt lgkmcnt(3)
  ds_read_b64_tr_b16 v[16:17], v1 offset:6144
  ds_read_u16_d16_hi v51, v51 offset:36864
  ds_read_u16_d16 v50, v50 offset:36864
  v_cvt_pk_bf16_f32 v66, v66, v67
  v_or_b32 v48, v48, v49
  v_lshlrev_b32_sdwa v67, 1, v66 dst_sel:DWORD dst_unused:UNUSED_PAD src0_sel:DWORD src1_sel:WORD_1
  v_lshlrev_b32_sdwa v66, 1, v66 dst_sel:DWORD dst_unused:UNUSED_PAD src0_sel:DWORD src1_sel:WORD_0
  v_exp_f16_sdwa v8, v9 dst_sel:WORD_1 dst_unused:UNUSED_PRESERVE src0_sel:WORD_1
  v_mfma_f32_32x32x16_bf16 v[208:223], v[24:27], v[104:107], v[208:223]
  s_waitcnt lgkmcnt(3)
  ds_read_b64_tr_b16 v[18:19], v1 offset:6400
  ds_read_u16_d16_hi v67, v67 offset:36864
  ds_read_u16_d16 v66, v66 offset:36864
  v_exp_f16_sdwa v10, v11 dst_sel:WORD_1 dst_unused:UNUSED_PRESERVE src0_sel:WORD_1
  v_cvt_pk_bf16_f32 v52, v52, v53
  v_or_b32 v64, v64, v65
  v_lshlrev_b32_sdwa v53, 1, v52 dst_sel:DWORD dst_unused:UNUSED_PAD src0_sel:DWORD src1_sel:WORD_1
  v_mfma_f32_32x32x16_bf16 v[176:191], v[28:31], v[88:91], v[176:191]
  ds_read_b64_tr_b16 v[20:21], v1 offset:7168
  ds_read_u16_d16_hi v53, v53 offset:36864
  v_lshlrev_b32_sdwa v52, 1, v52 dst_sel:DWORD dst_unused:UNUSED_PAD src0_sel:DWORD src1_sel:WORD_0
  v_pk_fma_f16 v8, v8, s57, s57
  v_pk_fma_f16 v10, v10, s57, s57
  v_rcp_f16 v9, v8
  v_cvt_pk_bf16_f32 v68, v68, v69
  v_rcp_f16 v11, v10
  v_mfma_f32_32x32x16_bf16 v[224:239], v[28:31], v[104:107], v[224:239]
  s_waitcnt lgkmcnt(5)
  ds_read_b64_tr_b16 v[22:23], v1 offset:7424
  ds_read_u16_d16 v52, v52 offset:36864
  v_or_b32 v49, v50, v51
  v_lshlrev_b32_sdwa v69, 1, v68 dst_sel:DWORD dst_unused:UNUSED_PAD src0_sel:DWORD src1_sel:WORD_1
  v_lshlrev_b32_sdwa v68, 1, v68 dst_sel:DWORD dst_unused:UNUSED_PAD src0_sel:DWORD src1_sel:WORD_0
  v_rcp_f16_sdwa v9, v8 dst_sel:WORD_1 dst_unused:UNUSED_PRESERVE src0_sel:WORD_1
  v_rcp_f16_sdwa v11, v10 dst_sel:WORD_1 dst_unused:UNUSED_PRESERVE src0_sel:WORD_1
  v_mfma_f32_32x32x16_bf16 v[192:207], v[32:35], v[80:83], v[192:207]
  s_waitcnt lgkmcnt(4)
  ds_read_b64_tr_b16 v[24:25], v1 offset:8192
  ds_read_u16_d16_hi v69, v69 offset:36864
  ds_read_u16_d16 v68, v68 offset:36864
  v_cvt_pk_bf16_f32 v54, v54, v55
  v_or_b32 v65, v66, v67
  v_lshlrev_b32_sdwa v55, 1, v54 dst_sel:DWORD dst_unused:UNUSED_PAD src0_sel:DWORD src1_sel:WORD_1
  v_lshlrev_b32_sdwa v54, 1, v54 dst_sel:DWORD dst_unused:UNUSED_PAD src0_sel:DWORD src1_sel:WORD_0
  v_fma_mix_f32 v60, v60, v9, 0 op_sel_hi:[0,1,0]
  v_mfma_f32_32x32x16_bf16 v[240:255], v[32:35], v[96:99], v[240:255]
  s_waitcnt lgkmcnt(3)
  ds_read_b64_tr_b16 v[26:27], v1 offset:8448
  ds_read_u16_d16_hi v55, v55 offset:36864
  ds_read_u16_d16 v54, v54 offset:36864
  v_fma_mix_f32 v76, v76, v11, 0 op_sel_hi:[0,1,0]
  v_fma_mix_f32 v61, v61, v9, 0 op_sel:[0,1,0] op_sel_hi:[0,1,0]
  v_cvt_pk_bf16_f32 v70, v70, v71
  v_fma_mix_f32 v77, v77, v11, 0 op_sel:[0,1,0] op_sel_hi:[0,1,0]
  v_or_b32 v50, v52, v53
  v_lshlrev_b32_sdwa v71, 1, v70 dst_sel:DWORD dst_unused:UNUSED_PAD src0_sel:DWORD src1_sel:WORD_1
  v_lshlrev_b32_sdwa v70, 1, v70 dst_sel:DWORD dst_unused:UNUSED_PAD src0_sel:DWORD src1_sel:WORD_0
  v_mfma_f32_32x32x16_bf16 v[192:207], v[36:39], v[88:91], v[192:207]
  s_waitcnt lgkmcnt(3)
  ds_read_b64_tr_b16 v[28:29], v1 offset:9216
  ds_read_u16_d16_hi v71, v71 offset:36864
  ds_read_u16_d16 v70, v70 offset:36864
  v_mul_f32 v62, s37, v62
  v_mul_f32 v78, s37, v78
  v_cvt_pk_bf16_f32 v56, v56, v57
  v_mul_f32 v63, s37, v63
  v_or_b32 v66, v68, v69
  v_lshlrev_b32_sdwa v57, 1, v56 dst_sel:DWORD dst_unused:UNUSED_PAD src0_sel:DWORD src1_sel:WORD_1
  v_mfma_f32_32x32x16_bf16 v[240:255], v[36:39], v[104:107], v[240:255]
  s_waitcnt lgkmcnt(3)
  ds_read_b64_tr_b16 v[30:31], v1 offset:9472
  ds_read_u16_d16_hi v57, v57 offset:36864
  v_lshlrev_b32_sdwa v56, 1, v56 dst_sel:DWORD dst_unused:UNUSED_PAD src0_sel:DWORD src1_sel:WORD_0
  v_mul_f32 v79, s37, v79
  v_cvt_pk_f16_f32 v8, v62, v63
  v_cvt_pk_f16_f32 v10, v78, v79
  v_cvt_pk_bf16_f32 v72, v72, v73
  v_pk_fma_f16 v9, v8, v8, s56
  v_or_b32 v51, v54, v55
  v_mfma_f32_32x32x16_bf16 v[96:111], v[16:19], v[136:139], 0
  ds_read_b64_tr_b16 v[32:33], v1 offset:10240
  ds_read_b64_tr_b16 v[34:35], v1 offset:10496
  ds_read_u16_d16 v56, v56 offset:36864
  v_lshlrev_b32_sdwa v73, 1, v72 dst_sel:DWORD dst_unused:UNUSED_PAD src0_sel:DWORD src1_sel:WORD_1
  v_lshlrev_b32_sdwa v72, 1, v72 dst_sel:DWORD dst_unused:UNUSED_PAD src0_sel:DWORD src1_sel:WORD_0
  v_pk_fma_f16 v11, v10, v10, s56
  v_pk_mul_f16 v9, v8, v9 neg_lo:[0,1] neg_hi:[0,1]
  v_pk_mul_f16 v11, v10, v11 neg_lo:[0,1] neg_hi:[0,1]
  v_exp_f16 v8, v9
  v_mfma_f32_32x32x16_bf16 v[96:111], v[20:23], v[140:143], v[96:111]
  s_waitcnt lgkmcnt(5)
  ds_read_b64_tr_b16 v[36:37], v1 offset:11264
  ds_read_b64_tr_b16 v[38:39], v1 offset:11520
  ds_read_u16_d16_hi v73, v73 offset:36864
  v_cvt_pk_bf16_f32 v58, v58, v59
  v_or_b32 v67, v70, v71
  v_lshlrev_b32_sdwa v59, 1, v58 dst_sel:DWORD dst_unused:UNUSED_PAD src0_sel:DWORD src1_sel:WORD_1
  v_lshlrev_b32_sdwa v58, 1, v58 dst_sel:DWORD dst_unused:UNUSED_PAD src0_sel:DWORD src1_sel:WORD_0
  v_exp_f16 v10, v11
  v_mfma_f32_32x32x16_bf16 v[96:111], v[24:27], v[144:147], v[96:111]
  s_waitcnt lgkmcnt(1)
  s_barrier
  ds_read_b64_tr_b16 v[16:17], v7 offset:12288
  ds_read_b64_tr_b16 v[18:19], v7 offset:13824
  ds_read_u16_d16 v72, v72 offset:36864
  v_exp_f16_sdwa v8, v9 dst_sel:WORD_1 dst_unused:UNUSED_PRESERVE src0_sel:WORD_1
  v_cvt_pk_bf16_f32 v74, v74, v75
  v_or_b32 v56, v56, v57
  v_mfma_f32_32x32x16_bf16 v[96:111], v[28:31], v[148:151], v[96:111]
  ds_read_b64_tr_b16 v[20:21], v7 offset:12352
  ds_read_b64_tr_b16 v[22:23], v7 offset:13888
  ds_read_u16_d16_hi v59, v59 offset:36864
  v_lshlrev_b32_sdwa v75, 1, v74 dst_sel:DWORD dst_unused:UNUSED_PAD src0_sel:DWORD src1_sel:WORD_1
  v_lshlrev_b32_sdwa v74, 1, v74 dst_sel:DWORD dst_unused:UNUSED_PAD src0_sel:DWORD src1_sel:WORD_0
  v_exp_f16_sdwa v10, v11 dst_sel:WORD_1 dst_unused:UNUSED_PRESERVE src0_sel:WORD_1
  v_pk_fma_f16 v8, v8, s57, s57
  v_pk_fma_f16 v10, v10, s57, s57
  v_mfma_f32_32x32x16_bf16 v[96:111], v[32:35], v[152:155], v[96:111]
  s_waitcnt lgkmcnt(3)
  ds_read_b64_tr_b16 v[24:25], v7 offset:15360
  ds_read_b64_tr_b16 v[26:27], v7 offset:16896
  ds_read_u16_d16 v58, v58 offset:36864
  v_rcp_f16 v9, v8
  v_or_b32 v72, v72, v73
  v_rcp_f16 v11, v10
  v_rcp_f16_sdwa v9, v8 dst_sel:WORD_1 dst_unused:UNUSED_PRESERVE src0_sel:WORD_1
  v_mfma_f32_32x32x16_bf16 v[96:111], v[36:39], v[156:159], v[96:111]
  s_waitcnt lgkmcnt(0)
  ds_read_b64_tr_b16 v[28:29], v7 offset:15424
  ds_read_b64_tr_b16 v[30:31], v7 offset:16960
  ds_read_u16_d16_hi v75, v75 offset:36864
  v_or_b32 v57, v58, v59
  v_cvt_pk_bf16_f32 v58, v60, v61
  v_rcp_f16_sdwa v11, v10 dst_sel:WORD_1 dst_unused:UNUSED_PRESERVE src0_sel:WORD_1
  v_fma_mix_f32 v62, v62, v9, 0 op_sel_hi:[0,1,0]
  v_mfma_f32_32x32x16_bf16 v[160:175], v[16:19], v[48:51], v[160:175]
  ds_read_b64_tr_b16 v[32:33], v7 offset:12416
  ds_read_u16_d16 v74, v74 offset:36864
  v_fma_mix_f32 v78, v78, v11, 0 op_sel_hi:[0,1,0]
  s_waitcnt lgkmcnt(0)
  v_or_b32 v73, v74, v75
  v_cvt_pk_bf16_f32 v74, v76, v77
  v_fma_mix_f32 v63, v63, v9, 0 op_sel:[0,1,0] op_sel_hi:[0,1,0]
  v_fma_mix_f32 v79, v79, v11, 0 op_sel:[0,1,0] op_sel_hi:[0,1,0]
  v_cvt_pk_bf16_f32 v59, v62, v63
  v_mfma_f32_32x32x16_bf16 v[208:223], v[16:19], v[64:67], v[208:223]
  ds_read_b64_tr_b16 v[34:35], v7 offset:13952
  v_cvt_pk_bf16_f32 v75, v78, v79
  v_cvt_pk_bf16_f32 v96, v96, v97
  v_lshlrev_b32_sdwa v97, 1, v96 dst_sel:DWORD dst_unused:UNUSED_PAD src0_sel:DWORD src1_sel:WORD_1
  v_lshlrev_b32_sdwa v96, 1, v96 dst_sel:DWORD dst_unused:UNUSED_PAD src0_sel:DWORD src1_sel:WORD_0
  v_mul_f32 v108, s37, v108
  v_mul_f32 v110, s37, v110
  v_mfma_f32_32x32x16_bf16 v[176:191], v[20:23], v[48:51], v[176:191]
  ds_read_b64_tr_b16 v[36:37], v7 offset:15488
  ds_read_u16_d16_hi v97, v97 offset:36864
  ds_read_u16_d16 v96, v96 offset:36864
  v_mul_f32 v109, s37, v109
  v_cvt_pk_bf16_f32 v98, v98, v99
  v_mfma_f32_32x32x16_bf16 v[224:239], v[20:23], v[64:67], v[224:239]
  ds_read_b64_tr_b16 v[38:39], v7 offset:17024
  v_mfma_f32_32x32x16_bf16 v[160:175], v[24:27], v[56:59], v[160:175]
  ds_read_b64_tr_b16 v[16:17], v1 offset:18432
  v_mfma_f32_32x32x16_bf16 v[208:223], v[24:27], v[72:75], v[208:223]
  ds_read_b64_tr_b16 v[18:19], v1 offset:18688
  s_nop 8
  v_cvt_pk_bf16_f32 v160, v160, v161
  v_cvt_pk_bf16_f32 v161, v162, v163
  v_lshlrev_b32_sdwa v99, 1, v98 dst_sel:DWORD dst_unused:UNUSED_PAD src0_sel:DWORD src1_sel:WORD_1
  v_lshlrev_b32_sdwa v98, 1, v98 dst_sel:DWORD dst_unused:UNUSED_PAD src0_sel:DWORD src1_sel:WORD_0
  v_cvt_pk_bf16_f32 v162, v164, v165
  v_cvt_pk_bf16_f32 v163, v166, v167
  v_mul_f32 v111, s37, v111
  v_cvt_pk_bf16_f32 v168, v168, v169
  v_cvt_pk_bf16_f32 v169, v170, v171
  v_cvt_pk_bf16_f32 v170, v172, v173
  v_cvt_pk_bf16_f32 v171, v174, v175
  s_nop 1
  v_permlane16_swap_b32 v160, v168
  v_permlane16_swap_b32 v161, v169
  v_permlane16_swap_b32 v162, v170
  v_permlane16_swap_b32 v163, v171
  v_cvt_pk_f16_f32 v8, v108, v109
  v_cvt_pk_f16_f32 v10, v110, v111
  v_cvt_pk_bf16_f32 v100, v100, v101
  v_lshlrev_b32_sdwa v101, 1, v100 dst_sel:DWORD dst_unused:UNUSED_PAD src0_sel:DWORD src1_sel:WORD_1
  v_mfma_f32_32x32x16_bf16 v[176:191], v[28:31], v[56:59], v[176:191]
  ds_read_b64_tr_b16 v[20:21], v1 offset:19456
  ds_read_u16_d16_hi v99, v99 offset:36864
  ds_read_u16_d16 v98, v98 offset:36864
  buffer_store_dwordx4 v[160:163], v2, s[28:31], s40 offen offset:0 sc1
  v_lshlrev_b32_sdwa v100, 1, v100 dst_sel:DWORD dst_unused:UNUSED_PAD src0_sel:DWORD src1_sel:WORD_0
  v_pk_fma_f16 v9, v8, v8, s56
  v_pk_fma_f16 v11, v10, v10, s56
  v_mfma_f32_32x32x16_bf16 v[224:239], v[28:31], v[72:75], v[224:239]
  s_waitcnt lgkmcnt(9)
  ds_read_b64_tr_b16 v[22:23], v1 offset:19712
  ds_read_u16_d16_hi v101, v101 offset:36864
  ds_read_u16_d16 v100, v100 offset:36864
  v_pk_mul_f16 v9, v8, v9 neg_lo:[0,1] neg_hi:[0,1]
  v_cvt_pk_bf16_f32 v102, v102, v103
  v_pk_mul_f16 v11, v10, v11 neg_lo:[0,1] neg_hi:[0,1]
  v_lshlrev_b32_sdwa v103, 1, v102 dst_sel:DWORD dst_unused:UNUSED_PAD src0_sel:DWORD src1_sel:WORD_1
  v_mfma_f32_32x32x16_bf16 v[192:207], v[32:35], v[48:51], v[192:207]
  ds_read_b64_tr_b16 v[24:25], v1 offset:20480
  ds_read_u16_d16_hi v103, v103 offset:36864
  v_lshlrev_b32_sdwa v102, 1, v102 dst_sel:DWORD dst_unused:UNUSED_PAD src0_sel:DWORD src1_sel:WORD_0
  v_exp_f16 v8, v9
  v_cvt_pk_bf16_f32 v104, v104, v105
  v_exp_f16 v10, v11
  v_mfma_f32_32x32x16_bf16 v[240:255], v[32:35], v[64:67], v[240:255]
  s_waitcnt lgkmcnt(10)
  ds_read_b64_tr_b16 v[26:27], v1 offset:20736
  ds_read_u16_d16 v102, v102 offset:36864
  buffer_store_dwordx4 v[168:171], v2, s[28:31], s40 offen offset:192 sc1
  v_lshlrev_b32_sdwa v105, 1, v104 dst_sel:DWORD dst_unused:UNUSED_PAD src0_sel:DWORD src1_sel:WORD_1
  v_lshlrev_b32_sdwa v104, 1, v104 dst_sel:DWORD dst_unused:UNUSED_PAD src0_sel:DWORD src1_sel:WORD_0
  v_cvt_pk_bf16_f32 v176, v176, v177
  v_cvt_pk_bf16_f32 v177, v178, v179
  v_mfma_f32_32x32x16_bf16 v[192:207], v[36:39], v[56:59], v[192:207]
  ds_read_b64_tr_b16 v[28:29], v1 offset:21504
  ds_read_u16_d16_hi v105, v105 offset:36864
  ds_read_u16_d16 v104, v104 offset:36864
  v_cvt_pk_bf16_f32 v178, v180, v181
  v_cvt_pk_bf16_f32 v179, v182, v183
  v_cvt_pk_bf16_f32 v184, v184, v185
  v_cvt_pk_bf16_f32 v185, v186, v187
  v_mfma_f32_32x32x16_bf16 v[240:255], v[36:39], v[72:75], v[240:255]
  s_waitcnt lgkmcnt(13)
  ds_read_b64_tr_b16 v[30:31], v1 offset:21760
  v_cvt_pk_bf16_f32 v186, v188, v189
  v_cvt_pk_bf16_f32 v187, v190, v191
  s_nop 1
  v_permlane16_swap_b32 v176, v184
  v_permlane16_swap_b32 v177, v185
  v_permlane16_swap_b32 v178, v186
  v_permlane16_swap_b32 v179, v187
  v_mfma_f32_32x32x16_bf16 v[64:79], v[16:19], v[136:139], 0
  s_waitcnt lgkmcnt(10)
  ds_read_b64_tr_b16 v[32:33], v1 offset:22528
  ds_read_b64_tr_b16 v[34:35], v1 offset:22784
  buffer_store_dwordx4 v[176:179], v2, s[28:31], s40 offen offset:64 sc1
  v_exp_f16_sdwa v8, v9 dst_sel:WORD_1 dst_unused:UNUSED_PRESERVE src0_sel:WORD_1
  v_cvt_pk_bf16_f32 v106, v106, v107
  v_mfma_f32_32x32x16_bf16 v[64:79], v[20:23], v[140:143], v[64:79]
  s_waitcnt lgkmcnt(7)
  ds_read_b64_tr_b16 v[36:37], v1 offset:23552
  ds_read_b64_tr_b16 v[38:39], v1 offset:23808
  v_or_b32 v96, v96, v97
  v_lshlrev_b32_sdwa v107, 1, v106 dst_sel:DWORD dst_unused:UNUSED_PAD src0_sel:DWORD src1_sel:WORD_1
  v_lshlrev_b32_sdwa v106, 1, v106 dst_sel:DWORD dst_unused:UNUSED_PAD src0_sel:DWORD src1_sel:WORD_0
  v_exp_f16_sdwa v10, v11 dst_sel:WORD_1 dst_unused:UNUSED_PRESERVE src0_sel:WORD_1
  v_mfma_f32_32x32x16_bf16 v[64:79], v[24:27], v[144:147], v[64:79]
  s_waitcnt lgkmcnt(4)
  ds_read_b64_tr_b16 v[16:17], v7 offset:24576
  ds_read_b64_tr_b16 v[18:19], v7 offset:26112
  ds_read_u16_d16_hi v107, v107 offset:36864
  v_pk_fma_f16 v8, v8, s57, s57
  v_or_b32 v97, v98, v99
  v_pk_fma_f16 v10, v10, s57, s57
  v_rcp_f16 v9, v8
  v_mfma_f32_32x32x16_bf16 v[64:79], v[28:31], v[148:151], v[64:79]
  s_waitcnt lgkmcnt(5)
  ds_read_b64_tr_b16 v[20:21], v7 offset:24640
  ds_read_b64_tr_b16 v[22:23], v7 offset:26176
  ds_read_u16_d16 v106, v106 offset:36864
  v_or_b32 v98, v100, v101
  v_rcp_f16 v11, v10
  v_mfma_f32_32x32x16_bf16 v[64:79], v[32:35], v[152:155], v[64:79]
  s_waitcnt lgkmcnt(6)
  ds_read_b64_tr_b16 v[24:25], v7 offset:27648
  ds_read_b64_tr_b16 v[26:27], v7 offset:29184
  buffer_store_dwordx4 v[184:187], v2, s[28:31], s40 offen offset:256 sc1
  v_rcp_f16_sdwa v9, v8 dst_sel:WORD_1 dst_unused:UNUSED_PRESERVE src0_sel:WORD_1
  v_or_b32 v99, v102, v103
  v_rcp_f16_sdwa v11, v10 dst_sel:WORD_1 dst_unused:UNUSED_PRESERVE src0_sel:WORD_1
  v_mfma_f32_32x32x16_bf16 v[64:79], v[36:39], v[156:159], v[64:79]
  s_waitcnt lgkmcnt(6)
  ds_read_b64_tr_b16 v[28:29], v7 offset:27712
  ds_read_b64_tr_b16 v[30:31], v7 offset:29248
  v_cvt_pk_bf16_f32 v192, v192, v193
  v_cvt_pk_bf16_f32 v193, v194, v195
  v_cvt_pk_bf16_f32 v194, v196, v197
  v_cvt_pk_bf16_f32 v195, v198, v199
  v_or_b32 v104, v104, v105
  v_mfma_f32_32x32x16_bf16 v[208:223], v[16:19], v[96:99], v[208:223]
  s_waitcnt lgkmcnt(5)
  ds_read_b64_tr_b16 v[32:33], v7 offset:24704
  ds_read_b64_tr_b16 v[34:35], v7 offset:26240
  v_cvt_pk_bf16_f32 v200, v200, v201
  v_cvt_pk_bf16_f32 v201, v202, v203
  v_fma_mix_f32 v108, v108, v9, 0 op_sel_hi:[0,1,0]
  v_cvt_pk_bf16_f32 v202, v204, v205
  v_cvt_pk_bf16_f32 v203, v206, v207
  s_nop 1
  v_permlane16_swap_b32 v192, v200
  v_permlane16_swap_b32 v193, v201
  v_permlane16_swap_b32 v194, v202
  v_permlane16_swap_b32 v195, v203
  v_mfma_f32_32x32x16_bf16 v[224:239], v[20:23], v[96:99], v[224:239]
  s_waitcnt lgkmcnt(4)
  ds_read_b64_tr_b16 v[36:37], v7 offset:27776
  ds_read_b64_tr_b16 v[38:39], v7 offset:29312
  buffer_store_dwordx4 v[192:195], v2, s[28:31], s40 offen offset:128 sc1
  v_fma_mix_f32 v110, v110, v11, 0 op_sel_hi:[0,1,0]
  v_fma_mix_f32 v109, v109, v9, 0 op_sel:[0,1,0] op_sel_hi:[0,1,0]
  v_fma_mix_f32 v111, v111, v11, 0 op_sel:[0,1,0] op_sel_hi:[0,1,0]
  v_or_b32 v105, v106, v107
  v_cvt_pk_bf16_f32 v106, v108, v109
  v_cvt_pk_bf16_f32 v107, v110, v111
  s_nop 1
  v_mfma_f32_32x32x16_bf16 v[208:223], v[24:27], v[104:107], v[208:223]
  s_waitcnt lgkmcnt(4)
  ds_read_b64_tr_b16 v[16:17], v1 offset:30720
  ds_read_b64_tr_b16 v[18:19], v1 offset:30976
  v_cvt_pk_bf16_f32 v64, v64, v65
  v_lshlrev_b32_sdwa v65, 1, v64 dst_sel:DWORD dst_unused:UNUSED_PAD src0_sel:DWORD src1_sel:WORD_1
  v_lshlrev_b32_sdwa v64, 1, v64 dst_sel:DWORD dst_unused:UNUSED_PAD src0_sel:DWORD src1_sel:WORD_0
  v_mul_f32 v76, s37, v76
  v_mfma_f32_32x32x16_bf16 v[224:239], v[28:31], v[104:107], v[224:239]
  s_waitcnt lgkmcnt(4)
  ds_read_b64_tr_b16 v[20:21], v1 offset:31744
  ds_read_b64_tr_b16 v[22:23], v1 offset:32000
  ds_read_u16_d16_hi v65, v65 offset:36864
  ds_read_u16_d16 v64, v64 offset:36864
  v_mul_f32 v78, s37, v78
  v_mul_f32 v77, s37, v77
  v_cvt_pk_bf16_f32 v66, v66, v67
  v_lshlrev_b32_sdwa v67, 1, v66 dst_sel:DWORD dst_unused:UNUSED_PAD src0_sel:DWORD src1_sel:WORD_1
  v_lshlrev_b32_sdwa v66, 1, v66 dst_sel:DWORD dst_unused:UNUSED_PAD src0_sel:DWORD src1_sel:WORD_0
  v_mfma_f32_32x32x16_bf16 v[240:255], v[32:35], v[96:99], v[240:255]
  s_waitcnt lgkmcnt(6)
  ds_read_b64_tr_b16 v[24:25], v1 offset:32768
  ds_read_b64_tr_b16 v[26:27], v1 offset:33024
  ds_read_u16_d16_hi v67, v67 offset:36864
  ds_read_u16_d16 v66, v66 offset:36864
  buffer_store_dwordx4 v[200:203], v2, s[28:31], s40 offen offset:320 sc1
  s_add_u32 s40, s40, s41
  v_mul_f32 v79, s37, v79
  v_cvt_pk_f16_f32 v8, v76, v77
  v_cvt_pk_f16_f32 v10, v78, v79
  v_mfma_f32_32x32x16_bf16 v[240:255], v[36:39], v[104:107], v[240:255]
  s_waitcnt lgkmcnt(8)
  ds_read_b64_tr_b16 v[28:29], v1 offset:33792
  ds_read_b64_tr_b16 v[30:31], v1 offset:34048
  v_cvt_pk_bf16_f32 v68, v68, v69
  v_lshlrev_b32_sdwa v69, 1, v68 dst_sel:DWORD dst_unused:UNUSED_PAD src0_sel:DWORD src1_sel:WORD_1
  v_lshlrev_b32_sdwa v68, 1, v68 dst_sel:DWORD dst_unused:UNUSED_PAD src0_sel:DWORD src1_sel:WORD_0
  v_pk_fma_f16 v9, v8, v8, s56
  v_pk_fma_f16 v11, v10, v10, s56
  v_pk_mul_f16 v9, v8, v9 neg_lo:[0,1] neg_hi:[0,1]
  v_mfma_f32_32x32x16_bf16 v[96:111], v[16:19], v[136:139], 0
  s_waitcnt lgkmcnt(8)
  ds_read_b64_tr_b16 v[32:33], v1 offset:34816
  ds_read_b64_tr_b16 v[34:35], v1 offset:35072
  ds_read_u16_d16_hi v69, v69 offset:36864
  ds_read_u16_d16 v68, v68 offset:36864
  v_cvt_pk_bf16_f32 v70, v70, v71
  v_pk_mul_f16 v11, v10, v11 neg_lo:[0,1] neg_hi:[0,1]
  v_lshlrev_b32_sdwa v71, 1, v70 dst_sel:DWORD dst_unused:UNUSED_PAD src0_sel:DWORD src1_sel:WORD_1
  v_lshlrev_b32_sdwa v70, 1, v70 dst_sel:DWORD dst_unused:UNUSED_PAD src0_sel:DWORD src1_sel:WORD_0
  v_exp_f16 v8, v9
  v_mfma_f32_32x32x16_bf16 v[96:111], v[20:23], v[140:143], v[96:111]
  s_waitcnt lgkmcnt(8)
  ds_read_b64_tr_b16 v[36:37], v1 offset:35840
  ds_read_b64_tr_b16 v[38:39], v1 offset:36096
  ds_read_u16_d16_hi v71, v71 offset:36864
  ds_read_u16_d16 v70, v70 offset:36864
  v_cvt_pk_bf16_f32 v72, v72, v73
  v_exp_f16 v10, v11
  v_lshlrev_b32_sdwa v73, 1, v72 dst_sel:DWORD dst_unused:UNUSED_PAD src0_sel:DWORD src1_sel:WORD_1
  v_mfma_f32_32x32x16_bf16 v[96:111], v[24:27], v[144:147], v[96:111]
  s_waitcnt lgkmcnt(8)
  ds_read_b64_tr_b16 v[16:17], v7 offset:36864
  ds_read_b64_tr_b16 v[18:19], v7 offset:38400
  ds_read_u16_d16_hi v73, v73 offset:36864
  v_lshlrev_b32_sdwa v72, 1, v72 dst_sel:DWORD dst_unused:UNUSED_PAD src0_sel:DWORD src1_sel:WORD_0
  v_exp_f16_sdwa v8, v9 dst_sel:WORD_1 dst_unused:UNUSED_PRESERVE src0_sel:WORD_1
  v_cvt_pk_bf16_f32 v74, v74, v75
  v_or_b32 v64, v64, v65
  v_lshlrev_b32_sdwa v75, 1, v74 dst_sel:DWORD dst_unused:UNUSED_PAD src0_sel:DWORD src1_sel:WORD_1
  v_mfma_f32_32x32x16_bf16 v[96:111], v[28:31], v[148:151], v[96:111]
  s_waitcnt lgkmcnt(9)
  ds_read_b64_tr_b16 v[20:21], v7 offset:36928
  ds_read_b64_tr_b16 v[22:23], v7 offset:38464
  ds_read_u16_d16 v72, v72 offset:36864
  ds_read_u16_d16_hi v75, v75 offset:36864
  v_lshlrev_b32_sdwa v74, 1, v74 dst_sel:DWORD dst_unused:UNUSED_PAD src0_sel:DWORD src1_sel:WORD_0
  v_exp_f16_sdwa v10, v11 dst_sel:WORD_1 dst_unused:UNUSED_PRESERVE src0_sel:WORD_1
  v_pk_fma_f16 v8, v8, s57, s57
  v_or_b32 v65, v66, v67
  v_mfma_f32_32x32x16_bf16 v[96:111], v[32:35], v[152:155], v[96:111]
  s_waitcnt lgkmcnt(9)
  ds_read_b64_tr_b16 v[24:25], v7 offset:39936
  ds_read_b64_tr_b16 v[26:27], v7 offset:41472
  ds_read_u16_d16 v74, v74 offset:36864
  v_pk_fma_f16 v10, v10, s57, s57
  v_rcp_f16 v9, v8
  v_or_b32 v66, v68, v69
  v_rcp_f16 v11, v10
  v_mfma_f32_32x32x16_bf16 v[96:111], v[36:39], v[156:159], v[96:111]
  s_waitcnt lgkmcnt(4)
  ds_read_b64_tr_b16 v[28:29], v7 offset:40000
  ds_read_b64_tr_b16 v[30:31], v7 offset:41536
  v_rcp_f16_sdwa v9, v8 dst_sel:WORD_1 dst_unused:UNUSED_PRESERVE src0_sel:WORD_1
  v_or_b32 v67, v70, v71
  v_rcp_f16_sdwa v11, v10 dst_sel:WORD_1 dst_unused:UNUSED_PRESERVE src0_sel:WORD_1
  v_or_b32 v72, v72, v73
  v_mfma_f32_32x32x16_bf16 v[208:223], v[16:19], v[64:67], v[208:223]
  s_waitcnt lgkmcnt(2)
  ds_read_b64_tr_b16 v[32:33], v7 offset:36992
  ds_read_b64_tr_b16 v[34:35], v7 offset:38528
  v_fma_mix_f32 v76, v76, v9, 0 op_sel_hi:[0,1,0]
  v_fma_mix_f32 v78, v78, v11, 0 op_sel_hi:[0,1,0]
  v_fma_mix_f32 v77, v77, v9, 0 op_sel:[0,1,0] op_sel_hi:[0,1,0]
  v_fma_mix_f32 v79, v79, v11, 0 op_sel:[0,1,0] op_sel_hi:[0,1,0]
  v_or_b32 v73, v74, v75
  v_cvt_pk_bf16_f32 v74, v76, v77
  v_mfma_f32_32x32x16_bf16 v[224:239], v[20:23], v[64:67], v[224:239]
  ds_read_b64_tr_b16 v[36:37], v7 offset:40064
  ds_read_b64_tr_b16 v[38:39], v7 offset:41600
  v_cvt_pk_bf16_f32 v75, v78, v79
  v_cvt_pk_bf16_f32 v96, v96, v97
  v_lshlrev_b32_sdwa v97, 1, v96 dst_sel:DWORD dst_unused:UNUSED_PAD src0_sel:DWORD src1_sel:WORD_1
  v_lshlrev_b32_sdwa v96, 1, v96 dst_sel:DWORD dst_unused:UNUSED_PAD src0_sel:DWORD src1_sel:WORD_0
  v_mul_f32 v108, s37, v108
  v_mul_f32 v110, s37, v110
  v_mfma_f32_32x32x16_bf16 v[208:223], v[24:27], v[72:75], v[208:223]
  s_waitcnt lgkmcnt(4)
  ds_read_b64_tr_b16 v[16:17], v1 offset:43008
  ds_read_b64_tr_b16 v[18:19], v1 offset:43264
  ds_read_u16_d16_hi v97, v97 offset:36864
  ds_read_u16_d16 v96, v96 offset:36864
  v_mul_f32 v109, s37, v109
  v_cvt_pk_bf16_f32 v98, v98, v99
  v_lshlrev_b32_sdwa v99, 1, v98 dst_sel:DWORD dst_unused:UNUSED_PAD src0_sel:DWORD src1_sel:WORD_1
  v_lshlrev_b32_sdwa v98, 1, v98 dst_sel:DWORD dst_unused:UNUSED_PAD src0_sel:DWORD src1_sel:WORD_0
  v_mfma_f32_32x32x16_bf16 v[224:239], v[28:31], v[72:75], v[224:239]
  s_waitcnt lgkmcnt(6)
  ds_read_b64_tr_b16 v[20:21], v1 offset:44032
  ds_read_b64_tr_b16 v[22:23], v1 offset:44288
  ds_read_u16_d16_hi v99, v99 offset:36864
  ds_read_u16_d16 v98, v98 offset:36864
  v_mul_f32 v111, s37, v111
  v_cvt_pk_f16_f32 v8, v108, v109
  v_cvt_pk_f16_f32 v10, v110, v111
  v_cvt_pk_bf16_f32 v100, v100, v101
  v_mfma_f32_32x32x16_bf16 v[240:255], v[32:35], v[64:67], v[240:255]
  s_waitcnt lgkmcnt(8)
  ds_read_b64_tr_b16 v[24:25], v1 offset:45056
  ds_read_b64_tr_b16 v[26:27], v1 offset:45312
  v_lshlrev_b32_sdwa v101, 1, v100 dst_sel:DWORD dst_unused:UNUSED_PAD src0_sel:DWORD src1_sel:WORD_1
  v_lshlrev_b32_sdwa v100, 1, v100 dst_sel:DWORD dst_unused:UNUSED_PAD src0_sel:DWORD src1_sel:WORD_0
  v_pk_fma_f16 v9, v8, v8, s56
  v_pk_fma_f16 v11, v10, v10, s56
  v_pk_mul_f16 v9, v8, v9 neg_lo:[0,1] neg_hi:[0,1]
  v_cvt_pk_bf16_f32 v102, v102, v103
  v_mfma_f32_32x32x16_bf16 v[240:255], v[36:39], v[72:75], v[240:255]
  s_waitcnt lgkmcnt(8)
  ds_read_b64_tr_b16 v[28:29], v1 offset:46080
  ds_read_b64_tr_b16 v[30:31], v1 offset:46336
  ds_read_u16_d16_hi v101, v101 offset:36864
  ds_read_u16_d16 v100, v100 offset:36864
  v_pk_mul_f16 v11, v10, v11 neg_lo:[0,1] neg_hi:[0,1]
  v_lshlrev_b32_sdwa v103, 1, v102 dst_sel:DWORD dst_unused:UNUSED_PAD src0_sel:DWORD src1_sel:WORD_1
  v_lshlrev_b32_sdwa v102, 1, v102 dst_sel:DWORD dst_unused:UNUSED_PAD src0_sel:DWORD src1_sel:WORD_0
  v_mfma_f32_32x32x16_bf16 v[64:79], v[16:19], v[136:139], 0
  s_waitcnt lgkmcnt(8)
  ds_read_b64_tr_b16 v[32:33], v1 offset:47104
  ds_read_b64_tr_b16 v[34:35], v1 offset:47360
  ds_read_u16_d16_hi v103, v103 offset:36864
  ds_read_u16_d16 v102, v102 offset:36864
  v_exp_f16 v8, v9
  v_cvt_pk_bf16_f32 v104, v104, v105
  v_exp_f16 v10, v11
  v_mfma_f32_32x32x16_bf16 v[64:79], v[20:23], v[140:143], v[64:79]
  s_waitcnt lgkmcnt(8)
  ds_read_b64_tr_b16 v[36:37], v1 offset:48128
  ds_read_b64_tr_b16 v[38:39], v1 offset:48384
  v_lshlrev_b32_sdwa v105, 1, v104 dst_sel:DWORD dst_unused:UNUSED_PAD src0_sel:DWORD src1_sel:WORD_1
  v_lshlrev_b32_sdwa v104, 1, v104 dst_sel:DWORD dst_unused:UNUSED_PAD src0_sel:DWORD src1_sel:WORD_0
  v_exp_f16_sdwa v8, v9 dst_sel:WORD_1 dst_unused:UNUSED_PRESERVE src0_sel:WORD_1
  v_cvt_pk_bf16_f32 v106, v106, v107
  v_mfma_f32_32x32x16_bf16 v[64:79], v[24:27], v[144:147], v[64:79]
  s_waitcnt lgkmcnt(8)
  v_add_u32 v1, 65536, v1
  v_add_u32 v7, 65536, v7
  ds_read_b64_tr_b16 v[16:17], v7 offset:0
  ds_read_b64_tr_b16 v[18:19], v7 offset:1536
  ds_read_u16_d16_hi v105, v105 offset:36864
  ds_read_u16_d16 v104, v104 offset:36864
  v_or_b32 v96, v96, v97
  v_lshlrev_b32_sdwa v107, 1, v106 dst_sel:DWORD dst_unused:UNUSED_PAD src0_sel:DWORD src1_sel:WORD_1
  v_mfma_f32_32x32x16_bf16 v[64:79], v[28:31], v[148:151], v[64:79]
  s_waitcnt lgkmcnt(8)
  ds_read_b64_tr_b16 v[20:21], v7 offset:64
  ds_read_b64_tr_b16 v[22:23], v7 offset:1600
  ds_read_u16_d16_hi v107, v107 offset:36864
  v_lshlrev_b32_sdwa v106, 1, v106 dst_sel:DWORD dst_unused:UNUSED_PAD src0_sel:DWORD src1_sel:WORD_0
  v_exp_f16_sdwa v10, v11 dst_sel:WORD_1 dst_unused:UNUSED_PRESERVE src0_sel:WORD_1
  v_pk_fma_f16 v8, v8, s57, s57
  v_or_b32 v97, v98, v99
  v_mfma_f32_32x32x16_bf16 v[64:79], v[32:35], v[152:155], v[64:79]
  s_waitcnt lgkmcnt(7)
  ds_read_b64_tr_b16 v[24:25], v7 offset:3072
  ds_read_b64_tr_b16 v[26:27], v7 offset:4608
  ds_read_u16_d16 v106, v106 offset:36864
  v_pk_fma_f16 v10, v10, s57, s57
  v_rcp_f16 v9, v8
  v_or_b32 v98, v100, v101
  v_rcp_f16 v11, v10
  v_mfma_f32_32x32x16_bf16 v[64:79], v[36:39], v[156:159], v[64:79]
  s_waitcnt lgkmcnt(6)
  ds_read_b64_tr_b16 v[28:29], v7 offset:3136
  ds_read_b64_tr_b16 v[30:31], v7 offset:4672
  v_rcp_f16_sdwa v9, v8 dst_sel:WORD_1 dst_unused:UNUSED_PRESERVE src0_sel:WORD_1
  v_or_b32 v99, v102, v103
  v_rcp_f16_sdwa v11, v10 dst_sel:WORD_1 dst_unused:UNUSED_PRESERVE src0_sel:WORD_1
  v_or_b32 v104, v104, v105
  v_mfma_f32_32x32x16_bf16 v[208:223], v[16:19], v[96:99], v[208:223]
  s_waitcnt lgkmcnt(2)
  ds_read_b64_tr_b16 v[32:33], v7 offset:128
  ds_read_b64_tr_b16 v[34:35], v7 offset:1664
  v_fma_mix_f32 v108, v108, v9, 0 op_sel_hi:[0,1,0]
  v_fma_mix_f32 v110, v110, v11, 0 op_sel_hi:[0,1,0]
  v_fma_mix_f32 v109, v109, v9, 0 op_sel:[0,1,0] op_sel_hi:[0,1,0]
  v_fma_mix_f32 v111, v111, v11, 0 op_sel:[0,1,0] op_sel_hi:[0,1,0]
  v_or_b32 v105, v106, v107
  v_cvt_pk_bf16_f32 v106, v108, v109
  v_mfma_f32_32x32x16_bf16 v[224:239], v[20:23], v[96:99], v[224:239]
  ds_read_b64_tr_b16 v[36:37], v7 offset:3200
  ds_read_b64_tr_b16 v[38:39], v7 offset:4736
  v_cvt_pk_bf16_f32 v107, v110, v111
  v_cvt_pk_bf16_f32 v64, v64, v65
  v_lshlrev_b32_sdwa v65, 1, v64 dst_sel:DWORD dst_unused:UNUSED_PAD src0_sel:DWORD src1_sel:WORD_1
  v_lshlrev_b32_sdwa v64, 1, v64 dst_sel:DWORD dst_unused:UNUSED_PAD src0_sel:DWORD src1_sel:WORD_0
  v_mul_f32 v76, s37, v76
  v_mul_f32 v78, s37, v78
  v_mfma_f32_32x32x16_bf16 v[208:223], v[24:27], v[104:107], v[208:223]
  s_waitcnt lgkmcnt(4)
  ds_read_b64_tr_b16 v[16:17], v1 offset:6144
  ds_read_b64_tr_b16 v[18:19], v1 offset:6400
  ds_read_u16_d16_hi v65, v65 offset:36864
  ds_read_u16_d16 v64, v64 offset:36864
  v_mul_f32 v77, s37, v77
  v_cvt_pk_bf16_f32 v66, v66, v67
  v_lshlrev_b32_sdwa v67, 1, v66 dst_sel:DWORD dst_unused:UNUSED_PAD src0_sel:DWORD src1_sel:WORD_1
  v_lshlrev_b32_sdwa v66, 1, v66 dst_sel:DWORD dst_unused:UNUSED_PAD src0_sel:DWORD src1_sel:WORD_0
  v_mfma_f32_32x32x16_bf16 v[224:239], v[28:31], v[104:107], v[224:239]
  s_waitcnt lgkmcnt(6)
  ds_read_b64_tr_b16 v[20:21], v1 offset:7168
  ds_read_b64_tr_b16 v[22:23], v1 offset:7424
  ds_read_u16_d16_hi v67, v67 offset:36864
  ds_read_u16_d16 v66, v66 offset:36864
  v_mul_f32 v79, s37, v79
  v_cvt_pk_f16_f32 v8, v76, v77
  v_cvt_pk_f16_f32 v10, v78, v79
  v_cvt_pk_bf16_f32 v68, v68, v69
  v_mfma_f32_32x32x16_bf16 v[240:255], v[32:35], v[96:99], v[240:255]
  s_waitcnt lgkmcnt(8)
  ds_read_b64_tr_b16 v[24:25], v1 offset:8192
  ds_read_b64_tr_b16 v[26:27], v1 offset:8448
  v_lshlrev_b32_sdwa v69, 1, v68 dst_sel:DWORD dst_unused:UNUSED_PAD src0_sel:DWORD src1_sel:WORD_1
  v_lshlrev_b32_sdwa v68, 1, v68 dst_sel:DWORD dst_unused:UNUSED_PAD src0_sel:DWORD src1_sel:WORD_0
  v_pk_fma_f16 v9, v8, v8, s56
  v_pk_fma_f16 v11, v10, v10, s56
  v_pk_mul_f16 v9, v8, v9 neg_lo:[0,1] neg_hi:[0,1]
  v_cvt_pk_bf16_f32 v70, v70, v71
  v_mfma_f32_32x32x16_bf16 v[240:255], v[36:39], v[104:107], v[240:255]
  s_waitcnt lgkmcnt(8)
  ds_read_b64_tr_b16 v[28:29], v1 offset:9216
  ds_read_b64_tr_b16 v[30:31], v1 offset:9472
  ds_read_u16_d16_hi v69, v69 offset:36864
  ds_read_u16_d16 v68, v68 offset:36864
  v_pk_mul_f16 v11, v10, v11 neg_lo:[0,1] neg_hi:[0,1]
  v_lshlrev_b32_sdwa v71, 1, v70 dst_sel:DWORD dst_unused:UNUSED_PAD src0_sel:DWORD src1_sel:WORD_1
  v_lshlrev_b32_sdwa v70, 1, v70 dst_sel:DWORD dst_unused:UNUSED_PAD src0_sel:DWORD src1_sel:WORD_0
  v_mfma_f32_32x32x16_bf16 v[96:111], v[16:19], v[136:139], 0
  s_waitcnt lgkmcnt(8)
  ds_read_b64_tr_b16 v[32:33], v1 offset:10240
  ds_read_b64_tr_b16 v[34:35], v1 offset:10496
  ds_read_u16_d16_hi v71, v71 offset:36864
  ds_read_u16_d16 v70, v70 offset:36864
  v_exp_f16 v8, v9
  v_cvt_pk_bf16_f32 v72, v72, v73
  v_exp_f16 v10, v11
  v_mfma_f32_32x32x16_bf16 v[96:111], v[20:23], v[140:143], v[96:111]
  s_waitcnt lgkmcnt(8)
  ds_read_b64_tr_b16 v[36:37], v1 offset:11264
  ds_read_b64_tr_b16 v[38:39], v1 offset:11520
  v_lshlrev_b32_sdwa v73, 1, v72 dst_sel:DWORD dst_unused:UNUSED_PAD src0_sel:DWORD src1_sel:WORD_1
  v_lshlrev_b32_sdwa v72, 1, v72 dst_sel:DWORD dst_unused:UNUSED_PAD src0_sel:DWORD src1_sel:WORD_0
  v_exp_f16_sdwa v8, v9 dst_sel:WORD_1 dst_unused:UNUSED_PRESERVE src0_sel:WORD_1
  v_cvt_pk_bf16_f32 v74, v74, v75
  v_mfma_f32_32x32x16_bf16 v[96:111], v[24:27], v[144:147], v[96:111]
  s_waitcnt lgkmcnt(8)
  ds_read_b64_tr_b16 v[16:17], v7 offset:12288
  ds_read_b64_tr_b16 v[18:19], v7 offset:13824
  ds_read_u16_d16_hi v73, v73 offset:36864
  ds_read_u16_d16 v72, v72 offset:36864
  v_or_b32 v64, v64, v65
  v_lshlrev_b32_sdwa v75, 1, v74 dst_sel:DWORD dst_unused:UNUSED_PAD src0_sel:DWORD src1_sel:WORD_1
  v_lshlrev_b32_sdwa v74, 1, v74 dst_sel:DWORD dst_unused:UNUSED_PAD src0_sel:DWORD src1_sel:WORD_0
  v_exp_f16_sdwa v10, v11 dst_sel:WORD_1 dst_unused:UNUSED_PRESERVE src0_sel:WORD_1
  v_mfma_f32_32x32x16_bf16 v[96:111], v[28:31], v[148:151], v[96:111]
  s_waitcnt lgkmcnt(8)
  ds_read_b64_tr_b16 v[20:21], v7 offset:12352
  ds_read_b64_tr_b16 v[22:23], v7 offset:13888
  ds_read_u16_d16_hi v75, v75 offset:36864
  ds_read_u16_d16 v74, v74 offset:36864
  v_pk_fma_f16 v8, v8, s57, s57
  v_or_b32 v65, v66, v67
  v_pk_fma_f16 v10, v10, s57, s57
  v_mfma_f32_32x32x16_bf16 v[96:111], v[32:35], v[152:155], v[96:111]
  s_waitcnt lgkmcnt(8)
  ds_read_b64_tr_b16 v[24:25], v7 offset:15360
  ds_read_b64_tr_b16 v[26:27], v7 offset:16896
  v_rcp_f16 v9, v8
  v_or_b32 v66, v68, v69
  v_rcp_f16 v11, v10
  v_rcp_f16_sdwa v9, v8 dst_sel:WORD_1 dst_unused:UNUSED_PRESERVE src0_sel:WORD_1
  v_mfma_f32_32x32x16_bf16 v[96:111], v[36:39], v[156:159], v[96:111]
  s_waitcnt lgkmcnt(6)
  ds_read_b64_tr_b16 v[28:29], v7 offset:15424
  ds_read_b64_tr_b16 v[30:31], v7 offset:16960
  v_or_b32 v67, v70, v71
  v_rcp_f16_sdwa v11, v10 dst_sel:WORD_1 dst_unused:UNUSED_PRESERVE src0_sel:WORD_1
  v_or_b32 v72, v72, v73
  v_mfma_f32_32x32x16_bf16 v[208:223], v[16:19], v[64:67], v[208:223]
  s_waitcnt lgkmcnt(4)
  ds_read_b64_tr_b16 v[32:33], v7 offset:12416
  ds_read_b64_tr_b16 v[34:35], v7 offset:13952
  v_fma_mix_f32 v76, v76, v9, 0 op_sel_hi:[0,1,0]
  v_fma_mix_f32 v78, v78, v11, 0 op_sel_hi:[0,1,0]
  v_fma_mix_f32 v77, v77, v9, 0 op_sel:[0,1,0] op_sel_hi:[0,1,0]
  v_fma_mix_f32 v79, v79, v11, 0 op_sel:[0,1,0] op_sel_hi:[0,1,0]
  v_or_b32 v73, v74, v75
  v_cvt_pk_bf16_f32 v74, v76, v77
  v_mfma_f32_32x32x16_bf16 v[224:239], v[20:23], v[64:67], v[224:239]
  s_waitcnt lgkmcnt(4)
  ds_read_b64_tr_b16 v[36:37], v7 offset:15488
  ds_read_b64_tr_b16 v[38:39], v7 offset:17024
  v_cvt_pk_bf16_f32 v75, v78, v79
  v_cvt_pk_bf16_f32 v96, v96, v97
  v_lshlrev_b32_sdwa v97, 1, v96 dst_sel:DWORD dst_unused:UNUSED_PAD src0_sel:DWORD src1_sel:WORD_1
  v_lshlrev_b32_sdwa v96, 1, v96 dst_sel:DWORD dst_unused:UNUSED_PAD src0_sel:DWORD src1_sel:WORD_0
  v_mul_f32 v108, s37, v108
  v_mul_f32 v110, s37, v110
  v_mfma_f32_32x32x16_bf16 v[208:223], v[24:27], v[72:75], v[208:223]
  s_waitcnt lgkmcnt(4)
  ds_read_b64_tr_b16 v[16:17], v1 offset:18432
  ds_read_b64_tr_b16 v[18:19], v1 offset:18688
  ds_read_u16_d16_hi v97, v97 offset:36864
  ds_read_u16_d16 v96, v96 offset:36864
  v_mul_f32 v109, s37, v109
  v_cvt_pk_bf16_f32 v98, v98, v99
  v_lshlrev_b32_sdwa v99, 1, v98 dst_sel:DWORD dst_unused:UNUSED_PAD src0_sel:DWORD src1_sel:WORD_1
  v_lshlrev_b32_sdwa v98, 1, v98 dst_sel:DWORD dst_unused:UNUSED_PAD src0_sel:DWORD src1_sel:WORD_0
  v_mfma_f32_32x32x16_bf16 v[224:239], v[28:31], v[72:75], v[224:239]
  s_waitcnt lgkmcnt(6)
  ds_read_b64_tr_b16 v[20:21], v1 offset:19456
  ds_read_b64_tr_b16 v[22:23], v1 offset:19712
  ds_read_u16_d16_hi v99, v99 offset:36864
  ds_read_u16_d16 v98, v98 offset:36864
  v_mul_f32 v111, s37, v111
  v_cvt_pk_f16_f32 v8, v108, v109
  v_cvt_pk_f16_f32 v10, v110, v111
  v_cvt_pk_bf16_f32 v100, v100, v101
  v_mfma_f32_32x32x16_bf16 v[240:255], v[32:35], v[64:67], v[240:255]
  s_waitcnt lgkmcnt(8)
  ds_read_b64_tr_b16 v[24:25], v1 offset:20480
  ds_read_b64_tr_b16 v[26:27], v1 offset:20736
  v_lshlrev_b32_sdwa v101, 1, v100 dst_sel:DWORD dst_unused:UNUSED_PAD src0_sel:DWORD src1_sel:WORD_1
  v_lshlrev_b32_sdwa v100, 1, v100 dst_sel:DWORD dst_unused:UNUSED_PAD src0_sel:DWORD src1_sel:WORD_0
  v_pk_fma_f16 v9, v8, v8, s56
  v_pk_fma_f16 v11, v10, v10, s56
  v_pk_mul_f16 v9, v8, v9 neg_lo:[0,1] neg_hi:[0,1]
  v_cvt_pk_bf16_f32 v102, v102, v103
  v_mfma_f32_32x32x16_bf16 v[240:255], v[36:39], v[72:75], v[240:255]
  s_waitcnt lgkmcnt(8)
  ds_read_b64_tr_b16 v[28:29], v1 offset:21504
  ds_read_b64_tr_b16 v[30:31], v1 offset:21760
  ds_read_u16_d16_hi v101, v101 offset:36864
  ds_read_u16_d16 v100, v100 offset:36864
  v_pk_mul_f16 v11, v10, v11 neg_lo:[0,1] neg_hi:[0,1]
  v_lshlrev_b32_sdwa v103, 1, v102 dst_sel:DWORD dst_unused:UNUSED_PAD src0_sel:DWORD src1_sel:WORD_1
  v_lshlrev_b32_sdwa v102, 1, v102 dst_sel:DWORD dst_unused:UNUSED_PAD src0_sel:DWORD src1_sel:WORD_0
  v_mfma_f32_32x32x16_bf16 v[64:79], v[16:19], v[136:139], 0
  s_waitcnt lgkmcnt(8)
  ds_read_b64_tr_b16 v[32:33], v1 offset:22528
  ds_read_b64_tr_b16 v[34:35], v1 offset:22784
  ds_read_u16_d16_hi v103, v103 offset:36864
  ds_read_u16_d16 v102, v102 offset:36864
  v_exp_f16 v8, v9
  v_cvt_pk_bf16_f32 v104, v104, v105
  v_exp_f16 v10, v11
  v_mfma_f32_32x32x16_bf16 v[64:79], v[20:23], v[140:143], v[64:79]
  s_waitcnt lgkmcnt(8)
  ds_read_b64_tr_b16 v[36:37], v1 offset:23552
  ds_read_b64_tr_b16 v[38:39], v1 offset:23808
  v_lshlrev_b32_sdwa v105, 1, v104 dst_sel:DWORD dst_unused:UNUSED_PAD src0_sel:DWORD src1_sel:WORD_1
  v_lshlrev_b32_sdwa v104, 1, v104 dst_sel:DWORD dst_unused:UNUSED_PAD src0_sel:DWORD src1_sel:WORD_0
  v_exp_f16_sdwa v8, v9 dst_sel:WORD_1 dst_unused:UNUSED_PRESERVE src0_sel:WORD_1
  v_cvt_pk_bf16_f32 v106, v106, v107
  v_mfma_f32_32x32x16_bf16 v[64:79], v[24:27], v[144:147], v[64:79]
  s_waitcnt lgkmcnt(8)
  ds_read_b64_tr_b16 v[16:17], v7 offset:24576
  ds_read_b64_tr_b16 v[18:19], v7 offset:26112
  ds_read_u16_d16_hi v105, v105 offset:36864
  ds_read_u16_d16 v104, v104 offset:36864
  v_or_b32 v96, v96, v97
  v_lshlrev_b32_sdwa v107, 1, v106 dst_sel:DWORD dst_unused:UNUSED_PAD src0_sel:DWORD src1_sel:WORD_1
  v_lshlrev_b32_sdwa v106, 1, v106 dst_sel:DWORD dst_unused:UNUSED_PAD src0_sel:DWORD src1_sel:WORD_0
  v_exp_f16_sdwa v10, v11 dst_sel:WORD_1 dst_unused:UNUSED_PRESERVE src0_sel:WORD_1
  v_mfma_f32_32x32x16_bf16 v[64:79], v[28:31], v[148:151], v[64:79]
  s_waitcnt lgkmcnt(8)
  ds_read_b64_tr_b16 v[20:21], v7 offset:24640
  ds_read_b64_tr_b16 v[22:23], v7 offset:26176
  ds_read_u16_d16_hi v107, v107 offset:36864
  ds_read_u16_d16 v106, v106 offset:36864
  v_pk_fma_f16 v8, v8, s57, s57
  v_or_b32 v97, v98, v99
  v_pk_fma_f16 v10, v10, s57, s57
  v_mfma_f32_32x32x16_bf16 v[64:79], v[32:35], v[152:155], v[64:79]
  s_waitcnt lgkmcnt(8)
  ds_read_b64_tr_b16 v[24:25], v7 offset:27648
  ds_read_b64_tr_b16 v[26:27], v7 offset:29184
  v_rcp_f16 v9, v8
  v_or_b32 v98, v100, v101
  v_rcp_f16 v11, v10
  v_rcp_f16_sdwa v9, v8 dst_sel:WORD_1 dst_unused:UNUSED_PRESERVE src0_sel:WORD_1
  v_mfma_f32_32x32x16_bf16 v[64:79], v[36:39], v[156:159], v[64:79]
  s_waitcnt lgkmcnt(6)
  ds_read_b64_tr_b16 v[28:29], v7 offset:27712
  ds_read_b64_tr_b16 v[30:31], v7 offset:29248
  v_or_b32 v99, v102, v103
  v_rcp_f16_sdwa v11, v10 dst_sel:WORD_1 dst_unused:UNUSED_PRESERVE src0_sel:WORD_1
  v_or_b32 v104, v104, v105
  v_mfma_f32_32x32x16_bf16 v[208:223], v[16:19], v[96:99], v[208:223]
  s_waitcnt lgkmcnt(4)
  ds_read_b64_tr_b16 v[32:33], v7 offset:24704
  ds_read_b64_tr_b16 v[34:35], v7 offset:26240
  v_fma_mix_f32 v108, v108, v9, 0 op_sel_hi:[0,1,0]
  v_fma_mix_f32 v110, v110, v11, 0 op_sel_hi:[0,1,0]
  v_fma_mix_f32 v109, v109, v9, 0 op_sel:[0,1,0] op_sel_hi:[0,1,0]
  v_fma_mix_f32 v111, v111, v11, 0 op_sel:[0,1,0] op_sel_hi:[0,1,0]
  v_or_b32 v105, v106, v107
  v_cvt_pk_bf16_f32 v106, v108, v109
  v_cvt_pk_bf16_f32 v107, v110, v111
  v_cvt_pk_bf16_f32 v64, v64, v65
  v_lshlrev_b32_sdwa v65, 1, v64 dst_sel:DWORD dst_unused:UNUSED_PAD src0_sel:DWORD src1_sel:WORD_1
  v_lshlrev_b32_sdwa v64, 1, v64 dst_sel:DWORD dst_unused:UNUSED_PAD src0_sel:DWORD src1_sel:WORD_0
  v_mul_f32 v76, s37, v76
  v_mul_f32 v78, s37, v78
  v_mfma_f32_32x32x16_bf16 v[224:239], v[20:23], v[96:99], v[224:239]
  s_waitcnt lgkmcnt(4)
  ds_read_b64_tr_b16 v[36:37], v7 offset:27776
  ds_read_b64_tr_b16 v[38:39], v7 offset:29312
  ds_read_u16_d16_hi v65, v65 offset:36864
  ds_read_u16_d16 v64, v64 offset:36864
  v_mul_f32 v77, s37, v77
  v_cvt_pk_bf16_f32 v66, v66, v67
  v_lshlrev_b32_sdwa v67, 1, v66 dst_sel:DWORD dst_unused:UNUSED_PAD src0_sel:DWORD src1_sel:WORD_1
  v_lshlrev_b32_sdwa v66, 1, v66 dst_sel:DWORD dst_unused:UNUSED_PAD src0_sel:DWORD src1_sel:WORD_0
  v_mul_f32 v79, s37, v79
  v_cvt_pk_f16_f32 v8, v76, v77
  v_cvt_pk_f16_f32 v10, v78, v79
  v_cvt_pk_bf16_f32 v68, v68, v69
  v_lshlrev_b32_sdwa v69, 1, v68 dst_sel:DWORD dst_unused:UNUSED_PAD src0_sel:DWORD src1_sel:WORD_1
  v_lshlrev_b32_sdwa v68, 1, v68 dst_sel:DWORD dst_unused:UNUSED_PAD src0_sel:DWORD src1_sel:WORD_0
  v_mfma_f32_32x32x16_bf16 v[208:223], v[24:27], v[104:107], v[208:223]
  s_waitcnt lgkmcnt(6)
  ds_read_b64_tr_b16 v[16:17], v7 offset:36864
  ds_read_b64_tr_b16 v[18:19], v7 offset:38400
  ds_read_u16_d16_hi v67, v67 offset:36864
  ds_read_u16_d16 v66, v66 offset:36864
  ds_read_u16_d16_hi v69, v69 offset:36864
  v_pk_fma_f16 v9, v8, v8, s56
  v_pk_fma_f16 v11, v10, v10, s56
  v_pk_mul_f16 v9, v8, v9 neg_lo:[0,1] neg_hi:[0,1]
  v_cvt_pk_bf16_f32 v70, v70, v71
  v_pk_mul_f16 v11, v10, v11 neg_lo:[0,1] neg_hi:[0,1]
  v_lshlrev_b32_sdwa v71, 1, v70 dst_sel:DWORD dst_unused:UNUSED_PAD src0_sel:DWORD src1_sel:WORD_1
  v_lshlrev_b32_sdwa v70, 1, v70 dst_sel:DWORD dst_unused:UNUSED_PAD src0_sel:DWORD src1_sel:WORD_0
  v_exp_f16 v8, v9
  v_mfma_f32_32x32x16_bf16 v[224:239], v[28:31], v[104:107], v[224:239]
  s_waitcnt lgkmcnt(9)
  ds_read_b64_tr_b16 v[20:21], v7 offset:36928
  ds_read_b64_tr_b16 v[22:23], v7 offset:38464
  ds_read_u16_d16 v68, v68 offset:36864
  ds_read_u16_d16_hi v71, v71 offset:36864
  ds_read_u16_d16 v70, v70 offset:36864
  v_cvt_pk_bf16_f32 v72, v72, v73
  v_exp_f16 v10, v11
  v_lshlrev_b32_sdwa v73, 1, v72 dst_sel:DWORD dst_unused:UNUSED_PAD src0_sel:DWORD src1_sel:WORD_1
  v_lshlrev_b32_sdwa v72, 1, v72 dst_sel:DWORD dst_unused:UNUSED_PAD src0_sel:DWORD src1_sel:WORD_0
  v_exp_f16_sdwa v8, v9 dst_sel:WORD_1 dst_unused:UNUSED_PRESERVE src0_sel:WORD_1
  v_cvt_pk_bf16_f32 v74, v74, v75
  v_mfma_f32_32x32x16_bf16 v[240:255], v[32:35], v[96:99], v[240:255]
  s_waitcnt lgkmcnt(6)
  ds_read_b64_tr_b16 v[24:25], v7 offset:39936
  ds_read_b64_tr_b16 v[26:27], v7 offset:41472
  ds_read_u16_d16_hi v73, v73 offset:36864
  ds_read_u16_d16 v72, v72 offset:36864
  v_or_b32 v64, v64, v65
  v_lshlrev_b32_sdwa v75, 1, v74 dst_sel:DWORD dst_unused:UNUSED_PAD src0_sel:DWORD src1_sel:WORD_1
  v_lshlrev_b32_sdwa v74, 1, v74 dst_sel:DWORD dst_unused:UNUSED_PAD src0_sel:DWORD src1_sel:WORD_0
  v_exp_f16_sdwa v10, v11 dst_sel:WORD_1 dst_unused:UNUSED_PRESERVE src0_sel:WORD_1
  v_pk_fma_f16 v8, v8, s57, s57
  v_or_b32 v65, v66, v67
  v_pk_fma_f16 v10, v10, s57, s57
  v_rcp_f16 v9, v8
  v_mfma_f32_32x32x16_bf16 v[240:255], v[36:39], v[104:107], v[240:255]
  s_waitcnt lgkmcnt(0)
  ds_read_b64_tr_b16 v[28:29], v7 offset:40000
  ds_read_b64_tr_b16 v[30:31], v7 offset:41536
  ds_read_u16_d16_hi v75, v75 offset:36864
  ds_read_u16_d16 v74, v74 offset:36864
  v_or_b32 v66, v68, v69
  v_rcp_f16 v11, v10
  v_rcp_f16_sdwa v9, v8 dst_sel:WORD_1 dst_unused:UNUSED_PRESERVE src0_sel:WORD_1
  v_or_b32 v67, v70, v71
  v_rcp_f16_sdwa v11, v10 dst_sel:WORD_1 dst_unused:UNUSED_PRESERVE src0_sel:WORD_1
  v_or_b32 v72, v72, v73
  v_mfma_f32_32x32x16_bf16 v[208:223], v[16:19], v[64:67], v[208:223]
  ds_read_b64_tr_b16 v[32:33], v7 offset:36992
  ds_read_b64_tr_b16 v[34:35], v7 offset:38528
  v_mov_b32 v116, 101888
  ds_read_b128 v[112:115], v116
  s_waitcnt lgkmcnt(0)
  v_max_u32 v112, v112, v113
  v_max3_u32 v112, v112, v114, v115
  s_nop 1
  v_readfirstlane_b32 s51, v112
  s_nop 3
  s_lshr_b32 s51, s51, 7
  s_add_u32 s51, s51, 8
  s_max_u32 s51, s51, 20
  s_sub_u32 s51, s51, 20
  s_cmp_gt_u32 s51, 117
  s_cselect_b32 s51, 127, s51
  s_sub_u32 s50, 113, s51
  s_cmp_le_u32 s50, 7
  s_cselect_b32 s51, 113, s51
  s_lshl_b32 s51, s51, 23
  v_mfma_f32_32x32x16_bf16 v[224:239], v[20:23], v[64:67], v[224:239]
  ds_read_b64_tr_b16 v[36:37], v7 offset:40064
  ds_read_b64_tr_b16 v[38:39], v7 offset:41600
  v_fma_mix_f32 v76, v76, v9, 0 op_sel_hi:[0,1,0]
  v_fma_mix_f32 v78, v78, v11, 0 op_sel_hi:[0,1,0]
  v_fma_mix_f32 v77, v77, v9, 0 op_sel:[0,1,0] op_sel_hi:[0,1,0]
  v_fma_mix_f32 v79, v79, v11, 0 op_sel:[0,1,0] op_sel_hi:[0,1,0]
  v_or_b32 v73, v74, v75
  v_cvt_pk_bf16_f32 v74, v76, v77
  v_cvt_pk_bf16_f32 v75, v78, v79
  s_nop 1
  v_mfma_f32_32x32x16_bf16 v[208:223], v[24:27], v[72:75], v[208:223]
  s_nop 11
  v_cvt_pk_bf16_f32 v208, v208, v209
  v_cvt_pk_bf16_f32 v209, v210, v211
  v_cvt_pk_bf16_f32 v210, v212, v213
  v_cvt_pk_bf16_f32 v211, v214, v215
  v_cvt_pk_bf16_f32 v216, v216, v217
  v_cvt_pk_bf16_f32 v217, v218, v219
  v_cvt_pk_bf16_f32 v218, v220, v221
  v_cvt_pk_bf16_f32 v219, v222, v223
  s_nop 1
  v_permlane16_swap_b32 v208, v216
  v_permlane16_swap_b32 v209, v217
  v_permlane16_swap_b32 v210, v218
  v_permlane16_swap_b32 v211, v219
  v_mfma_f32_32x32x16_bf16 v[224:239], v[28:31], v[72:75], v[224:239]
  buffer_store_dwordx4 v[208:211], v2, s[28:31], s40 offen offset:0 sc1
  s_nop 10
  v_cvt_pk_bf16_f32 v224, v224, v225
  v_cvt_pk_bf16_f32 v225, v226, v227
  v_cvt_pk_bf16_f32 v226, v228, v229
  v_cvt_pk_bf16_f32 v227, v230, v231
  v_cvt_pk_bf16_f32 v232, v232, v233
  v_cvt_pk_bf16_f32 v233, v234, v235
  v_cvt_pk_bf16_f32 v234, v236, v237
  v_cvt_pk_bf16_f32 v235, v238, v239
  s_nop 1
  v_permlane16_swap_b32 v224, v232
  v_permlane16_swap_b32 v225, v233
  v_permlane16_swap_b32 v226, v234
  v_permlane16_swap_b32 v227, v235
  v_mfma_f32_32x32x16_bf16 v[240:255], v[32:35], v[64:67], v[240:255]
  s_waitcnt lgkmcnt(0)
  buffer_store_dwordx4 v[216:219], v2, s[28:31], s40 offen offset:192 sc1
  buffer_store_dwordx4 v[224:227], v2, s[28:31], s40 offen offset:64 sc1
  v_mfma_f32_32x32x16_bf16 v[240:255], v[36:39], v[72:75], v[240:255]
  buffer_store_dwordx4 v[232:235], v2, s[28:31], s40 offen offset:256 sc1
  s_nop 10
  v_cvt_pk_bf16_f32 v240, v240, v241
  v_cvt_pk_bf16_f32 v241, v242, v243
  v_cvt_pk_bf16_f32 v242, v244, v245
  v_cvt_pk_bf16_f32 v243, v246, v247
  v_cvt_pk_bf16_f32 v248, v248, v249
  v_cvt_pk_bf16_f32 v249, v250, v251
  v_cvt_pk_bf16_f32 v250, v252, v253
  v_cvt_pk_bf16_f32 v251, v254, v255
  s_nop 1
  v_permlane16_swap_b32 v240, v248
  v_permlane16_swap_b32 v241, v249
  v_permlane16_swap_b32 v242, v250
  v_permlane16_swap_b32 v243, v251
  buffer_store_dwordx4 v[240:243], v2, s[28:31], s40 offen offset:128 sc1
  buffer_store_dwordx4 v[248:251], v2, s[28:31], s40 offen offset:320 sc1
  s_add_u32 s40, s40, s41
  s_cmp_lg_u32 s51, s65
  s_cbranch_scc1 L_redo
L_end:
  s_endpgm
F_main:
  s_barrier
  ds_read_b64_tr_b16 v[16:17], v1 offset:6144
  ds_read_b64_tr_b16 v[18:19], v1 offset:6400
  ds_read_b64_tr_b16 v[20:21], v1 offset:7168
  ds_read_b64_tr_b16 v[22:23], v1 offset:7424
  ds_read_b64_tr_b16 v[24:25], v1 offset:8192
  ds_read_b64_tr_b16 v[26:27], v1 offset:8448
  ds_read_b64_tr_b16 v[28:29], v1 offset:9216
  ds_read_b64_tr_b16 v[30:31], v1 offset:9472
  ds_read_b128 v[112:115], v3 offset:0
  ds_read_b128 v[116:119], v3 offset:4096
  ds_read_b128 v[120:123], v3 offset:8192
  ds_read_b128 v[124:127], v3 offset:12288
  ds_read_b128 v[128:131], v3 offset:16384
  ds_read_b128 v[132:135], v3 offset:20480
  s_waitcnt lgkmcnt(5)
  v_mfma_f32_32x32x16_bf16 v[80:95], v[16:19], v[112:115], 0
  s_waitcnt lgkmcnt(4)
  ds_read_b64_tr_b16 v[32:33], v1 offset:10240
  ds_read_b64_tr_b16 v[34:35], v1 offset:10496
  v_add_u32 v6, s43, v4
  v_mfma_f32_32x32x16_bf16 v[80:95], v[20:23], v[116:119], v[80:95]
  s_waitcnt lgkmcnt(5)
  ds_read_b64_tr_b16 v[36:37], v1 offset:11264
  ds_read_b64_tr_b16 v[38:39], v1 offset:11520
  s_mov_b32 s49, s43
  s_mov_b32 s43, s44
  s_mov_b32 s44, s45
  s_mov_b32 s45, s49
  v_mfma_f32_32x32x16_bf16 v[80:95], v[24:27], v[120:123], v[80:95]
  s_waitcnt lgkmcnt(0)
  s_barrier
  ds_read_b64_tr_b16 v[16:17], v1 offset:18432
  ds_read_b64_tr_b16 v[18:19], v1 offset:18688
  v_mfma_f32_32x32x16_bf16 v[80:95], v[28:31], v[124:127], v[80:95]
  ds_read_b64_tr_b16 v[20:21], v1 offset:19456
  ds_read_b64_tr_b16 v[22:23], v1 offset:19712
  v_mfma_f32_32x32x16_bf16 v[80:95], v[32:35], v[128:131], v[80:95]
  ds_read_b64_tr_b16 v[24:25], v1 offset:20480
  ds_read_b64_tr_b16 v[26:27], v1 offset:20736
  v_mfma_f32_32x32x16_bf16 v[80:95], v[36:39], v[132:135], v[80:95]
  s_waitcnt lgkmcnt(4)
  ds_read_b64_tr_b16 v[28:29], v1 offset:21504
  ds_read_b64_tr_b16 v[30:31], v1 offset:21760
  v_mfma_f32_32x32x16_bf16 v[48:63], v[16:19], v[112:115], 0
  s_waitcnt lgkmcnt(4)
  ds_read_b64_tr_b16 v[32:33], v1 offset:22528
  ds_read_b64_tr_b16 v[34:35], v1 offset:22784
  s_nop 4
  v_fmaak_f32 v8, v80, v80, 0x409d30fc
  v_fmaak_f32 v9, v81, v81, 0x409d30fc
  v_mul_f32 v8, v80, v8
  v_mul_f32 v9, v81, v9
  v_exp_f32 v8, -v8
  v_exp_f32 v9, -v9
  v_fma_f32 v8, v8, s36, s36
  v_fma_f32 v9, v9, s36, s36
  v_rcp_f32 v8, v8
  v_rcp_f32 v9, v9
  v_mul_f32 v80, v80, v8
  v_mul_f32 v81, v81, v9
  v_cvt_pk_bf16_f32 v80, v80, v81
  v_fmaak_f32 v10, v82, v82, 0x409d30fc
  v_fmaak_f32 v11, v83, v83, 0x409d30fc
  v_mul_f32 v10, v82, v10
  v_mfma_f32_32x32x16_bf16 v[48:63], v[20:23], v[116:119], v[48:63]
  s_waitcnt lgkmcnt(4)
  ds_read_b64_tr_b16 v[36:37], v1 offset:23552
  ds_read_b64_tr_b16 v[38:39], v1 offset:23808
  v_mul_f32 v11, v83, v11
  v_exp_f32 v10, -v10
  v_exp_f32 v11, -v11
  v_fma_f32 v10, v10, s36, s36
  v_fma_f32 v11, v11, s36, s36
  v_rcp_f32 v10, v10
  v_rcp_f32 v11, v11
  v_mul_f32 v82, v82, v10
  v_mul_f32 v83, v83, v11
  v_cvt_pk_bf16_f32 v81, v82, v83
  v_fmaak_f32 v8, v84, v84, 0x409d30fc
  v_fmaak_f32 v9, v85, v85, 0x409d30fc
  v_mul_f32 v8, v84, v8
  v_mul_f32 v9, v85, v9
  v_exp_f32 v8, -v8
  v_mfma_f32_32x32x16_bf16 v[48:63], v[24:27], v[120:123], v[48:63]
  s_waitcnt lgkmcnt(0)
  s_barrier
  ds_read_b64_tr_b16 v[16:17], v7 offset:24576
  ds_read_b64_tr_b16 v[18:19], v7 offset:26112
  v_exp_f32 v9, -v9
  v_fma_f32 v8, v8, s36, s36
  v_fma_f32 v9, v9, s36, s36
  v_rcp_f32 v8, v8
  v_rcp_f32 v9, v9
  v_mul_f32 v84, v84, v8
  v_mul_f32 v85, v85, v9
  v_cvt_pk_bf16_f32 v82, v84, v85
  v_fmaak_f32 v10, v86, v86, 0x409d30fc
  v_fmaak_f32 v11, v87, v87, 0x409d30fc
  v_mul_f32 v10, v86, v10
  v_mul_f32 v11, v87, v11
  v_exp_f32 v10, -v10
  v_exp_f32 v11, -v11
  v_mfma_f32_32x32x16_bf16 v[48:63], v[28:31], v[124:127], v[48:63]
  ds_read_b64_tr_b16 v[20:21], v7 offset:24640
  ds_read_b64_tr_b16 v[22:23], v7 offset:26176
  v_fma_f32 v10, v10, s36, s36
  v_fma_f32 v11, v11, s36, s36
  v_rcp_f32 v10, v10
  v_rcp_f32 v11, v11
  v_mul_f32 v86, v86, v10
  v_mul_f32 v87, v87, v11
  v_cvt_pk_bf16_f32 v83, v86, v87
  v_fmaak_f32 v8, v88, v88, 0x409d30fc
  v_fmaak_f32 v9, v89, v89, 0x409d30fc
  v_mul_f32 v8, v88, v8
  v_mul_f32 v9, v89, v9
  v_exp_f32 v8, -v8
  v_exp_f32 v9, -v9
  v_fma_f32 v8, v8, s36, s36
  v_fma_f32 v9, v9, s36, s36
  v_mfma_f32_32x32x16_bf16 v[48:63], v[32:35], v[128:131], v[48:63]
  ds_read_b64_tr_b16 v[24:25], v7 offset:27648
  ds_read_b64_tr_b16 v[26:27], v7 offset:29184
  v_rcp_f32 v8, v8
  v_rcp_f32 v9, v9
  v_mul_f32 v88, v88, v8
  v_mul_f32 v89, v89, v9
  v_cvt_pk_bf16_f32 v88, v88, v89
  v_add_u32 v0, 0, v6
  v_fmaak_f32 v10, v90, v90, 0x409d30fc
  v_fmaak_f32 v11, v91, v91, 0x409d30fc
  v_mul_f32 v10, v90, v10
  v_mul_f32 v11, v91, v11
  v_exp_f32 v10, -v10
  ds_read2_b32 v[40:41], v0 offset0:0 offset1:78
  ds_read2_b32 v[42:43], v0 offset0:156 offset1:234
  v_add_u32 v0, 2496, v6
  v_exp_f32 v11, -v11
  v_fma_f32 v10, v10, s36, s36
  v_mfma_f32_32x32x16_bf16 v[48:63], v[36:39], v[132:135], v[48:63]
  s_waitcnt lgkmcnt(6)
  ds_read_b64_tr_b16 v[28:29], v7 offset:27712
  ds_read_b64_tr_b16 v[30:31], v7 offset:29248
  ds_read2_b32 v[44:45], v0 offset0:0 offset1:78
  ds_read2_b32 v[46:47], v0 offset0:156 offset1:234
  v_fma_f32 v11, v11, s36, s36
  v_rcp_f32 v10, v10
  v_rcp_f32 v11, v11
  v_mul_f32 v90, v90, v10
  v_mul_f32 v91, v91, v11
  v_cvt_pk_bf16_f32 v89, v90, v91
  v_fmaak_f32 v8, v92, v92, 0x409d30fc
  v_fmaak_f32 v9, v93, v93, 0x409d30fc
  v_mul_f32 v8, v92, v8
  v_mul_f32 v9, v93, v9
  v_exp_f32 v8, -v8
  v_exp_f32 v9, -v9
  v_fma_f32 v8, v8, s36, s36
  v_fma_f32 v9, v9, s36, s36
  v_mfma_f32_32x32x16_bf16 v[160:175], v[16:19], v[80:83], 0
  s_waitcnt lgkmcnt(0)
  ds_read_b64_tr_b16 v[32:33], v7 offset:24704
  ds_read_b64_tr_b16 v[34:35], v7 offset:26240
  v_rcp_f32 v8, v8
  v_rcp_f32 v9, v9
  v_mul_f32 v92, v92, v8
  v_mul_f32 v93, v93, v9
  v_cvt_pk_bf16_f32 v90, v92, v93
  v_fmaak_f32 v10, v94, v94, 0x409d30fc
  v_fmaak_f32 v11, v95, v95, 0x409d30fc
  v_mul_f32 v10, v94, v10
  v_smfmac_f32_32x32x32_bf16 v[160:175], v[12:15], v[40:47], v5
  v_mul_f32 v11, v95, v11
  v_exp_f32 v10, -v10
  v_exp_f32 v11, -v11
  v_add_u32 v0, 4992, v6
  v_fma_f32 v10, v10, s36, s36
  v_fma_f32 v11, v11, s36, s36
  v_rcp_f32 v10, v10
  v_rcp_f32 v11, v11
  v_mfma_f32_32x32x16_bf16 v[176:191], v[20:23], v[80:83], 0
  ds_read_b64_tr_b16 v[36:37], v7 offset:27776
  ds_read_b64_tr_b16 v[38:39], v7 offset:29312
  ds_read2_b32 v[40:41], v0 offset0:0 offset1:78
  ds_read2_b32 v[42:43], v0 offset0:156 offset1:234
  v_add_u32 v0, 7488, v6
  v_mul_f32 v94, v94, v10
  v_mul_f32 v95, v95, v11
  v_cvt_pk_bf16_f32 v91, v94, v95
  v_fmaak_f32 v8, v48, v48, 0x409d30fc
  v_fmaak_f32 v9, v49, v49, 0x409d30fc
  v_mul_f32 v8, v48, v8
  v_mfma_f32_32x32x16_bf16 v[160:175], v[24:27], v[88:91], v[160:175]
  ds_read_b64_tr_b16 v[16:17], v1 offset:30720
  ds_read_b64_tr_b16 v[18:19], v1 offset:30976
  ds_read2_b32 v[44:45], v0 offset0:0 offset1:78
  ds_read2_b32 v[46:47], v0 offset0:156 offset1:234
  v_mul_f32 v9, v49, v9
  v_exp_f32 v8, -v8
  v_exp_f32 v9, -v9
  v_fma_f32 v8, v8, s36, s36
  v_fma_f32 v9, v9, s36, s36
  v_mfma_f32_32x32x16_bf16 v[176:191], v[28:31], v[88:91], v[176:191]
  s_waitcnt lgkmcnt(0)
  ds_read_b64_tr_b16 v[20:21], v1 offset:31744
  ds_read_b64_tr_b16 v[22:23], v1 offset:32000
  v_rcp_f32 v8, v8
  v_rcp_f32 v9, v9
  v_mul_f32 v48, v48, v8
  v_mul_f32 v49, v49, v9
  v_cvt_pk_bf16_f32 v48, v48, v49
  v_fmaak_f32 v10, v50, v50, 0x409d30fc
  v_fmaak_f32 v11, v51, v51, 0x409d30fc
  v_mul_f32 v10, v50, v10
  v_smfmac_f32_32x32x32_bf16 v[176:191], v[12:15], v[40:47], v5
  v_mul_f32 v11, v51, v11
  v_exp_f32 v10, -v10
  v_exp_f32 v11, -v11
  v_add_u32 v0, 9984, v6
  v_fma_f32 v10, v10, s36, s36
  v_fma_f32 v11, v11, s36, s36
  v_rcp_f32 v10, v10
  v_rcp_f32 v11, v11
  v_mfma_f32_32x32x16_bf16 v[192:207], v[32:35], v[80:83], 0
  ds_read_b64_tr_b16 v[24:25], v1 offset:32768
  ds_read_b64_tr_b16 v[26:27], v1 offset:33024
  ds_read2_b32 v[40:41], v0 offset0:0 offset1:78
  ds_read2_b32 v[42:43], v0 offset0:156 offset1:234
  v_add_u32 v0, 12480, v6
  v_mul_f32 v50, v50, v10
  v_mul_f32 v51, v51, v11
  v_cvt_pk_bf16_f32 v49, v50, v51
  v_fmaak_f32 v8, v52, v52, 0x409d30fc
  v_fmaak_f32 v9, v53, v53, 0x409d30fc
  v_mul_f32 v8, v52, v8
  v_mfma_f32_32x32x16_bf16 v[192:207], v[36:39], v[88:91], v[192:207]
  ds_read_b64_tr_b16 v[28:29], v1 offset:33792
  ds_read_b64_tr_b16 v[30:31], v1 offset:34048
  ds_read2_b32 v[44:45], v0 offset0:0 offset1:78
  ds_read2_b32 v[46:47], v0 offset0:156 offset1:234
  v_mul_f32 v9, v53, v9
  v_exp_f32 v8, -v8
  v_exp_f32 v9, -v9
  v_fma_f32 v8, v8, s36, s36
  v_fma_f32 v9, v9, s36, s36
  v_mfma_f32_32x32x16_bf16 v[80:95], v[16:19], v[112:115], 0
  s_waitcnt lgkmcnt(8)
  ds_read_b64_tr_b16 v[32:33], v1 offset:34816
  ds_read_b64_tr_b16 v[34:35], v1 offset:35072
  v_rcp_f32 v8, v8
  v_rcp_f32 v9, v9
  v_mul_f32 v52, v52, v8
  v_mul_f32 v53, v53, v9
  v_cvt_pk_bf16_f32 v50, v52, v53
  v_fmaak_f32 v10, v54, v54, 0x409d30fc
  v_fmaak_f32 v11, v55, v55, 0x409d30fc
  v_mul_f32 v10, v54, v10
  v_mfma_f32_32x32x16_bf16 v[80:95], v[20:23], v[116:119], v[80:95]
  s_waitcnt lgkmcnt(8)
  ds_read_b64_tr_b16 v[36:37], v1 offset:35840
  ds_read_b64_tr_b16 v[38:39], v1 offset:36096
  v_mul_f32 v11, v55, v11
  v_exp_f32 v10, -v10
  v_exp_f32 v11, -v11
  v_fma_f32 v10, v10, s36, s36
  v_fma_f32 v11, v11, s36, s36
  v_rcp_f32 v10, v10
  v_rcp_f32 v11, v11
  v_mfma_f32_32x32x16_bf16 v[80:95], v[24:27], v[120:123], v[80:95]
  s_waitcnt lgkmcnt(0)
  s_barrier
  ds_read_b64_tr_b16 v[16:17], v7 offset:0
  ds_read_b64_tr_b16 v[18:19], v7 offset:1536
  v_mul_f32 v54, v54, v10
  v_mul_f32 v55, v55, v11
  v_cvt_pk_bf16_f32 v51, v54, v55
  v_fmaak_f32 v8, v56, v56, 0x409d30fc
  v_fmaak_f32 v9, v57, v57, 0x409d30fc
  v_mul_f32 v8, v56, v8
  v_mul_f32 v9, v57, v9
  v_exp_f32 v8, -v8
  v_smfmac_f32_32x32x32_bf16 v[192:207], v[12:15], v[40:47], v5
  v_exp_f32 v9, -v9
  v_fma_f32 v8, v8, s36, s36
  v_fma_f32 v9, v9, s36, s36
  v_rcp_f32 v8, v8
  v_rcp_f32 v9, v9
  v_mul_f32 v56, v56, v8
  v_mfma_f32_32x32x16_bf16 v[80:95], v[28:31], v[124:127], v[80:95]
  ds_read_b64_tr_b16 v[20:21], v7 offset:64
  ds_read_b64_tr_b16 v[22:23], v7 offset:1600
  v_mul_f32 v57, v57, v9
  v_cvt_pk_bf16_f32 v56, v56, v57
  v_fmaak_f32 v10, v58, v58, 0x409d30fc
  v_fmaak_f32 v11, v59, v59, 0x409d30fc
  v_mul_f32 v10, v58, v10
  v_mul_f32 v11, v59, v11
  v_exp_f32 v10, -v10
  v_exp_f32 v11, -v11
  v_mfma_f32_32x32x16_bf16 v[80:95], v[32:35], v[128:131], v[80:95]
  ds_read_b64_tr_b16 v[24:25], v7 offset:3072
  ds_read_b64_tr_b16 v[26:27], v7 offset:4608
  v_fma_f32 v10, v10, s36, s36
  v_fma_f32 v11, v11, s36, s36
  v_rcp_f32 v10, v10
  v_rcp_f32 v11, v11
  v_mul_f32 v58, v58, v10
  v_mul_f32 v59, v59, v11
  v_cvt_pk_bf16_f32 v57, v58, v59
  v_fmaak_f32 v8, v60, v60, 0x409d30fc
  v_mfma_f32_32x32x16_bf16 v[80:95], v[36:39], v[132:135], v[80:95]
  s_waitcnt lgkmcnt(4)
  ds_read_b64_tr_b16 v[28:29], v7 offset:3136
  ds_read_b64_tr_b16 v[30:31], v7 offset:4672
  v_fmaak_f32 v9, v61, v61, 0x409d30fc
  v_mul_f32 v8, v60, v8
  v_mul_f32 v9, v61, v9
  v_exp_f32 v8, -v8
  v_exp_f32 v9, -v9
  v_fma_f32 v8, v8, s36, s36
  v_fma_f32 v9, v9, s36, s36
  v_mfma_f32_32x32x16_bf16 v[160:175], v[16:19], v[48:51], v[160:175]
  s_waitcnt lgkmcnt(4)
  ds_read_b64_tr_b16 v[32:33], v7 offset:128
  ds_read_b64_tr_b16 v[34:35], v7 offset:1664
  v_rcp_f32 v8, v8
  v_rcp_f32 v9, v9
  v_mul_f32 v60, v60, v8
  v_mul_f32 v61, v61, v9
  v_cvt_pk_bf16_f32 v58, v60, v61
  v_fmaak_f32 v10, v62, v62, 0x409d30fc
  v_fmaak_f32 v11, v63, v63, 0x409d30fc
  v_mul_f32 v10, v62, v10
  v_mul_f32 v11, v63, v11
  v_exp_f32 v10, -v10
  v_mfma_f32_32x32x16_bf16 v[176:191], v[20:23], v[48:51], v[176:191]
  s_waitcnt lgkmcnt(4)
  ds_read_b64_tr_b16 v[36:37], v7 offset:3200
  ds_read_b64_tr_b16 v[38:39], v7 offset:4736
  v_exp_f32 v11, -v11
  v_fma_f32 v10, v10, s36, s36
  v_fma_f32 v11, v11, s36, s36
  v_rcp_f32 v10, v10
  v_rcp_f32 v11, v11
  v_mul_f32 v62, v62, v10
  v_mul_f32 v63, v63, v11
  v_cvt_pk_bf16_f32 v59, v62, v63
  s_nop 1
  v_mfma_f32_32x32x16_bf16 v[160:175], v[24:27], v[56:59], v[160:175]
  s_waitcnt lgkmcnt(4)
  ds_read_b64_tr_b16 v[16:17], v1 offset:6144
  ds_read_b64_tr_b16 v[18:19], v1 offset:6400
  v_fmaak_f32 v8, v80, v80, 0x409d30fc
  v_fmaak_f32 v9, v81, v81, 0x409d30fc
  v_mul_f32 v8, v80, v8
  v_mul_f32 v9, v81, v9
  v_exp_f32 v8, -v8
  v_exp_f32 v9, -v9
  v_fma_f32 v8, v8, s36, s36
  v_fma_f32 v9, v9, s36, s36
  v_mfma_f32_32x32x16_bf16 v[176:191], v[28:31], v[56:59], v[176:191]
  s_waitcnt lgkmcnt(4)
  ds_read_b64_tr_b16 v[20:21], v1 offset:7168
  ds_read_b64_tr_b16 v[22:23], v1 offset:7424
  v_rcp_f32 v8, v8
  v_rcp_f32 v9, v9
  v_mul_f32 v80, v80, v8
  v_mul_f32 v81, v81, v9
  v_cvt_pk_bf16_f32 v80, v80, v81
  v_fmaak_f32 v10, v82, v82, 0x409d30fc
  v_fmaak_f32 v11, v83, v83, 0x409d30fc
  v_mul_f32 v10, v82, v10
  v_mul_f32 v11, v83, v11
  v_exp_f32 v10, -v10
  v_mfma_f32_32x32x16_bf16 v[192:207], v[32:35], v[48:51], v[192:207]
  s_waitcnt lgkmcnt(4)
  ds_read_b64_tr_b16 v[24:25], v1 offset:8192
  ds_read_b64_tr_b16 v[26:27], v1 offset:8448
  v_exp_f32 v11, -v11
  v_fma_f32 v10, v10, s36, s36
  v_fma_f32 v11, v11, s36, s36
  v_rcp_f32 v10, v10
  v_rcp_f32 v11, v11
  v_mul_f32 v82, v82, v10
  v_mul_f32 v83, v83, v11
  v_mfma_f32_32x32x16_bf16 v[192:207], v[36:39], v[56:59], v[192:207]
  s_waitcnt lgkmcnt(4)
  ds_read_b64_tr_b16 v[28:29], v1 offset:9216
  ds_read_b64_tr_b16 v[30:31], v1 offset:9472
  v_cvt_pk_bf16_f32 v81, v82, v83
  v_fmaak_f32 v8, v84, v84, 0x409d30fc
  v_fmaak_f32 v9, v85, v85, 0x409d30fc
  v_mul_f32 v8, v84, v8
  v_mul_f32 v9, v85, v9
  v_exp_f32 v8, -v8
  v_exp_f32 v9, -v9
  v_fma_f32 v8, v8, s36, s36
  v_fma_f32 v9, v9, s36, s36
  v_mfma_f32_32x32x16_bf16 v[48:63], v[16:19], v[112:115], 0
  s_waitcnt lgkmcnt(4)
  ds_read_b64_tr_b16 v[32:33], v1 offset:10240
  ds_read_b64_tr_b16 v[34:35], v1 offset:10496
  v_rcp_f32 v8, v8
  v_rcp_f32 v9, v9
  v_mul_f32 v84, v84, v8
  v_mul_f32 v85, v85, v9
  v_cvt_pk_bf16_f32 v82, v84, v85
  v_fmaak_f32 v10, v86, v86, 0x409d30fc
  v_fmaak_f32 v11, v87, v87, 0x409d30fc
  v_mul_f32 v10, v86, v10
  v_mul_f32 v11, v87, v11
  v_exp_f32 v10, -v10
  v_mfma_f32_32x32x16_bf16 v[48:63], v[20:23], v[116:119], v[48:63]
  s_waitcnt lgkmcnt(4)
  ds_read_b64_tr_b16 v[36:37], v1 offset:11264
  ds_read_b64_tr_b16 v[38:39], v1 offset:11520
  v_exp_f32 v11, -v11
  v_fma_f32 v10, v10, s36, s36
  v_fma_f32 v11, v11, s36, s36
  v_rcp_f32 v10, v10
  v_rcp_f32 v11, v11
  v_mul_f32 v86, v86, v10
  v_mul_f32 v87, v87, v11
  v_mfma_f32_32x32x16_bf16 v[48:63], v[24:27], v[120:123], v[48:63]
  s_waitcnt lgkmcnt(0)
  s_barrier
  ds_read_b64_tr_b16 v[16:17], v7 offset:12288
  ds_read_b64_tr_b16 v[18:19], v7 offset:13824
  v_cvt_pk_bf16_f32 v83, v86, v87
  v_fmaak_f32 v8, v88, v88, 0x409d30fc
  v_fmaak_f32 v9, v89, v89, 0x409d30fc
  v_mul_f32 v8, v88, v8
  v_mul_f32 v9, v89, v9
  v_exp_f32 v8, -v8
  v_exp_f32 v9, -v9
  v_fma_f32 v8, v8, s36, s36
  v_mfma_f32_32x32x16_bf16 v[48:63], v[28:31], v[124:127], v[48:63]
  ds_read_b64_tr_b16 v[20:21], v7 offset:12352
  ds_read_b64_tr_b16 v[22:23], v7 offset:13888
  v_fma_f32 v9, v9, s36, s36
  v_rcp_f32 v8, v8
  v_rcp_f32 v9, v9
  v_mul_f32 v88, v88, v8
  v_mul_f32 v89, v89, v9
  v_cvt_pk_bf16_f32 v88, v88, v89
  v_fmaak_f32 v10, v90, v90, 0x409d30fc
  v_fmaak_f32 v11, v91, v91, 0x409d30fc
  v_mul_f32 v10, v90, v10
  v_mul_f32 v11, v91, v11
  v_mfma_f32_32x32x16_bf16 v[48:63], v[32:35], v[128:131], v[48:63]
  ds_read_b64_tr_b16 v[24:25], v7 offset:15360
  ds_read_b64_tr_b16 v[26:27], v7 offset:16896
  v_exp_f32 v10, -v10
  v_exp_f32 v11, -v11
  v_fma_f32 v10, v10, s36, s36
  v_fma_f32 v11, v11, s36, s36
  v_rcp_f32 v10, v10
  v_rcp_f32 v11, v11
  v_mul_f32 v90, v90, v10
  v_mfma_f32_32x32x16_bf16 v[48:63], v[36:39], v[132:135], v[48:63]
  s_waitcnt lgkmcnt(4)
  ds_read_b64_tr_b16 v[28:29], v7 offset:15424
  ds_read_b64_tr_b16 v[30:31], v7 offset:16960
  v_mul_f32 v91, v91, v11
  v_cvt_pk_bf16_f32 v89, v90, v91
  v_fmaak_f32 v8, v92, v92, 0x409d30fc
  v_fmaak_f32 v9, v93, v93, 0x409d30fc
  v_mul_f32 v8, v92, v8
  v_mul_f32 v9, v93, v9
  v_exp_f32 v8, -v8
  v_exp_f32 v9, -v9
  v_fma_f32 v8, v8, s36, s36
  v_fma_f32 v9, v9, s36, s36
  v_mfma_f32_32x32x16_bf16 v[160:175], v[16:19], v[80:83], v[160:175]
  s_waitcnt lgkmcnt(4)
  ds_read_b64_tr_b16 v[32:33], v7 offset:12416
  ds_read_b64_tr_b16 v[34:35], v7 offset:13952
  v_rcp_f32 v8, v8
  v_rcp_f32 v9, v9
  v_mul_f32 v92, v92, v8
  v_mul_f32 v93, v93, v9
  v_cvt_pk_bf16_f32 v90, v92, v93
  v_fmaak_f32 v10, v94, v94, 0x409d30fc
  v_fmaak_f32 v11, v95, v95, 0x409d30fc
  v_mul_f32 v10, v94, v10
  v_mul_f32 v11, v95, v11
  v_exp_f32 v10, -v10
  v_mfma_f32_32x32x16_bf16 v[176:191], v[20:23], v[80:83], v[176:191]
  s_waitcnt lgkmcnt(4)
  ds_read_b64_tr_b16 v[36:37], v7 offset:15488
  ds_read_b64_tr_b16 v[38:39], v7 offset:17024
  v_exp_f32 v11, -v11
  v_fma_f32 v10, v10, s36, s36
  v_fma_f32 v11, v11, s36, s36
  v_rcp_f32 v10, v10
  v_rcp_f32 v11, v11
  v_mul_f32 v94, v94, v10
  v_mul_f32 v95, v95, v11
  v_cvt_pk_bf16_f32 v91, v94, v95
  s_nop 1
  v_mfma_f32_32x32x16_bf16 v[160:175], v[24:27], v[88:91], v[160:175]
  s_waitcnt lgkmcnt(4)
  ds_read_b64_tr_b16 v[16:17], v1 offset:18432
  ds_read_b64_tr_b16 v[18:19], v1 offset:18688
  v_fmaak_f32 v8, v48, v48, 0x409d30fc
  v_fmaak_f32 v9, v49, v49, 0x409d30fc
  v_mul_f32 v8, v48, v8
  v_mul_f32 v9, v49, v9
  v_exp_f32 v8, -v8
  v_exp_f32 v9, -v9
  v_fma_f32 v8, v8, s36, s36
  v_fma_f32 v9, v9, s36, s36
  v_mfma_f32_32x32x16_bf16 v[176:191], v[28:31], v[88:91], v[176:191]
  s_waitcnt lgkmcnt(4)
  ds_read_b64_tr_b16 v[20:21], v1 offset:19456
  ds_read_b64_tr_b16 v[22:23], v1 offset:19712
  v_rcp_f32 v8, v8
  v_rcp_f32 v9, v9
  v_mul_f32 v48, v48, v8
  v_mul_f32 v49, v49, v9
  v_cvt_pk_bf16_f32 v48, v48, v49
  v_fmaak_f32 v10, v50, v50, 0x409d30fc
  v_fmaak_f32 v11, v51, v51, 0x409d30fc
  v_mul_f32 v10, v50, v10
  v_mul_f32 v11, v51, v11
  v_exp_f32 v10, -v10
  v_mfma_f32_32x32x16_bf16 v[192:207], v[32:35], v[80:83], v[192:207]
  s_waitcnt lgkmcnt(4)
  ds_read_b64_tr_b16 v[24:25], v1 offset:20480
  ds_read_b64_tr_b16 v[26:27], v1 offset:20736
  v_exp_f32 v11, -v11
  v_fma_f32 v10, v10, s36, s36
  v_fma_f32 v11, v11, s36, s36
  v_rcp_f32 v10, v10
  v_rcp_f32 v11, v11
  v_mul_f32 v50, v50, v10
  v_mul_f32 v51, v51, v11
  v_mfma_f32_32x32x16_bf16 v[192:207], v[36:39], v[88:91], v[192:207]
  s_waitcnt lgkmcnt(4)
  ds_read_b64_tr_b16 v[28:29], v1 offset:21504
  ds_read_b64_tr_b16 v[30:31], v1 offset:21760
  v_cvt_pk_bf16_f32 v49, v50, v51
  v_fmaak_f32 v8, v52, v52, 0x409d30fc
  v_fmaak_f32 v9, v53, v53, 0x409d30fc
  v_mul_f32 v8, v52, v8
  v_mul_f32 v9, v53, v9
  v_exp_f32 v8, -v8
  v_exp_f32 v9, -v9
  v_fma_f32 v8, v8, s36, s36
  v_fma_f32 v9, v9, s36, s36
  v_mfma_f32_32x32x16_bf16 v[80:95], v[16:19], v[112:115], 0
  s_waitcnt lgkmcnt(4)
  ds_read_b64_tr_b16 v[32:33], v1 offset:22528
  ds_read_b64_tr_b16 v[34:35], v1 offset:22784
  v_rcp_f32 v8, v8
  v_rcp_f32 v9, v9
  v_mul_f32 v52, v52, v8
  v_mul_f32 v53, v53, v9
  v_cvt_pk_bf16_f32 v50, v52, v53
  v_fmaak_f32 v10, v54, v54, 0x409d30fc
  v_fmaak_f32 v11, v55, v55, 0x409d30fc
  v_mul_f32 v10, v54, v10
  v_mul_f32 v11, v55, v11
  v_exp_f32 v10, -v10
  v_mfma_f32_32x32x16_bf16 v[80:95], v[20:23], v[116:119], v[80:95]
  s_waitcnt lgkmcnt(4)
  ds_read_b64_tr_b16 v[36:37], v1 offset:23552
  ds_read_b64_tr_b16 v[38:39], v1 offset:23808
  v_exp_f32 v11, -v11
  v_fma_f32 v10, v10, s36, s36
  v_fma_f32 v11, v11, s36, s36
  v_rcp_f32 v10, v10
  v_rcp_f32 v11, v11
  v_mul_f32 v54, v54, v10
  v_mul_f32 v55, v55, v11
  v_mfma_f32_32x32x16_bf16 v[80:95], v[24:27], v[120:123], v[80:95]
  s_waitcnt lgkmcnt(0)
  s_barrier
  ds_read_b64_tr_b16 v[16:17], v7 offset:24576
  ds_read_b64_tr_b16 v[18:19], v7 offset:26112
  v_cvt_pk_bf16_f32 v51, v54, v55
  v_fmaak_f32 v8, v56, v56, 0x409d30fc
  v_fmaak_f32 v9, v57, v57, 0x409d30fc
  v_mul_f32 v8, v56, v8
  v_mul_f32 v9, v57, v9
  v_exp_f32 v8, -v8
  v_exp_f32 v9, -v9
  v_fma_f32 v8, v8, s36, s36
  v_mfma_f32_32x32x16_bf16 v[80:95], v[28:31], v[124:127], v[80:95]
  ds_read_b64_tr_b16 v[20:21], v7 offset:24640
  ds_read_b64_tr_b16 v[22:23], v7 offset:26176
  v_fma_f32 v9, v9, s36, s36
  v_rcp_f32 v8, v8
  v_rcp_f32 v9, v9
  v_mul_f32 v56, v56, v8
  v_mul_f32 v57, v57, v9
  v_cvt_pk_bf16_f32 v56, v56, v57
  v_fmaak_f32 v10, v58, v58, 0x409d30fc
  v_fmaak_f32 v11, v59, v59, 0x409d30fc
  v_mul_f32 v10, v58, v10
  v_mul_f32 v11, v59, v11
  v_mfma_f32_32x32x16_bf16 v[80:95], v[32:35], v[128:131], v[80:95]
  ds_read_b64_tr_b16 v[24:25], v7 offset:27648
  ds_read_b64_tr_b16 v[26:27], v7 offset:29184
  v_exp_f32 v10, -v10
  v_exp_f32 v11, -v11
  v_fma_f32 v10, v10, s36, s36
  v_fma_f32 v11, v11, s36, s36
  v_rcp_f32 v10, v10
  v_rcp_f32 v11, v11
  v_mul_f32 v58, v58, v10
  v_mfma_f32_32x32x16_bf16 v[80:95], v[36:39], v[132:135], v[80:95]
  s_waitcnt lgkmcnt(4)
  ds_read_b64_tr_b16 v[28:29], v7 offset:27712
  ds_read_b64_tr_b16 v[30:31], v7 offset:29248
  v_mul_f32 v59, v59, v11
  v_cvt_pk_bf16_f32 v57, v58, v59
  v_fmaak_f32 v8, v60, v60, 0x409d30fc
  v_fmaak_f32 v9, v61, v61, 0x409d30fc
  v_mul_f32 v8, v60, v8
  v_mul_f32 v9, v61, v9
  v_exp_f32 v8, -v8
  v_exp_f32 v9, -v9
  v_fma_f32 v8, v8, s36, s36
  v_fma_f32 v9, v9, s36, s36
  v_mfma_f32_32x32x16_bf16 v[160:175], v[16:19], v[48:51], v[160:175]
  s_waitcnt lgkmcnt(4)
  ds_read_b64_tr_b16 v[32:33], v7 offset:24704
  ds_read_b64_tr_b16 v[34:35], v7 offset:26240
  v_rcp_f32 v8, v8
  v_rcp_f32 v9, v9
  v_mul_f32 v60, v60, v8
  v_mul_f32 v61, v61, v9
  v_cvt_pk_bf16_f32 v58, v60, v61
  v_fmaak_f32 v10, v62, v62, 0x409d30fc
  v_fmaak_f32 v11, v63, v63, 0x409d30fc
  v_mul_f32 v10, v62, v10
  v_mul_f32 v11, v63, v11
  v_exp_f32 v10, -v10
  v_mfma_f32_32x32x16_bf16 v[176:191], v[20:23], v[48:51], v[176:191]
  s_waitcnt lgkmcnt(4)
  ds_read_b64_tr_b16 v[36:37], v7 offset:27776
  ds_read_b64_tr_b16 v[38:39], v7 offset:29312
  v_exp_f32 v11, -v11
  v_fma_f32 v10, v10, s36, s36
  v_fma_f32 v11, v11, s36, s36
  v_rcp_f32 v10, v10
  v_rcp_f32 v11, v11
  v_mul_f32 v62, v62, v10
  v_mul_f32 v63, v63, v11
  v_cvt_pk_bf16_f32 v59, v62, v63
  s_nop 1
  v_mfma_f32_32x32x16_bf16 v[160:175], v[24:27], v[56:59], v[160:175]
  s_waitcnt lgkmcnt(4)
  ds_read_b64_tr_b16 v[16:17], v1 offset:30720
  ds_read_b64_tr_b16 v[18:19], v1 offset:30976
  v_fmaak_f32 v8, v80, v80, 0x409d30fc
  v_fmaak_f32 v9, v81, v81, 0x409d30fc
  v_mul_f32 v8, v80, v8
  v_mul_f32 v9, v81, v9
  v_exp_f32 v8, -v8
  v_exp_f32 v9, -v9
  v_fma_f32 v8, v8, s36, s36
  v_fma_f32 v9, v9, s36, s36
  v_mfma_f32_32x32x16_bf16 v[176:191], v[28:31], v[56:59], v[176:191]
  s_waitcnt lgkmcnt(4)
  ds_read_b64_tr_b16 v[20:21], v1 offset:31744
  ds_read_b64_tr_b16 v[22:23], v1 offset:32000
  v_rcp_f32 v8, v8
  v_rcp_f32 v9, v9
  v_mul_f32 v80, v80, v8
  v_mul_f32 v81, v81, v9
  v_cvt_pk_bf16_f32 v80, v80, v81
  v_fmaak_f32 v10, v82, v82, 0x409d30fc
  v_fmaak_f32 v11, v83, v83, 0x409d30fc
  v_mul_f32 v10, v82, v10
  v_mul_f32 v11, v83, v11
  v_exp_f32 v10, -v10
  v_mfma_f32_32x32x16_bf16 v[192:207], v[32:35], v[48:51], v[192:207]
  s_waitcnt lgkmcnt(4)
  ds_read_b64_tr_b16 v[24:25], v1 offset:32768
  ds_read_b64_tr_b16 v[26:27], v1 offset:33024
  v_exp_f32 v11, -v11
  v_fma_f32 v10, v10, s36, s36
  v_fma_f32 v11, v11, s36, s36
  v_rcp_f32 v10, v10
  v_rcp_f32 v11, v11
  v_mul_f32 v82, v82, v10
  v_mul_f32 v83, v83, v11
  v_mfma_f32_32x32x16_bf16 v[192:207], v[36:39], v[56:59], v[192:207]
  s_waitcnt lgkmcnt(4)
  ds_read_b64_tr_b16 v[28:29], v1 offset:33792
  ds_read_b64_tr_b16 v[30:31], v1 offset:34048
  v_cvt_pk_bf16_f32 v81, v82, v83
  v_fmaak_f32 v8, v84, v84, 0x409d30fc
  v_fmaak_f32 v9, v85, v85, 0x409d30fc
  v_mul_f32 v8, v84, v8
  v_mul_f32 v9, v85, v9
  v_exp_f32 v8, -v8
  v_exp_f32 v9, -v9
  v_fma_f32 v8, v8, s36, s36
  v_fma_f32 v9, v9, s36, s36
  v_mfma_f32_32x32x16_bf16 v[48:63], v[16:19], v[112:115], 0
  s_waitcnt lgkmcnt(4)
  ds_read_b64_tr_b16 v[32:33], v1 offset:34816
  ds_read_b64_tr_b16 v[34:35], v1 offset:35072
  v_rcp_f32 v8, v8
  v_rcp_f32 v9, v9
  v_mul_f32 v84, v84, v8
  v_mul_f32 v85, v85, v9
  v_cvt_pk_bf16_f32 v82, v84, v85
  v_fmaak_f32 v10, v86, v86, 0x409d30fc
  v_fmaak_f32 v11, v87, v87, 0x409d30fc
  v_mul_f32 v10, v86, v10
  v_mul_f32 v11, v87, v11
  v_exp_f32 v10, -v10
  v_mfma_f32_32x32x16_bf16 v[48:63], v[20:23], v[116:119], v[48:63]
  s_waitcnt lgkmcnt(4)
  ds_read_b64_tr_b16 v[36:37], v1 offset:35840
  ds_read_b64_tr_b16 v[38:39], v1 offset:36096
  v_exp_f32 v11, -v11
  v_fma_f32 v10, v10, s36, s36
  v_fma_f32 v11, v11, s36, s36
  v_rcp_f32 v10, v10
  v_rcp_f32 v11, v11
  v_mul_f32 v86, v86, v10
  v_mul_f32 v87, v87, v11
  v_mfma_f32_32x32x16_bf16 v[48:63], v[24:27], v[120:123], v[48:63]
  s_waitcnt lgkmcnt(0)
  s_barrier
  ds_read_b64_tr_b16 v[16:17], v7 offset:0
  ds_read_b64_tr_b16 v[18:19], v7 offset:1536
  v_cvt_pk_bf16_f32 v83, v86, v87
  v_fmaak_f32 v8, v88, v88, 0x409d30fc
  v_fmaak_f32 v9, v89, v89, 0x409d30fc
  v_mul_f32 v8, v88, v8
  v_mul_f32 v9, v89, v9
  v_exp_f32 v8, -v8
  v_exp_f32 v9, -v9
  v_fma_f32 v8, v8, s36, s36
  v_mfma_f32_32x32x16_bf16 v[48:63], v[28:31], v[124:127], v[48:63]
  ds_read_b64_tr_b16 v[20:21], v7 offset:64
  ds_read_b64_tr_b16 v[22:23], v7 offset:1600
  v_fma_f32 v9, v9, s36, s36
  v_rcp_f32 v8, v8
  v_rcp_f32 v9, v9
  v_mul_f32 v88, v88, v8
  v_mul_f32 v89, v89, v9
  v_cvt_pk_bf16_f32 v88, v88, v89
  v_fmaak_f32 v10, v90, v90, 0x409d30fc
  v_fmaak_f32 v11, v91, v91, 0x409d30fc
  v_mul_f32 v10, v90, v10
  v_mul_f32 v11, v91, v11
  v_mfma_f32_32x32x16_bf16 v[48:63], v[32:35], v[128:131], v[48:63]
  ds_read_b64_tr_b16 v[24:25], v7 offset:3072
  ds_read_b64_tr_b16 v[26:27], v7 offset:4608
  v_exp_f32 v10, -v10
  v_exp_f32 v11, -v11
  v_fma_f32 v10, v10, s36, s36
  v_fma_f32 v11, v11, s36, s36
  v_rcp_f32 v10, v10
  v_rcp_f32 v11, v11
  v_mul_f32 v90, v90, v10
  v_mfma_f32_32x32x16_bf16 v[48:63], v[36:39], v[132:135], v[48:63]
  s_waitcnt lgkmcnt(4)
  ds_read_b64_tr_b16 v[28:29], v7 offset:3136
  ds_read_b64_tr_b16 v[30:31], v7 offset:4672
  v_mul_f32 v91, v91, v11
  v_cvt_pk_bf16_f32 v89, v90, v91
  v_fmaak_f32 v8, v92, v92, 0x409d30fc
  v_fmaak_f32 v9, v93, v93, 0x409d30fc
  v_mul_f32 v8, v92, v8
  v_mul_f32 v9, v93, v9
  v_exp_f32 v8, -v8
  v_exp_f32 v9, -v9
  v_fma_f32 v8, v8, s36, s36
  v_fma_f32 v9, v9, s36, s36
  v_mfma_f32_32x32x16_bf16 v[160:175], v[16:19], v[80:83], v[160:175]
  s_waitcnt lgkmcnt(4)
  ds_read_b64_tr_b16 v[32:33], v7 offset:128
  ds_read_b64_tr_b16 v[34:35], v7 offset:1664
  ds_read_b128 v[136:139], v3 offset:0
  ds_read_b128 v[140:143], v3 offset:4096
  v_rcp_f32 v8, v8
  v_rcp_f32 v9, v9
  v_mul_f32 v92, v92, v8
  v_mul_f32 v93, v93, v9
  v_mfma_f32_32x32x16_bf16 v[176:191], v[20:23], v[80:83], v[176:191]
  s_waitcnt lgkmcnt(6)
  ds_read_b64_tr_b16 v[36:37], v7 offset:3200
  ds_read_b64_tr_b16 v[38:39], v7 offset:4736
  ds_read_b128 v[144:147], v3 offset:8192
  ds_read_b128 v[148:151], v3 offset:12288
  v_cvt_pk_bf16_f32 v90, v92, v93
  v_fmaak_f32 v10, v94, v94, 0x409d30fc
  v_fmaak_f32 v11, v95, v95, 0x409d30fc
  v_mul_f32 v10, v94, v10
  v_mul_f32 v11, v95, v11
  v_exp_f32 v10, -v10
  v_exp_f32 v11, -v11
  v_add_u32 v6, s43, v4
  v_fma_f32 v10, v10, s36, s36
  v_fma_f32 v11, v11, s36, s36
  v_rcp_f32 v10, v10
  v_rcp_f32 v11, v11
  v_mul_f32 v94, v94, v10
  v_mul_f32 v95, v95, v11
  v_cvt_pk_bf16_f32 v91, v94, v95
  s_nop 1
  v_mfma_f32_32x32x16_bf16 v[160:175], v[24:27], v[88:91], v[160:175]
  s_waitcnt lgkmcnt(8)
  ds_read_b64_tr_b16 v[16:17], v1 offset:6144
  ds_read_b64_tr_b16 v[18:19], v1 offset:6400
  ds_read_b128 v[152:155], v3 offset:16384
  ds_read_b128 v[156:159], v3 offset:20480
  v_mfma_f32_32x32x16_bf16 v[176:191], v[28:31], v[88:91], v[176:191]
  s_waitcnt lgkmcnt(10)
  ds_read_b64_tr_b16 v[20:21], v1 offset:7168
  ds_read_b64_tr_b16 v[22:23], v1 offset:7424
  s_mov_b32 s49, s43
  s_mov_b32 s43, s44
  s_mov_b32 s44, s45
  s_mov_b32 s45, s49
  v_mfma_f32_32x32x16_bf16 v[192:207], v[32:35], v[80:83], v[192:207]
  s_waitcnt lgkmcnt(8)
  ds_read_b64_tr_b16 v[24:25], v1 offset:8192
  ds_read_b64_tr_b16 v[26:27], v1 offset:8448
  v_fmaak_f32 v8, v48, v48, 0x409d30fc
  v_fmaak_f32 v9, v49, v49, 0x409d30fc
  v_mul_f32 v8, v48, v8
  v_mfma_f32_32x32x16_bf16 v[192:207], v[36:39], v[88:91], v[192:207]
  s_waitcnt lgkmcnt(6)
  ds_read_b64_tr_b16 v[28:29], v1 offset:9216
  ds_read_b64_tr_b16 v[30:31], v1 offset:9472
  v_mul_f32 v9, v49, v9
  v_exp_f32 v8, -v8
  v_exp_f32 v9, -v9
  v_fma_f32 v8, v8, s36, s36
  v_fma_f32 v9, v9, s36, s36
  v_mfma_f32_32x32x16_bf16 v[80:95], v[16:19], v[112:115], 0
  ds_read_b64_tr_b16 v[32:33], v1 offset:10240
  v_rcp_f32 v8, v8
  v_rcp_f32 v9, v9
  v_mul_f32 v48, v48, v8
  v_mul_f32 v49, v49, v9
  v_cvt_pk_bf16_f32 v48, v48, v49
  v_fmaak_f32 v10, v50, v50, 0x409d30fc
  v_fmaak_f32 v11, v51, v51, 0x409d30fc
  v_mfma_f32_32x32x16_bf16 v[96:111], v[16:19], v[136:139], 0
  s_waitcnt lgkmcnt(5)
  ds_read_b64_tr_b16 v[34:35], v1 offset:10496
  v_mul_f32 v10, v50, v10
  v_mul_f32 v11, v51, v11
  v_exp_f32 v10, -v10
  v_exp_f32 v11, -v11
  v_fma_f32 v10, v10, s36, s36
  v_fma_f32 v11, v11, s36, s36
  v_mfma_f32_32x32x16_bf16 v[80:95], v[20:23], v[116:119], v[80:95]
  ds_read_b64_tr_b16 v[36:37], v1 offset:11264
  v_rcp_f32 v10, v10
  v_rcp_f32 v11, v11
  v_mul_f32 v50, v50, v10
  v_mul_f32 v51, v51, v11
  v_cvt_pk_bf16_f32 v49, v50, v51
  v_fmaak_f32 v8, v52, v52, 0x409d30fc
  v_fmaak_f32 v9, v53, v53, 0x409d30fc
  v_mfma_f32_32x32x16_bf16 v[96:111], v[20:23], v[140:143], v[96:111]
  s_waitcnt lgkmcnt(5)
  ds_read_b64_tr_b16 v[38:39], v1 offset:11520
  v_mul_f32 v8, v52, v8
  v_mul_f32 v9, v53, v9
  v_exp_f32 v8, -v8
  v_exp_f32 v9, -v9
  v_fma_f32 v8, v8, s36, s36
  v_fma_f32 v9, v9, s36, s36
  v_mfma_f32_32x32x16_bf16 v[80:95], v[24:27], v[120:123], v[80:95]
  v_rcp_f32 v8, v8
  v_rcp_f32 v9, v9
  v_mul_f32 v52, v52, v8
  v_mul_f32 v53, v53, v9
  v_cvt_pk_bf16_f32 v50, v52, v53
  v_fmaak_f32 v10, v54, v54, 0x409d30fc
  v_fmaak_f32 v11, v55, v55, 0x409d30fc
  v_mul_f32 v10, v54, v10
  v_mfma_f32_32x32x16_bf16 v[96:111], v[24:27], v[144:147], v[96:111]
  s_waitcnt lgkmcnt(4)
  v_mul_f32 v11, v55, v11
  v_exp_f32 v10, -v10
  v_exp_f32 v11, -v11
  v_fma_f32 v10, v10, s36, s36
  v_fma_f32 v11, v11, s36, s36
  v_rcp_f32 v10, v10
  v_mfma_f32_32x32x16_bf16 v[80:95], v[28:31], v[124:127], v[80:95]
  s_waitcnt lgkmcnt(0)
  s_barrier
  ds_read_b64_tr_b16 v[16:17], v7 offset:12288
  ds_read_b64_tr_b16 v[18:19], v7 offset:13824
  v_rcp_f32 v11, v11
  v_mul_f32 v54, v54, v10
  v_mul_f32 v55, v55, v11
  v_cvt_pk_bf16_f32 v51, v54, v55
  v_fmaak_f32 v8, v56, v56, 0x409d30fc
  v_fmaak_f32 v9, v57, v57, 0x409d30fc
  v_mfma_f32_32x32x16_bf16 v[96:111], v[28:31], v[148:151], v[96:111]
  ds_read_b64_tr_b16 v[20:21], v7 offset:12352
  ds_read_b64_tr_b16 v[22:23], v7 offset:13888
  v_mul_f32 v8, v56, v8
  v_mul_f32 v9, v57, v9
  v_exp_f32 v8, -v8
  v_exp_f32 v9, -v9
  v_fma_f32 v8, v8, s36, s36
  v_mfma_f32_32x32x16_bf16 v[80:95], v[32:35], v[128:131], v[80:95]
  ds_read_b64_tr_b16 v[24:25], v7 offset:15360
  v_fma_f32 v9, v9, s36, s36
  v_rcp_f32 v8, v8
  v_rcp_f32 v9, v9
  v_mul_f32 v56, v56, v8
  v_mul_f32 v57, v57, v9
  v_cvt_pk_bf16_f32 v56, v56, v57
  v_fmaak_f32 v10, v58, v58, 0x409d30fc
  v_mfma_f32_32x32x16_bf16 v[96:111], v[32:35], v[152:155], v[96:111]
  ds_read_b64_tr_b16 v[26:27], v7 offset:16896
  v_fmaak_f32 v11, v59, v59, 0x409d30fc
  v_mul_f32 v10, v58, v10
  v_mul_f32 v11, v59, v11
  v_exp_f32 v10, -v10
  v_exp_f32 v11, -v11
  v_fma_f32 v10, v10, s36, s36
  v_mfma_f32_32x32x16_bf16 v[80:95], v[36:39], v[132:135], v[80:95]
  ds_read_b64_tr_b16 v[28:29], v7 offset:15424
  v_fma_f32 v11, v11, s36, s36
  v_rcp_f32 v10, v10
  v_rcp_f32 v11, v11
  v_mul_f32 v58, v58, v10
  v_mul_f32 v59, v59, v11
  v_cvt_pk_bf16_f32 v57, v58, v59
  v_fmaak_f32 v8, v60, v60, 0x409d30fc
  v_mfma_f32_32x32x16_bf16 v[96:111], v[36:39], v[156:159], v[96:111]
  s_waitcnt lgkmcnt(5)
  ds_read_b64_tr_b16 v[30:31], v7 offset:16960
  v_fmaak_f32 v9, v61, v61, 0x409d30fc
  v_mul_f32 v8, v60, v8
  v_mul_f32 v9, v61, v9
  v_exp_f32 v8, -v8
  v_exp_f32 v9, -v9
  v_fma_f32 v8, v8, s36, s36
  v_fma_f32 v9, v9, s36, s36
  v_mfma_f32_32x32x16_bf16 v[160:175], v[16:19], v[48:51], v[160:175]
  s_waitcnt lgkmcnt(4)
  ds_read_b64_tr_b16 v[32:33], v7 offset:12416
  ds_read_b64_tr_b16 v[34:35], v7 offset:13952
  v_rcp_f32 v8, v8
  v_rcp_f32 v9, v9
  v_mul_f32 v60, v60, v8
  v_mul_f32 v61, v61, v9
  v_cvt_pk_bf16_f32 v58, v60, v61
  v_fmaak_f32 v10, v62, v62, 0x409d30fc
  v_fmaak_f32 v11, v63, v63, 0x409d30fc
  v_mul_f32 v10, v62, v10
  v_mul_f32 v11, v63, v11
  v_exp_f32 v10, -v10
  v_exp_f32 v11, -v11
  v_mfma_f32_32x32x16_bf16 v[176:191], v[20:23], v[48:51], v[176:191]
  s_waitcnt lgkmcnt(4)
  ds_read_b64_tr_b16 v[36:37], v7 offset:15488
  ds_read_b64_tr_b16 v[38:39], v7 offset:17024
  v_fma_f32 v10, v10, s36, s36
  v_fma_f32 v11, v11, s36, s36
  v_rcp_f32 v10, v10
  v_rcp_f32 v11, v11
  v_mul_f32 v62, v62, v10
  v_mul_f32 v63, v63, v11
  v_cvt_pk_bf16_f32 v59, v62, v63
  v_fmaak_f32 v8, v80, v80, 0x409d30fc
  v_fmaak_f32 v9, v81, v81, 0x409d30fc
  v_mul_f32 v8, v80, v8
  v_mul_f32 v9, v81, v9
  v_exp_f32 v8, -v8
  v_mfma_f32_32x32x16_bf16 v[160:175], v[24:27], v[56:59], v[160:175]
  s_waitcnt lgkmcnt(4)
  ds_read_b64_tr_b16 v[16:17], v1 offset:18432
  ds_read_b64_tr_b16 v[18:19], v1 offset:18688
  v_exp_f32 v9, -v9
  v_fma_f32 v8, v8, s36, s36
  v_fma_f32 v9, v9, s36, s36
  v_rcp_f32 v8, v8
  v_rcp_f32 v9, v9
  v_mul_f32 v80, v80, v8
  v_mul_f32 v81, v81, v9
  v_cvt_pk_bf16_f32 v80, v80, v81
  v_fmaak_f32 v10, v96, v96, 0x409d30fc
  v_fmaak_f32 v11, v97, v97, 0x409d30fc
  v_mul_f32 v10, v96, v10
  v_mul_f32 v11, v97, v11
  v_mfma_f32_32x32x16_bf16 v[176:191], v[28:31], v[56:59], v[176:191]
  s_waitcnt lgkmcnt(4)
  ds_read_b64_tr_b16 v[20:21], v1 offset:19456
  ds_read_b64_tr_b16 v[22:23], v1 offset:19712
  v_exp_f32 v10, -v10
  v_exp_f32 v11, -v11
  v_fma_f32 v10, v10, s36, s36
  v_fma_f32 v11, v11, s36, s36
  v_rcp_f32 v10, v10
  v_rcp_f32 v11, v11
  v_mul_f32 v96, v96, v10
  v_mul_f32 v97, v97, v11
  v_cvt_pk_bf16_f32 v96, v96, v97
  v_fmaak_f32 v8, v82, v82, 0x409d30fc
  v_fmaak_f32 v9, v83, v83, 0x409d30fc
  v_mfma_f32_32x32x16_bf16 v[192:207], v[32:35], v[48:51], v[192:207]
  s_waitcnt lgkmcnt(4)
  ds_read_b64_tr_b16 v[24:25], v1 offset:20480
  ds_read_b64_tr_b16 v[26:27], v1 offset:20736
  v_mul_f32 v8, v82, v8
  v_mul_f32 v9, v83, v9
  v_exp_f32 v8, -v8
  v_exp_f32 v9, -v9
  v_fma_f32 v8, v8, s36, s36
  v_fma_f32 v9, v9, s36, s36
  v_rcp_f32 v8, v8
  v_rcp_f32 v9, v9
  v_mul_f32 v82, v82, v8
  v_mul_f32 v83, v83, v9
  v_cvt_pk_bf16_f32 v81, v82, v83
  v_mfma_f32_32x32x16_bf16 v[192:207], v[36:39], v[56:59], v[192:207]
  s_waitcnt lgkmcnt(4)
  ds_read_b64_tr_b16 v[28:29], v1 offset:21504
  ds_read_b64_tr_b16 v[30:31], v1 offset:21760
  v_fmaak_f32 v10, v98, v98, 0x409d30fc
  v_fmaak_f32 v11, v99, v99, 0x409d30fc
  v_mul_f32 v10, v98, v10
  v_mul_f32 v11, v99, v11
  v_exp_f32 v10, -v10
  v_exp_f32 v11, -v11
  v_fma_f32 v10, v10, s36, s36
  v_fma_f32 v11, v11, s36, s36
  v_rcp_f32 v10, v10
  v_rcp_f32 v11, v11
  v_mul_f32 v98, v98, v10
  v_mfma_f32_32x32x16_bf16 v[48:63], v[16:19], v[112:115], 0
  ds_read_b64_tr_b16 v[32:33], v1 offset:22528
  v_mul_f32 v99, v99, v11
  v_cvt_pk_bf16_f32 v97, v98, v99
  v_fmaak_f32 v8, v84, v84, 0x409d30fc
  v_fmaak_f32 v9, v85, v85, 0x409d30fc
  v_mul_f32 v8, v84, v8
  v_mul_f32 v9, v85, v9
  v_exp_f32 v8, -v8
  v_exp_f32 v9, -v9
  v_fma_f32 v8, v8, s36, s36
  v_fma_f32 v9, v9, s36, s36
  v_rcp_f32 v8, v8
  v_rcp_f32 v9, v9
  v_mfma_f32_32x32x16_bf16 v[64:79], v[16:19], v[136:139], 0
  s_waitcnt lgkmcnt(5)
  ds_read_b64_tr_b16 v[34:35], v1 offset:22784
  v_mul_f32 v84, v84, v8
  v_mul_f32 v85, v85, v9
  v_cvt_pk_bf16_f32 v82, v84, v85
  v_fmaak_f32 v10, v100, v100, 0x409d30fc
  v_fmaak_f32 v11, v101, v101, 0x409d30fc
  v_mul_f32 v10, v100, v10
  v_mul_f32 v11, v101, v11
  v_exp_f32 v10, -v10
  v_exp_f32 v11, -v11
  v_fma_f32 v10, v10, s36, s36
  v_fma_f32 v11, v11, s36, s36
  v_rcp_f32 v10, v10
  v_rcp_f32 v11, v11
  v_mfma_f32_32x32x16_bf16 v[48:63], v[20:23], v[116:119], v[48:63]
  ds_read_b64_tr_b16 v[36:37], v1 offset:23552
  v_mul_f32 v100, v100, v10
  v_mul_f32 v101, v101, v11
  v_cvt_pk_bf16_f32 v98, v100, v101
  v_fmaak_f32 v8, v86, v86, 0x409d30fc
  v_fmaak_f32 v9, v87, v87, 0x409d30fc
  v_mul_f32 v8, v86, v8
  v_mul_f32 v9, v87, v9
  v_exp_f32 v8, -v8
  v_exp_f32 v9, -v9
  v_fma_f32 v8, v8, s36, s36
  v_fma_f32 v9, v9, s36, s36
  v_rcp_f32 v8, v8
  v_mfma_f32_32x32x16_bf16 v[64:79], v[20:23], v[140:143], v[64:79]
  s_waitcnt lgkmcnt(5)
  ds_read_b64_tr_b16 v[38:39], v1 offset:23808
  v_rcp_f32 v9, v9
  v_mul_f32 v86, v86, v8
  v_mul_f32 v87, v87, v9
  v_cvt_pk_bf16_f32 v83, v86, v87
  v_fmaak_f32 v10, v102, v102, 0x409d30fc
  v_fmaak_f32 v11, v103, v103, 0x409d30fc
  v_mul_f32 v10, v102, v10
  v_mul_f32 v11, v103, v11
  v_exp_f32 v10, -v10
  v_exp_f32 v11, -v11
  v_fma_f32 v10, v10, s36, s36
  v_fma_f32 v11, v11, s36, s36
  v_mfma_f32_32x32x16_bf16 v[48:63], v[24:27], v[120:123], v[48:63]
  v_rcp_f32 v10, v10
  v_rcp_f32 v11, v11
  v_mul_f32 v102, v102, v10
  v_mul_f32 v103, v103, v11
  v_cvt_pk_bf16_f32 v99, v102, v103
  v_fmaak_f32 v8, v88, v88, 0x409d30fc
  v_fmaak_f32 v9, v89, v89, 0x409d30fc
  v_mul_f32 v8, v88, v8
  v_mul_f32 v9, v89, v9
  v_exp_f32 v8, -v8
  v_exp_f32 v9, -v9
  v_fma_f32 v8, v8, s36, s36
  v_fma_f32 v9, v9, s36, s36
  v_mfma_f32_32x32x16_bf16 v[64:79], v[24:27], v[144:147], v[64:79]
  s_waitcnt lgkmcnt(4)
  v_rcp_f32 v8, v8
  v_rcp_f32 v9, v9
  v_mul_f32 v88, v88, v8
  v_mul_f32 v89, v89, v9
  v_cvt_pk_bf16_f32 v88, v88, v89
  v_fmaak_f32 v10, v104, v104, 0x409d30fc
  v_fmaak_f32 v11, v105, v105, 0x409d30fc
  v_mul_f32 v10, v104, v10
  v_mul_f32 v11, v105, v11
  v_exp_f32 v10, -v10
  v_exp_f32 v11, -v11
  v_fma_f32 v10, v10, s36, s36
  v_fma_f32 v11, v11, s36, s36
  v_mfma_f32_32x32x16_bf16 v[48:63], v[28:31], v[124:127], v[48:63]
  s_waitcnt lgkmcnt(0)
  s_barrier
  ds_read_b64_tr_b16 v[16:17], v7 offset:24576
  ds_read_b64_tr_b16 v[18:19], v7 offset:26112
  v_rcp_f32 v10, v10
  v_rcp_f32 v11, v11
  v_mul_f32 v104, v104, v10
  v_mul_f32 v105, v105, v11
  v_cvt_pk_bf16_f32 v104, v104, v105
  v_fmaak_f32 v8, v90, v90, 0x409d30fc
  v_fmaak_f32 v9, v91, v91, 0x409d30fc
  v_mul_f32 v8, v90, v8
  v_mul_f32 v9, v91, v9
  v_exp_f32 v8, -v8
  v_exp_f32 v9, -v9
  v_mfma_f32_32x32x16_bf16 v[64:79], v[28:31], v[148:151], v[64:79]
  ds_read_b64_tr_b16 v[20:21], v7 offset:24640
  ds_read_b64_tr_b16 v[22:23], v7 offset:26176
  v_fma_f32 v8, v8, s36, s36
  v_fma_f32 v9, v9, s36, s36
  v_rcp_f32 v8, v8
  v_rcp_f32 v9, v9
  v_mul_f32 v90, v90, v8
  v_mul_f32 v91, v91, v9
  v_cvt_pk_bf16_f32 v89, v90, v91
  v_fmaak_f32 v10, v106, v106, 0x409d30fc
  v_fmaak_f32 v11, v107, v107, 0x409d30fc
  v_mul_f32 v10, v106, v10
  v_mul_f32 v11, v107, v11
  v_exp_f32 v10, -v10
  v_mfma_f32_32x32x16_bf16 v[48:63], v[32:35], v[128:131], v[48:63]
  ds_read_b64_tr_b16 v[24:25], v7 offset:27648
  v_exp_f32 v11, -v11
  v_add_u32 v0, 0, v6
  v_fma_f32 v10, v10, s36, s36
  v_fma_f32 v11, v11, s36, s36
  v_rcp_f32 v10, v10
  v_rcp_f32 v11, v11
  v_mul_f32 v106, v106, v10
  v_mul_f32 v107, v107, v11
  v_cvt_pk_bf16_f32 v105, v106, v107
  v_fmaak_f32 v8, v92, v92, 0x409d30fc
  ds_read2_b32 v[40:41], v0 offset0:0 offset1:78
  ds_read2_b32 v[42:43], v0 offset0:156 offset1:234
  v_add_u32 v0, 2496, v6
  v_mfma_f32_32x32x16_bf16 v[64:79], v[32:35], v[152:155], v[64:79]
  ds_read_b64_tr_b16 v[26:27], v7 offset:29184
  ds_read2_b32 v[44:45], v0 offset0:0 offset1:78
  ds_read2_b32 v[46:47], v0 offset0:156 offset1:234
  v_fmaak_f32 v9, v93, v93, 0x409d30fc
  v_mul_f32 v8, v92, v8
  v_mul_f32 v9, v93, v9
  v_exp_f32 v8, -v8
  v_exp_f32 v9, -v9
  v_fma_f32 v8, v8, s36, s36
  v_fma_f32 v9, v9, s36, s36
  v_rcp_f32 v8, v8
  v_rcp_f32 v9, v9
  v_mfma_f32_32x32x16_bf16 v[48:63], v[36:39], v[132:135], v[48:63]
  ds_read_b64_tr_b16 v[28:29], v7 offset:27712
  v_mul_f32 v92, v92, v8
  v_mul_f32 v93, v93, v9
  v_cvt_pk_bf16_f32 v90, v92, v93
  v_fmaak_f32 v10, v108, v108, 0x409d30fc
  v_fmaak_f32 v11, v109, v109, 0x409d30fc
  v_mul_f32 v10, v108, v10
  v_mul_f32 v11, v109, v11
  v_exp_f32 v10, -v10
  v_exp_f32 v11, -v11
  v_fma_f32 v10, v10, s36, s36
  v_fma_f32 v11, v11, s36, s36
  v_rcp_f32 v10, v10
  v_rcp_f32 v11, v11
  v_mfma_f32_32x32x16_bf16 v[64:79], v[36:39], v[156:159], v[64:79]
  s_waitcnt lgkmcnt(9)
  ds_read_b64_tr_b16 v[30:31], v7 offset:29248
  v_mul_f32 v108, v108, v10
  v_mul_f32 v109, v109, v11
  v_cvt_pk_bf16_f32 v106, v108, v109
  v_fmaak_f32 v8, v94, v94, 0x409d30fc
  v_fmaak_f32 v9, v95, v95, 0x409d30fc
  v_mul_f32 v8, v94, v8
  v_mul_f32 v9, v95, v9
  v_exp_f32 v8, -v8
  v_exp_f32 v9, -v9
  v_fma_f32 v8, v8, s36, s36
  v_fma_f32 v9, v9, s36, s36
  v_rcp_f32 v8, v8
  v_mfma_f32_32x32x16_bf16 v[160:175], v[16:19], v[80:83], v[160:175]
  ds_read_b64_tr_b16 v[32:33], v7 offset:24704
  v_rcp_f32 v9, v9
  v_mul_f32 v94, v94, v8
  v_mul_f32 v95, v95, v9
  v_cvt_pk_bf16_f32 v91, v94, v95
  v_fmaak_f32 v10, v110, v110, 0x409d30fc
  v_fmaak_f32 v11, v111, v111, 0x409d30fc
  v_mul_f32 v10, v110, v10
  v_mul_f32 v11, v111, v11
  v_exp_f32 v10, -v10
  v_mfma_f32_32x32x16_bf16 v[208:223], v[16:19], v[96:99], 0
  s_waitcnt lgkmcnt(3)
  ds_read_b64_tr_b16 v[34:35], v7 offset:26240
  v_exp_f32 v11, -v11
  v_fma_f32 v10, v10, s36, s36
  v_fma_f32 v11, v11, s36, s36
  v_rcp_f32 v10, v10
  v_rcp_f32 v11, v11
  v_mul_f32 v110, v110, v10
  v_mul_f32 v111, v111, v11
  v_cvt_pk_bf16_f32 v107, v110, v111
  v_smfmac_f32_32x32x32_bf16 v[208:223], v[12:15], v[40:47], v5
  v_fmaak_f32 v8, v48, v48, 0x409d30fc
  v_add_u32 v0, 4992, v6
  v_fmaak_f32 v9, v49, v49, 0x409d30fc
  v_mul_f32 v8, v48, v8
  v_mul_f32 v9, v49, v9
  v_exp_f32 v8, -v8
  v_exp_f32 v9, -v9
  v_fma_f32 v8, v8, s36, s36
  v_mfma_f32_32x32x16_bf16 v[176:191], v[20:23], v[80:83], v[176:191]
  ds_read_b64_tr_b16 v[36:37], v7 offset:27776
  ds_read2_b32 v[40:41], v0 offset0:0 offset1:78
  ds_read2_b32 v[42:43], v0 offset0:156 offset1:234
  v_fma_f32 v9, v9, s36, s36
  v_rcp_f32 v8, v8
  v_add_u32 v0, 7488, v6
  v_rcp_f32 v9, v9
  v_mul_f32 v48, v48, v8
  v_mul_f32 v49, v49, v9
  v_cvt_pk_bf16_f32 v48, v48, v49
  v_mfma_f32_32x32x16_bf16 v[224:239], v[20:23], v[96:99], 0
  ds_read_b64_tr_b16 v[38:39], v7 offset:29312
  ds_read2_b32 v[44:45], v0 offset0:0 offset1:78
  ds_read2_b32 v[46:47], v0 offset0:156 offset1:234
  v_fmaak_f32 v10, v64, v64, 0x409d30fc
  v_fmaak_f32 v11, v65, v65, 0x409d30fc
  v_mul_f32 v10, v64, v10
  v_mul_f32 v11, v65, v11
  v_exp_f32 v10, -v10
  v_exp_f32 v11, -v11
  v_mfma_f32_32x32x16_bf16 v[160:175], v[24:27], v[88:91], v[160:175]
  ds_read_b64_tr_b16 v[16:17], v1 offset:30720
  v_fma_f32 v10, v10, s36, s36
  v_fma_f32 v11, v11, s36, s36
  v_rcp_f32 v10, v10
  v_rcp_f32 v11, v11
  v_mul_f32 v64, v64, v10
  v_mul_f32 v65, v65, v11
  v_cvt_pk_bf16_f32 v64, v64, v65
  v_fmaak_f32 v8, v50, v50, 0x409d30fc
  v_fmaak_f32 v9, v51, v51, 0x409d30fc
  v_mfma_f32_32x32x16_bf16 v[208:223], v[24:27], v[104:107], v[208:223]
  s_waitcnt lgkmcnt(9)
  ds_read_b64_tr_b16 v[18:19], v1 offset:30976
  v_mul_f32 v8, v50, v8
  v_mul_f32 v9, v51, v9
  v_exp_f32 v8, -v8
  v_exp_f32 v9, -v9
  v_fma_f32 v8, v8, s36, s36
  v_fma_f32 v9, v9, s36, s36
  v_rcp_f32 v8, v8
  v_mfma_f32_32x32x16_bf16 v[176:191], v[28:31], v[88:91], v[176:191]
  ds_read_b64_tr_b16 v[20:21], v1 offset:31744
  v_rcp_f32 v9, v9
  v_mul_f32 v50, v50, v8
  v_mul_f32 v51, v51, v9
  v_cvt_pk_bf16_f32 v49, v50, v51
  v_fmaak_f32 v10, v66, v66, 0x409d30fc
  v_fmaak_f32 v11, v67, v67, 0x409d30fc
  v_mul_f32 v10, v66, v10
  v_mul_f32 v11, v67, v11
  v_exp_f32 v10, -v10
  v_mfma_f32_32x32x16_bf16 v[224:239], v[28:31], v[104:107], v[224:239]
  s_waitcnt lgkmcnt(3)
  ds_read_b64_tr_b16 v[22:23], v1 offset:32000
  v_exp_f32 v11, -v11
  v_fma_f32 v10, v10, s36, s36
  v_fma_f32 v11, v11, s36, s36
  v_rcp_f32 v10, v10
  v_rcp_f32 v11, v11
  v_mul_f32 v66, v66, v10
  v_mul_f32 v67, v67, v11
  v_smfmac_f32_32x32x32_bf16 v[224:239], v[12:15], v[40:47], v5
  v_cvt_pk_bf16_f32 v65, v66, v67
  v_fmaak_f32 v8, v52, v52, 0x409d30fc
  v_fmaak_f32 v9, v53, v53, 0x409d30fc
  v_mul_f32 v8, v52, v8
  v_mul_f32 v9, v53, v9
  v_exp_f32 v8, -v8
  v_add_u32 v0, 9984, v6
  v_exp_f32 v9, -v9
  v_fma_f32 v8, v8, s36, s36
  v_mfma_f32_32x32x16_bf16 v[192:207], v[32:35], v[80:83], v[192:207]
  ds_read_b64_tr_b16 v[24:25], v1 offset:32768
  ds_read2_b32 v[40:41], v0 offset0:0 offset1:78
  ds_read2_b32 v[42:43], v0 offset0:156 offset1:234
  v_fma_f32 v9, v9, s36, s36
  v_rcp_f32 v8, v8
  v_rcp_f32 v9, v9
  v_mul_f32 v52, v52, v8
  v_mul_f32 v53, v53, v9
  v_add_u32 v0, 12480, v6
  v_cvt_pk_bf16_f32 v50, v52, v53
  v_mfma_f32_32x32x16_bf16 v[240:255], v[32:35], v[96:99], 0
  ds_read_b64_tr_b16 v[26:27], v1 offset:33024
  ds_read2_b32 v[44:45], v0 offset0:0 offset1:78
  ds_read2_b32 v[46:47], v0 offset0:156 offset1:234
  v_fmaak_f32 v10, v68, v68, 0x409d30fc
  v_fmaak_f32 v11, v69, v69, 0x409d30fc
  v_mul_f32 v10, v68, v10
  v_mul_f32 v11, v69, v11
  v_exp_f32 v10, -v10
  v_exp_f32 v11, -v11
  v_mfma_f32_32x32x16_bf16 v[192:207], v[36:39], v[88:91], v[192:207]
  ds_read_b64_tr_b16 v[28:29], v1 offset:33792
  v_fma_f32 v10, v10, s36, s36
  v_fma_f32 v11, v11, s36, s36
  v_rcp_f32 v10, v10
  v_rcp_f32 v11, v11
  v_mul_f32 v68, v68, v10
  v_mul_f32 v69, v69, v11
  v_cvt_pk_bf16_f32 v66, v68, v69
  v_fmaak_f32 v8, v54, v54, 0x409d30fc
  v_fmaak_f32 v9, v55, v55, 0x409d30fc
  v_mfma_f32_32x32x16_bf16 v[240:255], v[36:39], v[104:107], v[240:255]
  s_waitcnt lgkmcnt(9)
  ds_read_b64_tr_b16 v[30:31], v1 offset:34048
  v_mul_f32 v8, v54, v8
  v_mul_f32 v9, v55, v9
  v_exp_f32 v8, -v8
  v_exp_f32 v9, -v9
  v_fma_f32 v8, v8, s36, s36
  v_fma_f32 v9, v9, s36, s36
  v_rcp_f32 v8, v8
  v_mfma_f32_32x32x16_bf16 v[80:95], v[16:19], v[112:115], 0
  ds_read_b64_tr_b16 v[32:33], v1 offset:34816
  v_rcp_f32 v9, v9
  v_mul_f32 v54, v54, v8
  v_mul_f32 v55, v55, v9
  v_cvt_pk_bf16_f32 v51, v54, v55
  v_fmaak_f32 v10, v70, v70, 0x409d30fc
  v_fmaak_f32 v11, v71, v71, 0x409d30fc
  v_mul_f32 v10, v70, v10
  v_mul_f32 v11, v71, v11
  v_exp_f32 v10, -v10
  v_mfma_f32_32x32x16_bf16 v[96:111], v[16:19], v[136:139], 0
  s_waitcnt lgkmcnt(9)
  ds_read_b64_tr_b16 v[34:35], v1 offset:35072
  v_exp_f32 v11, -v11
  v_fma_f32 v10, v10, s36, s36
  v_fma_f32 v11, v11, s36, s36
  v_rcp_f32 v10, v10
  v_rcp_f32 v11, v11
  v_mul_f32 v70, v70, v10
  v_mul_f32 v71, v71, v11
  v_mfma_f32_32x32x16_bf16 v[80:95], v[20:23], v[116:119], v[80:95]
  ds_read_b64_tr_b16 v[36:37], v1 offset:35840
  v_cvt_pk_bf16_f32 v67, v70, v71
  v_fmaak_f32 v8, v56, v56, 0x409d30fc
  v_fmaak_f32 v9, v57, v57, 0x409d30fc
  v_mul_f32 v8, v56, v8
  v_mul_f32 v9, v57, v9
  v_exp_f32 v8, -v8
  v_exp_f32 v9, -v9
  v_fma_f32 v8, v8, s36, s36
  v_fma_f32 v9, v9, s36, s36
  v_mfma_f32_32x32x16_bf16 v[96:111], v[20:23], v[140:143], v[96:111]
  s_waitcnt lgkmcnt(7)
  ds_read_b64_tr_b16 v[38:39], v1 offset:36096
  v_rcp_f32 v8, v8
  v_rcp_f32 v9, v9
  v_mul_f32 v56, v56, v8
  v_mul_f32 v57, v57, v9
  v_cvt_pk_bf16_f32 v56, v56, v57
  v_fmaak_f32 v10, v72, v72, 0x409d30fc
  v_fmaak_f32 v11, v73, v73, 0x409d30fc
  v_mul_f32 v10, v72, v10
  v_mfma_f32_32x32x16_bf16 v[80:95], v[24:27], v[120:123], v[80:95]
  v_mul_f32 v11, v73, v11
  v_exp_f32 v10, -v10
  v_exp_f32 v11, -v11
  v_fma_f32 v10, v10, s36, s36
  v_fma_f32 v11, v11, s36, s36
  v_rcp_f32 v10, v10
  v_rcp_f32 v11, v11
  v_mul_f32 v72, v72, v10
  v_mfma_f32_32x32x16_bf16 v[96:111], v[24:27], v[144:147], v[96:111]
  s_waitcnt lgkmcnt(6)
  v_mul_f32 v73, v73, v11
  v_cvt_pk_bf16_f32 v72, v72, v73
  v_fmaak_f32 v8, v58, v58, 0x409d30fc
  v_fmaak_f32 v9, v59, v59, 0x409d30fc
  v_mul_f32 v8, v58, v8
  v_mul_f32 v9, v59, v9
  v_exp_f32 v8, -v8
  v_exp_f32 v9, -v9
  v_fma_f32 v8, v8, s36, s36
  v_fma_f32 v9, v9, s36, s36
  v_smfmac_f32_32x32x32_bf16 v[240:255], v[12:15], v[40:47], v5
  s_waitcnt lgkmcnt(0)
  s_barrier
  ds_read_b64_tr_b16 v[16:17], v7 offset:0
  ds_read_b64_tr_b16 v[18:19], v7 offset:1536
  v_rcp_f32 v8, v8
  v_rcp_f32 v9, v9
  v_mul_f32 v58, v58, v8
  v_mul_f32 v59, v59, v9
  v_cvt_pk_bf16_f32 v57, v58, v59
  v_mfma_f32_32x32x16_bf16 v[80:95], v[28:31], v[124:127], v[80:95]
  ds_read_b64_tr_b16 v[20:21], v7 offset:64
  v_fmaak_f32 v10, v74, v74, 0x409d30fc
  v_fmaak_f32 v11, v75, v75, 0x409d30fc
  v_mul_f32 v10, v74, v10
  v_mul_f32 v11, v75, v11
  v_exp_f32 v10, -v10
  v_exp_f32 v11, -v11
  v_fma_f32 v10, v10, s36, s36
  v_fma_f32 v11, v11, s36, s36
  v_rcp_f32 v10, v10
  v_mfma_f32_32x32x16_bf16 v[96:111], v[28:31], v[148:151], v[96:111]
  ds_read_b64_tr_b16 v[22:23], v7 offset:1600
  v_rcp_f32 v11, v11
  v_mul_f32 v74, v74, v10
  v_mul_f32 v75, v75, v11
  v_cvt_pk_bf16_f32 v73, v74, v75
  v_fmaak_f32 v8, v60, v60, 0x409d30fc
  v_fmaak_f32 v9, v61, v61, 0x409d30fc
  v_mul_f32 v8, v60, v8
  v_mul_f32 v9, v61, v9
  v_mfma_f32_32x32x16_bf16 v[80:95], v[32:35], v[128:131], v[80:95]
  ds_read_b64_tr_b16 v[24:25], v7 offset:3072
  v_exp_f32 v8, -v8
  v_exp_f32 v9, -v9
  v_fma_f32 v8, v8, s36, s36
  v_fma_f32 v9, v9, s36, s36
  v_rcp_f32 v8, v8
  v_rcp_f32 v9, v9
  v_mul_f32 v60, v60, v8
  v_mfma_f32_32x32x16_bf16 v[96:111], v[32:35], v[152:155], v[96:111]
  ds_read_b64_tr_b16 v[26:27], v7 offset:4608
  v_mul_f32 v61, v61, v9
  v_cvt_pk_bf16_f32 v58, v60, v61
  v_fmaak_f32 v10, v76, v76, 0x409d30fc
  v_fmaak_f32 v11, v77, v77, 0x409d30fc
  v_mul_f32 v10, v76, v10
  v_mul_f32 v11, v77, v11
  v_exp_f32 v10, -v10
  v_exp_f32 v11, -v11
  v_mfma_f32_32x32x16_bf16 v[80:95], v[36:39], v[132:135], v[80:95]
  ds_read_b64_tr_b16 v[28:29], v7 offset:3136
  v_fma_f32 v10, v10, s36, s36
  v_fma_f32 v11, v11, s36, s36
  v_rcp_f32 v10, v10
  v_rcp_f32 v11, v11
  v_mul_f32 v76, v76, v10
  v_mul_f32 v77, v77, v11
  v_cvt_pk_bf16_f32 v74, v76, v77
  v_fmaak_f32 v8, v62, v62, 0x409d30fc
  v_fmaak_f32 v9, v63, v63, 0x409d30fc
  v_mfma_f32_32x32x16_bf16 v[96:111], v[36:39], v[156:159], v[96:111]
  s_waitcnt lgkmcnt(5)
  ds_read_b64_tr_b16 v[30:31], v7 offset:4672
  v_mul_f32 v8, v62, v8
  v_mul_f32 v9, v63, v9
  v_exp_f32 v8, -v8
  v_exp_f32 v9, -v9
  v_fma_f32 v8, v8, s36, s36
  v_fma_f32 v9, v9, s36, s36
  v_rcp_f32 v8, v8
F_mloop:
  v_mfma_f32_32x32x16_bf16 v[160:175], v[16:19], v[48:51], v[160:175]
  ds_read_b64_tr_b16 v[32:33], v7 offset:128
  v_rcp_f32 v9, v9
  v_mul_f32 v62, v62, v8
  v_mul_f32 v63, v63, v9
  v_cvt_pk_bf16_f32 v59, v62, v63
  v_fmaak_f32 v10, v78, v78, 0x409d30fc
  v_fmaak_f32 v11, v79, v79, 0x409d30fc
  v_mul_f32 v10, v78, v10
  v_mul_f32 v11, v79, v11
  v_exp_f32 v10, -v10
  v_exp_f32 v11, -v11
  v_mfma_f32_32x32x16_bf16 v[208:223], v[16:19], v[64:67], v[208:223]
  s_waitcnt lgkmcnt(5)
  ds_read_b64_tr_b16 v[34:35], v7 offset:1664
  v_fma_f32 v10, v10, s36, s36
  v_fma_f32 v11, v11, s36, s36
  v_rcp_f32 v10, v10
  v_rcp_f32 v11, v11
  v_mul_f32 v78, v78, v10
  v_mul_f32 v79, v79, v11
  v_cvt_pk_bf16_f32 v75, v78, v79
  v_fmaak_f32 v8, v80, v80, 0x409d30fc
  v_mfma_f32_32x32x16_bf16 v[176:191], v[20:23], v[48:51], v[176:191]
  ds_read_b64_tr_b16 v[36:37], v7 offset:3200
  v_fmaak_f32 v9, v81, v81, 0x409d30fc
  v_mul_f32 v8, v80, v8
  v_mul_f32 v9, v81, v9
  v_exp_f32 v8, -v8
  v_exp_f32 v9, -v9
  v_fma_f32 v8, v8, s36, s36
  v_fma_f32 v9, v9, s36, s36
  v_rcp_f32 v8, v8
  v_mfma_f32_32x32x16_bf16 v[224:239], v[20:23], v[64:67], v[224:239]
  s_waitcnt lgkmcnt(5)
  ds_read_b64_tr_b16 v[38:39], v7 offset:4736
  v_rcp_f32 v9, v9
  v_mul_f32 v80, v80, v8
  v_mul_f32 v81, v81, v9
  v_cvt_pk_bf16_f32 v80, v80, v81
  v_fmaak_f32 v10, v96, v96, 0x409d30fc
  v_fmaak_f32 v11, v97, v97, 0x409d30fc
  v_mul_f32 v10, v96, v10
  v_mul_f32 v11, v97, v11
  v_exp_f32 v10, -v10
  v_exp_f32 v11, -v11
  v_mfma_f32_32x32x16_bf16 v[160:175], v[24:27], v[56:59], v[160:175]
  ds_read_b64_tr_b16 v[16:17], v1 offset:6144
  v_fma_f32 v10, v10, s36, s36
  v_fma_f32 v11, v11, s36, s36
  v_rcp_f32 v10, v10
  v_rcp_f32 v11, v11
  v_mul_f32 v96, v96, v10
  v_mul_f32 v97, v97, v11
  v_cvt_pk_bf16_f32 v96, v96, v97
  v_fmaak_f32 v8, v82, v82, 0x409d30fc
  v_mfma_f32_32x32x16_bf16 v[208:223], v[24:27], v[72:75], v[208:223]
  s_waitcnt lgkmcnt(5)
  ds_read_b64_tr_b16 v[18:19], v1 offset:6400
  v_fmaak_f32 v9, v83, v83, 0x409d30fc
  v_mul_f32 v8, v82, v8
  v_mul_f32 v9, v83, v9
  v_exp_f32 v8, -v8
  v_exp_f32 v9, -v9
  v_fma_f32 v8, v8, s36, s36
  v_fma_f32 v9, v9, s36, s36
  v_rcp_f32 v8, v8
  v_mfma_f32_32x32x16_bf16 v[176:191], v[28:31], v[56:59], v[176:191]
  ds_read_b64_tr_b16 v[20:21], v1 offset:7168
  v_rcp_f32 v9, v9
  v_mul_f32 v82, v82, v8
  v_mul_f32 v83, v83, v9
  v_cvt_pk_bf16_f32 v81, v82, v83
  v_fmaak_f32 v10, v98, v98, 0x409d30fc
  v_fmaak_f32 v11, v99, v99, 0x409d30fc
  v_mul_f32 v10, v98, v10
  v_mul_f32 v11, v99, v11
  v_exp_f32 v10, -v10
  v_exp_f32 v11, -v11
  v_mfma_f32_32x32x16_bf16 v[224:239], v[28:31], v[72:75], v[224:239]
  s_waitcnt lgkmcnt(5)
  ds_read_b64_tr_b16 v[22:23], v1 offset:7424
  v_fma_f32 v10, v10, s36, s36
  v_fma_f32 v11, v11, s36, s36
  v_rcp_f32 v10, v10
  v_rcp_f32 v11, v11
  v_mul_f32 v98, v98, v10
  v_mul_f32 v99, v99, v11
  v_cvt_pk_bf16_f32 v97, v98, v99
  v_fmaak_f32 v8, v84, v84, 0x409d30fc
  v_mfma_f32_32x32x16_bf16 v[192:207], v[32:35], v[48:51], v[192:207]
  ds_read_b64_tr_b16 v[24:25], v1 offset:8192
  v_fmaak_f32 v9, v85, v85, 0x409d30fc
  v_mul_f32 v8, v84, v8
  v_mul_f32 v9, v85, v9
  v_exp_f32 v8, -v8
  v_exp_f32 v9, -v9
  v_fma_f32 v8, v8, s36, s36
  v_fma_f32 v9, v9, s36, s36
  v_rcp_f32 v8, v8
  v_mfma_f32_32x32x16_bf16 v[240:255], v[32:35], v[64:67], v[240:255]
  s_waitcnt lgkmcnt(5)
  ds_read_b64_tr_b16 v[26:27], v1 offset:8448
  v_rcp_f32 v9, v9
  v_mul_f32 v84, v84, v8
  v_mul_f32 v85, v85, v9
  v_cvt_pk_bf16_f32 v82, v84, v85
  v_fmaak_f32 v10, v100, v100, 0x409d30fc
  v_fmaak_f32 v11, v101, v101, 0x409d30fc
  v_mul_f32 v10, v100, v10
  v_mul_f32 v11, v101, v11
  v_exp_f32 v10, -v10
  v_exp_f32 v11, -v11
  v_mfma_f32_32x32x16_bf16 v[192:207], v[36:39], v[56:59], v[192:207]
  ds_read_b64_tr_b16 v[28:29], v1 offset:9216
  v_fma_f32 v10, v10, s36, s36
  v_fma_f32 v11, v11, s36, s36
  v_rcp_f32 v10, v10
  v_rcp_f32 v11, v11
  v_mul_f32 v100, v100, v10
  v_mul_f32 v101, v101, v11
  v_cvt_pk_bf16_f32 v98, v100, v101
  v_fmaak_f32 v8, v86, v86, 0x409d30fc
  v_mfma_f32_32x32x16_bf16 v[240:255], v[36:39], v[72:75], v[240:255]
  s_waitcnt lgkmcnt(5)
  ds_read_b64_tr_b16 v[30:31], v1 offset:9472
  v_fmaak_f32 v9, v87, v87, 0x409d30fc
  v_mul_f32 v8, v86, v8
  v_mul_f32 v9, v87, v9
  v_exp_f32 v8, -v8
  v_exp_f32 v9, -v9
  v_fma_f32 v8, v8, s36, s36
  v_fma_f32 v9, v9, s36, s36
  v_rcp_f32 v8, v8
  v_mfma_f32_32x32x16_bf16 v[48:63], v[16:19], v[112:115], 0
  ds_read_b64_tr_b16 v[32:33], v1 offset:10240
  v_rcp_f32 v9, v9
  v_mul_f32 v86, v86, v8
  v_mul_f32 v87, v87, v9
  v_cvt_pk_bf16_f32 v83, v86, v87
  v_fmaak_f32 v10, v102, v102, 0x409d30fc
  v_fmaak_f32 v11, v103, v103, 0x409d30fc
  v_mul_f32 v10, v102, v10
  v_mul_f32 v11, v103, v11
  v_exp_f32 v10, -v10
  v_exp_f32 v11, -v11
  v_mfma_f32_32x32x16_bf16 v[64:79], v[16:19], v[136:139], 0
  s_waitcnt lgkmcnt(5)
  ds_read_b64_tr_b16 v[34:35], v1 offset:10496
  v_fma_f32 v10, v10, s36, s36
  v_fma_f32 v11, v11, s36, s36
  v_rcp_f32 v10, v10
  v_rcp_f32 v11, v11
  v_mul_f32 v102, v102, v10
  v_mul_f32 v103, v103, v11
  v_cvt_pk_bf16_f32 v99, v102, v103
  v_fmaak_f32 v8, v88, v88, 0x409d30fc
  v_mfma_f32_32x32x16_bf16 v[48:63], v[20:23], v[116:119], v[48:63]
  ds_read_b64_tr_b16 v[36:37], v1 offset:11264
  v_fmaak_f32 v9, v89, v89, 0x409d30fc
  v_mul_f32 v8, v88, v8
  v_mul_f32 v9, v89, v9
  v_exp_f32 v8, -v8
  v_exp_f32 v9, -v9
  v_fma_f32 v8, v8, s36, s36
  v_fma_f32 v9, v9, s36, s36
  v_rcp_f32 v8, v8
  v_mfma_f32_32x32x16_bf16 v[64:79], v[20:23], v[140:143], v[64:79]
  s_waitcnt lgkmcnt(5)
  ds_read_b64_tr_b16 v[38:39], v1 offset:11520
  v_rcp_f32 v9, v9
  v_mul_f32 v88, v88, v8
  v_mul_f32 v89, v89, v9
  v_cvt_pk_bf16_f32 v88, v88, v89
  v_fmaak_f32 v10, v104, v104, 0x409d30fc
  v_fmaak_f32 v11, v105, v105, 0x409d30fc
  v_mul_f32 v10, v104, v10
  v_mul_f32 v11, v105, v11
  v_exp_f32 v10, -v10
  v_exp_f32 v11, -v11
  v_mfma_f32_32x32x16_bf16 v[48:63], v[24:27], v[120:123], v[48:63]
  v_fma_f32 v10, v10, s36, s36
  v_fma_f32 v11, v11, s36, s36
  v_rcp_f32 v10, v10
  v_rcp_f32 v11, v11
  v_mul_f32 v104, v104, v10
  v_mul_f32 v105, v105, v11
  v_cvt_pk_bf16_f32 v104, v104, v105
  v_fmaak_f32 v8, v90, v90, 0x409d30fc
  v_fmaak_f32 v9, v91, v91, 0x409d30fc
  v_mfma_f32_32x32x16_bf16 v[64:79], v[24:27], v[144:147], v[64:79]
  s_waitcnt lgkmcnt(4)
  v_mul_f32 v8, v90, v8
  v_mul_f32 v9, v91, v9
  v_exp_f32 v8, -v8
  v_exp_f32 v9, -v9
  v_fma_f32 v8, v8, s36, s36
  v_fma_f32 v9, v9, s36, s36
  v_rcp_f32 v8, v8
  v_rcp_f32 v9, v9
  v_mfma_f32_32x32x16_bf16 v[48:63], v[28:31], v[124:127], v[48:63]
  s_waitcnt lgkmcnt(0)
  s_barrier
  ds_read_b64_tr_b16 v[16:17], v7 offset:12288
  ds_read_b64_tr_b16 v[18:19], v7 offset:13824
  v_mul_f32 v90, v90, v8
  v_mul_f32 v91, v91, v9
  v_cvt_pk_bf16_f32 v89, v90, v91
  v_fmaak_f32 v10, v106, v106, 0x409d30fc
  v_fmaak_f32 v11, v107, v107, 0x409d30fc
  v_mul_f32 v10, v106, v10
  v_mul_f32 v11, v107, v11
  v_exp_f32 v10, -v10
  v_exp_f32 v11, -v11
  v_mfma_f32_32x32x16_bf16 v[64:79], v[28:31], v[148:151], v[64:79]
  ds_read_b64_tr_b16 v[20:21], v7 offset:12352
  ds_read_b64_tr_b16 v[22:23], v7 offset:13888
  v_fma_f32 v10, v10, s36, s36
  v_fma_f32 v11, v11, s36, s36
  v_rcp_f32 v10, v10
  v_rcp_f32 v11, v11
  v_mul_f32 v106, v106, v10
  v_mul_f32 v107, v107, v11
  v_cvt_pk_bf16_f32 v105, v106, v107
  v_mfma_f32_32x32x16_bf16 v[48:63], v[32:35], v[128:131], v[48:63]
  ds_read_b64_tr_b16 v[24:25], v7 offset:15360
  v_fmaak_f32 v8, v92, v92, 0x409d30fc
  v_fmaak_f32 v9, v93, v93, 0x409d30fc
  v_mul_f32 v8, v92, v8
  v_mul_f32 v9, v93, v9
  v_exp_f32 v8, -v8
  v_exp_f32 v9, -v9
  v_fma_f32 v8, v8, s36, s36
  v_fma_f32 v9, v9, s36, s36
  v_rcp_f32 v8, v8
  v_mfma_f32_32x32x16_bf16 v[64:79], v[32:35], v[152:155], v[64:79]
  ds_read_b64_tr_b16 v[26:27], v7 offset:16896
  v_rcp_f32 v9, v9
  v_mul_f32 v92, v92, v8
  v_mul_f32 v93, v93, v9
  v_cvt_pk_bf16_f32 v90, v92, v93
  v_fmaak_f32 v10, v108, v108, 0x409d30fc
  v_fmaak_f32 v11, v109, v109, 0x409d30fc
  v_mul_f32 v10, v108, v10
  v_mul_f32 v11, v109, v11
  v_exp_f32 v10, -v10
  v_mfma_f32_32x32x16_bf16 v[48:63], v[36:39], v[132:135], v[48:63]
  ds_read_b64_tr_b16 v[28:29], v7 offset:15424
  v_exp_f32 v11, -v11
  v_fma_f32 v10, v10, s36, s36
  v_fma_f32 v11, v11, s36, s36
  v_rcp_f32 v10, v10
  v_rcp_f32 v11, v11
  v_mul_f32 v108, v108, v10
  v_mul_f32 v109, v109, v11
  v_cvt_pk_bf16_f32 v106, v108, v109
  v_mfma_f32_32x32x16_bf16 v[64:79], v[36:39], v[156:159], v[64:79]
  s_waitcnt lgkmcnt(5)
  ds_read_b64_tr_b16 v[30:31], v7 offset:16960
  v_fmaak_f32 v8, v94, v94, 0x409d30fc
  v_fmaak_f32 v9, v95, v95, 0x409d30fc
  v_mul_f32 v8, v94, v8
  v_mul_f32 v9, v95, v9
  v_exp_f32 v8, -v8
  v_exp_f32 v9, -v9
  v_fma_f32 v8, v8, s36, s36
  v_fma_f32 v9, v9, s36, s36
  v_rcp_f32 v8, v8
  v_mfma_f32_32x32x16_bf16 v[160:175], v[16:19], v[80:83], v[160:175]
  ds_read_b64_tr_b16 v[32:33], v7 offset:12416
  v_rcp_f32 v9, v9
  v_mul_f32 v94, v94, v8
  v_mul_f32 v95, v95, v9
  v_cvt_pk_bf16_f32 v91, v94, v95
  v_fmaak_f32 v10, v110, v110, 0x409d30fc
  v_fmaak_f32 v11, v111, v111, 0x409d30fc
  v_mul_f32 v10, v110, v10
  v_mul_f32 v11, v111, v11
  v_exp_f32 v10, -v10
  v_exp_f32 v11, -v11
  v_mfma_f32_32x32x16_bf16 v[208:223], v[16:19], v[96:99], v[208:223]
  s_waitcnt lgkmcnt(5)
  ds_read_b64_tr_b16 v[34:35], v7 offset:13952
  v_fma_f32 v10, v10, s36, s36
  v_fma_f32 v11, v11, s36, s36
  v_rcp_f32 v10, v10
  v_rcp_f32 v11, v11
  v_mul_f32 v110, v110, v10
  v_mul_f32 v111, v111, v11
  v_cvt_pk_bf16_f32 v107, v110, v111
  v_fmaak_f32 v8, v48, v48, 0x409d30fc
  v_mfma_f32_32x32x16_bf16 v[176:191], v[20:23], v[80:83], v[176:191]
  ds_read_b64_tr_b16 v[36:37], v7 offset:15488
  v_fmaak_f32 v9, v49, v49, 0x409d30fc
  v_mul_f32 v8, v48, v8
  v_mul_f32 v9, v49, v9
  v_exp_f32 v8, -v8
  v_exp_f32 v9, -v9
  v_fma_f32 v8, v8, s36, s36
  v_fma_f32 v9, v9, s36, s36
  v_rcp_f32 v8, v8
  v_mfma_f32_32x32x16_bf16 v[224:239], v[20:23], v[96:99], v[224:239]
  s_waitcnt lgkmcnt(5)
  ds_read_b64_tr_b16 v[38:39], v7 offset:17024
  v_rcp_f32 v9, v9
  v_mul_f32 v48, v48, v8
  v_mul_f32 v49, v49, v9
  v_cvt_pk_bf16_f32 v48, v48, v49
  v_fmaak_f32 v10, v64, v64, 0x409d30fc
  v_fmaak_f32 v11, v65, v65, 0x409d30fc
  v_mul_f32 v10, v64, v10
  v_mul_f32 v11, v65, v11
  v_exp_f32 v10, -v10
  v_exp_f32 v11, -v11
  v_mfma_f32_32x32x16_bf16 v[160:175], v[24:27], v[88:91], v[160:175]
  ds_read_b64_tr_b16 v[16:17], v1 offset:18432
  v_fma_f32 v10, v10, s36, s36
  v_fma_f32 v11, v11, s36, s36
  v_rcp_f32 v10, v10
  v_rcp_f32 v11, v11
  v_mul_f32 v64, v64, v10
  v_mul_f32 v65, v65, v11
  v_cvt_pk_bf16_f32 v64, v64, v65
  v_fmaak_f32 v8, v50, v50, 0x409d30fc
  v_mfma_f32_32x32x16_bf16 v[208:223], v[24:27], v[104:107], v[208:223]
  s_waitcnt lgkmcnt(5)
  ds_read_b64_tr_b16 v[18:19], v1 offset:18688
  v_fmaak_f32 v9, v51, v51, 0x409d30fc
  v_mul_f32 v8, v50, v8
  v_mul_f32 v9, v51, v9
  v_exp_f32 v8, -v8
  v_exp_f32 v9, -v9
  v_fma_f32 v8, v8, s36, s36
  v_fma_f32 v9, v9, s36, s36
  v_rcp_f32 v8, v8
  v_mfma_f32_32x32x16_bf16 v[176:191], v[28:31], v[88:91], v[176:191]
  ds_read_b64_tr_b16 v[20:21], v1 offset:19456
  v_rcp_f32 v9, v9
  v_mul_f32 v50, v50, v8
  v_mul_f32 v51, v51, v9
  v_cvt_pk_bf16_f32 v49, v50, v51
  v_fmaak_f32 v10, v66, v66, 0x409d30fc
  v_fmaak_f32 v11, v67, v67, 0x409d30fc
  v_mul_f32 v10, v66, v10
  v_mul_f32 v11, v67, v11
  v_exp_f32 v10, -v10
  v_exp_f32 v11, -v11
  v_mfma_f32_32x32x16_bf16 v[224:239], v[28:31], v[104:107], v[224:239]
  s_waitcnt lgkmcnt(5)
  ds_read_b64_tr_b16 v[22:23], v1 offset:19712
  v_fma_f32 v10, v10, s36, s36
  v_fma_f32 v11, v11, s36, s36
  v_rcp_f32 v10, v10
  v_rcp_f32 v11, v11
  v_mul_f32 v66, v66, v10
  v_mul_f32 v67, v67, v11
  v_cvt_pk_bf16_f32 v65, v66, v67
  v_fmaak_f32 v8, v52, v52, 0x409d30fc
  v_mfma_f32_32x32x16_bf16 v[192:207], v[32:35], v[80:83], v[192:207]
  ds_read_b64_tr_b16 v[24:25], v1 offset:20480
  v_fmaak_f32 v9, v53, v53, 0x409d30fc
  v_mul_f32 v8, v52, v8
  v_mul_f32 v9, v53, v9
  v_exp_f32 v8, -v8
  v_exp_f32 v9, -v9
  v_fma_f32 v8, v8, s36, s36
  v_fma_f32 v9, v9, s36, s36
  v_rcp_f32 v8, v8
  v_mfma_f32_32x32x16_bf16 v[240:255], v[32:35], v[96:99], v[240:255]
  s_waitcnt lgkmcnt(5)
  ds_read_b64_tr_b16 v[26:27], v1 offset:20736
  v_rcp_f32 v9, v9
  v_mul_f32 v52, v52, v8
  v_mul_f32 v53, v53, v9
  v_cvt_pk_bf16_f32 v50, v52, v53
  v_fmaak_f32 v10, v68, v68, 0x409d30fc
  v_fmaak_f32 v11, v69, v69, 0x409d30fc
  v_mul_f32 v10, v68, v10
  v_mul_f32 v11, v69, v11
  v_exp_f32 v10, -v10
  v_exp_f32 v11, -v11
  v_mfma_f32_32x32x16_bf16 v[192:207], v[36:39], v[88:91], v[192:207]
  ds_read_b64_tr_b16 v[28:29], v1 offset:21504
  v_fma_f32 v10, v10, s36, s36
  v_fma_f32 v11, v11, s36, s36
  v_rcp_f32 v10, v10
  v_rcp_f32 v11, v11
  v_mul_f32 v68, v68, v10
  v_mul_f32 v69, v69, v11
  v_cvt_pk_bf16_f32 v66, v68, v69
  v_fmaak_f32 v8, v54, v54, 0x409d30fc
  v_mfma_f32_32x32x16_bf16 v[240:255], v[36:39], v[104:107], v[240:255]
  s_waitcnt lgkmcnt(5)
  ds_read_b64_tr_b16 v[30:31], v1 offset:21760
  v_fmaak_f32 v9, v55, v55, 0x409d30fc
  v_mul_f32 v8, v54, v8
  v_mul_f32 v9, v55, v9
  v_exp_f32 v8, -v8
  v_exp_f32 v9, -v9
  v_fma_f32 v8, v8, s36, s36
  v_fma_f32 v9, v9, s36, s36
  v_rcp_f32 v8, v8
  v_mfma_f32_32x32x16_bf16 v[80:95], v[16:19], v[112:115], 0
  ds_read_b64_tr_b16 v[32:33], v1 offset:22528
  v_rcp_f32 v9, v9
  v_mul_f32 v54, v54, v8
  v_mul_f32 v55, v55, v9
  v_cvt_pk_bf16_f32 v51, v54, v55
  v_fmaak_f32 v10, v70, v70, 0x409d30fc
  v_fmaak_f32 v11, v71, v71, 0x409d30fc
  v_mul_f32 v10, v70, v10
  v_mul_f32 v11, v71, v11
  v_exp_f32 v10, -v10
  v_exp_f32 v11, -v11
  v_mfma_f32_32x32x16_bf16 v[96:111], v[16:19], v[136:139], 0
  s_waitcnt lgkmcnt(5)
  ds_read_b64_tr_b16 v[34:35], v1 offset:22784
  v_fma_f32 v10, v10, s36, s36
  v_fma_f32 v11, v11, s36, s36
  v_rcp_f32 v10, v10
  v_rcp_f32 v11, v11
  v_mul_f32 v70, v70, v10
  v_mul_f32 v71, v71, v11
  v_cvt_pk_bf16_f32 v67, v70, v71
  v_fmaak_f32 v8, v56, v56, 0x409d30fc
  v_mfma_f32_32x32x16_bf16 v[80:95], v[20:23], v[116:119], v[80:95]
  ds_read_b64_tr_b16 v[36:37], v1 offset:23552
  v_fmaak_f32 v9, v57, v57, 0x409d30fc
  v_mul_f32 v8, v56, v8
  v_mul_f32 v9, v57, v9
  v_exp_f32 v8, -v8
  v_exp_f32 v9, -v9
  v_fma_f32 v8, v8, s36, s36
  v_fma_f32 v9, v9, s36, s36
  v_rcp_f32 v8, v8
  v_mfma_f32_32x32x16_bf16 v[96:111], v[20:23], v[140:143], v[96:111]
  s_waitcnt lgkmcnt(5)
  ds_read_b64_tr_b16 v[38:39], v1 offset:23808
  v_rcp_f32 v9, v9
  v_mul_f32 v56, v56, v8
  v_mul_f32 v57, v57, v9
  v_cvt_pk_bf16_f32 v56, v56, v57
  v_fmaak_f32 v10, v72, v72, 0x409d30fc
  v_fmaak_f32 v11, v73, v73, 0x409d30fc
  v_mul_f32 v10, v72, v10
  v_mul_f32 v11, v73, v11
  v_exp_f32 v10, -v10
  v_exp_f32 v11, -v11
  v_mfma_f32_32x32x16_bf16 v[80:95], v[24:27], v[120:123], v[80:95]
  v_fma_f32 v10, v10, s36, s36
  v_fma_f32 v11, v11, s36, s36
  v_rcp_f32 v10, v10
  v_rcp_f32 v11, v11
  v_mul_f32 v72, v72, v10
  v_mul_f32 v73, v73, v11
  v_cvt_pk_bf16_f32 v72, v72, v73
  v_fmaak_f32 v8, v58, v58, 0x409d30fc
  v_fmaak_f32 v9, v59, v59, 0x409d30fc
  v_mfma_f32_32x32x16_bf16 v[96:111], v[24:27], v[144:147], v[96:111]
  s_waitcnt lgkmcnt(4)
  v_mul_f32 v8, v58, v8
  v_mul_f32 v9, v59, v9
  v_exp_f32 v8, -v8
  v_exp_f32 v9, -v9
  v_fma_f32 v8, v8, s36, s36
  v_fma_f32 v9, v9, s36, s36
  v_rcp_f32 v8, v8
  v_rcp_f32 v9, v9
  v_mfma_f32_32x32x16_bf16 v[80:95], v[28:31], v[124:127], v[80:95]
  s_waitcnt lgkmcnt(0)
  s_barrier
  ds_read_b64_tr_b16 v[16:17], v7 offset:24576
  ds_read_b64_tr_b16 v[18:19], v7 offset:26112
  v_mul_f32 v58, v58, v8
  v_mul_f32 v59, v59, v9
  v_cvt_pk_bf16_f32 v57, v58, v59
  v_fmaak_f32 v10, v74, v74, 0x409d30fc
  v_fmaak_f32 v11, v75, v75, 0x409d30fc
  v_mul_f32 v10, v74, v10
  v_mul_f32 v11, v75, v11
  v_exp_f32 v10, -v10
  v_exp_f32 v11, -v11
  v_mfma_f32_32x32x16_bf16 v[96:111], v[28:31], v[148:151], v[96:111]
  ds_read_b64_tr_b16 v[20:21], v7 offset:24640
  ds_read_b64_tr_b16 v[22:23], v7 offset:26176
  v_fma_f32 v10, v10, s36, s36
  v_fma_f32 v11, v11, s36, s36
  v_rcp_f32 v10, v10
  v_rcp_f32 v11, v11
  v_mul_f32 v74, v74, v10
  v_mul_f32 v75, v75, v11
  v_cvt_pk_bf16_f32 v73, v74, v75
  v_mfma_f32_32x32x16_bf16 v[80:95], v[32:35], v[128:131], v[80:95]
  ds_read_b64_tr_b16 v[24:25], v7 offset:27648
  v_fmaak_f32 v8, v60, v60, 0x409d30fc
  v_fmaak_f32 v9, v61, v61, 0x409d30fc
  v_mul_f32 v8, v60, v8
  v_mul_f32 v9, v61, v9
  v_exp_f32 v8, -v8
  v_exp_f32 v9, -v9
  v_fma_f32 v8, v8, s36, s36
  v_fma_f32 v9, v9, s36, s36
  v_rcp_f32 v8, v8
  v_mfma_f32_32x32x16_bf16 v[96:111], v[32:35], v[152:155], v[96:111]
  ds_read_b64_tr_b16 v[26:27], v7 offset:29184
  v_rcp_f32 v9, v9
  v_mul_f32 v60, v60, v8
  v_mul_f32 v61, v61, v9
  v_cvt_pk_bf16_f32 v58, v60, v61
  v_fmaak_f32 v10, v76, v76, 0x409d30fc
  v_fmaak_f32 v11, v77, v77, 0x409d30fc
  v_mul_f32 v10, v76, v10
  v_mul_f32 v11, v77, v11
  v_exp_f32 v10, -v10
  v_mfma_f32_32x32x16_bf16 v[80:95], v[36:39], v[132:135], v[80:95]
  ds_read_b64_tr_b16 v[28:29], v7 offset:27712
  v_exp_f32 v11, -v11
  v_fma_f32 v10, v10, s36, s36
  v_fma_f32 v11, v11, s36, s36
  v_rcp_f32 v10, v10
  v_rcp_f32 v11, v11
  v_mul_f32 v76, v76, v10
  v_mul_f32 v77, v77, v11
  v_cvt_pk_bf16_f32 v74, v76, v77
  v_mfma_f32_32x32x16_bf16 v[96:111], v[36:39], v[156:159], v[96:111]
  s_waitcnt lgkmcnt(5)
  ds_read_b64_tr_b16 v[30:31], v7 offset:29248
  v_fmaak_f32 v8, v62, v62, 0x409d30fc
  v_fmaak_f32 v9, v63, v63, 0x409d30fc
  v_mul_f32 v8, v62, v8
  v_mul_f32 v9, v63, v9
  v_exp_f32 v8, -v8
  v_exp_f32 v9, -v9
  v_fma_f32 v8, v8, s36, s36
  v_fma_f32 v9, v9, s36, s36
  v_rcp_f32 v8, v8
  s_cmp_eq_u32 s42, 3
  s_cbranch_scc1 F_mtail
  v_mfma_f32_32x32x16_bf16 v[160:175], v[16:19], v[48:51], v[160:175]
  ds_read_b64_tr_b16 v[32:33], v7 offset:24704
  v_rcp_f32 v9, v9
  v_mul_f32 v62, v62, v8
  v_mul_f32 v63, v63, v9
  v_cvt_pk_bf16_f32 v59, v62, v63
  v_fmaak_f32 v10, v78, v78, 0x409d30fc
  v_fmaak_f32 v11, v79, v79, 0x409d30fc
  v_mul_f32 v10, v78, v10
  v_mul_f32 v11, v79, v11
  v_exp_f32 v10, -v10
  v_exp_f32 v11, -v11
  v_mfma_f32_32x32x16_bf16 v[208:223], v[16:19], v[64:67], v[208:223]
  s_waitcnt lgkmcnt(5)
  ds_read_b64_tr_b16 v[34:35], v7 offset:26240
  v_fma_f32 v10, v10, s36, s36
  v_fma_f32 v11, v11, s36, s36
  v_rcp_f32 v10, v10
  v_rcp_f32 v11, v11
  v_mul_f32 v78, v78, v10
  v_mul_f32 v79, v79, v11
  v_cvt_pk_bf16_f32 v75, v78, v79
  v_fmaak_f32 v8, v80, v80, 0x409d30fc
  v_mfma_f32_32x32x16_bf16 v[176:191], v[20:23], v[48:51], v[176:191]
  ds_read_b64_tr_b16 v[36:37], v7 offset:27776
  v_fmaak_f32 v9, v81, v81, 0x409d30fc
  v_mul_f32 v8, v80, v8
  v_mul_f32 v9, v81, v9
  v_exp_f32 v8, -v8
  v_exp_f32 v9, -v9
  v_fma_f32 v8, v8, s36, s36
  v_fma_f32 v9, v9, s36, s36
  v_rcp_f32 v8, v8
  v_mfma_f32_32x32x16_bf16 v[224:239], v[20:23], v[64:67], v[224:239]
  s_waitcnt lgkmcnt(5)
  ds_read_b64_tr_b16 v[38:39], v7 offset:29312
  v_rcp_f32 v9, v9
  v_mul_f32 v80, v80, v8
  v_mul_f32 v81, v81, v9
  v_cvt_pk_bf16_f32 v80, v80, v81
  v_fmaak_f32 v10, v96, v96, 0x409d30fc
  v_fmaak_f32 v11, v97, v97, 0x409d30fc
  v_mul_f32 v10, v96, v10
  v_mul_f32 v11, v97, v11
  v_exp_f32 v10, -v10
  v_exp_f32 v11, -v11
  v_mfma_f32_32x32x16_bf16 v[160:175], v[24:27], v[56:59], v[160:175]
  ds_read_b64_tr_b16 v[16:17], v1 offset:30720
  v_fma_f32 v10, v10, s36, s36
  v_fma_f32 v11, v11, s36, s36
  v_rcp_f32 v10, v10
  v_rcp_f32 v11, v11
  v_mul_f32 v96, v96, v10
  v_mul_f32 v97, v97, v11
  v_cvt_pk_bf16_f32 v96, v96, v97
  v_fmaak_f32 v8, v82, v82, 0x409d30fc
  v_mfma_f32_32x32x16_bf16 v[208:223], v[24:27], v[72:75], v[208:223]
  s_waitcnt lgkmcnt(5)
  ds_read_b64_tr_b16 v[18:19], v1 offset:30976
  v_fmaak_f32 v9, v83, v83, 0x409d30fc
  v_mul_f32 v8, v82, v8
  v_mul_f32 v9, v83, v9
  v_exp_f32 v8, -v8
  v_exp_f32 v9, -v9
  v_fma_f32 v8, v8, s36, s36
  v_fma_f32 v9, v9, s36, s36
  v_rcp_f32 v8, v8
  v_mfma_f32_32x32x16_bf16 v[176:191], v[28:31], v[56:59], v[176:191]
  ds_read_b64_tr_b16 v[20:21], v1 offset:31744
  v_rcp_f32 v9, v9
  v_mul_f32 v82, v82, v8
  v_mul_f32 v83, v83, v9
  v_cvt_pk_bf16_f32 v81, v82, v83
  v_fmaak_f32 v10, v98, v98, 0x409d30fc
  v_fmaak_f32 v11, v99, v99, 0x409d30fc
  v_mul_f32 v10, v98, v10
  v_mul_f32 v11, v99, v11
  v_exp_f32 v10, -v10
  v_exp_f32 v11, -v11
  v_mfma_f32_32x32x16_bf16 v[224:239], v[28:31], v[72:75], v[224:239]
  s_waitcnt lgkmcnt(5)
  ds_read_b64_tr_b16 v[22:23], v1 offset:32000
  v_fma_f32 v10, v10, s36, s36
  v_fma_f32 v11, v11, s36, s36
  v_rcp_f32 v10, v10
  v_rcp_f32 v11, v11
  v_mul_f32 v98, v98, v10
  v_mul_f32 v99, v99, v11
  v_cvt_pk_bf16_f32 v97, v98, v99
  v_fmaak_f32 v8, v84, v84, 0x409d30fc
  v_mfma_f32_32x32x16_bf16 v[192:207], v[32:35], v[48:51], v[192:207]
  ds_read_b64_tr_b16 v[24:25], v1 offset:32768
  v_fmaak_f32 v9, v85, v85, 0x409d30fc
  v_mul_f32 v8, v84, v8
  v_mul_f32 v9, v85, v9
  v_exp_f32 v8, -v8
  v_exp_f32 v9, -v9
  v_fma_f32 v8, v8, s36, s36
  v_fma_f32 v9, v9, s36, s36
  v_rcp_f32 v8, v8
  v_mfma_f32_32x32x16_bf16 v[240:255], v[32:35], v[64:67], v[240:255]
  s_waitcnt lgkmcnt(5)
  ds_read_b64_tr_b16 v[26:27], v1 offset:33024
  v_rcp_f32 v9, v9
  v_mul_f32 v84, v84, v8
  v_mul_f32 v85, v85, v9
  v_cvt_pk_bf16_f32 v82, v84, v85
  v_fmaak_f32 v10, v100, v100, 0x409d30fc
  v_fmaak_f32 v11, v101, v101, 0x409d30fc
  v_mul_f32 v10, v100, v10
  v_mul_f32 v11, v101, v11
  v_exp_f32 v10, -v10
  v_exp_f32 v11, -v11
  v_mfma_f32_32x32x16_bf16 v[192:207], v[36:39], v[56:59], v[192:207]
  ds_read_b64_tr_b16 v[28:29], v1 offset:33792
  v_fma_f32 v10, v10, s36, s36
  v_fma_f32 v11, v11, s36, s36
  v_rcp_f32 v10, v10
  v_rcp_f32 v11, v11
  v_mul_f32 v100, v100, v10
  v_mul_f32 v101, v101, v11
  v_cvt_pk_bf16_f32 v98, v100, v101
  v_fmaak_f32 v8, v86, v86, 0x409d30fc
  v_mfma_f32_32x32x16_bf16 v[240:255], v[36:39], v[72:75], v[240:255]
  s_waitcnt lgkmcnt(5)
  ds_read_b64_tr_b16 v[30:31], v1 offset:34048
  v_fmaak_f32 v9, v87, v87, 0x409d30fc
  v_mul_f32 v8, v86, v8
  v_mul_f32 v9, v87, v9
  v_exp_f32 v8, -v8
  v_exp_f32 v9, -v9
  v_fma_f32 v8, v8, s36, s36
  v_fma_f32 v9, v9, s36, s36
  v_rcp_f32 v8, v8
  v_mfma_f32_32x32x16_bf16 v[48:63], v[16:19], v[112:115], 0
  ds_read_b64_tr_b16 v[32:33], v1 offset:34816
  v_rcp_f32 v9, v9
  v_mul_f32 v86, v86, v8
  v_mul_f32 v87, v87, v9
  v_cvt_pk_bf16_f32 v83, v86, v87
  v_fmaak_f32 v10, v102, v102, 0x409d30fc
  v_fmaak_f32 v11, v103, v103, 0x409d30fc
  v_mul_f32 v10, v102, v10
  v_mul_f32 v11, v103, v11
  v_exp_f32 v10, -v10
  v_exp_f32 v11, -v11
  v_mfma_f32_32x32x16_bf16 v[64:79], v[16:19], v[136:139], 0
  s_waitcnt lgkmcnt(5)
  ds_read_b64_tr_b16 v[34:35], v1 offset:35072
  v_fma_f32 v10, v10, s36, s36
  v_fma_f32 v11, v11, s36, s36
  v_rcp_f32 v10, v10
  v_rcp_f32 v11, v11
  v_mul_f32 v102, v102, v10
  v_mul_f32 v103, v103, v11
  v_cvt_pk_bf16_f32 v99, v102, v103
  v_fmaak_f32 v8, v88, v88, 0x409d30fc
  v_mfma_f32_32x32x16_bf16 v[48:63], v[20:23], v[116:119], v[48:63]
  ds_read_b64_tr_b16 v[36:37], v1 offset:35840
  v_fmaak_f32 v9, v89, v89, 0x409d30fc
  v_mul_f32 v8, v88, v8
  v_mul_f32 v9, v89, v9
  v_exp_f32 v8, -v8
  v_exp_f32 v9, -v9
  v_fma_f32 v8, v8, s36, s36
  v_fma_f32 v9, v9, s36, s36
  v_rcp_f32 v8, v8
  v_mfma_f32_32x32x16_bf16 v[64:79], v[20:23], v[140:143], v[64:79]
  s_waitcnt lgkmcnt(5)
  ds_read_b64_tr_b16 v[38:39], v1 offset:36096
  v_rcp_f32 v9, v9
  v_mul_f32 v88, v88, v8
  v_mul_f32 v89, v89, v9
  v_cvt_pk_bf16_f32 v88, v88, v89
  v_fmaak_f32 v10, v104, v104, 0x409d30fc
  v_fmaak_f32 v11, v105, v105, 0x409d30fc
  v_mul_f32 v10, v104, v10
  v_mul_f32 v11, v105, v11
  v_exp_f32 v10, -v10
  v_exp_f32 v11, -v11
  v_mfma_f32_32x32x16_bf16 v[48:63], v[24:27], v[120:123], v[48:63]
  v_fma_f32 v10, v10, s36, s36
  v_fma_f32 v11, v11, s36, s36
  v_rcp_f32 v10, v10
  v_rcp_f32 v11, v11
  v_mul_f32 v104, v104, v10
  v_mul_f32 v105, v105, v11
  v_cvt_pk_bf16_f32 v104, v104, v105
  v_fmaak_f32 v8, v90, v90, 0x409d30fc
  v_fmaak_f32 v9, v91, v91, 0x409d30fc
  v_mfma_f32_32x32x16_bf16 v[64:79], v[24:27], v[144:147], v[64:79]
  s_waitcnt lgkmcnt(4)
  v_mul_f32 v8, v90, v8
  v_mul_f32 v9, v91, v9
  v_exp_f32 v8, -v8
  v_exp_f32 v9, -v9
  v_fma_f32 v8, v8, s36, s36
  v_fma_f32 v9, v9, s36, s36
  v_rcp_f32 v8, v8
  v_rcp_f32 v9, v9
  v_mfma_f32_32x32x16_bf16 v[48:63], v[28:31], v[124:127], v[48:63]
  s_waitcnt lgkmcnt(0)
  s_barrier
  ds_read_b64_tr_b16 v[16:17], v7 offset:0
  ds_read_b64_tr_b16 v[18:19], v7 offset:1536
  v_mul_f32 v90, v90, v8
  v_mul_f32 v91, v91, v9
  v_cvt_pk_bf16_f32 v89, v90, v91
  v_fmaak_f32 v10, v106, v106, 0x409d30fc
  v_fmaak_f32 v11, v107, v107, 0x409d30fc
  v_mul_f32 v10, v106, v10
  v_mul_f32 v11, v107, v11
  v_exp_f32 v10, -v10
  v_exp_f32 v11, -v11
  v_mfma_f32_32x32x16_bf16 v[64:79], v[28:31], v[148:151], v[64:79]
  ds_read_b64_tr_b16 v[20:21], v7 offset:64
  ds_read_b64_tr_b16 v[22:23], v7 offset:1600
  v_fma_f32 v10, v10, s36, s36
  v_fma_f32 v11, v11, s36, s36
  v_rcp_f32 v10, v10
  v_rcp_f32 v11, v11
  v_mul_f32 v106, v106, v10
  v_mul_f32 v107, v107, v11
  v_cvt_pk_bf16_f32 v105, v106, v107
  v_mfma_f32_32x32x16_bf16 v[48:63], v[32:35], v[128:131], v[48:63]
  ds_read_b64_tr_b16 v[24:25], v7 offset:3072
  v_fmaak_f32 v8, v92, v92, 0x409d30fc
  v_fmaak_f32 v9, v93, v93, 0x409d30fc
  v_mul_f32 v8, v92, v8
  v_mul_f32 v9, v93, v9
  v_exp_f32 v8, -v8
  v_exp_f32 v9, -v9
  v_fma_f32 v8, v8, s36, s36
  v_fma_f32 v9, v9, s36, s36
  v_rcp_f32 v8, v8
  v_mfma_f32_32x32x16_bf16 v[64:79], v[32:35], v[152:155], v[64:79]
  ds_read_b64_tr_b16 v[26:27], v7 offset:4608
  v_rcp_f32 v9, v9
  v_mul_f32 v92, v92, v8
  v_mul_f32 v93, v93, v9
  v_cvt_pk_bf16_f32 v90, v92, v93
  v_fmaak_f32 v10, v108, v108, 0x409d30fc
  v_fmaak_f32 v11, v109, v109, 0x409d30fc
  v_mul_f32 v10, v108, v10
  v_mul_f32 v11, v109, v11
  v_exp_f32 v10, -v10
  v_mfma_f32_32x32x16_bf16 v[48:63], v[36:39], v[132:135], v[48:63]
  ds_read_b64_tr_b16 v[28:29], v7 offset:3136
  v_exp_f32 v11, -v11
  v_fma_f32 v10, v10, s36, s36
  v_fma_f32 v11, v11, s36, s36
  v_rcp_f32 v10, v10
  v_rcp_f32 v11, v11
  v_mul_f32 v108, v108, v10
  v_mul_f32 v109, v109, v11
  v_cvt_pk_bf16_f32 v106, v108, v109
  v_mfma_f32_32x32x16_bf16 v[64:79], v[36:39], v[156:159], v[64:79]
  s_waitcnt lgkmcnt(5)
  ds_read_b64_tr_b16 v[30:31], v7 offset:4672
  v_fmaak_f32 v8, v94, v94, 0x409d30fc
  v_fmaak_f32 v9, v95, v95, 0x409d30fc
  v_mul_f32 v8, v94, v8
  v_mul_f32 v9, v95, v9
  v_exp_f32 v8, -v8
  v_exp_f32 v9, -v9
  v_fma_f32 v8, v8, s36, s36
  v_fma_f32 v9, v9, s36, s36
  v_rcp_f32 v8, v8
  v_mfma_f32_32x32x16_bf16 v[160:175], v[16:19], v[80:83], v[160:175]
  ds_read_b64_tr_b16 v[32:33], v7 offset:128
  ds_read_b128 v[112:115], v3 offset:0
  ds_read_b128 v[116:119], v3 offset:4096
  v_rcp_f32 v9, v9
  v_mul_f32 v94, v94, v8
  v_mul_f32 v95, v95, v9
  v_cvt_pk_bf16_f32 v91, v94, v95
  v_fmaak_f32 v10, v110, v110, 0x409d30fc
  v_fmaak_f32 v11, v111, v111, 0x409d30fc
  v_mul_f32 v10, v110, v10
  v_mul_f32 v11, v111, v11
  v_exp_f32 v10, -v10
  v_mfma_f32_32x32x16_bf16 v[208:223], v[16:19], v[96:99], v[208:223]
  s_waitcnt lgkmcnt(7)
  ds_read_b64_tr_b16 v[34:35], v7 offset:1664
  ds_read_b128 v[120:123], v3 offset:8192
  ds_read_b128 v[124:127], v3 offset:12288
  v_exp_f32 v11, -v11
  v_fma_f32 v10, v10, s36, s36
  v_fma_f32 v11, v11, s36, s36
  v_rcp_f32 v10, v10
  v_rcp_f32 v11, v11
  v_mul_f32 v110, v110, v10
  v_mfma_f32_32x32x16_bf16 v[176:191], v[20:23], v[80:83], v[176:191]
  ds_read_b64_tr_b16 v[36:37], v7 offset:3200
  ds_read_b128 v[128:131], v3 offset:16384
  ds_read_b128 v[132:135], v3 offset:20480
  v_mul_f32 v111, v111, v11
  v_cvt_pk_bf16_f32 v107, v110, v111
  v_fmaak_f32 v8, v48, v48, 0x409d30fc
  v_fmaak_f32 v9, v49, v49, 0x409d30fc
  v_mul_f32 v8, v48, v8
  v_mul_f32 v9, v49, v9
  v_exp_f32 v8, -v8
  v_exp_f32 v9, -v9
  v_mfma_f32_32x32x16_bf16 v[224:239], v[20:23], v[96:99], v[224:239]
  s_waitcnt lgkmcnt(11)
  ds_read_b64_tr_b16 v[38:39], v7 offset:4736
  v_fma_f32 v8, v8, s36, s36
  v_fma_f32 v9, v9, s36, s36
  v_rcp_f32 v8, v8
  v_rcp_f32 v9, v9
  v_mul_f32 v48, v48, v8
  v_mul_f32 v49, v49, v9
  v_cvt_pk_bf16_f32 v48, v48, v49
  v_fmaak_f32 v10, v64, v64, 0x409d30fc
  v_fmaak_f32 v11, v65, v65, 0x409d30fc
  v_mfma_f32_32x32x16_bf16 v[160:175], v[24:27], v[88:91], v[160:175]
  ds_read_b64_tr_b16 v[16:17], v1 offset:6144
  v_mul_f32 v10, v64, v10
  v_mul_f32 v11, v65, v11
  v_exp_f32 v10, -v10
  v_exp_f32 v11, -v11
  v_fma_f32 v10, v10, s36, s36
  v_fma_f32 v11, v11, s36, s36
  v_rcp_f32 v10, v10
  v_rcp_f32 v11, v11
  v_mfma_f32_32x32x16_bf16 v[208:223], v[24:27], v[104:107], v[208:223]
  s_waitcnt lgkmcnt(11)
  ds_read_b64_tr_b16 v[18:19], v1 offset:6400
  v_mul_f32 v64, v64, v10
  v_mul_f32 v65, v65, v11
  v_cvt_pk_bf16_f32 v64, v64, v65
  v_fmaak_f32 v8, v50, v50, 0x409d30fc
  v_fmaak_f32 v9, v51, v51, 0x409d30fc
  v_mul_f32 v8, v50, v8
  v_mul_f32 v9, v51, v9
  v_exp_f32 v8, -v8
  v_exp_f32 v9, -v9
  v_mfma_f32_32x32x16_bf16 v[176:191], v[28:31], v[88:91], v[176:191]
  ds_read_b64_tr_b16 v[20:21], v1 offset:7168
  v_fma_f32 v8, v8, s36, s36
  v_fma_f32 v9, v9, s36, s36
  v_rcp_f32 v8, v8
  v_rcp_f32 v9, v9
  v_mul_f32 v50, v50, v8
  v_mul_f32 v51, v51, v9
  v_cvt_pk_bf16_f32 v49, v50, v51
  v_fmaak_f32 v10, v66, v66, 0x409d30fc
  v_fmaak_f32 v11, v67, v67, 0x409d30fc
  v_mul_f32 v10, v66, v10
  v_mfma_f32_32x32x16_bf16 v[224:239], v[28:31], v[104:107], v[224:239]
  s_waitcnt lgkmcnt(9)
  ds_read_b64_tr_b16 v[22:23], v1 offset:7424
  v_mul_f32 v11, v67, v11
  v_exp_f32 v10, -v10
  v_exp_f32 v11, -v11
  v_fma_f32 v10, v10, s36, s36
  v_fma_f32 v11, v11, s36, s36
  v_rcp_f32 v10, v10
  v_rcp_f32 v11, v11
  v_mfma_f32_32x32x16_bf16 v[192:207], v[32:35], v[80:83], v[192:207]
  ds_read_b64_tr_b16 v[24:25], v1 offset:8192
  v_mul_f32 v66, v66, v10
  v_mul_f32 v67, v67, v11
  v_cvt_pk_bf16_f32 v65, v66, v67
  v_fmaak_f32 v8, v52, v52, 0x409d30fc
  v_fmaak_f32 v9, v53, v53, 0x409d30fc
  v_mul_f32 v8, v52, v8
  v_mul_f32 v9, v53, v9
  v_exp_f32 v8, -v8
  v_exp_f32 v9, -v9
  v_fma_f32 v8, v8, s36, s36
  v_mfma_f32_32x32x16_bf16 v[240:255], v[32:35], v[96:99], v[240:255]
  s_waitcnt lgkmcnt(5)
  ds_read_b64_tr_b16 v[26:27], v1 offset:8448
  v_fma_f32 v9, v9, s36, s36
  v_rcp_f32 v8, v8
  v_rcp_f32 v9, v9
  v_mul_f32 v52, v52, v8
  v_mul_f32 v53, v53, v9
  v_cvt_pk_bf16_f32 v50, v52, v53
  v_fmaak_f32 v10, v68, v68, 0x409d30fc
  v_fmaak_f32 v11, v69, v69, 0x409d30fc
  v_mul_f32 v10, v68, v10
  v_mfma_f32_32x32x16_bf16 v[192:207], v[36:39], v[88:91], v[192:207]
  ds_read_b64_tr_b16 v[28:29], v1 offset:9216
  v_mul_f32 v11, v69, v11
  v_exp_f32 v10, -v10
  v_exp_f32 v11, -v11
  v_fma_f32 v10, v10, s36, s36
  v_fma_f32 v11, v11, s36, s36
  v_rcp_f32 v10, v10
  v_rcp_f32 v11, v11
  v_mul_f32 v68, v68, v10
  v_mfma_f32_32x32x16_bf16 v[240:255], v[36:39], v[104:107], v[240:255]
  s_waitcnt lgkmcnt(5)
  ds_read_b64_tr_b16 v[30:31], v1 offset:9472
  v_mul_f32 v69, v69, v11
  v_cvt_pk_bf16_f32 v66, v68, v69
  v_fmaak_f32 v8, v54, v54, 0x409d30fc
  v_fmaak_f32 v9, v55, v55, 0x409d30fc
  v_mul_f32 v8, v54, v8
  v_mul_f32 v9, v55, v9
  v_exp_f32 v8, -v8
  v_exp_f32 v9, -v9
  v_fma_f32 v8, v8, s36, s36
  v_mfma_f32_32x32x16_bf16 v[80:95], v[16:19], v[112:115], 0
  ds_read_b64_tr_b16 v[32:33], v1 offset:10240
  v_fma_f32 v9, v9, s36, s36
  v_rcp_f32 v8, v8
  v_rcp_f32 v9, v9
  v_mul_f32 v54, v54, v8
  v_mul_f32 v55, v55, v9
  v_cvt_pk_bf16_f32 v51, v54, v55
  v_fmaak_f32 v10, v70, v70, 0x409d30fc
  v_fmaak_f32 v11, v71, v71, 0x409d30fc
  v_mul_f32 v10, v70, v10
  v_mul_f32 v11, v71, v11
  v_mfma_f32_32x32x16_bf16 v[96:111], v[16:19], v[136:139], 0
  s_waitcnt lgkmcnt(5)
  ds_read_b64_tr_b16 v[34:35], v1 offset:10496
  v_exp_f32 v10, -v10
  v_exp_f32 v11, -v11
  v_fma_f32 v10, v10, s36, s36
  v_fma_f32 v11, v11, s36, s36
  v_rcp_f32 v10, v10
  v_rcp_f32 v11, v11
  v_mul_f32 v70, v70, v10
  v_mul_f32 v71, v71, v11
  v_mfma_f32_32x32x16_bf16 v[80:95], v[20:23], v[116:119], v[80:95]
  ds_read_b64_tr_b16 v[36:37], v1 offset:11264
  v_cvt_pk_bf16_f32 v67, v70, v71
  v_fmaak_f32 v8, v56, v56, 0x409d30fc
  v_fmaak_f32 v9, v57, v57, 0x409d30fc
  v_mul_f32 v8, v56, v8
  v_mul_f32 v9, v57, v9
  v_exp_f32 v8, -v8
  v_exp_f32 v9, -v9
  v_fma_f32 v8, v8, s36, s36
  v_fma_f32 v9, v9, s36, s36
  v_mfma_f32_32x32x16_bf16 v[96:111], v[20:23], v[140:143], v[96:111]
  s_waitcnt lgkmcnt(5)
  ds_read_b64_tr_b16 v[38:39], v1 offset:11520
  v_rcp_f32 v8, v8
  v_rcp_f32 v9, v9
  v_mul_f32 v56, v56, v8
  v_mul_f32 v57, v57, v9
  v_cvt_pk_bf16_f32 v56, v56, v57
  v_fmaak_f32 v10, v72, v72, 0x409d30fc
  v_fmaak_f32 v11, v73, v73, 0x409d30fc
  v_mul_f32 v10, v72, v10
  v_mul_f32 v11, v73, v11
  v_exp_f32 v10, -v10
  v_mfma_f32_32x32x16_bf16 v[80:95], v[24:27], v[120:123], v[80:95]
  v_exp_f32 v11, -v11
  v_fma_f32 v10, v10, s36, s36
  v_fma_f32 v11, v11, s36, s36
  v_rcp_f32 v10, v10
  v_rcp_f32 v11, v11
  v_mul_f32 v72, v72, v10
  v_mul_f32 v73, v73, v11
  v_cvt_pk_bf16_f32 v72, v72, v73
  v_mfma_f32_32x32x16_bf16 v[96:111], v[24:27], v[144:147], v[96:111]
  s_waitcnt lgkmcnt(4)
  v_fmaak_f32 v8, v58, v58, 0x409d30fc
  v_fmaak_f32 v9, v59, v59, 0x409d30fc
  v_mul_f32 v8, v58, v8
  v_mul_f32 v9, v59, v9
  v_exp_f32 v8, -v8
  v_exp_f32 v9, -v9
  v_fma_f32 v8, v8, s36, s36
  v_fma_f32 v9, v9, s36, s36
  v_rcp_f32 v8, v8
  v_rcp_f32 v9, v9
  v_mfma_f32_32x32x16_bf16 v[80:95], v[28:31], v[124:127], v[80:95]
  s_waitcnt lgkmcnt(0)
  s_barrier
  ds_read_b64_tr_b16 v[16:17], v7 offset:12288
  ds_read_b64_tr_b16 v[18:19], v7 offset:13824
  v_mul_f32 v58, v58, v8
  v_mul_f32 v59, v59, v9
  v_cvt_pk_bf16_f32 v57, v58, v59
  v_fmaak_f32 v10, v74, v74, 0x409d30fc
  v_fmaak_f32 v11, v75, v75, 0x409d30fc
  v_mul_f32 v10, v74, v10
  v_mul_f32 v11, v75, v11
  v_exp_f32 v10, -v10
  v_mfma_f32_32x32x16_bf16 v[96:111], v[28:31], v[148:151], v[96:111]
  ds_read_b64_tr_b16 v[20:21], v7 offset:12352
  ds_read_b64_tr_b16 v[22:23], v7 offset:13888
  v_exp_f32 v11, -v11
  v_fma_f32 v10, v10, s36, s36
  v_fma_f32 v11, v11, s36, s36
  v_rcp_f32 v10, v10
  v_rcp_f32 v11, v11
  v_mul_f32 v74, v74, v10
  v_mul_f32 v75, v75, v11
  v_mfma_f32_32x32x16_bf16 v[80:95], v[32:35], v[128:131], v[80:95]
  ds_read_b64_tr_b16 v[24:25], v7 offset:15360
  v_cvt_pk_bf16_f32 v73, v74, v75
  v_fmaak_f32 v8, v60, v60, 0x409d30fc
  v_fmaak_f32 v9, v61, v61, 0x409d30fc
  v_mul_f32 v8, v60, v8
  v_mul_f32 v9, v61, v9
  v_exp_f32 v8, -v8
  v_exp_f32 v9, -v9
  v_fma_f32 v8, v8, s36, s36
  v_fma_f32 v9, v9, s36, s36
  v_rcp_f32 v8, v8
  v_mfma_f32_32x32x16_bf16 v[96:111], v[32:35], v[152:155], v[96:111]
  ds_read_b64_tr_b16 v[26:27], v7 offset:16896
  v_rcp_f32 v9, v9
  v_mul_f32 v60, v60, v8
  v_mul_f32 v61, v61, v9
  v_cvt_pk_bf16_f32 v58, v60, v61
  v_fmaak_f32 v10, v76, v76, 0x409d30fc
  v_fmaak_f32 v11, v77, v77, 0x409d30fc
  v_mul_f32 v10, v76, v10
  v_mul_f32 v11, v77, v11
  v_exp_f32 v10, -v10
  v_mfma_f32_32x32x16_bf16 v[80:95], v[36:39], v[132:135], v[80:95]
  ds_read_b64_tr_b16 v[28:29], v7 offset:15424
  v_exp_f32 v11, -v11
  v_fma_f32 v10, v10, s36, s36
  v_fma_f32 v11, v11, s36, s36
  v_rcp_f32 v10, v10
  v_rcp_f32 v11, v11
  v_mul_f32 v76, v76, v10
  v_mul_f32 v77, v77, v11
  v_cvt_pk_bf16_f32 v74, v76, v77
  v_mfma_f32_32x32x16_bf16 v[96:111], v[36:39], v[156:159], v[96:111]
  s_waitcnt lgkmcnt(5)
  ds_read_b64_tr_b16 v[30:31], v7 offset:16960
  v_fmaak_f32 v8, v62, v62, 0x409d30fc
  v_fmaak_f32 v9, v63, v63, 0x409d30fc
  v_mul_f32 v8, v62, v8
  v_mul_f32 v9, v63, v9
  v_exp_f32 v8, -v8
  v_exp_f32 v9, -v9
  v_fma_f32 v8, v8, s36, s36
  v_fma_f32 v9, v9, s36, s36
  v_rcp_f32 v8, v8
  v_mfma_f32_32x32x16_bf16 v[160:175], v[16:19], v[48:51], v[160:175]
  ds_read_b64_tr_b16 v[32:33], v7 offset:12416
  v_add_u32 v6, s43, v4
  v_rcp_f32 v9, v9
  v_mul_f32 v62, v62, v8
  v_mul_f32 v63, v63, v9
  v_cvt_pk_bf16_f32 v59, v62, v63
  v_fmaak_f32 v10, v78, v78, 0x409d30fc
  v_fmaak_f32 v11, v79, v79, 0x409d30fc
  v_mul_f32 v10, v78, v10
  v_mul_f32 v11, v79, v11
  v_exp_f32 v10, -v10
  v_exp_f32 v11, -v11
  v_mfma_f32_32x32x16_bf16 v[208:223], v[16:19], v[64:67], v[208:223]
  s_waitcnt lgkmcnt(5)
  ds_read_b64_tr_b16 v[34:35], v7 offset:13952
  s_mov_b32 s49, s43
  s_mov_b32 s43, s44
  s_mov_b32 s44, s45
  s_mov_b32 s45, s49
  v_fma_f32 v10, v10, s36, s36
  v_fma_f32 v11, v11, s36, s36
  v_rcp_f32 v10, v10
  v_rcp_f32 v11, v11
  v_mul_f32 v78, v78, v10
  v_mul_f32 v79, v79, v11
  v_cvt_pk_bf16_f32 v75, v78, v79
  v_mfma_f32_32x32x16_bf16 v[176:191], v[20:23], v[48:51], v[176:191]
  ds_read_b64_tr_b16 v[36:37], v7 offset:15488
  v_fmaak_f32 v8, v80, v80, 0x409d30fc
  v_fmaak_f32 v9, v81, v81, 0x409d30fc
  v_mul_f32 v8, v80, v8
  v_mul_f32 v9, v81, v9
  v_exp_f32 v8, -v8
  v_exp_f32 v9, -v9
  v_fma_f32 v8, v8, s36, s36
  v_fma_f32 v9, v9, s36, s36
  v_rcp_f32 v8, v8
  v_rcp_f32 v9, v9
  v_mfma_f32_32x32x16_bf16 v[224:239], v[20:23], v[64:67], v[224:239]
  s_waitcnt lgkmcnt(5)
  ds_read_b64_tr_b16 v[38:39], v7 offset:17024
  v_mul_f32 v80, v80, v8
  v_mul_f32 v81, v81, v9
  v_cvt_pk_bf16_f32 v80, v80, v81
  v_fmaak_f32 v10, v96, v96, 0x409d30fc
  v_fmaak_f32 v11, v97, v97, 0x409d30fc
  v_mul_f32 v10, v96, v10
  v_mul_f32 v11, v97, v11
  v_exp_f32 v10, -v10
  v_exp_f32 v11, -v11
  v_fma_f32 v10, v10, s36, s36
  v_mfma_f32_32x32x16_bf16 v[160:175], v[24:27], v[56:59], v[160:175]
  ds_read_b64_tr_b16 v[16:17], v1 offset:18432
  v_fma_f32 v11, v11, s36, s36
  v_rcp_f32 v10, v10
  v_rcp_f32 v11, v11
  v_mul_f32 v96, v96, v10
  v_mul_f32 v97, v97, v11
  v_cvt_pk_bf16_f32 v96, v96, v97
  v_fmaak_f32 v8, v82, v82, 0x409d30fc
  v_fmaak_f32 v9, v83, v83, 0x409d30fc
  v_mul_f32 v8, v82, v8
  v_mul_f32 v9, v83, v9
  v_exp_f32 v8, -v8
  v_mfma_f32_32x32x16_bf16 v[208:223], v[24:27], v[72:75], v[208:223]
  s_waitcnt lgkmcnt(5)
  ds_read_b64_tr_b16 v[18:19], v1 offset:18688
  v_exp_f32 v9, -v9
  v_fma_f32 v8, v8, s36, s36
  v_fma_f32 v9, v9, s36, s36
  v_rcp_f32 v8, v8
  v_rcp_f32 v9, v9
  v_cvt_pk_bf16_f32 v160, v160, v161
  v_cvt_pk_bf16_f32 v161, v162, v163
  v_cvt_pk_bf16_f32 v162, v164, v165
  v_cvt_pk_bf16_f32 v163, v166, v167
  v_mul_f32 v82, v82, v8
  v_mfma_f32_32x32x16_bf16 v[176:191], v[28:31], v[56:59], v[176:191]
  ds_read_b64_tr_b16 v[20:21], v1 offset:19456
  v_mul_f32 v83, v83, v9
  v_cvt_pk_bf16_f32 v81, v82, v83
  v_fmaak_f32 v10, v98, v98, 0x409d30fc
  v_fmaak_f32 v11, v99, v99, 0x409d30fc
  v_cvt_pk_bf16_f32 v168, v168, v169
  v_cvt_pk_bf16_f32 v169, v170, v171
  v_mul_f32 v10, v98, v10
  v_cvt_pk_bf16_f32 v170, v172, v173
  v_cvt_pk_bf16_f32 v171, v174, v175
  s_nop 1
  v_permlane16_swap_b32 v160, v168
  v_permlane16_swap_b32 v161, v169
  v_permlane16_swap_b32 v162, v170
  v_permlane16_swap_b32 v163, v171
  v_mfma_f32_32x32x16_bf16 v[224:239], v[28:31], v[72:75], v[224:239]
  s_waitcnt lgkmcnt(5)
  ds_read_b64_tr_b16 v[22:23], v1 offset:19712
  buffer_store_dwordx4 v[160:163], v2, s[28:31], s40 offen offset:0 sc1
  v_mul_f32 v11, v99, v11
  v_exp_f32 v10, -v10
  v_exp_f32 v11, -v11
  v_fma_f32 v10, v10, s36, s36
  v_fma_f32 v11, v11, s36, s36
  v_rcp_f32 v10, v10
  v_rcp_f32 v11, v11
  v_mfma_f32_32x32x16_bf16 v[192:207], v[32:35], v[48:51], v[192:207]
  ds_read_b64_tr_b16 v[24:25], v1 offset:20480
  v_mul_f32 v98, v98, v10
  v_mul_f32 v99, v99, v11
  v_cvt_pk_bf16_f32 v97, v98, v99
  v_fmaak_f32 v8, v84, v84, 0x409d30fc
  v_fmaak_f32 v9, v85, v85, 0x409d30fc
  v_mul_f32 v8, v84, v8
  v_mul_f32 v9, v85, v9
  v_exp_f32 v8, -v8
  v_exp_f32 v9, -v9
  v_fma_f32 v8, v8, s36, s36
  v_fma_f32 v9, v9, s36, s36
  v_mfma_f32_32x32x16_bf16 v[240:255], v[32:35], v[64:67], v[240:255]
  s_waitcnt lgkmcnt(5)
  ds_read_b64_tr_b16 v[26:27], v1 offset:20736
  v_rcp_f32 v8, v8
  v_rcp_f32 v9, v9
  v_mul_f32 v84, v84, v8
  v_mul_f32 v85, v85, v9
  v_cvt_pk_bf16_f32 v82, v84, v85
  v_fmaak_f32 v10, v100, v100, 0x409d30fc
  v_fmaak_f32 v11, v101, v101, 0x409d30fc
  v_mul_f32 v10, v100, v10
  v_mul_f32 v11, v101, v11
  v_exp_f32 v10, -v10
  v_exp_f32 v11, -v11
  v_mfma_f32_32x32x16_bf16 v[192:207], v[36:39], v[56:59], v[192:207]
  ds_read_b64_tr_b16 v[28:29], v1 offset:21504
  v_fma_f32 v10, v10, s36, s36
  v_fma_f32 v11, v11, s36, s36
  v_rcp_f32 v10, v10
  v_rcp_f32 v11, v11
  v_mul_f32 v100, v100, v10
  v_mul_f32 v101, v101, v11
  v_cvt_pk_bf16_f32 v98, v100, v101
  v_fmaak_f32 v8, v86, v86, 0x409d30fc
  v_fmaak_f32 v9, v87, v87, 0x409d30fc
  v_mul_f32 v8, v86, v8
  v_mfma_f32_32x32x16_bf16 v[240:255], v[36:39], v[72:75], v[240:255]
  s_waitcnt lgkmcnt(5)
  ds_read_b64_tr_b16 v[30:31], v1 offset:21760
  v_mul_f32 v9, v87, v9
  v_exp_f32 v8, -v8
  v_exp_f32 v9, -v9
  v_fma_f32 v8, v8, s36, s36
  v_fma_f32 v9, v9, s36, s36
  v_rcp_f32 v8, v8
  v_rcp_f32 v9, v9
  v_mul_f32 v86, v86, v8
  v_mul_f32 v87, v87, v9
  v_mfma_f32_32x32x16_bf16 v[48:63], v[16:19], v[112:115], 0
  ds_read_b64_tr_b16 v[32:33], v1 offset:22528
  buffer_store_dwordx4 v[168:171], v2, s[28:31], s40 offen offset:192 sc1
  v_cvt_pk_bf16_f32 v83, v86, v87
  v_fmaak_f32 v10, v102, v102, 0x409d30fc
  v_fmaak_f32 v11, v103, v103, 0x409d30fc
  v_mul_f32 v10, v102, v10
  v_mul_f32 v11, v103, v11
  v_exp_f32 v10, -v10
  v_cvt_pk_bf16_f32 v176, v176, v177
  v_cvt_pk_bf16_f32 v177, v178, v179
  v_cvt_pk_bf16_f32 v178, v180, v181
  v_exp_f32 v11, -v11
  v_mfma_f32_32x32x16_bf16 v[64:79], v[16:19], v[136:139], 0
  s_waitcnt lgkmcnt(5)
  ds_read_b64_tr_b16 v[34:35], v1 offset:22784
  v_cvt_pk_bf16_f32 v179, v182, v183
  v_fma_f32 v10, v10, s36, s36
  v_fma_f32 v11, v11, s36, s36
  v_rcp_f32 v10, v10
  v_cvt_pk_bf16_f32 v184, v184, v185
  v_cvt_pk_bf16_f32 v185, v186, v187
  v_cvt_pk_bf16_f32 v186, v188, v189
  v_cvt_pk_bf16_f32 v187, v190, v191
  s_nop 1
  v_permlane16_swap_b32 v176, v184
  v_permlane16_swap_b32 v177, v185
  v_permlane16_swap_b32 v178, v186
  v_permlane16_swap_b32 v179, v187
  v_mfma_f32_32x32x16_bf16 v[48:63], v[20:23], v[116:119], v[48:63]
  ds_read_b64_tr_b16 v[36:37], v1 offset:23552
  buffer_store_dwordx4 v[176:179], v2, s[28:31], s40 offen offset:64 sc1
  v_rcp_f32 v11, v11
  v_mul_f32 v102, v102, v10
  v_mul_f32 v103, v103, v11
  v_cvt_pk_bf16_f32 v99, v102, v103
  v_fmaak_f32 v8, v88, v88, 0x409d30fc
  v_fmaak_f32 v9, v89, v89, 0x409d30fc
  v_mul_f32 v8, v88, v8
  v_mul_f32 v9, v89, v9
  v_exp_f32 v8, -v8
  v_exp_f32 v9, -v9
  v_mfma_f32_32x32x16_bf16 v[64:79], v[20:23], v[140:143], v[64:79]
  s_waitcnt lgkmcnt(5)
  ds_read_b64_tr_b16 v[38:39], v1 offset:23808
  v_fma_f32 v8, v8, s36, s36
  v_fma_f32 v9, v9, s36, s36
  v_rcp_f32 v8, v8
  v_rcp_f32 v9, v9
  v_mul_f32 v88, v88, v8
  v_mul_f32 v89, v89, v9
  v_cvt_pk_bf16_f32 v88, v88, v89
  v_fmaak_f32 v10, v104, v104, 0x409d30fc
  v_fmaak_f32 v11, v105, v105, 0x409d30fc
  v_mul_f32 v10, v104, v10
  v_mfma_f32_32x32x16_bf16 v[48:63], v[24:27], v[120:123], v[48:63]
  v_mul_f32 v11, v105, v11
  v_exp_f32 v10, -v10
  v_exp_f32 v11, -v11
  v_fma_f32 v10, v10, s36, s36
  v_fma_f32 v11, v11, s36, s36
  v_rcp_f32 v10, v10
  v_rcp_f32 v11, v11
  v_mul_f32 v104, v104, v10
  v_mul_f32 v105, v105, v11
  v_cvt_pk_bf16_f32 v104, v104, v105
  v_mfma_f32_32x32x16_bf16 v[64:79], v[24:27], v[144:147], v[64:79]
  s_waitcnt lgkmcnt(4)
  v_fmaak_f32 v8, v90, v90, 0x409d30fc
  v_fmaak_f32 v9, v91, v91, 0x409d30fc
  v_mul_f32 v8, v90, v8
  v_mul_f32 v9, v91, v9
  v_exp_f32 v8, -v8
  v_exp_f32 v9, -v9
  v_fma_f32 v8, v8, s36, s36
  v_fma_f32 v9, v9, s36, s36
  v_rcp_f32 v8, v8
  v_rcp_f32 v9, v9
  v_mfma_f32_32x32x16_bf16 v[48:63], v[28:31], v[124:127], v[48:63]
  s_waitcnt lgkmcnt(0)
  s_barrier
  ds_read_b64_tr_b16 v[16:17], v7 offset:24576
  ds_read_b64_tr_b16 v[18:19], v7 offset:26112
  v_mul_f32 v90, v90, v8
  v_mul_f32 v91, v91, v9
  v_cvt_pk_bf16_f32 v89, v90, v91
  v_fmaak_f32 v10, v106, v106, 0x409d30fc
  v_fmaak_f32 v11, v107, v107, 0x409d30fc
  v_mul_f32 v10, v106, v10
  v_mul_f32 v11, v107, v11
  v_exp_f32 v10, -v10
  v_exp_f32 v11, -v11
  v_mfma_f32_32x32x16_bf16 v[64:79], v[28:31], v[148:151], v[64:79]
  ds_read_b64_tr_b16 v[20:21], v7 offset:24640
  ds_read_b64_tr_b16 v[22:23], v7 offset:26176
  buffer_store_dwordx4 v[184:187], v2, s[28:31], s40 offen offset:256 sc1
  v_add_u32 v0, 0, v6
  v_fma_f32 v10, v10, s36, s36
  v_fma_f32 v11, v11, s36, s36
  v_rcp_f32 v10, v10
  v_rcp_f32 v11, v11
  v_mul_f32 v106, v106, v10
  v_mul_f32 v107, v107, v11
  v_cvt_pk_bf16_f32 v105, v106, v107
  v_fmaak_f32 v8, v92, v92, 0x409d30fc
  ds_read2_b32 v[40:41], v0 offset0:0 offset1:78
  ds_read2_b32 v[42:43], v0 offset0:156 offset1:234
  v_add_u32 v0, 2496, v6
  v_mfma_f32_32x32x16_bf16 v[48:63], v[32:35], v[128:131], v[48:63]
  ds_read_b64_tr_b16 v[24:25], v7 offset:27648
  ds_read2_b32 v[44:45], v0 offset0:0 offset1:78
  ds_read2_b32 v[46:47], v0 offset0:156 offset1:234
  v_fmaak_f32 v9, v93, v93, 0x409d30fc
  v_mul_f32 v8, v92, v8
  v_mul_f32 v9, v93, v9
  v_exp_f32 v8, -v8
  v_exp_f32 v9, -v9
  v_fma_f32 v8, v8, s36, s36
  v_fma_f32 v9, v9, s36, s36
  v_mfma_f32_32x32x16_bf16 v[64:79], v[32:35], v[152:155], v[64:79]
  ds_read_b64_tr_b16 v[26:27], v7 offset:29184
  v_rcp_f32 v8, v8
  v_rcp_f32 v9, v9
  v_mul_f32 v92, v92, v8
  v_mul_f32 v93, v93, v9
  v_cvt_pk_bf16_f32 v90, v92, v93
  v_fmaak_f32 v10, v108, v108, 0x409d30fc
  v_fmaak_f32 v11, v109, v109, 0x409d30fc
  v_mul_f32 v10, v108, v10
  v_mul_f32 v11, v109, v11
  v_exp_f32 v10, -v10
  v_mfma_f32_32x32x16_bf16 v[48:63], v[36:39], v[132:135], v[48:63]
  ds_read_b64_tr_b16 v[28:29], v7 offset:27712
  v_exp_f32 v11, -v11
  v_fma_f32 v10, v10, s36, s36
  v_fma_f32 v11, v11, s36, s36
  v_rcp_f32 v10, v10
  v_rcp_f32 v11, v11
  v_mul_f32 v108, v108, v10
  v_mul_f32 v109, v109, v11
  v_cvt_pk_bf16_f32 v106, v108, v109
  v_fmaak_f32 v8, v94, v94, 0x409d30fc
  v_fmaak_f32 v9, v95, v95, 0x409d30fc
  v_mfma_f32_32x32x16_bf16 v[64:79], v[36:39], v[156:159], v[64:79]
  s_waitcnt lgkmcnt(9)
  ds_read_b64_tr_b16 v[30:31], v7 offset:29248
  v_mul_f32 v8, v94, v8
  v_mul_f32 v9, v95, v9
  v_exp_f32 v8, -v8
  v_cvt_pk_bf16_f32 v192, v192, v193
  v_cvt_pk_bf16_f32 v193, v194, v195
  v_cvt_pk_bf16_f32 v194, v196, v197
  v_cvt_pk_bf16_f32 v195, v198, v199
  v_exp_f32 v9, -v9
  v_fma_f32 v8, v8, s36, s36
  v_fma_f32 v9, v9, s36, s36
  v_rcp_f32 v8, v8
  v_mfma_f32_32x32x16_bf16 v[160:175], v[16:19], v[80:83], 0
  ds_read_b64_tr_b16 v[32:33], v7 offset:24704
  v_cvt_pk_bf16_f32 v200, v200, v201
  v_cvt_pk_bf16_f32 v201, v202, v203
  v_cvt_pk_bf16_f32 v202, v204, v205
  v_cvt_pk_bf16_f32 v203, v206, v207
  s_nop 1
  v_permlane16_swap_b32 v192, v200
  v_permlane16_swap_b32 v193, v201
  v_permlane16_swap_b32 v194, v202
  v_permlane16_swap_b32 v195, v203
  v_rcp_f32 v9, v9
  v_mfma_f32_32x32x16_bf16 v[208:223], v[16:19], v[96:99], v[208:223]
  s_waitcnt lgkmcnt(4)
  ds_read_b64_tr_b16 v[34:35], v7 offset:26240
  buffer_store_dwordx4 v[192:195], v2, s[28:31], s40 offen offset:128 sc1
  v_mul_f32 v94, v94, v8
  v_mul_f32 v95, v95, v9
  v_cvt_pk_bf16_f32 v91, v94, v95
  v_fmaak_f32 v10, v110, v110, 0x409d30fc
  v_fmaak_f32 v11, v111, v111, 0x409d30fc
  v_mul_f32 v10, v110, v10
  v_mul_f32 v11, v111, v11
  v_exp_f32 v10, -v10
  v_exp_f32 v11, -v11
  v_smfmac_f32_32x32x32_bf16 v[160:175], v[12:15], v[40:47], v5
  v_fma_f32 v10, v10, s36, s36
  v_fma_f32 v11, v11, s36, s36
  v_rcp_f32 v10, v10
  v_rcp_f32 v11, v11
  v_mul_f32 v110, v110, v10
  v_mul_f32 v111, v111, v11
  v_cvt_pk_bf16_f32 v107, v110, v111
  v_fmaak_f32 v8, v48, v48, 0x409d30fc
  v_mfma_f32_32x32x16_bf16 v[176:191], v[20:23], v[80:83], 0
  ds_read_b64_tr_b16 v[36:37], v7 offset:27776
  v_add_u32 v0, 4992, v6
  v_fmaak_f32 v9, v49, v49, 0x409d30fc
  v_mul_f32 v8, v48, v8
  v_mul_f32 v9, v49, v9
  v_exp_f32 v8, -v8
  v_exp_f32 v9, -v9
  v_fma_f32 v8, v8, s36, s36
  v_fma_f32 v9, v9, s36, s36
  v_rcp_f32 v8, v8
  v_mfma_f32_32x32x16_bf16 v[224:239], v[20:23], v[96:99], v[224:239]
  s_waitcnt lgkmcnt(5)
  ds_read_b64_tr_b16 v[38:39], v7 offset:29312
  ds_read2_b32 v[40:41], v0 offset0:0 offset1:78
  ds_read2_b32 v[42:43], v0 offset0:156 offset1:234
  v_add_u32 v0, 7488, v6
  v_rcp_f32 v9, v9
  v_mul_f32 v48, v48, v8
  v_mul_f32 v49, v49, v9
  v_cvt_pk_bf16_f32 v48, v48, v49
  v_fmaak_f32 v10, v64, v64, 0x409d30fc
  v_fmaak_f32 v11, v65, v65, 0x409d30fc
  v_mfma_f32_32x32x16_bf16 v[160:175], v[24:27], v[88:91], v[160:175]
  ds_read_b64_tr_b16 v[16:17], v1 offset:30720
  ds_read2_b32 v[44:45], v0 offset0:0 offset1:78
  ds_read2_b32 v[46:47], v0 offset0:156 offset1:234
  v_mul_f32 v10, v64, v10
  v_mul_f32 v11, v65, v11
  v_exp_f32 v10, -v10
  v_exp_f32 v11, -v11
  v_fma_f32 v10, v10, s36, s36
  v_fma_f32 v11, v11, s36, s36
  v_rcp_f32 v10, v10
  v_mfma_f32_32x32x16_bf16 v[208:223], v[24:27], v[104:107], v[208:223]
  s_waitcnt lgkmcnt(9)
  ds_read_b64_tr_b16 v[18:19], v1 offset:30976
  v_rcp_f32 v11, v11
  v_mul_f32 v64, v64, v10
  v_mul_f32 v65, v65, v11
  v_cvt_pk_bf16_f32 v64, v64, v65
  v_fmaak_f32 v8, v50, v50, 0x409d30fc
  v_fmaak_f32 v9, v51, v51, 0x409d30fc
  v_mul_f32 v8, v50, v8
  v_mul_f32 v9, v51, v9
  v_exp_f32 v8, -v8
  v_mfma_f32_32x32x16_bf16 v[176:191], v[28:31], v[88:91], v[176:191]
  ds_read_b64_tr_b16 v[20:21], v1 offset:31744
  buffer_store_dwordx4 v[200:203], v2, s[28:31], s40 offen offset:320 sc1
  s_add_u32 s40, s40, s41
  v_exp_f32 v9, -v9
  v_fma_f32 v8, v8, s36, s36
  v_fma_f32 v9, v9, s36, s36
  v_rcp_f32 v8, v8
  v_rcp_f32 v9, v9
  v_mfma_f32_32x32x16_bf16 v[224:239], v[28:31], v[104:107], v[224:239]
  s_waitcnt lgkmcnt(2)
  ds_read_b64_tr_b16 v[22:23], v1 offset:32000
  v_mul_f32 v50, v50, v8
  v_mul_f32 v51, v51, v9
  v_cvt_pk_bf16_f32 v49, v50, v51
  v_fmaak_f32 v10, v66, v66, 0x409d30fc
  v_fmaak_f32 v11, v67, v67, 0x409d30fc
  v_mul_f32 v10, v66, v10
  v_mul_f32 v11, v67, v11
  v_exp_f32 v10, -v10
  v_exp_f32 v11, -v11
  v_smfmac_f32_32x32x32_bf16 v[176:191], v[12:15], v[40:47], v5
  v_fma_f32 v10, v10, s36, s36
  v_fma_f32 v11, v11, s36, s36
  v_rcp_f32 v10, v10
  v_rcp_f32 v11, v11
  v_mul_f32 v66, v66, v10
  v_mul_f32 v67, v67, v11
  v_cvt_pk_bf16_f32 v65, v66, v67
  v_fmaak_f32 v8, v52, v52, 0x409d30fc
  v_fmaak_f32 v9, v53, v53, 0x409d30fc
  v_mfma_f32_32x32x16_bf16 v[192:207], v[32:35], v[80:83], 0
  ds_read_b64_tr_b16 v[24:25], v1 offset:32768
  v_mul_f32 v8, v52, v8
  v_mul_f32 v9, v53, v9
  v_exp_f32 v8, -v8
  v_add_u32 v0, 9984, v6
  v_exp_f32 v9, -v9
  v_fma_f32 v8, v8, s36, s36
  v_fma_f32 v9, v9, s36, s36
  v_rcp_f32 v8, v8
  v_mfma_f32_32x32x16_bf16 v[240:255], v[32:35], v[96:99], v[240:255]
  ds_read_b64_tr_b16 v[26:27], v1 offset:33024
  ds_read2_b32 v[40:41], v0 offset0:0 offset1:78
  ds_read2_b32 v[42:43], v0 offset0:156 offset1:234
  v_rcp_f32 v9, v9
  v_mul_f32 v52, v52, v8
  v_mul_f32 v53, v53, v9
  v_add_u32 v0, 12480, v6
  v_cvt_pk_bf16_f32 v50, v52, v53
  v_fmaak_f32 v10, v68, v68, 0x409d30fc
  v_fmaak_f32 v11, v69, v69, 0x409d30fc
  v_mul_f32 v10, v68, v10
  v_mfma_f32_32x32x16_bf16 v[192:207], v[36:39], v[88:91], v[192:207]
  ds_read_b64_tr_b16 v[28:29], v1 offset:33792
  ds_read2_b32 v[44:45], v0 offset0:0 offset1:78
  ds_read2_b32 v[46:47], v0 offset0:156 offset1:234
  v_mul_f32 v11, v69, v11
  v_exp_f32 v10, -v10
  v_exp_f32 v11, -v11
  v_fma_f32 v10, v10, s36, s36
  v_fma_f32 v11, v11, s36, s36
  v_rcp_f32 v10, v10
  v_mfma_f32_32x32x16_bf16 v[240:255], v[36:39], v[104:107], v[240:255]
  s_waitcnt lgkmcnt(9)
  ds_read_b64_tr_b16 v[30:31], v1 offset:34048
  v_rcp_f32 v11, v11
  v_mul_f32 v68, v68, v10
  v_mul_f32 v69, v69, v11
  v_cvt_pk_bf16_f32 v66, v68, v69
  v_fmaak_f32 v8, v54, v54, 0x409d30fc
  v_fmaak_f32 v9, v55, v55, 0x409d30fc
  v_mul_f32 v8, v54, v8
  v_mul_f32 v9, v55, v9
  v_exp_f32 v8, -v8
  v_mfma_f32_32x32x16_bf16 v[80:95], v[16:19], v[112:115], 0
  ds_read_b64_tr_b16 v[32:33], v1 offset:34816
  v_exp_f32 v9, -v9
  v_fma_f32 v8, v8, s36, s36
  v_fma_f32 v9, v9, s36, s36
  v_rcp_f32 v8, v8
  v_rcp_f32 v9, v9
  v_mul_f32 v54, v54, v8
  v_mul_f32 v55, v55, v9
  v_cvt_pk_bf16_f32 v51, v54, v55
  v_mfma_f32_32x32x16_bf16 v[96:111], v[16:19], v[136:139], 0
  s_waitcnt lgkmcnt(9)
  ds_read_b64_tr_b16 v[34:35], v1 offset:35072
  v_fmaak_f32 v10, v70, v70, 0x409d30fc
  v_fmaak_f32 v11, v71, v71, 0x409d30fc
  v_mul_f32 v10, v70, v10
  v_mul_f32 v11, v71, v11
  v_exp_f32 v10, -v10
  v_exp_f32 v11, -v11
  v_fma_f32 v10, v10, s36, s36
  v_fma_f32 v11, v11, s36, s36
  v_rcp_f32 v10, v10
  v_mfma_f32_32x32x16_bf16 v[80:95], v[20:23], v[116:119], v[80:95]
  ds_read_b64_tr_b16 v[36:37], v1 offset:35840
  v_rcp_f32 v11, v11
  v_mul_f32 v70, v70, v10
  v_mul_f32 v71, v71, v11
  v_cvt_pk_bf16_f32 v67, v70, v71
  v_fmaak_f32 v8, v56, v56, 0x409d30fc
  v_fmaak_f32 v9, v57, v57, 0x409d30fc
  v_mul_f32 v8, v56, v8
  v_mul_f32 v9, v57, v9
  v_exp_f32 v8, -v8
  v_mfma_f32_32x32x16_bf16 v[96:111], v[20:23], v[140:143], v[96:111]
  s_waitcnt lgkmcnt(9)
  ds_read_b64_tr_b16 v[38:39], v1 offset:36096
  v_exp_f32 v9, -v9
  v_fma_f32 v8, v8, s36, s36
  v_fma_f32 v9, v9, s36, s36
  v_rcp_f32 v8, v8
  v_rcp_f32 v9, v9
  v_mul_f32 v56, v56, v8
  v_mul_f32 v57, v57, v9
  v_mfma_f32_32x32x16_bf16 v[80:95], v[24:27], v[120:123], v[80:95]
  v_cvt_pk_bf16_f32 v56, v56, v57
  v_fmaak_f32 v10, v72, v72, 0x409d30fc
  v_fmaak_f32 v11, v73, v73, 0x409d30fc
  v_mul_f32 v10, v72, v10
  v_mul_f32 v11, v73, v11
  v_exp_f32 v10, -v10
  v_exp_f32 v11, -v11
  v_fma_f32 v10, v10, s36, s36
  v_fma_f32 v11, v11, s36, s36
  v_rcp_f32 v10, v10
  v_mfma_f32_32x32x16_bf16 v[96:111], v[24:27], v[144:147], v[96:111]
  s_waitcnt lgkmcnt(5)
  v_rcp_f32 v11, v11
  v_mul_f32 v72, v72, v10
  v_mul_f32 v73, v73, v11
  v_cvt_pk_bf16_f32 v72, v72, v73
  v_fmaak_f32 v8, v58, v58, 0x409d30fc
  v_fmaak_f32 v9, v59, v59, 0x409d30fc
  v_mul_f32 v8, v58, v8
  v_mul_f32 v9, v59, v9
  v_exp_f32 v8, -v8
  v_smfmac_f32_32x32x32_bf16 v[192:207], v[12:15], v[40:47], v5
  s_waitcnt lgkmcnt(0)
  s_barrier
  ds_read_b64_tr_b16 v[16:17], v7 offset:0
  ds_read_b64_tr_b16 v[18:19], v7 offset:1536
  v_exp_f32 v9, -v9
  v_fma_f32 v8, v8, s36, s36
  v_fma_f32 v9, v9, s36, s36
  v_rcp_f32 v8, v8
  v_rcp_f32 v9, v9
  v_mfma_f32_32x32x16_bf16 v[80:95], v[28:31], v[124:127], v[80:95]
  ds_read_b64_tr_b16 v[20:21], v7 offset:64
  v_mul_f32 v58, v58, v8
  v_mul_f32 v59, v59, v9
  v_cvt_pk_bf16_f32 v57, v58, v59
  v_fmaak_f32 v10, v74, v74, 0x409d30fc
  v_fmaak_f32 v11, v75, v75, 0x409d30fc
  v_mul_f32 v10, v74, v10
  v_mul_f32 v11, v75, v11
  v_exp_f32 v10, -v10
  v_exp_f32 v11, -v11
  v_mfma_f32_32x32x16_bf16 v[96:111], v[28:31], v[148:151], v[96:111]
  ds_read_b64_tr_b16 v[22:23], v7 offset:1600
  v_fma_f32 v10, v10, s36, s36
  v_fma_f32 v11, v11, s36, s36
  v_rcp_f32 v10, v10
  v_rcp_f32 v11, v11
  v_mul_f32 v74, v74, v10
  v_mul_f32 v75, v75, v11
  v_cvt_pk_bf16_f32 v73, v74, v75
  v_fmaak_f32 v8, v60, v60, 0x409d30fc
  v_fmaak_f32 v9, v61, v61, 0x409d30fc
  v_mfma_f32_32x32x16_bf16 v[80:95], v[32:35], v[128:131], v[80:95]
  ds_read_b64_tr_b16 v[24:25], v7 offset:3072
  v_mul_f32 v8, v60, v8
  v_mul_f32 v9, v61, v9
  v_exp_f32 v8, -v8
  v_exp_f32 v9, -v9
  v_fma_f32 v8, v8, s36, s36
  v_fma_f32 v9, v9, s36, s36
  v_rcp_f32 v8, v8
  v_rcp_f32 v9, v9
  v_mfma_f32_32x32x16_bf16 v[96:111], v[32:35], v[152:155], v[96:111]
  ds_read_b64_tr_b16 v[26:27], v7 offset:4608
  v_mul_f32 v60, v60, v8
  v_mul_f32 v61, v61, v9
  v_cvt_pk_bf16_f32 v58, v60, v61
  v_fmaak_f32 v10, v76, v76, 0x409d30fc
  v_fmaak_f32 v11, v77, v77, 0x409d30fc
  v_mul_f32 v10, v76, v10
  v_mul_f32 v11, v77, v11
  v_exp_f32 v10, -v10
  v_exp_f32 v11, -v11
  v_mfma_f32_32x32x16_bf16 v[80:95], v[36:39], v[132:135], v[80:95]
  ds_read_b64_tr_b16 v[28:29], v7 offset:3136
  v_fma_f32 v10, v10, s36, s36
  v_fma_f32 v11, v11, s36, s36
  v_rcp_f32 v10, v10
  v_rcp_f32 v11, v11
  v_mul_f32 v76, v76, v10
  v_mul_f32 v77, v77, v11
  v_cvt_pk_bf16_f32 v74, v76, v77
  v_fmaak_f32 v8, v62, v62, 0x409d30fc
  v_mfma_f32_32x32x16_bf16 v[96:111], v[36:39], v[156:159], v[96:111]
  s_waitcnt lgkmcnt(5)
  ds_read_b64_tr_b16 v[30:31], v7 offset:4672
  v_fmaak_f32 v9, v63, v63, 0x409d30fc
  v_mul_f32 v8, v62, v8
  v_mul_f32 v9, v63, v9
  v_exp_f32 v8, -v8
  v_exp_f32 v9, -v9
  v_fma_f32 v8, v8, s36, s36
  v_fma_f32 v9, v9, s36, s36
  v_rcp_f32 v8, v8
  v_mfma_f32_32x32x16_bf16 v[160:175], v[16:19], v[48:51], v[160:175]
  ds_read_b64_tr_b16 v[32:33], v7 offset:128
  v_rcp_f32 v9, v9
  v_mul_f32 v62, v62, v8
  v_mul_f32 v63, v63, v9
  v_cvt_pk_bf16_f32 v59, v62, v63
  v_fmaak_f32 v10, v78, v78, 0x409d30fc
  v_fmaak_f32 v11, v79, v79, 0x409d30fc
  v_mul_f32 v10, v78, v10
  v_mul_f32 v11, v79, v11
  v_exp_f32 v10, -v10
  v_exp_f32 v11, -v11
  v_mfma_f32_32x32x16_bf16 v[208:223], v[16:19], v[64:67], v[208:223]
  s_waitcnt lgkmcnt(5)
  ds_read_b64_tr_b16 v[34:35], v7 offset:1664
  v_fma_f32 v10, v10, s36, s36
  v_fma_f32 v11, v11, s36, s36
  v_rcp_f32 v10, v10
  v_rcp_f32 v11, v11
  v_mul_f32 v78, v78, v10
  v_mul_f32 v79, v79, v11
  v_cvt_pk_bf16_f32 v75, v78, v79
  v_fmaak_f32 v8, v80, v80, 0x409d30fc
  v_mfma_f32_32x32x16_bf16 v[176:191], v[20:23], v[48:51], v[176:191]
  ds_read_b64_tr_b16 v[36:37], v7 offset:3200
  v_fmaak_f32 v9, v81, v81, 0x409d30fc
  v_mul_f32 v8, v80, v8
  v_mul_f32 v9, v81, v9
  v_exp_f32 v8, -v8
  v_exp_f32 v9, -v9
  v_fma_f32 v8, v8, s36, s36
  v_fma_f32 v9, v9, s36, s36
  v_rcp_f32 v8, v8
  v_mfma_f32_32x32x16_bf16 v[224:239], v[20:23], v[64:67], v[224:239]
  s_waitcnt lgkmcnt(5)
  ds_read_b64_tr_b16 v[38:39], v7 offset:4736
  v_rcp_f32 v9, v9
  v_mul_f32 v80, v80, v8
  v_mul_f32 v81, v81, v9
  v_cvt_pk_bf16_f32 v80, v80, v81
  v_fmaak_f32 v10, v96, v96, 0x409d30fc
  v_fmaak_f32 v11, v97, v97, 0x409d30fc
  v_mul_f32 v10, v96, v10
  v_mul_f32 v11, v97, v11
  v_exp_f32 v10, -v10
  v_exp_f32 v11, -v11
  v_mfma_f32_32x32x16_bf16 v[160:175], v[24:27], v[56:59], v[160:175]
  ds_read_b64_tr_b16 v[16:17], v1 offset:6144
  v_fma_f32 v10, v10, s36, s36
  v_fma_f32 v11, v11, s36, s36
  v_rcp_f32 v10, v10
  v_rcp_f32 v11, v11
  v_mul_f32 v96, v96, v10
  v_mul_f32 v97, v97, v11
  v_cvt_pk_bf16_f32 v96, v96, v97
  v_fmaak_f32 v8, v82, v82, 0x409d30fc
  v_mfma_f32_32x32x16_bf16 v[208:223], v[24:27], v[72:75], v[208:223]
  s_waitcnt lgkmcnt(5)
  ds_read_b64_tr_b16 v[18:19], v1 offset:6400
  v_fmaak_f32 v9, v83, v83, 0x409d30fc
  v_mul_f32 v8, v82, v8
  v_mul_f32 v9, v83, v9
  v_exp_f32 v8, -v8
  v_exp_f32 v9, -v9
  v_fma_f32 v8, v8, s36, s36
  v_fma_f32 v9, v9, s36, s36
  v_rcp_f32 v8, v8
  v_mfma_f32_32x32x16_bf16 v[176:191], v[28:31], v[56:59], v[176:191]
  ds_read_b64_tr_b16 v[20:21], v1 offset:7168
  v_rcp_f32 v9, v9
  v_mul_f32 v82, v82, v8
  v_mul_f32 v83, v83, v9
  v_cvt_pk_bf16_f32 v81, v82, v83
  v_fmaak_f32 v10, v98, v98, 0x409d30fc
  v_fmaak_f32 v11, v99, v99, 0x409d30fc
  v_mul_f32 v10, v98, v10
  v_mul_f32 v11, v99, v11
  v_exp_f32 v10, -v10
  v_exp_f32 v11, -v11
  v_mfma_f32_32x32x16_bf16 v[224:239], v[28:31], v[72:75], v[224:239]
  s_waitcnt lgkmcnt(5)
  ds_read_b64_tr_b16 v[22:23], v1 offset:7424
  v_fma_f32 v10, v10, s36, s36
  v_fma_f32 v11, v11, s36, s36
  v_rcp_f32 v10, v10
  v_rcp_f32 v11, v11
  v_mul_f32 v98, v98, v10
  v_mul_f32 v99, v99, v11
  v_cvt_pk_bf16_f32 v97, v98, v99
  v_fmaak_f32 v8, v84, v84, 0x409d30fc
  v_mfma_f32_32x32x16_bf16 v[192:207], v[32:35], v[48:51], v[192:207]
  ds_read_b64_tr_b16 v[24:25], v1 offset:8192
  v_fmaak_f32 v9, v85, v85, 0x409d30fc
  v_mul_f32 v8, v84, v8
  v_mul_f32 v9, v85, v9
  v_exp_f32 v8, -v8
  v_exp_f32 v9, -v9
  v_fma_f32 v8, v8, s36, s36
  v_fma_f32 v9, v9, s36, s36
  v_rcp_f32 v8, v8
  v_mfma_f32_32x32x16_bf16 v[240:255], v[32:35], v[64:67], v[240:255]
  s_waitcnt lgkmcnt(5)
  ds_read_b64_tr_b16 v[26:27], v1 offset:8448
  v_rcp_f32 v9, v9
  v_mul_f32 v84, v84, v8
  v_mul_f32 v85, v85, v9
  v_cvt_pk_bf16_f32 v82, v84, v85
  v_fmaak_f32 v10, v100, v100, 0x409d30fc
  v_fmaak_f32 v11, v101, v101, 0x409d30fc
  v_mul_f32 v10, v100, v10
  v_mul_f32 v11, v101, v11
  v_exp_f32 v10, -v10
  v_exp_f32 v11, -v11
  v_mfma_f32_32x32x16_bf16 v[192:207], v[36:39], v[56:59], v[192:207]
  ds_read_b64_tr_b16 v[28:29], v1 offset:9216
  v_fma_f32 v10, v10, s36, s36
  v_fma_f32 v11, v11, s36, s36
  v_rcp_f32 v10, v10
  v_rcp_f32 v11, v11
  v_mul_f32 v100, v100, v10
  v_mul_f32 v101, v101, v11
  v_cvt_pk_bf16_f32 v98, v100, v101
  v_fmaak_f32 v8, v86, v86, 0x409d30fc
  v_mfma_f32_32x32x16_bf16 v[240:255], v[36:39], v[72:75], v[240:255]
  s_waitcnt lgkmcnt(5)
  ds_read_b64_tr_b16 v[30:31], v1 offset:9472
  v_fmaak_f32 v9, v87, v87, 0x409d30fc
  v_mul_f32 v8, v86, v8
  v_mul_f32 v9, v87, v9
  v_exp_f32 v8, -v8
  v_exp_f32 v9, -v9
  v_fma_f32 v8, v8, s36, s36
  v_fma_f32 v9, v9, s36, s36
  v_rcp_f32 v8, v8
  v_mfma_f32_32x32x16_bf16 v[48:63], v[16:19], v[112:115], 0
  ds_read_b64_tr_b16 v[32:33], v1 offset:10240
  v_rcp_f32 v9, v9
  v_mul_f32 v86, v86, v8
  v_mul_f32 v87, v87, v9
  v_cvt_pk_bf16_f32 v83, v86, v87
  v_fmaak_f32 v10, v102, v102, 0x409d30fc
  v_fmaak_f32 v11, v103, v103, 0x409d30fc
  v_mul_f32 v10, v102, v10
  v_mul_f32 v11, v103, v11
  v_exp_f32 v10, -v10
  v_exp_f32 v11, -v11
  v_mfma_f32_32x32x16_bf16 v[64:79], v[16:19], v[136:139], 0
  s_waitcnt lgkmcnt(5)
  ds_read_b64_tr_b16 v[34:35], v1 offset:10496
  v_fma_f32 v10, v10, s36, s36
  v_fma_f32 v11, v11, s36, s36
  v_rcp_f32 v10, v10
  v_rcp_f32 v11, v11
  v_mul_f32 v102, v102, v10
  v_mul_f32 v103, v103, v11
  v_cvt_pk_bf16_f32 v99, v102, v103
  v_fmaak_f32 v8, v88, v88, 0x409d30fc
  v_mfma_f32_32x32x16_bf16 v[48:63], v[20:23], v[116:119], v[48:63]
  ds_read_b64_tr_b16 v[36:37], v1 offset:11264
  v_fmaak_f32 v9, v89, v89, 0x409d30fc
  v_mul_f32 v8, v88, v8
  v_mul_f32 v9, v89, v9
  v_exp_f32 v8, -v8
  v_exp_f32 v9, -v9
  v_fma_f32 v8, v8, s36, s36
  v_fma_f32 v9, v9, s36, s36
  v_rcp_f32 v8, v8
  v_mfma_f32_32x32x16_bf16 v[64:79], v[20:23], v[140:143], v[64:79]
  s_waitcnt lgkmcnt(5)
  ds_read_b64_tr_b16 v[38:39], v1 offset:11520
  v_rcp_f32 v9, v9
  v_mul_f32 v88, v88, v8
  v_mul_f32 v89, v89, v9
  v_cvt_pk_bf16_f32 v88, v88, v89
  v_fmaak_f32 v10, v104, v104, 0x409d30fc
  v_fmaak_f32 v11, v105, v105, 0x409d30fc
  v_mul_f32 v10, v104, v10
  v_mul_f32 v11, v105, v11
  v_exp_f32 v10, -v10
  v_exp_f32 v11, -v11
  v_mfma_f32_32x32x16_bf16 v[48:63], v[24:27], v[120:123], v[48:63]
  v_fma_f32 v10, v10, s36, s36
  v_fma_f32 v11, v11, s36, s36
  v_rcp_f32 v10, v10
  v_rcp_f32 v11, v11
  v_mul_f32 v104, v104, v10
  v_mul_f32 v105, v105, v11
  v_cvt_pk_bf16_f32 v104, v104, v105
  v_fmaak_f32 v8, v90, v90, 0x409d30fc
  v_fmaak_f32 v9, v91, v91, 0x409d30fc
  v_mfma_f32_32x32x16_bf16 v[64:79], v[24:27], v[144:147], v[64:79]
  s_waitcnt lgkmcnt(4)
  v_mul_f32 v8, v90, v8
  v_mul_f32 v9, v91, v9
  v_exp_f32 v8, -v8
  v_exp_f32 v9, -v9
  v_fma_f32 v8, v8, s36, s36
  v_fma_f32 v9, v9, s36, s36
  v_rcp_f32 v8, v8
  v_rcp_f32 v9, v9
  v_mfma_f32_32x32x16_bf16 v[48:63], v[28:31], v[124:127], v[48:63]
  s_waitcnt lgkmcnt(0)
  s_barrier
  ds_read_b64_tr_b16 v[16:17], v7 offset:12288
  ds_read_b64_tr_b16 v[18:19], v7 offset:13824
  v_mul_f32 v90, v90, v8
  v_mul_f32 v91, v91, v9
  v_cvt_pk_bf16_f32 v89, v90, v91
  v_fmaak_f32 v10, v106, v106, 0x409d30fc
  v_fmaak_f32 v11, v107, v107, 0x409d30fc
  v_mul_f32 v10, v106, v10
  v_mul_f32 v11, v107, v11
  v_exp_f32 v10, -v10
  v_exp_f32 v11, -v11
  v_mfma_f32_32x32x16_bf16 v[64:79], v[28:31], v[148:151], v[64:79]
  ds_read_b64_tr_b16 v[20:21], v7 offset:12352
  ds_read_b64_tr_b16 v[22:23], v7 offset:13888
  v_fma_f32 v10, v10, s36, s36
  v_fma_f32 v11, v11, s36, s36
  v_rcp_f32 v10, v10
  v_rcp_f32 v11, v11
  v_mul_f32 v106, v106, v10
  v_mul_f32 v107, v107, v11
  v_cvt_pk_bf16_f32 v105, v106, v107
  v_mfma_f32_32x32x16_bf16 v[48:63], v[32:35], v[128:131], v[48:63]
  ds_read_b64_tr_b16 v[24:25], v7 offset:15360
  v_fmaak_f32 v8, v92, v92, 0x409d30fc
  v_fmaak_f32 v9, v93, v93, 0x409d30fc
  v_mul_f32 v8, v92, v8
  v_mul_f32 v9, v93, v9
  v_exp_f32 v8, -v8
  v_exp_f32 v9, -v9
  v_fma_f32 v8, v8, s36, s36
  v_fma_f32 v9, v9, s36, s36
  v_rcp_f32 v8, v8
  v_mfma_f32_32x32x16_bf16 v[64:79], v[32:35], v[152:155], v[64:79]
  ds_read_b64_tr_b16 v[26:27], v7 offset:16896
  v_rcp_f32 v9, v9
  v_mul_f32 v92, v92, v8
  v_mul_f32 v93, v93, v9
  v_cvt_pk_bf16_f32 v90, v92, v93
  v_fmaak_f32 v10, v108, v108, 0x409d30fc
  v_fmaak_f32 v11, v109, v109, 0x409d30fc
  v_mul_f32 v10, v108, v10
  v_mul_f32 v11, v109, v11
  v_exp_f32 v10, -v10
  v_mfma_f32_32x32x16_bf16 v[48:63], v[36:39], v[132:135], v[48:63]
  ds_read_b64_tr_b16 v[28:29], v7 offset:15424
  v_exp_f32 v11, -v11
  v_fma_f32 v10, v10, s36, s36
  v_fma_f32 v11, v11, s36, s36
  v_rcp_f32 v10, v10
  v_rcp_f32 v11, v11
  v_mul_f32 v108, v108, v10
  v_mul_f32 v109, v109, v11
  v_cvt_pk_bf16_f32 v106, v108, v109
  v_mfma_f32_32x32x16_bf16 v[64:79], v[36:39], v[156:159], v[64:79]
  s_waitcnt lgkmcnt(5)
  ds_read_b64_tr_b16 v[30:31], v7 offset:16960
  v_fmaak_f32 v8, v94, v94, 0x409d30fc
  v_fmaak_f32 v9, v95, v95, 0x409d30fc
  v_mul_f32 v8, v94, v8
  v_mul_f32 v9, v95, v9
  v_exp_f32 v8, -v8
  v_exp_f32 v9, -v9
  v_fma_f32 v8, v8, s36, s36
  v_fma_f32 v9, v9, s36, s36
  v_rcp_f32 v8, v8
  v_mfma_f32_32x32x16_bf16 v[160:175], v[16:19], v[80:83], v[160:175]
  ds_read_b64_tr_b16 v[32:33], v7 offset:12416
  v_rcp_f32 v9, v9
  v_mul_f32 v94, v94, v8
  v_mul_f32 v95, v95, v9
  v_cvt_pk_bf16_f32 v91, v94, v95
  v_fmaak_f32 v10, v110, v110, 0x409d30fc
  v_fmaak_f32 v11, v111, v111, 0x409d30fc
  v_mul_f32 v10, v110, v10
  v_mul_f32 v11, v111, v11
  v_exp_f32 v10, -v10
  v_exp_f32 v11, -v11
  v_mfma_f32_32x32x16_bf16 v[208:223], v[16:19], v[96:99], v[208:223]
  s_waitcnt lgkmcnt(5)
  ds_read_b64_tr_b16 v[34:35], v7 offset:13952
  v_fma_f32 v10, v10, s36, s36
  v_fma_f32 v11, v11, s36, s36
  v_rcp_f32 v10, v10
  v_rcp_f32 v11, v11
  v_mul_f32 v110, v110, v10
  v_mul_f32 v111, v111, v11
  v_cvt_pk_bf16_f32 v107, v110, v111
  v_fmaak_f32 v8, v48, v48, 0x409d30fc
  v_mfma_f32_32x32x16_bf16 v[176:191], v[20:23], v[80:83], v[176:191]
  ds_read_b64_tr_b16 v[36:37], v7 offset:15488
  v_fmaak_f32 v9, v49, v49, 0x409d30fc
  v_mul_f32 v8, v48, v8
  v_mul_f32 v9, v49, v9
  v_exp_f32 v8, -v8
  v_exp_f32 v9, -v9
  v_fma_f32 v8, v8, s36, s36
  v_fma_f32 v9, v9, s36, s36
  v_rcp_f32 v8, v8
  v_mfma_f32_32x32x16_bf16 v[224:239], v[20:23], v[96:99], v[224:239]
  s_waitcnt lgkmcnt(5)
  ds_read_b64_tr_b16 v[38:39], v7 offset:17024
  v_rcp_f32 v9, v9
  v_mul_f32 v48, v48, v8
  v_mul_f32 v49, v49, v9
  v_cvt_pk_bf16_f32 v48, v48, v49
  v_fmaak_f32 v10, v64, v64, 0x409d30fc
  v_fmaak_f32 v11, v65, v65, 0x409d30fc
  v_mul_f32 v10, v64, v10
  v_mul_f32 v11, v65, v11
  v_exp_f32 v10, -v10
  v_exp_f32 v11, -v11
  v_mfma_f32_32x32x16_bf16 v[160:175], v[24:27], v[88:91], v[160:175]
  ds_read_b64_tr_b16 v[16:17], v1 offset:18432
  v_fma_f32 v10, v10, s36, s36
  v_fma_f32 v11, v11, s36, s36
  v_rcp_f32 v10, v10
  v_rcp_f32 v11, v11
  v_mul_f32 v64, v64, v10
  v_mul_f32 v65, v65, v11
  v_cvt_pk_bf16_f32 v64, v64, v65
  v_fmaak_f32 v8, v50, v50, 0x409d30fc
  v_mfma_f32_32x32x16_bf16 v[208:223], v[24:27], v[104:107], v[208:223]
  s_waitcnt lgkmcnt(5)
  ds_read_b64_tr_b16 v[18:19], v1 offset:18688
  v_fmaak_f32 v9, v51, v51, 0x409d30fc
  v_mul_f32 v8, v50, v8
  v_mul_f32 v9, v51, v9
  v_exp_f32 v8, -v8
  v_exp_f32 v9, -v9
  v_fma_f32 v8, v8, s36, s36
  v_fma_f32 v9, v9, s36, s36
  v_rcp_f32 v8, v8
  v_mfma_f32_32x32x16_bf16 v[176:191], v[28:31], v[88:91], v[176:191]
  ds_read_b64_tr_b16 v[20:21], v1 offset:19456
  v_rcp_f32 v9, v9
  v_mul_f32 v50, v50, v8
  v_mul_f32 v51, v51, v9
  v_cvt_pk_bf16_f32 v49, v50, v51
  v_fmaak_f32 v10, v66, v66, 0x409d30fc
  v_fmaak_f32 v11, v67, v67, 0x409d30fc
  v_mul_f32 v10, v66, v10
  v_mul_f32 v11, v67, v11
  v_exp_f32 v10, -v10
  v_exp_f32 v11, -v11
  v_mfma_f32_32x32x16_bf16 v[224:239], v[28:31], v[104:107], v[224:239]
  s_waitcnt lgkmcnt(5)
  ds_read_b64_tr_b16 v[22:23], v1 offset:19712
  v_fma_f32 v10, v10, s36, s36
  v_fma_f32 v11, v11, s36, s36
  v_rcp_f32 v10, v10
  v_rcp_f32 v11, v11
  v_mul_f32 v66, v66, v10
  v_mul_f32 v67, v67, v11
  v_cvt_pk_bf16_f32 v65, v66, v67
  v_fmaak_f32 v8, v52, v52, 0x409d30fc
  v_mfma_f32_32x32x16_bf16 v[192:207], v[32:35], v[80:83], v[192:207]
  ds_read_b64_tr_b16 v[24:25], v1 offset:20480
  v_fmaak_f32 v9, v53, v53, 0x409d30fc
  v_mul_f32 v8, v52, v8
  v_mul_f32 v9, v53, v9
  v_exp_f32 v8, -v8
  v_exp_f32 v9, -v9
  v_fma_f32 v8, v8, s36, s36
  v_fma_f32 v9, v9, s36, s36
  v_rcp_f32 v8, v8
  v_mfma_f32_32x32x16_bf16 v[240:255], v[32:35], v[96:99], v[240:255]
  s_waitcnt lgkmcnt(5)
  ds_read_b64_tr_b16 v[26:27], v1 offset:20736
  v_rcp_f32 v9, v9
  v_mul_f32 v52, v52, v8
  v_mul_f32 v53, v53, v9
  v_cvt_pk_bf16_f32 v50, v52, v53
  v_fmaak_f32 v10, v68, v68, 0x409d30fc
  v_fmaak_f32 v11, v69, v69, 0x409d30fc
  v_mul_f32 v10, v68, v10
  v_mul_f32 v11, v69, v11
  v_exp_f32 v10, -v10
  v_exp_f32 v11, -v11
  v_mfma_f32_32x32x16_bf16 v[192:207], v[36:39], v[88:91], v[192:207]
  ds_read_b64_tr_b16 v[28:29], v1 offset:21504
  v_fma_f32 v10, v10, s36, s36
  v_fma_f32 v11, v11, s36, s36
  v_rcp_f32 v10, v10
  v_rcp_f32 v11, v11
  v_mul_f32 v68, v68, v10
  v_mul_f32 v69, v69, v11
  v_cvt_pk_bf16_f32 v66, v68, v69
  v_fmaak_f32 v8, v54, v54, 0x409d30fc
  v_mfma_f32_32x32x16_bf16 v[240:255], v[36:39], v[104:107], v[240:255]
  s_waitcnt lgkmcnt(5)
  ds_read_b64_tr_b16 v[30:31], v1 offset:21760
  v_fmaak_f32 v9, v55, v55, 0x409d30fc
  v_mul_f32 v8, v54, v8
  v_mul_f32 v9, v55, v9
  v_exp_f32 v8, -v8
  v_exp_f32 v9, -v9
  v_fma_f32 v8, v8, s36, s36
  v_fma_f32 v9, v9, s36, s36
  v_rcp_f32 v8, v8
  v_mfma_f32_32x32x16_bf16 v[80:95], v[16:19], v[112:115], 0
  ds_read_b64_tr_b16 v[32:33], v1 offset:22528
  v_rcp_f32 v9, v9
  v_mul_f32 v54, v54, v8
  v_mul_f32 v55, v55, v9
  v_cvt_pk_bf16_f32 v51, v54, v55
  v_fmaak_f32 v10, v70, v70, 0x409d30fc
  v_fmaak_f32 v11, v71, v71, 0x409d30fc
  v_mul_f32 v10, v70, v10
  v_mul_f32 v11, v71, v11
  v_exp_f32 v10, -v10
  v_exp_f32 v11, -v11
  v_mfma_f32_32x32x16_bf16 v[96:111], v[16:19], v[136:139], 0
  s_waitcnt lgkmcnt(5)
  ds_read_b64_tr_b16 v[34:35], v1 offset:22784
  v_fma_f32 v10, v10, s36, s36
  v_fma_f32 v11, v11, s36, s36
  v_rcp_f32 v10, v10
  v_rcp_f32 v11, v11
  v_mul_f32 v70, v70, v10
  v_mul_f32 v71, v71, v11
  v_cvt_pk_bf16_f32 v67, v70, v71
  v_fmaak_f32 v8, v56, v56, 0x409d30fc
  v_mfma_f32_32x32x16_bf16 v[80:95], v[20:23], v[116:119], v[80:95]
  ds_read_b64_tr_b16 v[36:37], v1 offset:23552
  v_fmaak_f32 v9, v57, v57, 0x409d30fc
  v_mul_f32 v8, v56, v8
  v_mul_f32 v9, v57, v9
  v_exp_f32 v8, -v8
  v_exp_f32 v9, -v9
  v_fma_f32 v8, v8, s36, s36
  v_fma_f32 v9, v9, s36, s36
  v_rcp_f32 v8, v8
  v_mfma_f32_32x32x16_bf16 v[96:111], v[20:23], v[140:143], v[96:111]
  s_waitcnt lgkmcnt(5)
  ds_read_b64_tr_b16 v[38:39], v1 offset:23808
  v_rcp_f32 v9, v9
  v_mul_f32 v56, v56, v8
  v_mul_f32 v57, v57, v9
  v_cvt_pk_bf16_f32 v56, v56, v57
  v_fmaak_f32 v10, v72, v72, 0x409d30fc
  v_fmaak_f32 v11, v73, v73, 0x409d30fc
  v_mul_f32 v10, v72, v10
  v_mul_f32 v11, v73, v11
  v_exp_f32 v10, -v10
  v_exp_f32 v11, -v11
  v_mfma_f32_32x32x16_bf16 v[80:95], v[24:27], v[120:123], v[80:95]
  v_fma_f32 v10, v10, s36, s36
  v_fma_f32 v11, v11, s36, s36
  v_rcp_f32 v10, v10
  v_rcp_f32 v11, v11
  v_mul_f32 v72, v72, v10
  v_mul_f32 v73, v73, v11
  v_cvt_pk_bf16_f32 v72, v72, v73
  v_fmaak_f32 v8, v58, v58, 0x409d30fc
  v_fmaak_f32 v9, v59, v59, 0x409d30fc
  v_mfma_f32_32x32x16_bf16 v[96:111], v[24:27], v[144:147], v[96:111]
  s_waitcnt lgkmcnt(4)
  v_mul_f32 v8, v58, v8
  v_mul_f32 v9, v59, v9
  v_exp_f32 v8, -v8
  v_exp_f32 v9, -v9
  v_fma_f32 v8, v8, s36, s36
  v_fma_f32 v9, v9, s36, s36
  v_rcp_f32 v8, v8
  v_rcp_f32 v9, v9
  v_mfma_f32_32x32x16_bf16 v[80:95], v[28:31], v[124:127], v[80:95]
  s_waitcnt lgkmcnt(0)
  s_barrier
  ds_read_b64_tr_b16 v[16:17], v7 offset:24576
  ds_read_b64_tr_b16 v[18:19], v7 offset:26112
  v_mul_f32 v58, v58, v8
  v_mul_f32 v59, v59, v9
  v_cvt_pk_bf16_f32 v57, v58, v59
  v_fmaak_f32 v10, v74, v74, 0x409d30fc
  v_fmaak_f32 v11, v75, v75, 0x409d30fc
  v_mul_f32 v10, v74, v10
  v_mul_f32 v11, v75, v11
  v_exp_f32 v10, -v10
  v_exp_f32 v11, -v11
  v_mfma_f32_32x32x16_bf16 v[96:111], v[28:31], v[148:151], v[96:111]
  ds_read_b64_tr_b16 v[20:21], v7 offset:24640
  ds_read_b64_tr_b16 v[22:23], v7 offset:26176
  v_fma_f32 v10, v10, s36, s36
  v_fma_f32 v11, v11, s36, s36
  v_rcp_f32 v10, v10
  v_rcp_f32 v11, v11
  v_mul_f32 v74, v74, v10
  v_mul_f32 v75, v75, v11
  v_cvt_pk_bf16_f32 v73, v74, v75
  v_mfma_f32_32x32x16_bf16 v[80:95], v[32:35], v[128:131], v[80:95]
  ds_read_b64_tr_b16 v[24:25], v7 offset:27648
  v_fmaak_f32 v8, v60, v60, 0x409d30fc
  v_fmaak_f32 v9, v61, v61, 0x409d30fc
  v_mul_f32 v8, v60, v8
  v_mul_f32 v9, v61, v9
  v_exp_f32 v8, -v8
  v_exp_f32 v9, -v9
  v_fma_f32 v8, v8, s36, s36
  v_fma_f32 v9, v9, s36, s36
  v_rcp_f32 v8, v8
  v_mfma_f32_32x32x16_bf16 v[96:111], v[32:35], v[152:155], v[96:111]
  ds_read_b64_tr_b16 v[26:27], v7 offset:29184
  v_rcp_f32 v9, v9
  v_mul_f32 v60, v60, v8
  v_mul_f32 v61, v61, v9
  v_cvt_pk_bf16_f32 v58, v60, v61
  v_fmaak_f32 v10, v76, v76, 0x409d30fc
  v_fmaak_f32 v11, v77, v77, 0x409d30fc
  v_mul_f32 v10, v76, v10
  v_mul_f32 v11, v77, v11
  v_exp_f32 v10, -v10
  v_mfma_f32_32x32x16_bf16 v[80:95], v[36:39], v[132:135], v[80:95]
  ds_read_b64_tr_b16 v[28:29], v7 offset:27712
  v_exp_f32 v11, -v11
  v_fma_f32 v10, v10, s36, s36
  v_fma_f32 v11, v11, s36, s36
  v_rcp_f32 v10, v10
  v_rcp_f32 v11, v11
  v_mul_f32 v76, v76, v10
  v_mul_f32 v77, v77, v11
  v_cvt_pk_bf16_f32 v74, v76, v77
  v_mfma_f32_32x32x16_bf16 v[96:111], v[36:39], v[156:159], v[96:111]
  s_waitcnt lgkmcnt(5)
  ds_read_b64_tr_b16 v[30:31], v7 offset:29248
  v_fmaak_f32 v8, v62, v62, 0x409d30fc
  v_fmaak_f32 v9, v63, v63, 0x409d30fc
  v_mul_f32 v8, v62, v8
  v_mul_f32 v9, v63, v9
  v_exp_f32 v8, -v8
  v_exp_f32 v9, -v9
  v_fma_f32 v8, v8, s36, s36
  v_fma_f32 v9, v9, s36, s36
  v_rcp_f32 v8, v8
  v_mfma_f32_32x32x16_bf16 v[160:175], v[16:19], v[48:51], v[160:175]
  ds_read_b64_tr_b16 v[32:33], v7 offset:24704
  v_rcp_f32 v9, v9
  v_mul_f32 v62, v62, v8
  v_mul_f32 v63, v63, v9
  v_cvt_pk_bf16_f32 v59, v62, v63
  v_fmaak_f32 v10, v78, v78, 0x409d30fc
  v_fmaak_f32 v11, v79, v79, 0x409d30fc
  v_mul_f32 v10, v78, v10
  v_mul_f32 v11, v79, v11
  v_exp_f32 v10, -v10
  v_exp_f32 v11, -v11
  v_mfma_f32_32x32x16_bf16 v[208:223], v[16:19], v[64:67], v[208:223]
  s_waitcnt lgkmcnt(5)
  ds_read_b64_tr_b16 v[34:35], v7 offset:26240
  v_fma_f32 v10, v10, s36, s36
  v_fma_f32 v11, v11, s36, s36
  v_rcp_f32 v10, v10
  v_rcp_f32 v11, v11
  v_mul_f32 v78, v78, v10
  v_mul_f32 v79, v79, v11
  v_cvt_pk_bf16_f32 v75, v78, v79
  v_fmaak_f32 v8, v80, v80, 0x409d30fc
  v_mfma_f32_32x32x16_bf16 v[176:191], v[20:23], v[48:51], v[176:191]
  ds_read_b64_tr_b16 v[36:37], v7 offset:27776
  v_fmaak_f32 v9, v81, v81, 0x409d30fc
  v_mul_f32 v8, v80, v8
  v_mul_f32 v9, v81, v9
  v_exp_f32 v8, -v8
  v_exp_f32 v9, -v9
  v_fma_f32 v8, v8, s36, s36
  v_fma_f32 v9, v9, s36, s36
  v_rcp_f32 v8, v8
  v_mfma_f32_32x32x16_bf16 v[224:239], v[20:23], v[64:67], v[224:239]
  s_waitcnt lgkmcnt(5)
  ds_read_b64_tr_b16 v[38:39], v7 offset:29312
  v_rcp_f32 v9, v9
  v_mul_f32 v80, v80, v8
  v_mul_f32 v81, v81, v9
  v_cvt_pk_bf16_f32 v80, v80, v81
  v_fmaak_f32 v10, v96, v96, 0x409d30fc
  v_fmaak_f32 v11, v97, v97, 0x409d30fc
  v_mul_f32 v10, v96, v10
  v_mul_f32 v11, v97, v11
  v_exp_f32 v10, -v10
  v_exp_f32 v11, -v11
  v_mfma_f32_32x32x16_bf16 v[160:175], v[24:27], v[56:59], v[160:175]
  ds_read_b64_tr_b16 v[16:17], v1 offset:30720
  v_fma_f32 v10, v10, s36, s36
  v_fma_f32 v11, v11, s36, s36
  v_rcp_f32 v10, v10
  v_rcp_f32 v11, v11
  v_mul_f32 v96, v96, v10
  v_mul_f32 v97, v97, v11
  v_cvt_pk_bf16_f32 v96, v96, v97
  v_fmaak_f32 v8, v82, v82, 0x409d30fc
  v_mfma_f32_32x32x16_bf16 v[208:223], v[24:27], v[72:75], v[208:223]
  s_waitcnt lgkmcnt(5)
  ds_read_b64_tr_b16 v[18:19], v1 offset:30976
  v_fmaak_f32 v9, v83, v83, 0x409d30fc
  v_mul_f32 v8, v82, v8
  v_mul_f32 v9, v83, v9
  v_exp_f32 v8, -v8
  v_exp_f32 v9, -v9
  v_fma_f32 v8, v8, s36, s36
  v_fma_f32 v9, v9, s36, s36
  v_rcp_f32 v8, v8
  v_mfma_f32_32x32x16_bf16 v[176:191], v[28:31], v[56:59], v[176:191]
  ds_read_b64_tr_b16 v[20:21], v1 offset:31744
  v_rcp_f32 v9, v9
  v_mul_f32 v82, v82, v8
  v_mul_f32 v83, v83, v9
  v_cvt_pk_bf16_f32 v81, v82, v83
  v_fmaak_f32 v10, v98, v98, 0x409d30fc
  v_fmaak_f32 v11, v99, v99, 0x409d30fc
  v_mul_f32 v10, v98, v10
  v_mul_f32 v11, v99, v11
  v_exp_f32 v10, -v10
  v_exp_f32 v11, -v11
  v_mfma_f32_32x32x16_bf16 v[224:239], v[28:31], v[72:75], v[224:239]
  s_waitcnt lgkmcnt(5)
  ds_read_b64_tr_b16 v[22:23], v1 offset:32000
  v_fma_f32 v10, v10, s36, s36
  v_fma_f32 v11, v11, s36, s36
  v_rcp_f32 v10, v10
  v_rcp_f32 v11, v11
  v_mul_f32 v98, v98, v10
  v_mul_f32 v99, v99, v11
  v_cvt_pk_bf16_f32 v97, v98, v99
  v_fmaak_f32 v8, v84, v84, 0x409d30fc
  v_mfma_f32_32x32x16_bf16 v[192:207], v[32:35], v[48:51], v[192:207]
  ds_read_b64_tr_b16 v[24:25], v1 offset:32768
  v_fmaak_f32 v9, v85, v85, 0x409d30fc
  v_mul_f32 v8, v84, v8
  v_mul_f32 v9, v85, v9
  v_exp_f32 v8, -v8
  v_exp_f32 v9, -v9
  v_fma_f32 v8, v8, s36, s36
  v_fma_f32 v9, v9, s36, s36
  v_rcp_f32 v8, v8
  v_mfma_f32_32x32x16_bf16 v[240:255], v[32:35], v[64:67], v[240:255]
  s_waitcnt lgkmcnt(5)
  ds_read_b64_tr_b16 v[26:27], v1 offset:33024
  v_rcp_f32 v9, v9
  v_mul_f32 v84, v84, v8
  v_mul_f32 v85, v85, v9
  v_cvt_pk_bf16_f32 v82, v84, v85
  v_fmaak_f32 v10, v100, v100, 0x409d30fc
  v_fmaak_f32 v11, v101, v101, 0x409d30fc
  v_mul_f32 v10, v100, v10
  v_mul_f32 v11, v101, v11
  v_exp_f32 v10, -v10
  v_exp_f32 v11, -v11
  v_mfma_f32_32x32x16_bf16 v[192:207], v[36:39], v[56:59], v[192:207]
  ds_read_b64_tr_b16 v[28:29], v1 offset:33792
  v_fma_f32 v10, v10, s36, s36
  v_fma_f32 v11, v11, s36, s36
  v_rcp_f32 v10, v10
  v_rcp_f32 v11, v11
  v_mul_f32 v100, v100, v10
  v_mul_f32 v101, v101, v11
  v_cvt_pk_bf16_f32 v98, v100, v101
  v_fmaak_f32 v8, v86, v86, 0x409d30fc
  v_mfma_f32_32x32x16_bf16 v[240:255], v[36:39], v[72:75], v[240:255]
  s_waitcnt lgkmcnt(5)
  ds_read_b64_tr_b16 v[30:31], v1 offset:34048
  v_fmaak_f32 v9, v87, v87, 0x409d30fc
  v_mul_f32 v8, v86, v8
  v_mul_f32 v9, v87, v9
  v_exp_f32 v8, -v8
  v_exp_f32 v9, -v9
  v_fma_f32 v8, v8, s36, s36
  v_fma_f32 v9, v9, s36, s36
  v_rcp_f32 v8, v8
  v_mfma_f32_32x32x16_bf16 v[48:63], v[16:19], v[112:115], 0
  ds_read_b64_tr_b16 v[32:33], v1 offset:34816
  v_rcp_f32 v9, v9
  v_mul_f32 v86, v86, v8
  v_mul_f32 v87, v87, v9
  v_cvt_pk_bf16_f32 v83, v86, v87
  v_fmaak_f32 v10, v102, v102, 0x409d30fc
  v_fmaak_f32 v11, v103, v103, 0x409d30fc
  v_mul_f32 v10, v102, v10
  v_mul_f32 v11, v103, v11
  v_exp_f32 v10, -v10
  v_exp_f32 v11, -v11
  v_mfma_f32_32x32x16_bf16 v[64:79], v[16:19], v[136:139], 0
  s_waitcnt lgkmcnt(5)
  ds_read_b64_tr_b16 v[34:35], v1 offset:35072
  v_fma_f32 v10, v10, s36, s36
  v_fma_f32 v11, v11, s36, s36
  v_rcp_f32 v10, v10
  v_rcp_f32 v11, v11
  v_mul_f32 v102, v102, v10
  v_mul_f32 v103, v103, v11
  v_cvt_pk_bf16_f32 v99, v102, v103
  v_fmaak_f32 v8, v88, v88, 0x409d30fc
  v_mfma_f32_32x32x16_bf16 v[48:63], v[20:23], v[116:119], v[48:63]
  ds_read_b64_tr_b16 v[36:37], v1 offset:35840
  v_fmaak_f32 v9, v89, v89, 0x409d30fc
  v_mul_f32 v8, v88, v8
  v_mul_f32 v9, v89, v9
  v_exp_f32 v8, -v8
  v_exp_f32 v9, -v9
  v_fma_f32 v8, v8, s36, s36
  v_fma_f32 v9, v9, s36, s36
  v_rcp_f32 v8, v8
  v_mfma_f32_32x32x16_bf16 v[64:79], v[20:23], v[140:143], v[64:79]
  s_waitcnt lgkmcnt(5)
  ds_read_b64_tr_b16 v[38:39], v1 offset:36096
  v_rcp_f32 v9, v9
  v_mul_f32 v88, v88, v8
  v_mul_f32 v89, v89, v9
  v_cvt_pk_bf16_f32 v88, v88, v89
  v_fmaak_f32 v10, v104, v104, 0x409d30fc
  v_fmaak_f32 v11, v105, v105, 0x409d30fc
  v_mul_f32 v10, v104, v10
  v_mul_f32 v11, v105, v11
  v_exp_f32 v10, -v10
  v_exp_f32 v11, -v11
  v_mfma_f32_32x32x16_bf16 v[48:63], v[24:27], v[120:123], v[48:63]
  v_fma_f32 v10, v10, s36, s36
  v_fma_f32 v11, v11, s36, s36
  v_rcp_f32 v10, v10
  v_rcp_f32 v11, v11
  v_mul_f32 v104, v104, v10
  v_mul_f32 v105, v105, v11
  v_cvt_pk_bf16_f32 v104, v104, v105
  v_fmaak_f32 v8, v90, v90, 0x409d30fc
  v_fmaak_f32 v9, v91, v91, 0x409d30fc
  v_mfma_f32_32x32x16_bf16 v[64:79], v[24:27], v[144:147], v[64:79]
  s_waitcnt lgkmcnt(4)
  v_mul_f32 v8, v90, v8
  v_mul_f32 v9, v91, v9
  v_exp_f32 v8, -v8
  v_exp_f32 v9, -v9
  v_fma_f32 v8, v8, s36, s36
  v_fma_f32 v9, v9, s36, s36
  v_rcp_f32 v8, v8
  v_rcp_f32 v9, v9
  v_mfma_f32_32x32x16_bf16 v[48:63], v[28:31], v[124:127], v[48:63]
  s_waitcnt lgkmcnt(0)
  s_barrier
  ds_read_b64_tr_b16 v[16:17], v7 offset:0
  ds_read_b64_tr_b16 v[18:19], v7 offset:1536
  v_mul_f32 v90, v90, v8
  v_mul_f32 v91, v91, v9
  v_cvt_pk_bf16_f32 v89, v90, v91
  v_fmaak_f32 v10, v106, v106, 0x409d30fc
  v_fmaak_f32 v11, v107, v107, 0x409d30fc
  v_mul_f32 v10, v106, v10
  v_mul_f32 v11, v107, v11
  v_exp_f32 v10, -v10
  v_exp_f32 v11, -v11
  v_mfma_f32_32x32x16_bf16 v[64:79], v[28:31], v[148:151], v[64:79]
  ds_read_b64_tr_b16 v[20:21], v7 offset:64
  ds_read_b64_tr_b16 v[22:23], v7 offset:1600
  v_fma_f32 v10, v10, s36, s36
  v_fma_f32 v11, v11, s36, s36
  v_rcp_f32 v10, v10
  v_rcp_f32 v11, v11
  v_mul_f32 v106, v106, v10
  v_mul_f32 v107, v107, v11
  v_cvt_pk_bf16_f32 v105, v106, v107
  v_mfma_f32_32x32x16_bf16 v[48:63], v[32:35], v[128:131], v[48:63]
  ds_read_b64_tr_b16 v[24:25], v7 offset:3072
  v_fmaak_f32 v8, v92, v92, 0x409d30fc
  v_fmaak_f32 v9, v93, v93, 0x409d30fc
  v_mul_f32 v8, v92, v8
  v_mul_f32 v9, v93, v9
  v_exp_f32 v8, -v8
  v_exp_f32 v9, -v9
  v_fma_f32 v8, v8, s36, s36
  v_fma_f32 v9, v9, s36, s36
  v_rcp_f32 v8, v8
  v_mfma_f32_32x32x16_bf16 v[64:79], v[32:35], v[152:155], v[64:79]
  ds_read_b64_tr_b16 v[26:27], v7 offset:4608
  v_rcp_f32 v9, v9
  v_mul_f32 v92, v92, v8
  v_mul_f32 v93, v93, v9
  v_cvt_pk_bf16_f32 v90, v92, v93
  v_fmaak_f32 v10, v108, v108, 0x409d30fc
  v_fmaak_f32 v11, v109, v109, 0x409d30fc
  v_mul_f32 v10, v108, v10
  v_mul_f32 v11, v109, v11
  v_exp_f32 v10, -v10
  v_mfma_f32_32x32x16_bf16 v[48:63], v[36:39], v[132:135], v[48:63]
  ds_read_b64_tr_b16 v[28:29], v7 offset:3136
  v_exp_f32 v11, -v11
  v_fma_f32 v10, v10, s36, s36
  v_fma_f32 v11, v11, s36, s36
  v_rcp_f32 v10, v10
  v_rcp_f32 v11, v11
  v_mul_f32 v108, v108, v10
  v_mul_f32 v109, v109, v11
  v_cvt_pk_bf16_f32 v106, v108, v109
  v_mfma_f32_32x32x16_bf16 v[64:79], v[36:39], v[156:159], v[64:79]
  s_waitcnt lgkmcnt(5)
  ds_read_b64_tr_b16 v[30:31], v7 offset:4672
  v_fmaak_f32 v8, v94, v94, 0x409d30fc
  v_fmaak_f32 v9, v95, v95, 0x409d30fc
  v_mul_f32 v8, v94, v8
  v_mul_f32 v9, v95, v9
  v_exp_f32 v8, -v8
  v_exp_f32 v9, -v9
  v_fma_f32 v8, v8, s36, s36
  v_fma_f32 v9, v9, s36, s36
  v_rcp_f32 v8, v8
  v_mfma_f32_32x32x16_bf16 v[160:175], v[16:19], v[80:83], v[160:175]
  ds_read_b64_tr_b16 v[32:33], v7 offset:128
  ds_read_b128 v[136:139], v3 offset:0
  ds_read_b128 v[140:143], v3 offset:4096
  v_rcp_f32 v9, v9
  v_mul_f32 v94, v94, v8
  v_mul_f32 v95, v95, v9
  v_cvt_pk_bf16_f32 v91, v94, v95
  v_fmaak_f32 v10, v110, v110, 0x409d30fc
  v_fmaak_f32 v11, v111, v111, 0x409d30fc
  v_mul_f32 v10, v110, v10
  v_mul_f32 v11, v111, v11
  v_exp_f32 v10, -v10
  v_mfma_f32_32x32x16_bf16 v[208:223], v[16:19], v[96:99], v[208:223]
  s_waitcnt lgkmcnt(7)
  ds_read_b64_tr_b16 v[34:35], v7 offset:1664
  ds_read_b128 v[144:147], v3 offset:8192
  ds_read_b128 v[148:151], v3 offset:12288
  v_exp_f32 v11, -v11
  v_fma_f32 v10, v10, s36, s36
  v_fma_f32 v11, v11, s36, s36
  v_rcp_f32 v10, v10
  v_rcp_f32 v11, v11
  v_mul_f32 v110, v110, v10
  v_mfma_f32_32x32x16_bf16 v[176:191], v[20:23], v[80:83], v[176:191]
  ds_read_b64_tr_b16 v[36:37], v7 offset:3200
  ds_read_b128 v[152:155], v3 offset:16384
  ds_read_b128 v[156:159], v3 offset:20480
  v_mul_f32 v111, v111, v11
  v_cvt_pk_bf16_f32 v107, v110, v111
  v_fmaak_f32 v8, v48, v48, 0x409d30fc
  v_fmaak_f32 v9, v49, v49, 0x409d30fc
  v_mul_f32 v8, v48, v8
  v_mul_f32 v9, v49, v9
  v_exp_f32 v8, -v8
  v_exp_f32 v9, -v9
  v_mfma_f32_32x32x16_bf16 v[224:239], v[20:23], v[96:99], v[224:239]
  s_waitcnt lgkmcnt(11)
  ds_read_b64_tr_b16 v[38:39], v7 offset:4736
  v_fma_f32 v8, v8, s36, s36
  v_fma_f32 v9, v9, s36, s36
  v_rcp_f32 v8, v8
  v_rcp_f32 v9, v9
  v_mul_f32 v48, v48, v8
  v_mul_f32 v49, v49, v9
  v_cvt_pk_bf16_f32 v48, v48, v49
  v_fmaak_f32 v10, v64, v64, 0x409d30fc
  v_fmaak_f32 v11, v65, v65, 0x409d30fc
  v_mfma_f32_32x32x16_bf16 v[160:175], v[24:27], v[88:91], v[160:175]
  ds_read_b64_tr_b16 v[16:17], v1 offset:6144
  v_mul_f32 v10, v64, v10
  v_mul_f32 v11, v65, v11
  v_exp_f32 v10, -v10
  v_exp_f32 v11, -v11
  v_fma_f32 v10, v10, s36, s36
  v_fma_f32 v11, v11, s36, s36
  v_rcp_f32 v10, v10
  v_rcp_f32 v11, v11
  v_mfma_f32_32x32x16_bf16 v[208:223], v[24:27], v[104:107], v[208:223]
  s_waitcnt lgkmcnt(11)
  ds_read_b64_tr_b16 v[18:19], v1 offset:6400
  v_mul_f32 v64, v64, v10
  v_mul_f32 v65, v65, v11
  v_cvt_pk_bf16_f32 v64, v64, v65
  v_fmaak_f32 v8, v50, v50, 0x409d30fc
  v_fmaak_f32 v9, v51, v51, 0x409d30fc
  v_mul_f32 v8, v50, v8
  v_mul_f32 v9, v51, v9
  v_exp_f32 v8, -v8
  v_exp_f32 v9, -v9
  v_mfma_f32_32x32x16_bf16 v[176:191], v[28:31], v[88:91], v[176:191]
  ds_read_b64_tr_b16 v[20:21], v1 offset:7168
  v_fma_f32 v8, v8, s36, s36
  v_fma_f32 v9, v9, s36, s36
  v_rcp_f32 v8, v8
  v_rcp_f32 v9, v9
  v_mul_f32 v50, v50, v8
  v_mul_f32 v51, v51, v9
  v_cvt_pk_bf16_f32 v49, v50, v51
  v_fmaak_f32 v10, v66, v66, 0x409d30fc
  v_fmaak_f32 v11, v67, v67, 0x409d30fc
  v_mul_f32 v10, v66, v10
  v_mfma_f32_32x32x16_bf16 v[224:239], v[28:31], v[104:107], v[224:239]
  s_waitcnt lgkmcnt(9)
  ds_read_b64_tr_b16 v[22:23], v1 offset:7424
  v_mul_f32 v11, v67, v11
  v_exp_f32 v10, -v10
  v_exp_f32 v11, -v11
  v_fma_f32 v10, v10, s36, s36
  v_fma_f32 v11, v11, s36, s36
  v_rcp_f32 v10, v10
  v_rcp_f32 v11, v11
  v_mfma_f32_32x32x16_bf16 v[192:207], v[32:35], v[80:83], v[192:207]
  ds_read_b64_tr_b16 v[24:25], v1 offset:8192
  v_mul_f32 v66, v66, v10
  v_mul_f32 v67, v67, v11
  v_cvt_pk_bf16_f32 v65, v66, v67
  v_fmaak_f32 v8, v52, v52, 0x409d30fc
  v_fmaak_f32 v9, v53, v53, 0x409d30fc
  v_mul_f32 v8, v52, v8
  v_mul_f32 v9, v53, v9
  v_exp_f32 v8, -v8
  v_exp_f32 v9, -v9
  v_fma_f32 v8, v8, s36, s36
  v_mfma_f32_32x32x16_bf16 v[240:255], v[32:35], v[96:99], v[240:255]
  s_waitcnt lgkmcnt(5)
  ds_read_b64_tr_b16 v[26:27], v1 offset:8448
  v_fma_f32 v9, v9, s36, s36
  v_rcp_f32 v8, v8
  v_rcp_f32 v9, v9
  v_mul_f32 v52, v52, v8
  v_mul_f32 v53, v53, v9
  v_cvt_pk_bf16_f32 v50, v52, v53
  v_fmaak_f32 v10, v68, v68, 0x409d30fc
  v_fmaak_f32 v11, v69, v69, 0x409d30fc
  v_mul_f32 v10, v68, v10
  v_mfma_f32_32x32x16_bf16 v[192:207], v[36:39], v[88:91], v[192:207]
  ds_read_b64_tr_b16 v[28:29], v1 offset:9216
  v_mul_f32 v11, v69, v11
  v_exp_f32 v10, -v10
  v_exp_f32 v11, -v11
  v_fma_f32 v10, v10, s36, s36
  v_fma_f32 v11, v11, s36, s36
  v_rcp_f32 v10, v10
  v_rcp_f32 v11, v11
  v_mul_f32 v68, v68, v10
  v_mfma_f32_32x32x16_bf16 v[240:255], v[36:39], v[104:107], v[240:255]
  s_waitcnt lgkmcnt(5)
  ds_read_b64_tr_b16 v[30:31], v1 offset:9472
  v_mul_f32 v69, v69, v11
  v_cvt_pk_bf16_f32 v66, v68, v69
  v_fmaak_f32 v8, v54, v54, 0x409d30fc
  v_fmaak_f32 v9, v55, v55, 0x409d30fc
  v_mul_f32 v8, v54, v8
  v_mul_f32 v9, v55, v9
  v_exp_f32 v8, -v8
  v_exp_f32 v9, -v9
  v_fma_f32 v8, v8, s36, s36
  v_mfma_f32_32x32x16_bf16 v[80:95], v[16:19], v[112:115], 0
  ds_read_b64_tr_b16 v[32:33], v1 offset:10240
  v_fma_f32 v9, v9, s36, s36
  v_rcp_f32 v8, v8
  v_rcp_f32 v9, v9
  v_mul_f32 v54, v54, v8
  v_mul_f32 v55, v55, v9
  v_cvt_pk_bf16_f32 v51, v54, v55
  v_fmaak_f32 v10, v70, v70, 0x409d30fc
  v_fmaak_f32 v11, v71, v71, 0x409d30fc
  v_mul_f32 v10, v70, v10
  v_mul_f32 v11, v71, v11
  v_mfma_f32_32x32x16_bf16 v[96:111], v[16:19], v[136:139], 0
  s_waitcnt lgkmcnt(5)
  ds_read_b64_tr_b16 v[34:35], v1 offset:10496
  v_exp_f32 v10, -v10
  v_exp_f32 v11, -v11
  v_fma_f32 v10, v10, s36, s36
  v_fma_f32 v11, v11, s36, s36
  v_rcp_f32 v10, v10
  v_rcp_f32 v11, v11
  v_mul_f32 v70, v70, v10
  v_mul_f32 v71, v71, v11
  v_mfma_f32_32x32x16_bf16 v[80:95], v[20:23], v[116:119], v[80:95]
  ds_read_b64_tr_b16 v[36:37], v1 offset:11264
  v_cvt_pk_bf16_f32 v67, v70, v71
  v_fmaak_f32 v8, v56, v56, 0x409d30fc
  v_fmaak_f32 v9, v57, v57, 0x409d30fc
  v_mul_f32 v8, v56, v8
  v_mul_f32 v9, v57, v9
  v_exp_f32 v8, -v8
  v_exp_f32 v9, -v9
  v_fma_f32 v8, v8, s36, s36
  v_fma_f32 v9, v9, s36, s36
  v_mfma_f32_32x32x16_bf16 v[96:111], v[20:23], v[140:143], v[96:111]
  s_waitcnt lgkmcnt(5)
  ds_read_b64_tr_b16 v[38:39], v1 offset:11520
  v_rcp_f32 v8, v8
  v_rcp_f32 v9, v9
  v_mul_f32 v56, v56, v8
  v_mul_f32 v57, v57, v9
  v_cvt_pk_bf16_f32 v56, v56, v57
  v_fmaak_f32 v10, v72, v72, 0x409d30fc
  v_fmaak_f32 v11, v73, v73, 0x409d30fc
  v_mul_f32 v10, v72, v10
  v_mul_f32 v11, v73, v11
  v_exp_f32 v10, -v10
  v_mfma_f32_32x32x16_bf16 v[80:95], v[24:27], v[120:123], v[80:95]
  v_exp_f32 v11, -v11
  v_fma_f32 v10, v10, s36, s36
  v_fma_f32 v11, v11, s36, s36
  v_rcp_f32 v10, v10
  v_rcp_f32 v11, v11
  v_mul_f32 v72, v72, v10
  v_mul_f32 v73, v73, v11
  v_cvt_pk_bf16_f32 v72, v72, v73
  v_mfma_f32_32x32x16_bf16 v[96:111], v[24:27], v[144:147], v[96:111]
  s_waitcnt lgkmcnt(4)
  v_fmaak_f32 v8, v58, v58, 0x409d30fc
  v_fmaak_f32 v9, v59, v59, 0x409d30fc
  v_mul_f32 v8, v58, v8
  v_mul_f32 v9, v59, v9
  v_exp_f32 v8, -v8
  v_exp_f32 v9, -v9
  v_fma_f32 v8, v8, s36, s36
  v_fma_f32 v9, v9, s36, s36
  v_rcp_f32 v8, v8
  v_rcp_f32 v9, v9
  v_mfma_f32_32x32x16_bf16 v[80:95], v[28:31], v[124:127], v[80:95]
  s_waitcnt lgkmcnt(0)
  s_barrier
  ds_read_b64_tr_b16 v[16:17], v7 offset:12288
  ds_read_b64_tr_b16 v[18:19], v7 offset:13824
  v_mul_f32 v58, v58, v8
  v_mul_f32 v59, v59, v9
  v_cvt_pk_bf16_f32 v57, v58, v59
  v_fmaak_f32 v10, v74, v74, 0x409d30fc
  v_fmaak_f32 v11, v75, v75, 0x409d30fc
  v_mul_f32 v10, v74, v10
  v_mul_f32 v11, v75, v11
  v_exp_f32 v10, -v10
  v_mfma_f32_32x32x16_bf16 v[96:111], v[28:31], v[148:151], v[96:111]
  ds_read_b64_tr_b16 v[20:21], v7 offset:12352
  ds_read_b64_tr_b16 v[22:23], v7 offset:13888
  v_exp_f32 v11, -v11
  v_fma_f32 v10, v10, s36, s36
  v_fma_f32 v11, v11, s36, s36
  v_rcp_f32 v10, v10
  v_rcp_f32 v11, v11
  v_mul_f32 v74, v74, v10
  v_mul_f32 v75, v75, v11
  v_mfma_f32_32x32x16_bf16 v[80:95], v[32:35], v[128:131], v[80:95]
  ds_read_b64_tr_b16 v[24:25], v7 offset:15360
  v_cvt_pk_bf16_f32 v73, v74, v75
  v_fmaak_f32 v8, v60, v60, 0x409d30fc
  v_fmaak_f32 v9, v61, v61, 0x409d30fc
  v_mul_f32 v8, v60, v8
  v_mul_f32 v9, v61, v9
  v_exp_f32 v8, -v8
  v_exp_f32 v9, -v9
  v_fma_f32 v8, v8, s36, s36
  v_fma_f32 v9, v9, s36, s36
  v_rcp_f32 v8, v8
  v_mfma_f32_32x32x16_bf16 v[96:111], v[32:35], v[152:155], v[96:111]
  ds_read_b64_tr_b16 v[26:27], v7 offset:16896
  v_rcp_f32 v9, v9
  v_mul_f32 v60, v60, v8
  v_mul_f32 v61, v61, v9
  v_cvt_pk_bf16_f32 v58, v60, v61
  v_fmaak_f32 v10, v76, v76, 0x409d30fc
  v_fmaak_f32 v11, v77, v77, 0x409d30fc
  v_mul_f32 v10, v76, v10
  v_mul_f32 v11, v77, v11
  v_exp_f32 v10, -v10
  v_mfma_f32_32x32x16_bf16 v[80:95], v[36:39], v[132:135], v[80:95]
  ds_read_b64_tr_b16 v[28:29], v7 offset:15424
  v_exp_f32 v11, -v11
  v_fma_f32 v10, v10, s36, s36
  v_fma_f32 v11, v11, s36, s36
  v_rcp_f32 v10, v10
  v_rcp_f32 v11, v11
  v_mul_f32 v76, v76, v10
  v_mul_f32 v77, v77, v11
  v_cvt_pk_bf16_f32 v74, v76, v77
  v_mfma_f32_32x32x16_bf16 v[96:111], v[36:39], v[156:159], v[96:111]
  s_waitcnt lgkmcnt(5)
  ds_read_b64_tr_b16 v[30:31], v7 offset:16960
  v_fmaak_f32 v8, v62, v62, 0x409d30fc
  v_fmaak_f32 v9, v63, v63, 0x409d30fc
  v_mul_f32 v8, v62, v8
  v_mul_f32 v9, v63, v9
  v_exp_f32 v8, -v8
  v_exp_f32 v9, -v9
  v_fma_f32 v8, v8, s36, s36
  v_fma_f32 v9, v9, s36, s36
  v_rcp_f32 v8, v8
  v_mfma_f32_32x32x16_bf16 v[160:175], v[16:19], v[48:51], v[160:175]
  ds_read_b64_tr_b16 v[32:33], v7 offset:12416
  v_add_u32 v6, s43, v4
  v_rcp_f32 v9, v9
  v_mul_f32 v62, v62, v8
  v_mul_f32 v63, v63, v9
  v_cvt_pk_bf16_f32 v59, v62, v63
  v_fmaak_f32 v10, v78, v78, 0x409d30fc
  v_fmaak_f32 v11, v79, v79, 0x409d30fc
  v_mul_f32 v10, v78, v10
  v_mul_f32 v11, v79, v11
  v_exp_f32 v10, -v10
  v_exp_f32 v11, -v11
  v_mfma_f32_32x32x16_bf16 v[208:223], v[16:19], v[64:67], v[208:223]
  s_waitcnt lgkmcnt(5)
  ds_read_b64_tr_b16 v[34:35], v7 offset:13952
  s_mov_b32 s49, s43
  s_mov_b32 s43, s44
  s_mov_b32 s44, s45
  s_mov_b32 s45, s49
  v_fma_f32 v10, v10, s36, s36
  v_fma_f32 v11, v11, s36, s36
  v_rcp_f32 v10, v10
  v_rcp_f32 v11, v11
  v_mul_f32 v78, v78, v10
  v_mul_f32 v79, v79, v11
  v_cvt_pk_bf16_f32 v75, v78, v79
  v_mfma_f32_32x32x16_bf16 v[176:191], v[20:23], v[48:51], v[176:191]
  ds_read_b64_tr_b16 v[36:37], v7 offset:15488
  v_fmaak_f32 v8, v80, v80, 0x409d30fc
  v_fmaak_f32 v9, v81, v81, 0x409d30fc
  v_mul_f32 v8, v80, v8
  v_mul_f32 v9, v81, v9
  v_exp_f32 v8, -v8
  v_exp_f32 v9, -v9
  v_fma_f32 v8, v8, s36, s36
  v_fma_f32 v9, v9, s36, s36
  v_rcp_f32 v8, v8
  v_rcp_f32 v9, v9
  v_mfma_f32_32x32x16_bf16 v[224:239], v[20:23], v[64:67], v[224:239]
  s_waitcnt lgkmcnt(5)
  ds_read_b64_tr_b16 v[38:39], v7 offset:17024
  v_mul_f32 v80, v80, v8
  v_mul_f32 v81, v81, v9
  v_cvt_pk_bf16_f32 v80, v80, v81
  v_fmaak_f32 v10, v96, v96, 0x409d30fc
  v_fmaak_f32 v11, v97, v97, 0x409d30fc
  v_mul_f32 v10, v96, v10
  v_mul_f32 v11, v97, v11
  v_exp_f32 v10, -v10
  v_exp_f32 v11, -v11
  v_fma_f32 v10, v10, s36, s36
  v_mfma_f32_32x32x16_bf16 v[160:175], v[24:27], v[56:59], v[160:175]
  ds_read_b64_tr_b16 v[16:17], v1 offset:18432
  v_fma_f32 v11, v11, s36, s36
  v_rcp_f32 v10, v10
  v_rcp_f32 v11, v11
  v_mul_f32 v96, v96, v10
  v_mul_f32 v97, v97, v11
  v_cvt_pk_bf16_f32 v96, v96, v97
  v_fmaak_f32 v8, v82, v82, 0x409d30fc
  v_fmaak_f32 v9, v83, v83, 0x409d30fc
  v_mul_f32 v8, v82, v8
  v_mul_f32 v9, v83, v9
  v_exp_f32 v8, -v8
  v_mfma_f32_32x32x16_bf16 v[208:223], v[24:27], v[72:75], v[208:223]
  s_waitcnt lgkmcnt(5)
  ds_read_b64_tr_b16 v[18:19], v1 offset:18688
  v_exp_f32 v9, -v9
  v_fma_f32 v8, v8, s36, s36
  v_fma_f32 v9, v9, s36, s36
  v_rcp_f32 v8, v8
  v_rcp_f32 v9, v9
  s_nop 4
  v_cvt_pk_bf16_f32 v208, v208, v209
  v_cvt_pk_bf16_f32 v209, v210, v211
  v_cvt_pk_bf16_f32 v210, v212, v213
  v_cvt_pk_bf16_f32 v211, v214, v215
  v_mul_f32 v82, v82, v8
  v_mfma_f32_32x32x16_bf16 v[176:191], v[28:31], v[56:59], v[176:191]
  ds_read_b64_tr_b16 v[20:21], v1 offset:19456
  v_mul_f32 v83, v83, v9
  v_cvt_pk_bf16_f32 v81, v82, v83
  v_fmaak_f32 v10, v98, v98, 0x409d30fc
  v_fmaak_f32 v11, v99, v99, 0x409d30fc
  v_cvt_pk_bf16_f32 v216, v216, v217
  v_cvt_pk_bf16_f32 v217, v218, v219
  v_mul_f32 v10, v98, v10
  v_cvt_pk_bf16_f32 v218, v220, v221
  v_cvt_pk_bf16_f32 v219, v222, v223
  s_nop 1
  v_permlane16_swap_b32 v208, v216
  v_permlane16_swap_b32 v209, v217
  v_permlane16_swap_b32 v210, v218
  v_permlane16_swap_b32 v211, v219
  v_mfma_f32_32x32x16_bf16 v[224:239], v[28:31], v[72:75], v[224:239]
  s_waitcnt lgkmcnt(5)
  ds_read_b64_tr_b16 v[22:23], v1 offset:19712
  buffer_store_dwordx4 v[208:211], v2, s[28:31], s40 offen offset:0 sc1
  v_mul_f32 v11, v99, v11
  v_exp_f32 v10, -v10
  v_exp_f32 v11, -v11
  v_fma_f32 v10, v10, s36, s36
  v_fma_f32 v11, v11, s36, s36
  v_rcp_f32 v10, v10
  v_rcp_f32 v11, v11
  v_mfma_f32_32x32x16_bf16 v[192:207], v[32:35], v[48:51], v[192:207]
  ds_read_b64_tr_b16 v[24:25], v1 offset:20480
  v_mul_f32 v98, v98, v10
  v_mul_f32 v99, v99, v11
  v_cvt_pk_bf16_f32 v97, v98, v99
  v_fmaak_f32 v8, v84, v84, 0x409d30fc
  v_fmaak_f32 v9, v85, v85, 0x409d30fc
  v_mul_f32 v8, v84, v8
  v_mul_f32 v9, v85, v9
  v_exp_f32 v8, -v8
  v_exp_f32 v9, -v9
  v_fma_f32 v8, v8, s36, s36
  v_fma_f32 v9, v9, s36, s36
  v_mfma_f32_32x32x16_bf16 v[240:255], v[32:35], v[64:67], v[240:255]
  s_waitcnt lgkmcnt(5)
  ds_read_b64_tr_b16 v[26:27], v1 offset:20736
  v_rcp_f32 v8, v8
  v_rcp_f32 v9, v9
  v_mul_f32 v84, v84, v8
  v_mul_f32 v85, v85, v9
  v_cvt_pk_bf16_f32 v82, v84, v85
  v_fmaak_f32 v10, v100, v100, 0x409d30fc
  v_fmaak_f32 v11, v101, v101, 0x409d30fc
  v_mul_f32 v10, v100, v10
  v_mul_f32 v11, v101, v11
  v_exp_f32 v10, -v10
  v_exp_f32 v11, -v11
  v_mfma_f32_32x32x16_bf16 v[192:207], v[36:39], v[56:59], v[192:207]
  ds_read_b64_tr_b16 v[28:29], v1 offset:21504
  v_fma_f32 v10, v10, s36, s36
  v_fma_f32 v11, v11, s36, s36
  v_rcp_f32 v10, v10
  v_rcp_f32 v11, v11
  v_mul_f32 v100, v100, v10
  v_mul_f32 v101, v101, v11
  v_cvt_pk_bf16_f32 v98, v100, v101
  v_fmaak_f32 v8, v86, v86, 0x409d30fc
  v_fmaak_f32 v9, v87, v87, 0x409d30fc
  v_mul_f32 v8, v86, v8
  v_mfma_f32_32x32x16_bf16 v[240:255], v[36:39], v[72:75], v[240:255]
  s_waitcnt lgkmcnt(5)
  ds_read_b64_tr_b16 v[30:31], v1 offset:21760
  v_mul_f32 v9, v87, v9
  v_exp_f32 v8, -v8
  v_exp_f32 v9, -v9
  v_fma_f32 v8, v8, s36, s36
  v_fma_f32 v9, v9, s36, s36
  v_rcp_f32 v8, v8
  v_rcp_f32 v9, v9
  v_mul_f32 v86, v86, v8
  v_mul_f32 v87, v87, v9
  v_mfma_f32_32x32x16_bf16 v[48:63], v[16:19], v[112:115], 0
  ds_read_b64_tr_b16 v[32:33], v1 offset:22528
  buffer_store_dwordx4 v[216:219], v2, s[28:31], s40 offen offset:192 sc1
  v_cvt_pk_bf16_f32 v83, v86, v87
  v_fmaak_f32 v10, v102, v102, 0x409d30fc
  v_fmaak_f32 v11, v103, v103, 0x409d30fc
  v_mul_f32 v10, v102, v10
  v_mul_f32 v11, v103, v11
  v_exp_f32 v10, -v10
  v_cvt_pk_bf16_f32 v224, v224, v225
  v_cvt_pk_bf16_f32 v225, v226, v227
  v_cvt_pk_bf16_f32 v226, v228, v229
  v_exp_f32 v11, -v11
  v_mfma_f32_32x32x16_bf16 v[64:79], v[16:19], v[136:139], 0
  s_waitcnt lgkmcnt(5)
  ds_read_b64_tr_b16 v[34:35], v1 offset:22784
  v_cvt_pk_bf16_f32 v227, v230, v231
  v_fma_f32 v10, v10, s36, s36
  v_fma_f32 v11, v11, s36, s36
  v_rcp_f32 v10, v10
  v_cvt_pk_bf16_f32 v232, v232, v233
  v_cvt_pk_bf16_f32 v233, v234, v235
  v_cvt_pk_bf16_f32 v234, v236, v237
  v_cvt_pk_bf16_f32 v235, v238, v239
  s_nop 1
  v_permlane16_swap_b32 v224, v232
  v_permlane16_swap_b32 v225, v233
  v_permlane16_swap_b32 v226, v234
  v_permlane16_swap_b32 v227, v235
  v_mfma_f32_32x32x16_bf16 v[48:63], v[20:23], v[116:119], v[48:63]
  ds_read_b64_tr_b16 v[36:37], v1 offset:23552
  buffer_store_dwordx4 v[224:227], v2, s[28:31], s40 offen offset:64 sc1
  v_rcp_f32 v11, v11
  v_mul_f32 v102, v102, v10
  v_mul_f32 v103, v103, v11
  v_cvt_pk_bf16_f32 v99, v102, v103
  v_fmaak_f32 v8, v88, v88, 0x409d30fc
  v_fmaak_f32 v9, v89, v89, 0x409d30fc
  v_mul_f32 v8, v88, v8
  v_mul_f32 v9, v89, v9
  v_exp_f32 v8, -v8
  v_exp_f32 v9, -v9
  v_mfma_f32_32x32x16_bf16 v[64:79], v[20:23], v[140:143], v[64:79]
  s_waitcnt lgkmcnt(5)
  ds_read_b64_tr_b16 v[38:39], v1 offset:23808
  v_fma_f32 v8, v8, s36, s36
  v_fma_f32 v9, v9, s36, s36
  v_rcp_f32 v8, v8
  v_rcp_f32 v9, v9
  v_mul_f32 v88, v88, v8
  v_mul_f32 v89, v89, v9
  v_cvt_pk_bf16_f32 v88, v88, v89
  v_fmaak_f32 v10, v104, v104, 0x409d30fc
  v_fmaak_f32 v11, v105, v105, 0x409d30fc
  v_mul_f32 v10, v104, v10
  v_mfma_f32_32x32x16_bf16 v[48:63], v[24:27], v[120:123], v[48:63]
  v_mul_f32 v11, v105, v11
  v_exp_f32 v10, -v10
  v_exp_f32 v11, -v11
  v_fma_f32 v10, v10, s36, s36
  v_fma_f32 v11, v11, s36, s36
  v_rcp_f32 v10, v10
  v_rcp_f32 v11, v11
  v_mul_f32 v104, v104, v10
  v_mul_f32 v105, v105, v11
  v_cvt_pk_bf16_f32 v104, v104, v105
  v_mfma_f32_32x32x16_bf16 v[64:79], v[24:27], v[144:147], v[64:79]
  s_waitcnt lgkmcnt(4)
  v_fmaak_f32 v8, v90, v90, 0x409d30fc
  v_fmaak_f32 v9, v91, v91, 0x409d30fc
  v_mul_f32 v8, v90, v8
  v_mul_f32 v9, v91, v9
  v_exp_f32 v8, -v8
  v_exp_f32 v9, -v9
  v_fma_f32 v8, v8, s36, s36
  v_fma_f32 v9, v9, s36, s36
  v_rcp_f32 v8, v8
  v_rcp_f32 v9, v9
  v_mfma_f32_32x32x16_bf16 v[48:63], v[28:31], v[124:127], v[48:63]
  s_waitcnt lgkmcnt(0)
  s_barrier
  ds_read_b64_tr_b16 v[16:17], v7 offset:24576
  ds_read_b64_tr_b16 v[18:19], v7 offset:26112
  v_mul_f32 v90, v90, v8
  v_mul_f32 v91, v91, v9
  v_cvt_pk_bf16_f32 v89, v90, v91
  v_fmaak_f32 v10, v106, v106, 0x409d30fc
  v_fmaak_f32 v11, v107, v107, 0x409d30fc
  v_mul_f32 v10, v106, v10
  v_mul_f32 v11, v107, v11
  v_exp_f32 v10, -v10
  v_exp_f32 v11, -v11
  v_mfma_f32_32x32x16_bf16 v[64:79], v[28:31], v[148:151], v[64:79]
  ds_read_b64_tr_b16 v[20:21], v7 offset:24640
  ds_read_b64_tr_b16 v[22:23], v7 offset:26176
  buffer_store_dwordx4 v[232:235], v2, s[28:31], s40 offen offset:256 sc1
  v_add_u32 v0, 0, v6
  v_fma_f32 v10, v10, s36, s36
  v_fma_f32 v11, v11, s36, s36
  v_rcp_f32 v10, v10
  v_rcp_f32 v11, v11
  v_mul_f32 v106, v106, v10
  v_mul_f32 v107, v107, v11
  v_cvt_pk_bf16_f32 v105, v106, v107
  v_fmaak_f32 v8, v92, v92, 0x409d30fc
  ds_read2_b32 v[40:41], v0 offset0:0 offset1:78
  ds_read2_b32 v[42:43], v0 offset0:156 offset1:234
  v_add_u32 v0, 2496, v6
  v_mfma_f32_32x32x16_bf16 v[48:63], v[32:35], v[128:131], v[48:63]
  ds_read_b64_tr_b16 v[24:25], v7 offset:27648
  ds_read2_b32 v[44:45], v0 offset0:0 offset1:78
  ds_read2_b32 v[46:47], v0 offset0:156 offset1:234
  v_fmaak_f32 v9, v93, v93, 0x409d30fc
  v_mul_f32 v8, v92, v8
  v_mul_f32 v9, v93, v9
  v_exp_f32 v8, -v8
  v_exp_f32 v9, -v9
  v_fma_f32 v8, v8, s36, s36
  v_fma_f32 v9, v9, s36, s36
  v_mfma_f32_32x32x16_bf16 v[64:79], v[32:35], v[152:155], v[64:79]
  ds_read_b64_tr_b16 v[26:27], v7 offset:29184
  v_rcp_f32 v8, v8
  v_rcp_f32 v9, v9
  v_mul_f32 v92, v92, v8
  v_mul_f32 v93, v93, v9
  v_cvt_pk_bf16_f32 v90, v92, v93
  v_fmaak_f32 v10, v108, v108, 0x409d30fc
  v_fmaak_f32 v11, v109, v109, 0x409d30fc
  v_mul_f32 v10, v108, v10
  v_mul_f32 v11, v109, v11
  v_exp_f32 v10, -v10
  v_mfma_f32_32x32x16_bf16 v[48:63], v[36:39], v[132:135], v[48:63]
  ds_read_b64_tr_b16 v[28:29], v7 offset:27712
  v_exp_f32 v11, -v11
  v_fma_f32 v10, v10, s36, s36
  v_fma_f32 v11, v11, s36, s36
  v_rcp_f32 v10, v10
  v_rcp_f32 v11, v11
  v_mul_f32 v108, v108, v10
  v_mul_f32 v109, v109, v11
  v_cvt_pk_bf16_f32 v106, v108, v109
  v_fmaak_f32 v8, v94, v94, 0x409d30fc
  v_fmaak_f32 v9, v95, v95, 0x409d30fc
  v_mfma_f32_32x32x16_bf16 v[64:79], v[36:39], v[156:159], v[64:79]
  s_waitcnt lgkmcnt(9)
  ds_read_b64_tr_b16 v[30:31], v7 offset:29248
  v_mul_f32 v8, v94, v8
  v_mul_f32 v9, v95, v9
  v_exp_f32 v8, -v8
  v_cvt_pk_bf16_f32 v240, v240, v241
  v_cvt_pk_bf16_f32 v241, v242, v243
  v_cvt_pk_bf16_f32 v242, v244, v245
  v_cvt_pk_bf16_f32 v243, v246, v247
  v_exp_f32 v9, -v9
  v_fma_f32 v8, v8, s36, s36
  v_fma_f32 v9, v9, s36, s36
  v_rcp_f32 v8, v8
  v_mfma_f32_32x32x16_bf16 v[160:175], v[16:19], v[80:83], v[160:175]
  ds_read_b64_tr_b16 v[32:33], v7 offset:24704
  v_cvt_pk_bf16_f32 v248, v248, v249
  v_cvt_pk_bf16_f32 v249, v250, v251
  v_cvt_pk_bf16_f32 v250, v252, v253
  v_cvt_pk_bf16_f32 v251, v254, v255
  s_nop 1
  v_permlane16_swap_b32 v240, v248
  v_permlane16_swap_b32 v241, v249
  v_permlane16_swap_b32 v242, v250
  v_permlane16_swap_b32 v243, v251
  v_rcp_f32 v9, v9
  v_mfma_f32_32x32x16_bf16 v[208:223], v[16:19], v[96:99], 0
  s_waitcnt lgkmcnt(4)
  ds_read_b64_tr_b16 v[34:35], v7 offset:26240
  buffer_store_dwordx4 v[240:243], v2, s[28:31], s40 offen offset:128 sc1
  v_mul_f32 v94, v94, v8
  v_mul_f32 v95, v95, v9
  v_cvt_pk_bf16_f32 v91, v94, v95
  v_fmaak_f32 v10, v110, v110, 0x409d30fc
  v_fmaak_f32 v11, v111, v111, 0x409d30fc
  v_mul_f32 v10, v110, v10
  v_mul_f32 v11, v111, v11
  v_exp_f32 v10, -v10
  v_exp_f32 v11, -v11
  v_smfmac_f32_32x32x32_bf16 v[208:223], v[12:15], v[40:47], v5
  v_fma_f32 v10, v10, s36, s36
  v_fma_f32 v11, v11, s36, s36
  v_rcp_f32 v10, v10
  v_rcp_f32 v11, v11
  v_mul_f32 v110, v110, v10
  v_mul_f32 v111, v111, v11
  v_cvt_pk_bf16_f32 v107, v110, v111
  v_fmaak_f32 v8, v48, v48, 0x409d30fc
  v_mfma_f32_32x32x16_bf16 v[176:191], v[20:23], v[80:83], v[176:191]
  ds_read_b64_tr_b16 v[36:37], v7 offset:27776
  v_add_u32 v0, 4992, v6
  v_fmaak_f32 v9, v49, v49, 0x409d30fc
  v_mul_f32 v8, v48, v8
  v_mul_f32 v9, v49, v9
  v_exp_f32 v8, -v8
  v_exp_f32 v9, -v9
  v_fma_f32 v8, v8, s36, s36
  v_fma_f32 v9, v9, s36, s36
  v_rcp_f32 v8, v8
  v_mfma_f32_32x32x16_bf16 v[224:239], v[20:23], v[96:99], 0
  s_waitcnt lgkmcnt(5)
  ds_read_b64_tr_b16 v[38:39], v7 offset:29312
  ds_read2_b32 v[40:41], v0 offset0:0 offset1:78
  ds_read2_b32 v[42:43], v0 offset0:156 offset1:234
  v_add_u32 v0, 7488, v6
  v_rcp_f32 v9, v9
  v_mul_f32 v48, v48, v8
  v_mul_f32 v49, v49, v9
  v_cvt_pk_bf16_f32 v48, v48, v49
  v_fmaak_f32 v10, v64, v64, 0x409d30fc
  v_fmaak_f32 v11, v65, v65, 0x409d30fc
  v_mfma_f32_32x32x16_bf16 v[160:175], v[24:27], v[88:91], v[160:175]
  ds_read_b64_tr_b16 v[16:17], v1 offset:30720
  ds_read2_b32 v[44:45], v0 offset0:0 offset1:78
  ds_read2_b32 v[46:47], v0 offset0:156 offset1:234
  v_mul_f32 v10, v64, v10
  v_mul_f32 v11, v65, v11
  v_exp_f32 v10, -v10
  v_exp_f32 v11, -v11
  v_fma_f32 v10, v10, s36, s36
  v_fma_f32 v11, v11, s36, s36
  v_rcp_f32 v10, v10
  v_mfma_f32_32x32x16_bf16 v[208:223], v[24:27], v[104:107], v[208:223]
  s_waitcnt lgkmcnt(9)
  ds_read_b64_tr_b16 v[18:19], v1 offset:30976
  v_rcp_f32 v11, v11
  v_mul_f32 v64, v64, v10
  v_mul_f32 v65, v65, v11
  v_cvt_pk_bf16_f32 v64, v64, v65
  v_fmaak_f32 v8, v50, v50, 0x409d30fc
  v_fmaak_f32 v9, v51, v51, 0x409d30fc
  v_mul_f32 v8, v50, v8
  v_mul_f32 v9, v51, v9
  v_exp_f32 v8, -v8
  v_mfma_f32_32x32x16_bf16 v[176:191], v[28:31], v[88:91], v[176:191]
  ds_read_b64_tr_b16 v[20:21], v1 offset:31744
  buffer_store_dwordx4 v[248:251], v2, s[28:31], s40 offen offset:320 sc1
  s_add_u32 s40, s40, s41
  v_exp_f32 v9, -v9
  v_fma_f32 v8, v8, s36, s36
  v_fma_f32 v9, v9, s36, s36
  v_rcp_f32 v8, v8
  v_rcp_f32 v9, v9
  v_mfma_f32_32x32x16_bf16 v[224:239], v[28:31], v[104:107], v[224:239]
  s_waitcnt lgkmcnt(2)
  ds_read_b64_tr_b16 v[22:23], v1 offset:32000
  v_mul_f32 v50, v50, v8
  v_mul_f32 v51, v51, v9
  v_cvt_pk_bf16_f32 v49, v50, v51
  v_fmaak_f32 v10, v66, v66, 0x409d30fc
  v_fmaak_f32 v11, v67, v67, 0x409d30fc
  v_mul_f32 v10, v66, v10
  v_mul_f32 v11, v67, v11
  v_exp_f32 v10, -v10
  v_exp_f32 v11, -v11
  v_smfmac_f32_32x32x32_bf16 v[224:239], v[12:15], v[40:47], v5
  v_fma_f32 v10, v10, s36, s36
  v_fma_f32 v11, v11, s36, s36
  v_rcp_f32 v10, v10
  v_rcp_f32 v11, v11
  v_mul_f32 v66, v66, v10
  v_mul_f32 v67, v67, v11
  v_cvt_pk_bf16_f32 v65, v66, v67
  v_fmaak_f32 v8, v52, v52, 0x409d30fc
  v_fmaak_f32 v9, v53, v53, 0x409d30fc
  v_mfma_f32_32x32x16_bf16 v[192:207], v[32:35], v[80:83], v[192:207]
  ds_read_b64_tr_b16 v[24:25], v1 offset:32768
  v_mul_f32 v8, v52, v8
  v_mul_f32 v9, v53, v9
  v_exp_f32 v8, -v8
  v_add_u32 v0, 9984, v6
  v_exp_f32 v9, -v9
  v_fma_f32 v8, v8, s36, s36
  v_fma_f32 v9, v9, s36, s36
  v_rcp_f32 v8, v8
  v_mfma_f32_32x32x16_bf16 v[240:255], v[32:35], v[96:99], 0
  ds_read_b64_tr_b16 v[26:27], v1 offset:33024
  ds_read2_b32 v[40:41], v0 offset0:0 offset1:78
  ds_read2_b32 v[42:43], v0 offset0:156 offset1:234
  v_rcp_f32 v9, v9
  v_mul_f32 v52, v52, v8
  v_mul_f32 v53, v53, v9
  v_add_u32 v0, 12480, v6
  v_cvt_pk_bf16_f32 v50, v52, v53
  v_fmaak_f32 v10, v68, v68, 0x409d30fc
  v_fmaak_f32 v11, v69, v69, 0x409d30fc
  v_mul_f32 v10, v68, v10
  v_mfma_f32_32x32x16_bf16 v[192:207], v[36:39], v[88:91], v[192:207]
  ds_read_b64_tr_b16 v[28:29], v1 offset:33792
  ds_read2_b32 v[44:45], v0 offset0:0 offset1:78
  ds_read2_b32 v[46:47], v0 offset0:156 offset1:234
  v_mul_f32 v11, v69, v11
  v_exp_f32 v10, -v10
  v_exp_f32 v11, -v11
  v_fma_f32 v10, v10, s36, s36
  v_fma_f32 v11, v11, s36, s36
  v_rcp_f32 v10, v10
  v_mfma_f32_32x32x16_bf16 v[240:255], v[36:39], v[104:107], v[240:255]
  s_waitcnt lgkmcnt(9)
  ds_read_b64_tr_b16 v[30:31], v1 offset:34048
  v_rcp_f32 v11, v11
  v_mul_f32 v68, v68, v10
  v_mul_f32 v69, v69, v11
  v_cvt_pk_bf16_f32 v66, v68, v69
  v_fmaak_f32 v8, v54, v54, 0x409d30fc
  v_fmaak_f32 v9, v55, v55, 0x409d30fc
  v_mul_f32 v8, v54, v8
  v_mul_f32 v9, v55, v9
  v_exp_f32 v8, -v8
  v_mfma_f32_32x32x16_bf16 v[80:95], v[16:19], v[112:115], 0
  ds_read_b64_tr_b16 v[32:33], v1 offset:34816
  v_exp_f32 v9, -v9
  v_fma_f32 v8, v8, s36, s36
  v_fma_f32 v9, v9, s36, s36
  v_rcp_f32 v8, v8
  v_rcp_f32 v9, v9
  v_mul_f32 v54, v54, v8
  v_mul_f32 v55, v55, v9
  v_cvt_pk_bf16_f32 v51, v54, v55
  v_mfma_f32_32x32x16_bf16 v[96:111], v[16:19], v[136:139], 0
  s_waitcnt lgkmcnt(9)
  ds_read_b64_tr_b16 v[34:35], v1 offset:35072
  v_fmaak_f32 v10, v70, v70, 0x409d30fc
  v_fmaak_f32 v11, v71, v71, 0x409d30fc
  v_mul_f32 v10, v70, v10
  v_mul_f32 v11, v71, v11
  v_exp_f32 v10, -v10
  v_exp_f32 v11, -v11
  v_fma_f32 v10, v10, s36, s36
  v_fma_f32 v11, v11, s36, s36
  v_rcp_f32 v10, v10
  v_mfma_f32_32x32x16_bf16 v[80:95], v[20:23], v[116:119], v[80:95]
  ds_read_b64_tr_b16 v[36:37], v1 offset:35840
  v_rcp_f32 v11, v11
  v_mul_f32 v70, v70, v10
  v_mul_f32 v71, v71, v11
  v_cvt_pk_bf16_f32 v67, v70, v71
  v_fmaak_f32 v8, v56, v56, 0x409d30fc
  v_fmaak_f32 v9, v57, v57, 0x409d30fc
  v_mul_f32 v8, v56, v8
  v_mul_f32 v9, v57, v9
  v_exp_f32 v8, -v8
  v_mfma_f32_32x32x16_bf16 v[96:111], v[20:23], v[140:143], v[96:111]
  s_waitcnt lgkmcnt(9)
  ds_read_b64_tr_b16 v[38:39], v1 offset:36096
  v_exp_f32 v9, -v9
  v_fma_f32 v8, v8, s36, s36
  v_fma_f32 v9, v9, s36, s36
  v_rcp_f32 v8, v8
  v_rcp_f32 v9, v9
  v_mul_f32 v56, v56, v8
  v_mul_f32 v57, v57, v9
  v_mfma_f32_32x32x16_bf16 v[80:95], v[24:27], v[120:123], v[80:95]
  v_cvt_pk_bf16_f32 v56, v56, v57
  v_fmaak_f32 v10, v72, v72, 0x409d30fc
  v_fmaak_f32 v11, v73, v73, 0x409d30fc
  v_mul_f32 v10, v72, v10
  v_mul_f32 v11, v73, v11
  v_exp_f32 v10, -v10
  v_exp_f32 v11, -v11
  v_fma_f32 v10, v10, s36, s36
  v_fma_f32 v11, v11, s36, s36
  v_rcp_f32 v10, v10
  v_mfma_f32_32x32x16_bf16 v[96:111], v[24:27], v[144:147], v[96:111]
  s_waitcnt lgkmcnt(5)
  v_rcp_f32 v11, v11
  v_mul_f32 v72, v72, v10
  v_mul_f32 v73, v73, v11
  v_cvt_pk_bf16_f32 v72, v72, v73
  v_fmaak_f32 v8, v58, v58, 0x409d30fc
  v_fmaak_f32 v9, v59, v59, 0x409d30fc
  v_mul_f32 v8, v58, v8
  v_mul_f32 v9, v59, v9
  v_exp_f32 v8, -v8
  v_smfmac_f32_32x32x32_bf16 v[240:255], v[12:15], v[40:47], v5
  s_waitcnt lgkmcnt(0)
  s_barrier
  ds_read_b64_tr_b16 v[16:17], v7 offset:0
  ds_read_b64_tr_b16 v[18:19], v7 offset:1536
  v_exp_f32 v9, -v9
  v_fma_f32 v8, v8, s36, s36
  v_fma_f32 v9, v9, s36, s36
  v_rcp_f32 v8, v8
  v_rcp_f32 v9, v9
  v_mfma_f32_32x32x16_bf16 v[80:95], v[28:31], v[124:127], v[80:95]
  ds_read_b64_tr_b16 v[20:21], v7 offset:64
  v_mul_f32 v58, v58, v8
  v_mul_f32 v59, v59, v9
  v_cvt_pk_bf16_f32 v57, v58, v59
  v_fmaak_f32 v10, v74, v74, 0x409d30fc
  v_fmaak_f32 v11, v75, v75, 0x409d30fc
  v_mul_f32 v10, v74, v10
  v_mul_f32 v11, v75, v11
  v_exp_f32 v10, -v10
  v_exp_f32 v11, -v11
  v_mfma_f32_32x32x16_bf16 v[96:111], v[28:31], v[148:151], v[96:111]
  ds_read_b64_tr_b16 v[22:23], v7 offset:1600
  v_fma_f32 v10, v10, s36, s36
  v_fma_f32 v11, v11, s36, s36
  v_rcp_f32 v10, v10
  v_rcp_f32 v11, v11
  v_mul_f32 v74, v74, v10
  v_mul_f32 v75, v75, v11
  v_cvt_pk_bf16_f32 v73, v74, v75
  v_fmaak_f32 v8, v60, v60, 0x409d30fc
  v_fmaak_f32 v9, v61, v61, 0x409d30fc
  v_mfma_f32_32x32x16_bf16 v[80:95], v[32:35], v[128:131], v[80:95]
  ds_read_b64_tr_b16 v[24:25], v7 offset:3072
  v_mul_f32 v8, v60, v8
  v_mul_f32 v9, v61, v9
  v_exp_f32 v8, -v8
  v_exp_f32 v9, -v9
  v_fma_f32 v8, v8, s36, s36
  v_fma_f32 v9, v9, s36, s36
  v_rcp_f32 v8, v8
  v_rcp_f32 v9, v9
  v_mfma_f32_32x32x16_bf16 v[96:111], v[32:35], v[152:155], v[96:111]
  ds_read_b64_tr_b16 v[26:27], v7 offset:4608
  v_mul_f32 v60, v60, v8
  v_mul_f32 v61, v61, v9
  v_cvt_pk_bf16_f32 v58, v60, v61
  v_fmaak_f32 v10, v76, v76, 0x409d30fc
  v_fmaak_f32 v11, v77, v77, 0x409d30fc
  v_mul_f32 v10, v76, v10
  v_mul_f32 v11, v77, v11
  v_exp_f32 v10, -v10
  v_exp_f32 v11, -v11
  v_mfma_f32_32x32x16_bf16 v[80:95], v[36:39], v[132:135], v[80:95]
  ds_read_b64_tr_b16 v[28:29], v7 offset:3136
  v_fma_f32 v10, v10, s36, s36
  v_fma_f32 v11, v11, s36, s36
  v_rcp_f32 v10, v10
  v_rcp_f32 v11, v11
  v_mul_f32 v76, v76, v10
  v_mul_f32 v77, v77, v11
  v_cvt_pk_bf16_f32 v74, v76, v77
  v_fmaak_f32 v8, v62, v62, 0x409d30fc
  v_mfma_f32_32x32x16_bf16 v[96:111], v[36:39], v[156:159], v[96:111]
  s_waitcnt lgkmcnt(5)
  ds_read_b64_tr_b16 v[30:31], v7 offset:4672
  v_fmaak_f32 v9, v63, v63, 0x409d30fc
  v_mul_f32 v8, v62, v8
  v_mul_f32 v9, v63, v9
  v_exp_f32 v8, -v8
  v_exp_f32 v9, -v9
  v_fma_f32 v8, v8, s36, s36
  v_fma_f32 v9, v9, s36, s36
  v_rcp_f32 v8, v8
  s_add_u32 s42, s42, 1
  s_branch F_mloop
F_mtail:
  v_mfma_f32_32x32x16_bf16 v[160:175], v[16:19], v[48:51], v[160:175]
  ds_read_b64_tr_b16 v[32:33], v7 offset:24704
  v_rcp_f32 v9, v9
  v_mul_f32 v62, v62, v8
  v_mul_f32 v63, v63, v9
  v_cvt_pk_bf16_f32 v59, v62, v63
  v_fmaak_f32 v10, v78, v78, 0x409d30fc
  v_fmaak_f32 v11, v79, v79, 0x409d30fc
  v_mul_f32 v10, v78, v10
  v_mul_f32 v11, v79, v11
  v_exp_f32 v10, -v10
  v_exp_f32 v11, -v11
  v_mfma_f32_32x32x16_bf16 v[208:223], v[16:19], v[64:67], v[208:223]
  s_waitcnt lgkmcnt(5)
  ds_read_b64_tr_b16 v[34:35], v7 offset:26240
  v_fma_f32 v10, v10, s36, s36
  v_fma_f32 v11, v11, s36, s36
  v_rcp_f32 v10, v10
  v_rcp_f32 v11, v11
  v_mul_f32 v78, v78, v10
  v_mul_f32 v79, v79, v11
  v_cvt_pk_bf16_f32 v75, v78, v79
  v_fmaak_f32 v8, v80, v80, 0x409d30fc
  v_mfma_f32_32x32x16_bf16 v[176:191], v[20:23], v[48:51], v[176:191]
  ds_read_b64_tr_b16 v[36:37], v7 offset:27776
  v_fmaak_f32 v9, v81, v81, 0x409d30fc
  v_mul_f32 v8, v80, v8
  v_mul_f32 v9, v81, v9
  v_exp_f32 v8, -v8
  v_exp_f32 v9, -v9
  v_fma_f32 v8, v8, s36, s36
  v_fma_f32 v9, v9, s36, s36
  v_rcp_f32 v8, v8
  v_mfma_f32_32x32x16_bf16 v[224:239], v[20:23], v[64:67], v[224:239]
  s_waitcnt lgkmcnt(5)
  ds_read_b64_tr_b16 v[38:39], v7 offset:29312
  v_rcp_f32 v9, v9
  v_mul_f32 v80, v80, v8
  v_mul_f32 v81, v81, v9
  v_cvt_pk_bf16_f32 v80, v80, v81
  v_fmaak_f32 v10, v96, v96, 0x409d30fc
  v_fmaak_f32 v11, v97, v97, 0x409d30fc
  v_mul_f32 v10, v96, v10
  v_mul_f32 v11, v97, v11
  v_exp_f32 v10, -v10
  v_exp_f32 v11, -v11
  v_mfma_f32_32x32x16_bf16 v[160:175], v[24:27], v[56:59], v[160:175]
  ds_read_b64_tr_b16 v[16:17], v1 offset:30720
  v_fma_f32 v10, v10, s36, s36
  v_fma_f32 v11, v11, s36, s36
  v_rcp_f32 v10, v10
  v_rcp_f32 v11, v11
  v_mul_f32 v96, v96, v10
  v_mul_f32 v97, v97, v11
  v_cvt_pk_bf16_f32 v96, v96, v97
  v_fmaak_f32 v8, v82, v82, 0x409d30fc
  v_mfma_f32_32x32x16_bf16 v[208:223], v[24:27], v[72:75], v[208:223]
  s_waitcnt lgkmcnt(5)
  ds_read_b64_tr_b16 v[18:19], v1 offset:30976
  v_fmaak_f32 v9, v83, v83, 0x409d30fc
  v_mul_f32 v8, v82, v8
  v_mul_f32 v9, v83, v9
  v_exp_f32 v8, -v8
  v_exp_f32 v9, -v9
  v_fma_f32 v8, v8, s36, s36
  v_fma_f32 v9, v9, s36, s36
  v_rcp_f32 v8, v8
  v_mfma_f32_32x32x16_bf16 v[176:191], v[28:31], v[56:59], v[176:191]
  ds_read_b64_tr_b16 v[20:21], v1 offset:31744
  v_rcp_f32 v9, v9
  v_mul_f32 v82, v82, v8
  v_mul_f32 v83, v83, v9
  v_cvt_pk_bf16_f32 v81, v82, v83
  v_fmaak_f32 v10, v98, v98, 0x409d30fc
  v_fmaak_f32 v11, v99, v99, 0x409d30fc
  v_mul_f32 v10, v98, v10
  v_mul_f32 v11, v99, v11
  v_exp_f32 v10, -v10
  v_exp_f32 v11, -v11
  v_mfma_f32_32x32x16_bf16 v[224:239], v[28:31], v[72:75], v[224:239]
  s_waitcnt lgkmcnt(5)
  ds_read_b64_tr_b16 v[22:23], v1 offset:32000
  v_fma_f32 v10, v10, s36, s36
  v_fma_f32 v11, v11, s36, s36
  v_rcp_f32 v10, v10
  v_rcp_f32 v11, v11
  v_mul_f32 v98, v98, v10
  v_mul_f32 v99, v99, v11
  v_cvt_pk_bf16_f32 v97, v98, v99
  v_fmaak_f32 v8, v84, v84, 0x409d30fc
  v_mfma_f32_32x32x16_bf16 v[192:207], v[32:35], v[48:51], v[192:207]
  ds_read_b64_tr_b16 v[24:25], v1 offset:32768
  v_fmaak_f32 v9, v85, v85, 0x409d30fc
  v_mul_f32 v8, v84, v8
  v_mul_f32 v9, v85, v9
  v_exp_f32 v8, -v8
  v_exp_f32 v9, -v9
  v_fma_f32 v8, v8, s36, s36
  v_fma_f32 v9, v9, s36, s36
  v_rcp_f32 v8, v8
  v_mfma_f32_32x32x16_bf16 v[240:255], v[32:35], v[64:67], v[240:255]
  s_waitcnt lgkmcnt(5)
  ds_read_b64_tr_b16 v[26:27], v1 offset:33024
  v_rcp_f32 v9, v9
  v_mul_f32 v84, v84, v8
  v_mul_f32 v85, v85, v9
  v_cvt_pk_bf16_f32 v82, v84, v85
  v_fmaak_f32 v10, v100, v100, 0x409d30fc
  v_fmaak_f32 v11, v101, v101, 0x409d30fc
  v_mul_f32 v10, v100, v10
  v_mul_f32 v11, v101, v11
  v_exp_f32 v10, -v10
  v_exp_f32 v11, -v11
  v_mfma_f32_32x32x16_bf16 v[192:207], v[36:39], v[56:59], v[192:207]
  ds_read_b64_tr_b16 v[28:29], v1 offset:33792
  v_fma_f32 v10, v10, s36, s36
  v_fma_f32 v11, v11, s36, s36
  v_rcp_f32 v10, v10
  v_rcp_f32 v11, v11
  v_mul_f32 v100, v100, v10
  v_mul_f32 v101, v101, v11
  v_cvt_pk_bf16_f32 v98, v100, v101
  v_fmaak_f32 v8, v86, v86, 0x409d30fc
  v_mfma_f32_32x32x16_bf16 v[240:255], v[36:39], v[72:75], v[240:255]
  s_waitcnt lgkmcnt(5)
  ds_read_b64_tr_b16 v[30:31], v1 offset:34048
  v_fmaak_f32 v9, v87, v87, 0x409d30fc
  v_mul_f32 v8, v86, v8
  v_mul_f32 v9, v87, v9
  v_exp_f32 v8, -v8
  v_exp_f32 v9, -v9
  v_fma_f32 v8, v8, s36, s36
  v_fma_f32 v9, v9, s36, s36
  v_rcp_f32 v8, v8
  v_mfma_f32_32x32x16_bf16 v[48:63], v[16:19], v[112:115], 0
  ds_read_b64_tr_b16 v[32:33], v1 offset:34816
  v_rcp_f32 v9, v9
  v_mul_f32 v86, v86, v8
  v_mul_f32 v87, v87, v9
  v_cvt_pk_bf16_f32 v83, v86, v87
  v_fmaak_f32 v10, v102, v102, 0x409d30fc
  v_fmaak_f32 v11, v103, v103, 0x409d30fc
  v_mul_f32 v10, v102, v10
  v_mul_f32 v11, v103, v11
  v_exp_f32 v10, -v10
  v_exp_f32 v11, -v11
  v_mfma_f32_32x32x16_bf16 v[64:79], v[16:19], v[136:139], 0
  s_waitcnt lgkmcnt(5)
  ds_read_b64_tr_b16 v[34:35], v1 offset:35072
  v_fma_f32 v10, v10, s36, s36
  v_fma_f32 v11, v11, s36, s36
  v_rcp_f32 v10, v10
  v_rcp_f32 v11, v11
  v_mul_f32 v102, v102, v10
  v_mul_f32 v103, v103, v11
  v_cvt_pk_bf16_f32 v99, v102, v103
  v_fmaak_f32 v8, v88, v88, 0x409d30fc
  v_mfma_f32_32x32x16_bf16 v[48:63], v[20:23], v[116:119], v[48:63]
  ds_read_b64_tr_b16 v[36:37], v1 offset:35840
  v_fmaak_f32 v9, v89, v89, 0x409d30fc
  v_mul_f32 v8, v88, v8
  v_mul_f32 v9, v89, v9
  v_exp_f32 v8, -v8
  v_exp_f32 v9, -v9
  v_fma_f32 v8, v8, s36, s36
  v_fma_f32 v9, v9, s36, s36
  v_rcp_f32 v8, v8
  v_mfma_f32_32x32x16_bf16 v[64:79], v[20:23], v[140:143], v[64:79]
  s_waitcnt lgkmcnt(5)
  ds_read_b64_tr_b16 v[38:39], v1 offset:36096
  v_rcp_f32 v9, v9
  v_mul_f32 v88, v88, v8
  v_mul_f32 v89, v89, v9
  v_cvt_pk_bf16_f32 v88, v88, v89
  v_fmaak_f32 v10, v104, v104, 0x409d30fc
  v_fmaak_f32 v11, v105, v105, 0x409d30fc
  v_mul_f32 v10, v104, v10
  v_mul_f32 v11, v105, v11
  v_exp_f32 v10, -v10
  v_exp_f32 v11, -v11
  v_mfma_f32_32x32x16_bf16 v[48:63], v[24:27], v[120:123], v[48:63]
  v_fma_f32 v10, v10, s36, s36
  v_fma_f32 v11, v11, s36, s36
  v_rcp_f32 v10, v10
  v_rcp_f32 v11, v11
  v_mul_f32 v104, v104, v10
  v_mul_f32 v105, v105, v11
  v_cvt_pk_bf16_f32 v104, v104, v105
  v_fmaak_f32 v8, v90, v90, 0x409d30fc
  v_fmaak_f32 v9, v91, v91, 0x409d30fc
  v_mfma_f32_32x32x16_bf16 v[64:79], v[24:27], v[144:147], v[64:79]
  s_waitcnt lgkmcnt(4)
  v_mul_f32 v8, v90, v8
  v_mul_f32 v9, v91, v9
  v_exp_f32 v8, -v8
  v_exp_f32 v9, -v9
  v_fma_f32 v8, v8, s36, s36
  v_fma_f32 v9, v9, s36, s36
  v_rcp_f32 v8, v8
  v_rcp_f32 v9, v9
  v_mfma_f32_32x32x16_bf16 v[48:63], v[28:31], v[124:127], v[48:63]
  s_waitcnt lgkmcnt(0)
  s_barrier
  v_add_u32 v1, 41984, v1
  v_add_u32 v7, 41984, v7
  ds_read_b64_tr_b16 v[16:17], v7 offset:0
  ds_read_b64_tr_b16 v[18:19], v7 offset:1536
  v_mul_f32 v90, v90, v8
  v_mul_f32 v91, v91, v9
  v_cvt_pk_bf16_f32 v89, v90, v91
  v_fmaak_f32 v10, v106, v106, 0x409d30fc
  v_fmaak_f32 v11, v107, v107, 0x409d30fc
  v_mul_f32 v10, v106, v10
  v_mul_f32 v11, v107, v11
  v_exp_f32 v10, -v10
  v_mfma_f32_32x32x16_bf16 v[64:79], v[28:31], v[148:151], v[64:79]
  ds_read_b64_tr_b16 v[20:21], v7 offset:64
  ds_read_b64_tr_b16 v[22:23], v7 offset:1600
  v_exp_f32 v11, -v11
  v_fma_f32 v10, v10, s36, s36
  v_fma_f32 v11, v11, s36, s36
  v_rcp_f32 v10, v10
  v_rcp_f32 v11, v11
  v_mul_f32 v106, v106, v10
  v_mfma_f32_32x32x16_bf16 v[48:63], v[32:35], v[128:131], v[48:63]
  ds_read_b64_tr_b16 v[24:25], v7 offset:3072
  v_mul_f32 v107, v107, v11
  v_cvt_pk_bf16_f32 v105, v106, v107
  v_fmaak_f32 v8, v92, v92, 0x409d30fc
  v_fmaak_f32 v9, v93, v93, 0x409d30fc
  v_mul_f32 v8, v92, v8
  v_mul_f32 v9, v93, v9
  v_exp_f32 v8, -v8
  v_exp_f32 v9, -v9
  v_fma_f32 v8, v8, s36, s36
  v_mfma_f32_32x32x16_bf16 v[64:79], v[32:35], v[152:155], v[64:79]
  ds_read_b64_tr_b16 v[26:27], v7 offset:4608
  v_fma_f32 v9, v9, s36, s36
  v_rcp_f32 v8, v8
  v_rcp_f32 v9, v9
  v_mul_f32 v92, v92, v8
  v_mul_f32 v93, v93, v9
  v_cvt_pk_bf16_f32 v90, v92, v93
  v_fmaak_f32 v10, v108, v108, 0x409d30fc
  v_fmaak_f32 v11, v109, v109, 0x409d30fc
  v_mul_f32 v10, v108, v10
  v_mul_f32 v11, v109, v11
  v_mfma_f32_32x32x16_bf16 v[48:63], v[36:39], v[132:135], v[48:63]
  ds_read_b64_tr_b16 v[28:29], v7 offset:3136
  v_exp_f32 v10, -v10
  v_exp_f32 v11, -v11
  v_fma_f32 v10, v10, s36, s36
  v_fma_f32 v11, v11, s36, s36
  v_rcp_f32 v10, v10
  v_rcp_f32 v11, v11
  v_mul_f32 v108, v108, v10
  v_mfma_f32_32x32x16_bf16 v[64:79], v[36:39], v[156:159], v[64:79]
  s_waitcnt lgkmcnt(5)
  ds_read_b64_tr_b16 v[30:31], v7 offset:4672
  v_mul_f32 v109, v109, v11
  v_cvt_pk_bf16_f32 v106, v108, v109
  v_fmaak_f32 v8, v94, v94, 0x409d30fc
  v_fmaak_f32 v9, v95, v95, 0x409d30fc
  v_mul_f32 v8, v94, v8
  v_mul_f32 v9, v95, v9
  v_exp_f32 v8, -v8
  v_exp_f32 v9, -v9
  v_fma_f32 v8, v8, s36, s36
  v_fma_f32 v9, v9, s36, s36
  v_rcp_f32 v8, v8
  v_mfma_f32_32x32x16_bf16 v[160:175], v[16:19], v[80:83], v[160:175]
  ds_read_b64_tr_b16 v[32:33], v7 offset:128
  v_rcp_f32 v9, v9
  v_mul_f32 v94, v94, v8
  v_mul_f32 v95, v95, v9
  v_cvt_pk_bf16_f32 v91, v94, v95
  v_fmaak_f32 v10, v110, v110, 0x409d30fc
  v_fmaak_f32 v11, v111, v111, 0x409d30fc
  v_mul_f32 v10, v110, v10
  v_mul_f32 v11, v111, v11
  v_exp_f32 v10, -v10
  v_exp_f32 v11, -v11
  v_fma_f32 v10, v10, s36, s36
  v_fma_f32 v11, v11, s36, s36
  v_rcp_f32 v10, v10
  v_mfma_f32_32x32x16_bf16 v[208:223], v[16:19], v[96:99], v[208:223]
  s_waitcnt lgkmcnt(5)
  ds_read_b64_tr_b16 v[34:35], v7 offset:1664
  v_rcp_f32 v11, v11
  v_mul_f32 v110, v110, v10
  v_mul_f32 v111, v111, v11
  v_cvt_pk_bf16_f32 v107, v110, v111
  v_fmaak_f32 v8, v48, v48, 0x409d30fc
  v_fmaak_f32 v9, v49, v49, 0x409d30fc
  v_mul_f32 v8, v48, v8
  v_mul_f32 v9, v49, v9
  v_exp_f32 v8, -v8
  v_exp_f32 v9, -v9
  v_fma_f32 v8, v8, s36, s36
  v_mfma_f32_32x32x16_bf16 v[176:191], v[20:23], v[80:83], v[176:191]
  ds_read_b64_tr_b16 v[36:37], v7 offset:3200
  v_fma_f32 v9, v9, s36, s36
  v_rcp_f32 v8, v8
  v_rcp_f32 v9, v9
  v_mul_f32 v48, v48, v8
  v_mul_f32 v49, v49, v9
  v_cvt_pk_bf16_f32 v48, v48, v49
  v_fmaak_f32 v10, v64, v64, 0x409d30fc
  v_fmaak_f32 v11, v65, v65, 0x409d30fc
  v_mul_f32 v10, v64, v10
  v_mul_f32 v11, v65, v11
  v_exp_f32 v10, -v10
  v_exp_f32 v11, -v11
  v_mfma_f32_32x32x16_bf16 v[224:239], v[20:23], v[96:99], v[224:239]
  s_waitcnt lgkmcnt(5)
  ds_read_b64_tr_b16 v[38:39], v7 offset:4736
  v_fma_f32 v10, v10, s36, s36
  v_fma_f32 v11, v11, s36, s36
  v_rcp_f32 v10, v10
  v_rcp_f32 v11, v11
  v_mul_f32 v64, v64, v10
  v_mul_f32 v65, v65, v11
  v_cvt_pk_bf16_f32 v64, v64, v65
  v_fmaak_f32 v8, v50, v50, 0x409d30fc
  v_fmaak_f32 v9, v51, v51, 0x409d30fc
  v_mul_f32 v8, v50, v8
  v_mul_f32 v9, v51, v9
  v_exp_f32 v8, -v8
  v_mfma_f32_32x32x16_bf16 v[160:175], v[24:27], v[88:91], v[160:175]
  ds_read_b64_tr_b16 v[16:17], v1 offset:6144
  v_exp_f32 v9, -v9
  v_fma_f32 v8, v8, s36, s36
  v_fma_f32 v9, v9, s36, s36
  v_rcp_f32 v8, v8
  v_rcp_f32 v9, v9
  v_mul_f32 v50, v50, v8
  v_mul_f32 v51, v51, v9
  v_cvt_pk_bf16_f32 v49, v50, v51
  v_fmaak_f32 v10, v66, v66, 0x409d30fc
  v_fmaak_f32 v11, v67, v67, 0x409d30fc
  v_mul_f32 v10, v66, v10
  v_mul_f32 v11, v67, v11
  v_exp_f32 v10, -v10
  v_mfma_f32_32x32x16_bf16 v[208:223], v[24:27], v[104:107], v[208:223]
  s_waitcnt lgkmcnt(5)
  ds_read_b64_tr_b16 v[18:19], v1 offset:6400
  v_exp_f32 v11, -v11
  v_fma_f32 v10, v10, s36, s36
  v_fma_f32 v11, v11, s36, s36
  v_rcp_f32 v10, v10
  v_rcp_f32 v11, v11
  v_mul_f32 v66, v66, v10
  v_mul_f32 v67, v67, v11
  v_cvt_pk_bf16_f32 v65, v66, v67
  v_fmaak_f32 v8, v52, v52, 0x409d30fc
  v_fmaak_f32 v9, v53, v53, 0x409d30fc
  v_mul_f32 v8, v52, v8
  v_mfma_f32_32x32x16_bf16 v[176:191], v[28:31], v[88:91], v[176:191]
  ds_read_b64_tr_b16 v[20:21], v1 offset:7168
  v_mul_f32 v9, v53, v9
  v_exp_f32 v8, -v8
  v_exp_f32 v9, -v9
  v_fma_f32 v8, v8, s36, s36
  v_fma_f32 v9, v9, s36, s36
  v_rcp_f32 v8, v8
  v_rcp_f32 v9, v9
  v_mul_f32 v52, v52, v8
  v_mul_f32 v53, v53, v9
  v_cvt_pk_bf16_f32 v50, v52, v53
  v_fmaak_f32 v10, v68, v68, 0x409d30fc
  v_fmaak_f32 v11, v69, v69, 0x409d30fc
  v_mfma_f32_32x32x16_bf16 v[224:239], v[28:31], v[104:107], v[224:239]
  s_waitcnt lgkmcnt(5)
  ds_read_b64_tr_b16 v[22:23], v1 offset:7424
  v_mul_f32 v10, v68, v10
  v_mul_f32 v11, v69, v11
  v_exp_f32 v10, -v10
  v_exp_f32 v11, -v11
  v_fma_f32 v10, v10, s36, s36
  v_fma_f32 v11, v11, s36, s36
  v_rcp_f32 v10, v10
  v_rcp_f32 v11, v11
  v_mul_f32 v68, v68, v10
  v_mul_f32 v69, v69, v11
  v_cvt_pk_bf16_f32 v66, v68, v69
  v_mfma_f32_32x32x16_bf16 v[192:207], v[32:35], v[80:83], v[192:207]
  ds_read_b64_tr_b16 v[24:25], v1 offset:8192
  v_fmaak_f32 v8, v54, v54, 0x409d30fc
  v_fmaak_f32 v9, v55, v55, 0x409d30fc
  v_mul_f32 v8, v54, v8
  v_mul_f32 v9, v55, v9
  v_exp_f32 v8, -v8
  v_exp_f32 v9, -v9
  v_fma_f32 v8, v8, s36, s36
  v_fma_f32 v9, v9, s36, s36
  v_rcp_f32 v8, v8
  v_rcp_f32 v9, v9
  v_mul_f32 v54, v54, v8
  v_mfma_f32_32x32x16_bf16 v[240:255], v[32:35], v[96:99], v[240:255]
  s_waitcnt lgkmcnt(5)
  ds_read_b64_tr_b16 v[26:27], v1 offset:8448
  v_mul_f32 v55, v55, v9
  v_cvt_pk_bf16_f32 v51, v54, v55
  v_fmaak_f32 v10, v70, v70, 0x409d30fc
  v_fmaak_f32 v11, v71, v71, 0x409d30fc
  v_mul_f32 v10, v70, v10
  v_mul_f32 v11, v71, v11
  v_exp_f32 v10, -v10
  v_exp_f32 v11, -v11
  v_fma_f32 v10, v10, s36, s36
  v_fma_f32 v11, v11, s36, s36
  v_rcp_f32 v10, v10
  v_rcp_f32 v11, v11
  v_mfma_f32_32x32x16_bf16 v[192:207], v[36:39], v[88:91], v[192:207]
  ds_read_b64_tr_b16 v[28:29], v1 offset:9216
  v_mul_f32 v70, v70, v10
  v_mul_f32 v71, v71, v11
  v_cvt_pk_bf16_f32 v67, v70, v71
  v_fmaak_f32 v8, v56, v56, 0x409d30fc
  v_fmaak_f32 v9, v57, v57, 0x409d30fc
  v_mul_f32 v8, v56, v8
  v_mul_f32 v9, v57, v9
  v_exp_f32 v8, -v8
  v_exp_f32 v9, -v9
  v_fma_f32 v8, v8, s36, s36
  v_fma_f32 v9, v9, s36, s36
  v_rcp_f32 v8, v8
  v_mfma_f32_32x32x16_bf16 v[240:255], v[36:39], v[104:107], v[240:255]
  s_waitcnt lgkmcnt(5)
  ds_read_b64_tr_b16 v[30:31], v1 offset:9472
  v_rcp_f32 v9, v9
  v_mul_f32 v56, v56, v8
  v_mul_f32 v57, v57, v9
  v_cvt_pk_bf16_f32 v56, v56, v57
  v_fmaak_f32 v10, v72, v72, 0x409d30fc
  v_fmaak_f32 v11, v73, v73, 0x409d30fc
  v_mul_f32 v10, v72, v10
  v_mul_f32 v11, v73, v11
  v_exp_f32 v10, -v10
  v_exp_f32 v11, -v11
  v_fma_f32 v10, v10, s36, s36
  v_fma_f32 v11, v11, s36, s36
  v_rcp_f32 v10, v10
  v_mfma_f32_32x32x16_bf16 v[96:111], v[16:19], v[136:139], 0
  s_waitcnt lgkmcnt(4)
  ds_read_b64_tr_b16 v[32:33], v1 offset:10240
  ds_read_b64_tr_b16 v[34:35], v1 offset:10496
  v_rcp_f32 v11, v11
  v_mul_f32 v72, v72, v10
  v_mul_f32 v73, v73, v11
  v_cvt_pk_bf16_f32 v72, v72, v73
  v_fmaak_f32 v8, v58, v58, 0x409d30fc
  v_fmaak_f32 v9, v59, v59, 0x409d30fc
  v_mul_f32 v8, v58, v8
  v_mul_f32 v9, v59, v9
  v_exp_f32 v8, -v8
  v_exp_f32 v9, -v9
  v_mfma_f32_32x32x16_bf16 v[96:111], v[20:23], v[140:143], v[96:111]
  s_waitcnt lgkmcnt(4)
  ds_read_b64_tr_b16 v[36:37], v1 offset:11264
  ds_read_b64_tr_b16 v[38:39], v1 offset:11520
  v_fma_f32 v8, v8, s36, s36
  v_fma_f32 v9, v9, s36, s36
  v_rcp_f32 v8, v8
  v_rcp_f32 v9, v9
  v_mul_f32 v58, v58, v8
  v_mul_f32 v59, v59, v9
  v_cvt_pk_bf16_f32 v57, v58, v59
  v_fmaak_f32 v10, v74, v74, 0x409d30fc
  v_fmaak_f32 v11, v75, v75, 0x409d30fc
  v_mul_f32 v10, v74, v10
  v_mul_f32 v11, v75, v11
  v_exp_f32 v10, -v10
  v_mfma_f32_32x32x16_bf16 v[96:111], v[24:27], v[144:147], v[96:111]
  s_waitcnt lgkmcnt(0)
  s_barrier
  ds_read_b64_tr_b16 v[16:17], v7 offset:12288
  ds_read_b64_tr_b16 v[18:19], v7 offset:13824
  v_exp_f32 v11, -v11
  v_fma_f32 v10, v10, s36, s36
  v_fma_f32 v11, v11, s36, s36
  v_rcp_f32 v10, v10
  v_rcp_f32 v11, v11
  v_mul_f32 v74, v74, v10
  v_mul_f32 v75, v75, v11
  v_cvt_pk_bf16_f32 v73, v74, v75
  v_fmaak_f32 v8, v60, v60, 0x409d30fc
  v_fmaak_f32 v9, v61, v61, 0x409d30fc
  v_mfma_f32_32x32x16_bf16 v[96:111], v[28:31], v[148:151], v[96:111]
  ds_read_b64_tr_b16 v[20:21], v7 offset:12352
  ds_read_b64_tr_b16 v[22:23], v7 offset:13888
  v_mul_f32 v8, v60, v8
  v_mul_f32 v9, v61, v9
  v_exp_f32 v8, -v8
  v_exp_f32 v9, -v9
  v_fma_f32 v8, v8, s36, s36
  v_fma_f32 v9, v9, s36, s36
  v_rcp_f32 v8, v8
  v_rcp_f32 v9, v9
  v_mul_f32 v60, v60, v8
  v_mul_f32 v61, v61, v9
  v_cvt_pk_bf16_f32 v58, v60, v61
  v_mfma_f32_32x32x16_bf16 v[96:111], v[32:35], v[152:155], v[96:111]
  ds_read_b64_tr_b16 v[24:25], v7 offset:15360
  ds_read_b64_tr_b16 v[26:27], v7 offset:16896
  v_fmaak_f32 v10, v76, v76, 0x409d30fc
  v_fmaak_f32 v11, v77, v77, 0x409d30fc
  v_mul_f32 v10, v76, v10
  v_mul_f32 v11, v77, v11
  v_exp_f32 v10, -v10
  v_exp_f32 v11, -v11
  v_fma_f32 v10, v10, s36, s36
  v_fma_f32 v11, v11, s36, s36
  v_rcp_f32 v10, v10
  v_rcp_f32 v11, v11
  v_mfma_f32_32x32x16_bf16 v[96:111], v[36:39], v[156:159], v[96:111]
  s_waitcnt lgkmcnt(4)
  ds_read_b64_tr_b16 v[28:29], v7 offset:15424
  ds_read_b64_tr_b16 v[30:31], v7 offset:16960
  v_mul_f32 v76, v76, v10
  v_mul_f32 v77, v77, v11
  v_cvt_pk_bf16_f32 v74, v76, v77
  v_fmaak_f32 v8, v62, v62, 0x409d30fc
  v_fmaak_f32 v9, v63, v63, 0x409d30fc
  v_mul_f32 v8, v62, v8
  v_mul_f32 v9, v63, v9
  v_exp_f32 v8, -v8
  v_exp_f32 v9, -v9
  v_fma_f32 v8, v8, s36, s36
  v_fma_f32 v9, v9, s36, s36
  v_rcp_f32 v8, v8
  v_mfma_f32_32x32x16_bf16 v[160:175], v[16:19], v[48:51], v[160:175]
  ds_read_b64_tr_b16 v[32:33], v7 offset:12416
  v_rcp_f32 v9, v9
  v_mul_f32 v62, v62, v8
  v_mul_f32 v63, v63, v9
  v_cvt_pk_bf16_f32 v59, v62, v63
  v_fmaak_f32 v10, v78, v78, 0x409d30fc
  v_fmaak_f32 v11, v79, v79, 0x409d30fc
  v_mul_f32 v10, v78, v10
  v_mul_f32 v11, v79, v11
  v_exp_f32 v10, -v10
  v_mfma_f32_32x32x16_bf16 v[208:223], v[16:19], v[64:67], v[208:223]
  s_waitcnt lgkmcnt(5)
  ds_read_b64_tr_b16 v[34:35], v7 offset:13952
  v_exp_f32 v11, -v11
  v_fma_f32 v10, v10, s36, s36
  v_fma_f32 v11, v11, s36, s36
  v_rcp_f32 v10, v10
  v_rcp_f32 v11, v11
  v_mul_f32 v78, v78, v10
  v_mfma_f32_32x32x16_bf16 v[176:191], v[20:23], v[48:51], v[176:191]
  ds_read_b64_tr_b16 v[36:37], v7 offset:15488
  v_mul_f32 v79, v79, v11
  v_cvt_pk_bf16_f32 v75, v78, v79
  v_fmaak_f32 v8, v96, v96, 0x409d30fc
  v_fmaak_f32 v9, v97, v97, 0x409d30fc
  v_mul_f32 v8, v96, v8
  v_mul_f32 v9, v97, v9
  v_exp_f32 v8, -v8
  v_exp_f32 v9, -v9
  v_mfma_f32_32x32x16_bf16 v[224:239], v[20:23], v[64:67], v[224:239]
  s_waitcnt lgkmcnt(5)
  ds_read_b64_tr_b16 v[38:39], v7 offset:17024
  v_fma_f32 v8, v8, s36, s36
  v_fma_f32 v9, v9, s36, s36
  v_rcp_f32 v8, v8
  v_mfma_f32_32x32x16_bf16 v[160:175], v[24:27], v[56:59], v[160:175]
  ds_read_b64_tr_b16 v[16:17], v1 offset:18432
  v_mfma_f32_32x32x16_bf16 v[208:223], v[24:27], v[72:75], v[208:223]
  s_waitcnt lgkmcnt(5)
  ds_read_b64_tr_b16 v[18:19], v1 offset:18688
  s_nop 7
  v_cvt_pk_bf16_f32 v160, v160, v161
  v_cvt_pk_bf16_f32 v161, v162, v163
  v_cvt_pk_bf16_f32 v162, v164, v165
  v_cvt_pk_bf16_f32 v163, v166, v167
  v_rcp_f32 v9, v9
  v_cvt_pk_bf16_f32 v168, v168, v169
  v_cvt_pk_bf16_f32 v169, v170, v171
  v_mul_f32 v96, v96, v8
  v_cvt_pk_bf16_f32 v170, v172, v173
  v_cvt_pk_bf16_f32 v171, v174, v175
  s_nop 1
  v_permlane16_swap_b32 v160, v168
  v_permlane16_swap_b32 v161, v169
  v_permlane16_swap_b32 v162, v170
  v_permlane16_swap_b32 v163, v171
  v_mul_f32 v97, v97, v9
  v_cvt_pk_bf16_f32 v96, v96, v97
  v_fmaak_f32 v10, v98, v98, 0x409d30fc
  v_fmaak_f32 v11, v99, v99, 0x409d30fc
  v_mul_f32 v10, v98, v10
  v_mul_f32 v11, v99, v11
  v_exp_f32 v10, -v10
  v_mfma_f32_32x32x16_bf16 v[176:191], v[28:31], v[56:59], v[176:191]
  ds_read_b64_tr_b16 v[20:21], v1 offset:19456
  buffer_store_dwordx4 v[160:163], v2, s[28:31], s40 offen offset:0 sc1
  v_exp_f32 v11, -v11
  v_fma_f32 v10, v10, s36, s36
  v_fma_f32 v11, v11, s36, s36
  v_rcp_f32 v10, v10
  v_rcp_f32 v11, v11
  v_mul_f32 v98, v98, v10
  v_mfma_f32_32x32x16_bf16 v[224:239], v[28:31], v[72:75], v[224:239]
  s_waitcnt lgkmcnt(5)
  ds_read_b64_tr_b16 v[22:23], v1 offset:19712
  v_mul_f32 v99, v99, v11
  v_cvt_pk_bf16_f32 v97, v98, v99
  v_fmaak_f32 v8, v100, v100, 0x409d30fc
  v_fmaak_f32 v9, v101, v101, 0x409d30fc
  v_mul_f32 v8, v100, v8
  v_mul_f32 v9, v101, v9
  v_exp_f32 v8, -v8
  v_exp_f32 v9, -v9
  v_mfma_f32_32x32x16_bf16 v[192:207], v[32:35], v[48:51], v[192:207]
  ds_read_b64_tr_b16 v[24:25], v1 offset:20480
  v_fma_f32 v8, v8, s36, s36
  v_fma_f32 v9, v9, s36, s36
  v_rcp_f32 v8, v8
  v_rcp_f32 v9, v9
  v_mul_f32 v100, v100, v8
  v_mul_f32 v101, v101, v9
  v_cvt_pk_bf16_f32 v176, v176, v177
  v_mfma_f32_32x32x16_bf16 v[240:255], v[32:35], v[64:67], v[240:255]
  s_waitcnt lgkmcnt(5)
  ds_read_b64_tr_b16 v[26:27], v1 offset:20736
  buffer_store_dwordx4 v[168:171], v2, s[28:31], s40 offen offset:192 sc1
  v_cvt_pk_bf16_f32 v177, v178, v179
  v_cvt_pk_bf16_f32 v178, v180, v181
  v_cvt_pk_bf16_f32 v98, v100, v101
  v_cvt_pk_bf16_f32 v179, v182, v183
  v_fmaak_f32 v10, v102, v102, 0x409d30fc
  v_fmaak_f32 v11, v103, v103, 0x409d30fc
  v_cvt_pk_bf16_f32 v184, v184, v185
  v_cvt_pk_bf16_f32 v185, v186, v187
  v_cvt_pk_bf16_f32 v186, v188, v189
  v_mfma_f32_32x32x16_bf16 v[192:207], v[36:39], v[56:59], v[192:207]
  ds_read_b64_tr_b16 v[28:29], v1 offset:21504
  v_cvt_pk_bf16_f32 v187, v190, v191
  s_nop 1
  v_permlane16_swap_b32 v176, v184
  v_permlane16_swap_b32 v177, v185
  v_permlane16_swap_b32 v178, v186
  v_permlane16_swap_b32 v179, v187
  v_mul_f32 v10, v102, v10
  v_mul_f32 v11, v103, v11
  v_exp_f32 v10, -v10
  v_mfma_f32_32x32x16_bf16 v[240:255], v[36:39], v[72:75], v[240:255]
  s_waitcnt lgkmcnt(5)
  ds_read_b64_tr_b16 v[30:31], v1 offset:21760
  buffer_store_dwordx4 v[176:179], v2, s[28:31], s40 offen offset:64 sc1
  v_exp_f32 v11, -v11
  v_fma_f32 v10, v10, s36, s36
  v_fma_f32 v11, v11, s36, s36
  v_rcp_f32 v10, v10
  v_rcp_f32 v11, v11
  v_mfma_f32_32x32x16_bf16 v[64:79], v[16:19], v[136:139], 0
  s_waitcnt lgkmcnt(4)
  ds_read_b64_tr_b16 v[32:33], v1 offset:22528
  ds_read_b64_tr_b16 v[34:35], v1 offset:22784
  v_mul_f32 v102, v102, v10
  v_mul_f32 v103, v103, v11
  v_cvt_pk_bf16_f32 v99, v102, v103
  v_fmaak_f32 v8, v104, v104, 0x409d30fc
  v_fmaak_f32 v9, v105, v105, 0x409d30fc
  v_mul_f32 v8, v104, v8
  v_mul_f32 v9, v105, v9
  v_exp_f32 v8, -v8
  v_mfma_f32_32x32x16_bf16 v[64:79], v[20:23], v[140:143], v[64:79]
  s_waitcnt lgkmcnt(4)
  ds_read_b64_tr_b16 v[36:37], v1 offset:23552
  ds_read_b64_tr_b16 v[38:39], v1 offset:23808
  v_exp_f32 v9, -v9
  v_fma_f32 v8, v8, s36, s36
  v_fma_f32 v9, v9, s36, s36
  v_rcp_f32 v8, v8
  v_rcp_f32 v9, v9
  v_mul_f32 v104, v104, v8
  v_mfma_f32_32x32x16_bf16 v[64:79], v[24:27], v[144:147], v[64:79]
  s_waitcnt lgkmcnt(4)
  ds_read_b64_tr_b16 v[16:17], v7 offset:24576
  ds_read_b64_tr_b16 v[18:19], v7 offset:26112
  buffer_store_dwordx4 v[184:187], v2, s[28:31], s40 offen offset:256 sc1
  v_mul_f32 v105, v105, v9
  v_cvt_pk_bf16_f32 v104, v104, v105
  v_fmaak_f32 v10, v106, v106, 0x409d30fc
  v_fmaak_f32 v11, v107, v107, 0x409d30fc
  v_mul_f32 v10, v106, v10
  v_mul_f32 v11, v107, v11
  v_exp_f32 v10, -v10
  v_mfma_f32_32x32x16_bf16 v[64:79], v[28:31], v[148:151], v[64:79]
  s_waitcnt lgkmcnt(4)
  ds_read_b64_tr_b16 v[20:21], v7 offset:24640
  ds_read_b64_tr_b16 v[22:23], v7 offset:26176
  v_exp_f32 v11, -v11
  v_fma_f32 v10, v10, s36, s36
  v_fma_f32 v11, v11, s36, s36
  v_rcp_f32 v10, v10
  v_rcp_f32 v11, v11
  v_mfma_f32_32x32x16_bf16 v[64:79], v[32:35], v[152:155], v[64:79]
  s_waitcnt lgkmcnt(4)
  ds_read_b64_tr_b16 v[24:25], v7 offset:27648
  ds_read_b64_tr_b16 v[26:27], v7 offset:29184
  v_mul_f32 v106, v106, v10
  v_mul_f32 v107, v107, v11
  v_cvt_pk_bf16_f32 v105, v106, v107
  v_fmaak_f32 v8, v108, v108, 0x409d30fc
  v_fmaak_f32 v9, v109, v109, 0x409d30fc
  v_mul_f32 v8, v108, v8
  v_mul_f32 v9, v109, v9
  v_exp_f32 v8, -v8
  v_mfma_f32_32x32x16_bf16 v[64:79], v[36:39], v[156:159], v[64:79]
  s_waitcnt lgkmcnt(4)
  ds_read_b64_tr_b16 v[28:29], v7 offset:27712
  ds_read_b64_tr_b16 v[30:31], v7 offset:29248
  v_exp_f32 v9, -v9
  v_cvt_pk_bf16_f32 v192, v192, v193
  v_cvt_pk_bf16_f32 v193, v194, v195
  v_cvt_pk_bf16_f32 v194, v196, v197
  v_cvt_pk_bf16_f32 v195, v198, v199
  v_fma_f32 v8, v8, s36, s36
  v_fma_f32 v9, v9, s36, s36
  v_mfma_f32_32x32x16_bf16 v[208:223], v[16:19], v[96:99], v[208:223]
  s_waitcnt lgkmcnt(4)
  ds_read_b64_tr_b16 v[32:33], v7 offset:24704
  ds_read_b64_tr_b16 v[34:35], v7 offset:26240
  v_cvt_pk_bf16_f32 v200, v200, v201
  v_cvt_pk_bf16_f32 v201, v202, v203
  v_rcp_f32 v8, v8
  v_cvt_pk_bf16_f32 v202, v204, v205
  v_cvt_pk_bf16_f32 v203, v206, v207
  s_nop 1
  v_permlane16_swap_b32 v192, v200
  v_permlane16_swap_b32 v193, v201
  v_permlane16_swap_b32 v194, v202
  v_permlane16_swap_b32 v195, v203
  v_rcp_f32 v9, v9
  v_mfma_f32_32x32x16_bf16 v[224:239], v[20:23], v[96:99], v[224:239]
  s_waitcnt lgkmcnt(4)
  ds_read_b64_tr_b16 v[36:37], v7 offset:27776
  ds_read_b64_tr_b16 v[38:39], v7 offset:29312
  buffer_store_dwordx4 v[192:195], v2, s[28:31], s40 offen offset:128 sc1
  v_mul_f32 v108, v108, v8
  v_mul_f32 v109, v109, v9
  v_cvt_pk_bf16_f32 v106, v108, v109
  v_fmaak_f32 v10, v110, v110, 0x409d30fc
  v_fmaak_f32 v11, v111, v111, 0x409d30fc
  v_mul_f32 v10, v110, v10
  v_mul_f32 v11, v111, v11
  v_exp_f32 v10, -v10
  v_exp_f32 v11, -v11
  v_fma_f32 v10, v10, s36, s36
  v_fma_f32 v11, v11, s36, s36
  v_rcp_f32 v10, v10
  v_rcp_f32 v11, v11
  v_mul_f32 v110, v110, v10
  v_mul_f32 v111, v111, v11
  v_cvt_pk_bf16_f32 v107, v110, v111
  s_nop 1
  v_mfma_f32_32x32x16_bf16 v[208:223], v[24:27], v[104:107], v[208:223]
  s_waitcnt lgkmcnt(4)
  ds_read_b64_tr_b16 v[16:17], v1 offset:30720
  ds_read_b64_tr_b16 v[18:19], v1 offset:30976
  v_fmaak_f32 v8, v64, v64, 0x409d30fc
  v_fmaak_f32 v9, v65, v65, 0x409d30fc
  v_mul_f32 v8, v64, v8
  v_mfma_f32_32x32x16_bf16 v[224:239], v[28:31], v[104:107], v[224:239]
  s_waitcnt lgkmcnt(4)
  ds_read_b64_tr_b16 v[20:21], v1 offset:31744
  ds_read_b64_tr_b16 v[22:23], v1 offset:32000
  buffer_store_dwordx4 v[200:203], v2, s[28:31], s40 offen offset:320 sc1
  s_add_u32 s40, s40, s41
  v_mul_f32 v9, v65, v9
  v_exp_f32 v8, -v8
  v_exp_f32 v9, -v9
  v_fma_f32 v8, v8, s36, s36
  v_fma_f32 v9, v9, s36, s36
  v_rcp_f32 v8, v8
  v_rcp_f32 v9, v9
  v_mfma_f32_32x32x16_bf16 v[240:255], v[32:35], v[96:99], v[240:255]
  s_waitcnt lgkmcnt(4)
  ds_read_b64_tr_b16 v[24:25], v1 offset:32768
  ds_read_b64_tr_b16 v[26:27], v1 offset:33024
  v_mul_f32 v64, v64, v8
  v_mul_f32 v65, v65, v9
  v_cvt_pk_bf16_f32 v64, v64, v65
  v_fmaak_f32 v10, v66, v66, 0x409d30fc
  v_fmaak_f32 v11, v67, v67, 0x409d30fc
  v_mul_f32 v10, v66, v10
  v_mul_f32 v11, v67, v11
  v_exp_f32 v10, -v10
  v_exp_f32 v11, -v11
  v_fma_f32 v10, v10, s36, s36
  v_mfma_f32_32x32x16_bf16 v[240:255], v[36:39], v[104:107], v[240:255]
  s_waitcnt lgkmcnt(4)
  ds_read_b64_tr_b16 v[28:29], v1 offset:33792
  ds_read_b64_tr_b16 v[30:31], v1 offset:34048
  v_fma_f32 v11, v11, s36, s36
  v_rcp_f32 v10, v10
  v_rcp_f32 v11, v11
  v_mul_f32 v66, v66, v10
  v_mul_f32 v67, v67, v11
  v_cvt_pk_bf16_f32 v65, v66, v67
  v_fmaak_f32 v8, v68, v68, 0x409d30fc
  v_fmaak_f32 v9, v69, v69, 0x409d30fc
  v_mul_f32 v8, v68, v8
  v_mul_f32 v9, v69, v9
  v_mfma_f32_32x32x16_bf16 v[96:111], v[16:19], v[136:139], 0
  s_waitcnt lgkmcnt(4)
  ds_read_b64_tr_b16 v[32:33], v1 offset:34816
  ds_read_b64_tr_b16 v[34:35], v1 offset:35072
  v_exp_f32 v8, -v8
  v_exp_f32 v9, -v9
  v_fma_f32 v8, v8, s36, s36
  v_fma_f32 v9, v9, s36, s36
  v_rcp_f32 v8, v8
  v_rcp_f32 v9, v9
  v_mul_f32 v68, v68, v8
  v_mul_f32 v69, v69, v9
  v_cvt_pk_bf16_f32 v66, v68, v69
  v_mfma_f32_32x32x16_bf16 v[96:111], v[20:23], v[140:143], v[96:111]
  s_waitcnt lgkmcnt(4)
  ds_read_b64_tr_b16 v[36:37], v1 offset:35840
  ds_read_b64_tr_b16 v[38:39], v1 offset:36096
  v_fmaak_f32 v10, v70, v70, 0x409d30fc
  v_fmaak_f32 v11, v71, v71, 0x409d30fc
  v_mul_f32 v10, v70, v10
  v_mul_f32 v11, v71, v11
  v_exp_f32 v10, -v10
  v_exp_f32 v11, -v11
  v_fma_f32 v10, v10, s36, s36
  v_fma_f32 v11, v11, s36, s36
  v_rcp_f32 v10, v10
  v_mfma_f32_32x32x16_bf16 v[96:111], v[24:27], v[144:147], v[96:111]
  s_waitcnt lgkmcnt(4)
  ds_read_b64_tr_b16 v[16:17], v7 offset:36864
  ds_read_b64_tr_b16 v[18:19], v7 offset:38400
  v_rcp_f32 v11, v11
  v_mul_f32 v70, v70, v10
  v_mul_f32 v71, v71, v11
  v_cvt_pk_bf16_f32 v67, v70, v71
  v_fmaak_f32 v8, v72, v72, 0x409d30fc
  v_fmaak_f32 v9, v73, v73, 0x409d30fc
  v_mul_f32 v8, v72, v8
  v_mul_f32 v9, v73, v9
  v_exp_f32 v8, -v8
  v_exp_f32 v9, -v9
  v_mfma_f32_32x32x16_bf16 v[96:111], v[28:31], v[148:151], v[96:111]
  s_waitcnt lgkmcnt(4)
  ds_read_b64_tr_b16 v[20:21], v7 offset:36928
  ds_read_b64_tr_b16 v[22:23], v7 offset:38464
  v_fma_f32 v8, v8, s36, s36
  v_fma_f32 v9, v9, s36, s36
  v_rcp_f32 v8, v8
  v_rcp_f32 v9, v9
  v_mul_f32 v72, v72, v8
  v_mul_f32 v73, v73, v9
  v_cvt_pk_bf16_f32 v72, v72, v73
  v_fmaak_f32 v10, v74, v74, 0x409d30fc
  v_fmaak_f32 v11, v75, v75, 0x409d30fc
  v_mul_f32 v10, v74, v10
  v_mfma_f32_32x32x16_bf16 v[96:111], v[32:35], v[152:155], v[96:111]
  s_waitcnt lgkmcnt(4)
  ds_read_b64_tr_b16 v[24:25], v7 offset:39936
  ds_read_b64_tr_b16 v[26:27], v7 offset:41472
  v_mul_f32 v11, v75, v11
  v_exp_f32 v10, -v10
  v_exp_f32 v11, -v11
  v_fma_f32 v10, v10, s36, s36
  v_fma_f32 v11, v11, s36, s36
  v_rcp_f32 v10, v10
  v_rcp_f32 v11, v11
  v_mul_f32 v74, v74, v10
  v_mfma_f32_32x32x16_bf16 v[96:111], v[36:39], v[156:159], v[96:111]
  s_waitcnt lgkmcnt(4)
  ds_read_b64_tr_b16 v[28:29], v7 offset:40000
  ds_read_b64_tr_b16 v[30:31], v7 offset:41536
  v_mul_f32 v75, v75, v11
  v_cvt_pk_bf16_f32 v73, v74, v75
  v_fmaak_f32 v8, v76, v76, 0x409d30fc
  v_fmaak_f32 v9, v77, v77, 0x409d30fc
  v_mul_f32 v8, v76, v8
  v_mul_f32 v9, v77, v9
  v_exp_f32 v8, -v8
  v_exp_f32 v9, -v9
  v_fma_f32 v8, v8, s36, s36
  v_fma_f32 v9, v9, s36, s36
  v_mfma_f32_32x32x16_bf16 v[208:223], v[16:19], v[64:67], v[208:223]
  s_waitcnt lgkmcnt(4)
  ds_read_b64_tr_b16 v[32:33], v7 offset:36992
  ds_read_b64_tr_b16 v[34:35], v7 offset:38528
  v_rcp_f32 v8, v8
  v_rcp_f32 v9, v9
  v_mul_f32 v76, v76, v8
  v_mul_f32 v77, v77, v9
  v_cvt_pk_bf16_f32 v74, v76, v77
  v_fmaak_f32 v10, v78, v78, 0x409d30fc
  v_fmaak_f32 v11, v79, v79, 0x409d30fc
  v_mul_f32 v10, v78, v10
  v_mul_f32 v11, v79, v11
  v_exp_f32 v10, -v10
  v_mfma_f32_32x32x16_bf16 v[224:239], v[20:23], v[64:67], v[224:239]
  s_waitcnt lgkmcnt(4)
  ds_read_b64_tr_b16 v[36:37], v7 offset:40064
  ds_read_b64_tr_b16 v[38:39], v7 offset:41600
  v_exp_f32 v11, -v11
  v_fma_f32 v10, v10, s36, s36
  v_fma_f32 v11, v11, s36, s36
  v_rcp_f32 v10, v10
  v_rcp_f32 v11, v11
  v_mul_f32 v78, v78, v10
  v_mul_f32 v79, v79, v11
  v_cvt_pk_bf16_f32 v75, v78, v79
  s_nop 1
  v_mfma_f32_32x32x16_bf16 v[208:223], v[24:27], v[72:75], v[208:223]
  s_waitcnt lgkmcnt(4)
  ds_read_b64_tr_b16 v[16:17], v1 offset:43008
  ds_read_b64_tr_b16 v[18:19], v1 offset:43264
  v_fmaak_f32 v8, v96, v96, 0x409d30fc
  v_fmaak_f32 v9, v97, v97, 0x409d30fc
  v_mul_f32 v8, v96, v8
  v_mul_f32 v9, v97, v9
  v_exp_f32 v8, -v8
  v_exp_f32 v9, -v9
  v_fma_f32 v8, v8, s36, s36
  v_fma_f32 v9, v9, s36, s36
  v_mfma_f32_32x32x16_bf16 v[224:239], v[28:31], v[72:75], v[224:239]
  s_waitcnt lgkmcnt(4)
  ds_read_b64_tr_b16 v[20:21], v1 offset:44032
  ds_read_b64_tr_b16 v[22:23], v1 offset:44288
  v_rcp_f32 v8, v8
  v_rcp_f32 v9, v9
  v_mul_f32 v96, v96, v8
  v_mul_f32 v97, v97, v9
  v_cvt_pk_bf16_f32 v96, v96, v97
  v_fmaak_f32 v10, v98, v98, 0x409d30fc
  v_fmaak_f32 v11, v99, v99, 0x409d30fc
  v_mul_f32 v10, v98, v10
  v_mul_f32 v11, v99, v11
  v_exp_f32 v10, -v10
  v_mfma_f32_32x32x16_bf16 v[240:255], v[32:35], v[64:67], v[240:255]
  s_waitcnt lgkmcnt(4)
  ds_read_b64_tr_b16 v[24:25], v1 offset:45056
  ds_read_b64_tr_b16 v[26:27], v1 offset:45312
  v_exp_f32 v11, -v11
  v_fma_f32 v10, v10, s36, s36
  v_fma_f32 v11, v11, s36, s36
  v_rcp_f32 v10, v10
  v_rcp_f32 v11, v11
  v_mul_f32 v98, v98, v10
  v_mul_f32 v99, v99, v11
  v_mfma_f32_32x32x16_bf16 v[240:255], v[36:39], v[72:75], v[240:255]
  s_waitcnt lgkmcnt(4)
  ds_read_b64_tr_b16 v[28:29], v1 offset:46080
  ds_read_b64_tr_b16 v[30:31], v1 offset:46336
  v_cvt_pk_bf16_f32 v97, v98, v99
  v_fmaak_f32 v8, v100, v100, 0x409d30fc
  v_fmaak_f32 v9, v101, v101, 0x409d30fc
  v_mul_f32 v8, v100, v8
  v_mul_f32 v9, v101, v9
  v_exp_f32 v8, -v8
  v_exp_f32 v9, -v9
  v_fma_f32 v8, v8, s36, s36
  v_fma_f32 v9, v9, s36, s36
  v_mfma_f32_32x32x16_bf16 v[64:79], v[16:19], v[136:139], 0
  s_waitcnt lgkmcnt(4)
  ds_read_b64_tr_b16 v[32:33], v1 offset:47104
  ds_read_b64_tr_b16 v[34:35], v1 offset:47360
  v_rcp_f32 v8, v8
  v_rcp_f32 v9, v9
  v_mul_f32 v100, v100, v8
  v_mul_f32 v101, v101, v9
  v_cvt_pk_bf16_f32 v98, v100, v101
  v_fmaak_f32 v10, v102, v102, 0x409d30fc
  v_fmaak_f32 v11, v103, v103, 0x409d30fc
  v_mul_f32 v10, v102, v10
  v_mul_f32 v11, v103, v11
  v_exp_f32 v10, -v10
  v_mfma_f32_32x32x16_bf16 v[64:79], v[20:23], v[140:143], v[64:79]
  s_waitcnt lgkmcnt(4)
  ds_read_b64_tr_b16 v[36:37], v1 offset:48128
  ds_read_b64_tr_b16 v[38:39], v1 offset:48384
  v_exp_f32 v11, -v11
  v_fma_f32 v10, v10, s36, s36
  v_fma_f32 v11, v11, s36, s36
  v_rcp_f32 v10, v10
  v_rcp_f32 v11, v11
  v_mul_f32 v102, v102, v10
  v_mul_f32 v103, v103, v11
  v_mfma_f32_32x32x16_bf16 v[64:79], v[24:27], v[144:147], v[64:79]
  s_waitcnt lgkmcnt(4)
  v_add_u32 v1, 65536, v1
  v_add_u32 v7, 65536, v7
  ds_read_b64_tr_b16 v[16:17], v7 offset:0
  ds_read_b64_tr_b16 v[18:19], v7 offset:1536
  v_cvt_pk_bf16_f32 v99, v102, v103
  v_fmaak_f32 v8, v104, v104, 0x409d30fc
  v_fmaak_f32 v9, v105, v105, 0x409d30fc
  v_mul_f32 v8, v104, v8
  v_mul_f32 v9, v105, v9
  v_exp_f32 v8, -v8
  v_exp_f32 v9, -v9
  v_mfma_f32_32x32x16_bf16 v[64:79], v[28:31], v[148:151], v[64:79]
  s_waitcnt lgkmcnt(4)
  ds_read_b64_tr_b16 v[20:21], v7 offset:64
  ds_read_b64_tr_b16 v[22:23], v7 offset:1600
  v_fma_f32 v8, v8, s36, s36
  v_fma_f32 v9, v9, s36, s36
  v_rcp_f32 v8, v8
  v_rcp_f32 v9, v9
  v_mul_f32 v104, v104, v8
  v_mul_f32 v105, v105, v9
  v_cvt_pk_bf16_f32 v104, v104, v105
  v_fmaak_f32 v10, v106, v106, 0x409d30fc
  v_fmaak_f32 v11, v107, v107, 0x409d30fc
  v_mul_f32 v10, v106, v10
  v_mfma_f32_32x32x16_bf16 v[64:79], v[32:35], v[152:155], v[64:79]
  s_waitcnt lgkmcnt(4)
  ds_read_b64_tr_b16 v[24:25], v7 offset:3072
  ds_read_b64_tr_b16 v[26:27], v7 offset:4608
  v_mul_f32 v11, v107, v11
  v_exp_f32 v10, -v10
  v_exp_f32 v11, -v11
  v_fma_f32 v10, v10, s36, s36
  v_fma_f32 v11, v11, s36, s36
  v_rcp_f32 v10, v10
  v_rcp_f32 v11, v11
  v_mfma_f32_32x32x16_bf16 v[64:79], v[36:39], v[156:159], v[64:79]
  s_waitcnt lgkmcnt(4)
  ds_read_b64_tr_b16 v[28:29], v7 offset:3136
  ds_read_b64_tr_b16 v[30:31], v7 offset:4672
  v_mul_f32 v106, v106, v10
  v_mul_f32 v107, v107, v11
  v_cvt_pk_bf16_f32 v105, v106, v107
  v_fmaak_f32 v8, v108, v108, 0x409d30fc
  v_fmaak_f32 v9, v109, v109, 0x409d30fc
  v_mul_f32 v8, v108, v8
  v_mul_f32 v9, v109, v9
  v_exp_f32 v8, -v8
  v_exp_f32 v9, -v9
  v_fma_f32 v8, v8, s36, s36
  v_fma_f32 v9, v9, s36, s36
  v_mfma_f32_32x32x16_bf16 v[208:223], v[16:19], v[96:99], v[208:223]
  s_waitcnt lgkmcnt(4)
  ds_read_b64_tr_b16 v[32:33], v7 offset:128
  ds_read_b64_tr_b16 v[34:35], v7 offset:1664
  v_rcp_f32 v8, v8
  v_rcp_f32 v9, v9
  v_mul_f32 v108, v108, v8
  v_mul_f32 v109, v109, v9
  v_cvt_pk_bf16_f32 v106, v108, v109
  v_fmaak_f32 v10, v110, v110, 0x409d30fc
  v_fmaak_f32 v11, v111, v111, 0x409d30fc
  v_mul_f32 v10, v110, v10
  v_mul_f32 v11, v111, v11
  v_exp_f32 v10, -v10
  v_mfma_f32_32x32x16_bf16 v[224:239], v[20:23], v[96:99], v[224:239]
  s_waitcnt lgkmcnt(4)
  ds_read_b64_tr_b16 v[36:37], v7 offset:3200
  ds_read_b64_tr_b16 v[38:39], v7 offset:4736
  v_exp_f32 v11, -v11
  v_fma_f32 v10, v10, s36, s36
  v_fma_f32 v11, v11, s36, s36
  v_rcp_f32 v10, v10
  v_rcp_f32 v11, v11
  v_mul_f32 v110, v110, v10
  v_mul_f32 v111, v111, v11
  v_cvt_pk_bf16_f32 v107, v110, v111
  s_nop 1
  v_mfma_f32_32x32x16_bf16 v[208:223], v[24:27], v[104:107], v[208:223]
  s_waitcnt lgkmcnt(4)
  ds_read_b64_tr_b16 v[16:17], v1 offset:6144
  ds_read_b64_tr_b16 v[18:19], v1 offset:6400
  v_fmaak_f32 v8, v64, v64, 0x409d30fc
  v_fmaak_f32 v9, v65, v65, 0x409d30fc
  v_mul_f32 v8, v64, v8
  v_mul_f32 v9, v65, v9
  v_exp_f32 v8, -v8
  v_exp_f32 v9, -v9
  v_fma_f32 v8, v8, s36, s36
  v_fma_f32 v9, v9, s36, s36
  v_mfma_f32_32x32x16_bf16 v[224:239], v[28:31], v[104:107], v[224:239]
  s_waitcnt lgkmcnt(4)
  ds_read_b64_tr_b16 v[20:21], v1 offset:7168
  ds_read_b64_tr_b16 v[22:23], v1 offset:7424
  v_rcp_f32 v8, v8
  v_rcp_f32 v9, v9
  v_mul_f32 v64, v64, v8
  v_mul_f32 v65, v65, v9
  v_cvt_pk_bf16_f32 v64, v64, v65
  v_fmaak_f32 v10, v66, v66, 0x409d30fc
  v_fmaak_f32 v11, v67, v67, 0x409d30fc
  v_mul_f32 v10, v66, v10
  v_mul_f32 v11, v67, v11
  v_exp_f32 v10, -v10
  v_mfma_f32_32x32x16_bf16 v[240:255], v[32:35], v[96:99], v[240:255]
  s_waitcnt lgkmcnt(4)
  ds_read_b64_tr_b16 v[24:25], v1 offset:8192
  ds_read_b64_tr_b16 v[26:27], v1 offset:8448
  v_exp_f32 v11, -v11
  v_fma_f32 v10, v10, s36, s36
  v_fma_f32 v11, v11, s36, s36
  v_rcp_f32 v10, v10
  v_rcp_f32 v11, v11
  v_mul_f32 v66, v66, v10
  v_mul_f32 v67, v67, v11
  v_mfma_f32_32x32x16_bf16 v[240:255], v[36:39], v[104:107], v[240:255]
  s_waitcnt lgkmcnt(4)
  ds_read_b64_tr_b16 v[28:29], v1 offset:9216
  ds_read_b64_tr_b16 v[30:31], v1 offset:9472
  v_cvt_pk_bf16_f32 v65, v66, v67
  v_fmaak_f32 v8, v68, v68, 0x409d30fc
  v_fmaak_f32 v9, v69, v69, 0x409d30fc
  v_mul_f32 v8, v68, v8
  v_mul_f32 v9, v69, v9
  v_exp_f32 v8, -v8
  v_exp_f32 v9, -v9
  v_fma_f32 v8, v8, s36, s36
  v_fma_f32 v9, v9, s36, s36
  v_mfma_f32_32x32x16_bf16 v[96:111], v[16:19], v[136:139], 0
  s_waitcnt lgkmcnt(4)
  ds_read_b64_tr_b16 v[32:33], v1 offset:10240
  ds_read_b64_tr_b16 v[34:35], v1 offset:10496
  v_rcp_f32 v8, v8
  v_rcp_f32 v9, v9
  v_mul_f32 v68, v68, v8
  v_mul_f32 v69, v69, v9
  v_cvt_pk_bf16_f32 v66, v68, v69
  v_fmaak_f32 v10, v70, v70, 0x409d30fc
  v_fmaak_f32 v11, v71, v71, 0x409d30fc
  v_mul_f32 v10, v70, v10
  v_mul_f32 v11, v71, v11
  v_exp_f32 v10, -v10
  v_mfma_f32_32x32x16_bf16 v[96:111], v[20:23], v[140:143], v[96:111]
  s_waitcnt lgkmcnt(4)
  ds_read_b64_tr_b16 v[36:37], v1 offset:11264
  ds_read_b64_tr_b16 v[38:39], v1 offset:11520
  v_exp_f32 v11, -v11
  v_fma_f32 v10, v10, s36, s36
  v_fma_f32 v11, v11, s36, s36
  v_rcp_f32 v10, v10
  v_rcp_f32 v11, v11
  v_mul_f32 v70, v70, v10
  v_mul_f32 v71, v71, v11
  v_mfma_f32_32x32x16_bf16 v[96:111], v[24:27], v[144:147], v[96:111]
  s_waitcnt lgkmcnt(4)
  ds_read_b64_tr_b16 v[16:17], v7 offset:12288
  ds_read_b64_tr_b16 v[18:19], v7 offset:13824
  v_cvt_pk_bf16_f32 v67, v70, v71
  v_fmaak_f32 v8, v72, v72, 0x409d30fc
  v_fmaak_f32 v9, v73, v73, 0x409d30fc
  v_mul_f32 v8, v72, v8
  v_mul_f32 v9, v73, v9
  v_exp_f32 v8, -v8
  v_exp_f32 v9, -v9
  v_fma_f32 v8, v8, s36, s36
  v_fma_f32 v9, v9, s36, s36
  v_mfma_f32_32x32x16_bf16 v[96:111], v[28:31], v[148:151], v[96:111]
  s_waitcnt lgkmcnt(4)
  ds_read_b64_tr_b16 v[20:21], v7 offset:12352
  ds_read_b64_tr_b16 v[22:23], v7 offset:13888
  v_rcp_f32 v8, v8
  v_rcp_f32 v9, v9
  v_mul_f32 v72, v72, v8
  v_mul_f32 v73, v73, v9
  v_cvt_pk_bf16_f32 v72, v72, v73
  v_fmaak_f32 v10, v74, v74, 0x409d30fc
  v_fmaak_f32 v11, v75, v75, 0x409d30fc
  v_mul_f32 v10, v74, v10
  v_mul_f32 v11, v75, v11
  v_exp_f32 v10, -v10
  v_mfma_f32_32x32x16_bf16 v[96:111], v[32:35], v[152:155], v[96:111]
  s_waitcnt lgkmcnt(4)
  ds_read_b64_tr_b16 v[24:25], v7 offset:15360
  ds_read_b64_tr_b16 v[26:27], v7 offset:16896
  v_exp_f32 v11, -v11
  v_fma_f32 v10, v10, s36, s36
  v_fma_f32 v11, v11, s36, s36
  v_rcp_f32 v10, v10
  v_rcp_f32 v11, v11
  v_mul_f32 v74, v74, v10
  v_mul_f32 v75, v75, v11
  v_mfma_f32_32x32x16_bf16 v[96:111], v[36:39], v[156:159], v[96:111]
  s_waitcnt lgkmcnt(4)
  ds_read_b64_tr_b16 v[28:29], v7 offset:15424
  ds_read_b64_tr_b16 v[30:31], v7 offset:16960
  v_cvt_pk_bf16_f32 v73, v74, v75
  v_fmaak_f32 v8, v76, v76, 0x409d30fc
  v_fmaak_f32 v9, v77, v77, 0x409d30fc
  v_mul_f32 v8, v76, v8
  v_mul_f32 v9, v77, v9
  v_exp_f32 v8, -v8
  v_exp_f32 v9, -v9
  v_fma_f32 v8, v8, s36, s36
  v_fma_f32 v9, v9, s36, s36
  v_mfma_f32_32x32x16_bf16 v[208:223], v[16:19], v[64:67], v[208:223]
  s_waitcnt lgkmcnt(4)
  ds_read_b64_tr_b16 v[32:33], v7 offset:12416
  ds_read_b64_tr_b16 v[34:35], v7 offset:13952
  v_rcp_f32 v8, v8
  v_rcp_f32 v9, v9
  v_mul_f32 v76, v76, v8
  v_mul_f32 v77, v77, v9
  v_cvt_pk_bf16_f32 v74, v76, v77
  v_fmaak_f32 v10, v78, v78, 0x409d30fc
  v_fmaak_f32 v11, v79, v79, 0x409d30fc
  v_mul_f32 v10, v78, v10
  v_mul_f32 v11, v79, v11
  v_exp_f32 v10, -v10
  v_mfma_f32_32x32x16_bf16 v[224:239], v[20:23], v[64:67], v[224:239]
  s_waitcnt lgkmcnt(4)
  ds_read_b64_tr_b16 v[36:37], v7 offset:15488
  ds_read_b64_tr_b16 v[38:39], v7 offset:17024
  v_exp_f32 v11, -v11
  v_fma_f32 v10, v10, s36, s36
  v_fma_f32 v11, v11, s36, s36
  v_rcp_f32 v10, v10
  v_rcp_f32 v11, v11
  v_mul_f32 v78, v78, v10
  v_mul_f32 v79, v79, v11
  v_cvt_pk_bf16_f32 v75, v78, v79
  s_nop 1
  v_mfma_f32_32x32x16_bf16 v[208:223], v[24:27], v[72:75], v[208:223]
  s_waitcnt lgkmcnt(4)
  ds_read_b64_tr_b16 v[16:17], v1 offset:18432
  ds_read_b64_tr_b16 v[18:19], v1 offset:18688
  v_fmaak_f32 v8, v96, v96, 0x409d30fc
  v_fmaak_f32 v9, v97, v97, 0x409d30fc
  v_mul_f32 v8, v96, v8
  v_mul_f32 v9, v97, v9
  v_exp_f32 v8, -v8
  v_exp_f32 v9, -v9
  v_fma_f32 v8, v8, s36, s36
  v_fma_f32 v9, v9, s36, s36
  v_mfma_f32_32x32x16_bf16 v[224:239], v[28:31], v[72:75], v[224:239]
  s_waitcnt lgkmcnt(4)
  ds_read_b64_tr_b16 v[20:21], v1 offset:19456
  ds_read_b64_tr_b16 v[22:23], v1 offset:19712
  v_rcp_f32 v8, v8
  v_rcp_f32 v9, v9
  v_mul_f32 v96, v96, v8
  v_mul_f32 v97, v97, v9
  v_cvt_pk_bf16_f32 v96, v96, v97
  v_fmaak_f32 v10, v98, v98, 0x409d30fc
  v_fmaak_f32 v11, v99, v99, 0x409d30fc
  v_mul_f32 v10, v98, v10
  v_mul_f32 v11, v99, v11
  v_exp_f32 v10, -v10
  v_mfma_f32_32x32x16_bf16 v[240:255], v[32:35], v[64:67], v[240:255]
  s_waitcnt lgkmcnt(4)
  ds_read_b64_tr_b16 v[24:25], v1 offset:20480
  ds_read_b64_tr_b16 v[26:27], v1 offset:20736
  v_exp_f32 v11, -v11
  v_fma_f32 v10, v10, s36, s36
  v_fma_f32 v11, v11, s36, s36
  v_rcp_f32 v10, v10
  v_rcp_f32 v11, v11
  v_mul_f32 v98, v98, v10
  v_mul_f32 v99, v99, v11
  v_mfma_f32_32x32x16_bf16 v[240:255], v[36:39], v[72:75], v[240:255]
  s_waitcnt lgkmcnt(4)
  ds_read_b64_tr_b16 v[28:29], v1 offset:21504
  ds_read_b64_tr_b16 v[30:31], v1 offset:21760
  v_cvt_pk_bf16_f32 v97, v98, v99
  v_fmaak_f32 v8, v100, v100, 0x409d30fc
  v_fmaak_f32 v9, v101, v101, 0x409d30fc
  v_mul_f32 v8, v100, v8
  v_mul_f32 v9, v101, v9
  v_exp_f32 v8, -v8
  v_exp_f32 v9, -v9
  v_fma_f32 v8, v8, s36, s36
  v_fma_f32 v9, v9, s36, s36
  v_mfma_f32_32x32x16_bf16 v[64:79], v[16:19], v[136:139], 0
  s_waitcnt lgkmcnt(4)
  ds_read_b64_tr_b16 v[32:33], v1 offset:22528
  ds_read_b64_tr_b16 v[34:35], v1 offset:22784
  v_rcp_f32 v8, v8
  v_rcp_f32 v9, v9
  v_mul_f32 v100, v100, v8
  v_mul_f32 v101, v101, v9
  v_cvt_pk_bf16_f32 v98, v100, v101
  v_fmaak_f32 v10, v102, v102, 0x409d30fc
  v_fmaak_f32 v11, v103, v103, 0x409d30fc
  v_mul_f32 v10, v102, v10
  v_mul_f32 v11, v103, v11
  v_exp_f32 v10, -v10
  v_mfma_f32_32x32x16_bf16 v[64:79], v[20:23], v[140:143], v[64:79]
  s_waitcnt lgkmcnt(4)
  ds_read_b64_tr_b16 v[36:37], v1 offset:23552
  ds_read_b64_tr_b16 v[38:39], v1 offset:23808
  v_exp_f32 v11, -v11
  v_fma_f32 v10, v10, s36, s36
  v_fma_f32 v11, v11, s36, s36
  v_rcp_f32 v10, v10
  v_rcp_f32 v11, v11
  v_mul_f32 v102, v102, v10
  v_mul_f32 v103, v103, v11
  v_mfma_f32_32x32x16_bf16 v[64:79], v[24:27], v[144:147], v[64:79]
  s_waitcnt lgkmcnt(4)
  ds_read_b64_tr_b16 v[16:17], v7 offset:24576
  ds_read_b64_tr_b16 v[18:19], v7 offset:26112
  v_cvt_pk_bf16_f32 v99, v102, v103
  v_fmaak_f32 v8, v104, v104, 0x409d30fc
  v_fmaak_f32 v9, v105, v105, 0x409d30fc
  v_mul_f32 v8, v104, v8
  v_mul_f32 v9, v105, v9
  v_exp_f32 v8, -v8
  v_exp_f32 v9, -v9
  v_fma_f32 v8, v8, s36, s36
  v_fma_f32 v9, v9, s36, s36
  v_mfma_f32_32x32x16_bf16 v[64:79], v[28:31], v[148:151], v[64:79]
  s_waitcnt lgkmcnt(4)
  ds_read_b64_tr_b16 v[20:21], v7 offset:24640
  ds_read_b64_tr_b16 v[22:23], v7 offset:26176
  v_rcp_f32 v8, v8
  v_rcp_f32 v9, v9
  v_mul_f32 v104, v104, v8
  v_mul_f32 v105, v105, v9
  v_cvt_pk_bf16_f32 v104, v104, v105
  v_fmaak_f32 v10, v106, v106, 0x409d30fc
  v_fmaak_f32 v11, v107, v107, 0x409d30fc
  v_mul_f32 v10, v106, v10
  v_mul_f32 v11, v107, v11
  v_exp_f32 v10, -v10
  v_mfma_f32_32x32x16_bf16 v[64:79], v[32:35], v[152:155], v[64:79]
  s_waitcnt lgkmcnt(4)
  ds_read_b64_tr_b16 v[24:25], v7 offset:27648
  ds_read_b64_tr_b16 v[26:27], v7 offset:29184
  v_exp_f32 v11, -v11
  v_fma_f32 v10, v10, s36, s36
  v_fma_f32 v11, v11, s36, s36
  v_rcp_f32 v10, v10
  v_rcp_f32 v11, v11
  v_mul_f32 v106, v106, v10
  v_mul_f32 v107, v107, v11
  v_mfma_f32_32x32x16_bf16 v[64:79], v[36:39], v[156:159], v[64:79]
  s_waitcnt lgkmcnt(4)
  ds_read_b64_tr_b16 v[28:29], v7 offset:27712
  ds_read_b64_tr_b16 v[30:31], v7 offset:29248
  v_cvt_pk_bf16_f32 v105, v106, v107
  v_fmaak_f32 v8, v108, v108, 0x409d30fc
  v_fmaak_f32 v9, v109, v109, 0x409d30fc
  v_mul_f32 v8, v108, v8
  v_mul_f32 v9, v109, v9
  v_exp_f32 v8, -v8
  v_exp_f32 v9, -v9
  v_fma_f32 v8, v8, s36, s36
  v_fma_f32 v9, v9, s36, s36
  v_mfma_f32_32x32x16_bf16 v[208:223], v[16:19], v[96:99], v[208:223]
  s_waitcnt lgkmcnt(4)
  ds_read_b64_tr_b16 v[32:33], v7 offset:24704
  ds_read_b64_tr_b16 v[34:35], v7 offset:26240
  v_rcp_f32 v8, v8
  v_rcp_f32 v9, v9
  v_mul_f32 v108, v108, v8
  v_mul_f32 v109, v109, v9
  v_cvt_pk_bf16_f32 v106, v108, v109
  v_fmaak_f32 v10, v110, v110, 0x409d30fc
  v_fmaak_f32 v11, v111, v111, 0x409d30fc
  v_mul_f32 v10, v110, v10
  v_mul_f32 v11, v111, v11
  v_exp_f32 v10, -v10
  v_exp_f32 v11, -v11
  v_fma_f32 v10, v10, s36, s36
  v_fma_f32 v11, v11, s36, s36
  v_rcp_f32 v10, v10
  v_rcp_f32 v11, v11
  v_mul_f32 v110, v110, v10
  v_mul_f32 v111, v111, v11
  v_mfma_f32_32x32x16_bf16 v[224:239], v[20:23], v[96:99], v[224:239]
  s_waitcnt lgkmcnt(4)
  ds_read_b64_tr_b16 v[36:37], v7 offset:27776
  ds_read_b64_tr_b16 v[38:39], v7 offset:29312
  v_cvt_pk_bf16_f32 v107, v110, v111
  v_fmaak_f32 v8, v64, v64, 0x409d30fc
  v_fmaak_f32 v9, v65, v65, 0x409d30fc
  v_mul_f32 v8, v64, v8
  v_mul_f32 v9, v65, v9
  v_exp_f32 v8, -v8
  v_exp_f32 v9, -v9
  v_fma_f32 v8, v8, s36, s36
  v_fma_f32 v9, v9, s36, s36
  v_rcp_f32 v8, v8
  v_rcp_f32 v9, v9
  v_mul_f32 v64, v64, v8
  v_mul_f32 v65, v65, v9
  v_cvt_pk_bf16_f32 v64, v64, v65
  v_fmaak_f32 v10, v66, v66, 0x409d30fc
  v_fmaak_f32 v11, v67, v67, 0x409d30fc
  v_mul_f32 v10, v66, v10
  v_mul_f32 v11, v67, v11
  v_exp_f32 v10, -v10
  v_mfma_f32_32x32x16_bf16 v[208:223], v[24:27], v[104:107], v[208:223]
  s_waitcnt lgkmcnt(4)
  ds_read_b64_tr_b16 v[16:17], v7 offset:36864
  ds_read_b64_tr_b16 v[18:19], v7 offset:38400
  v_exp_f32 v11, -v11
  v_fma_f32 v10, v10, s36, s36
  v_fma_f32 v11, v11, s36, s36
  v_rcp_f32 v10, v10
  v_rcp_f32 v11, v11
  v_mul_f32 v66, v66, v10
  v_mul_f32 v67, v67, v11
  v_cvt_pk_bf16_f32 v65, v66, v67
  v_fmaak_f32 v8, v68, v68, 0x409d30fc
  v_fmaak_f32 v9, v69, v69, 0x409d30fc
  v_mul_f32 v8, v68, v8
  v_mul_f32 v9, v69, v9
  v_exp_f32 v8, -v8
  v_exp_f32 v9, -v9
  v_fma_f32 v8, v8, s36, s36
  v_fma_f32 v9, v9, s36, s36
  v_mfma_f32_32x32x16_bf16 v[224:239], v[28:31], v[104:107], v[224:239]
  s_waitcnt lgkmcnt(4)
  ds_read_b64_tr_b16 v[20:21], v7 offset:36928
  ds_read_b64_tr_b16 v[22:23], v7 offset:38464
  v_rcp_f32 v8, v8
  v_rcp_f32 v9, v9
  v_mul_f32 v68, v68, v8
  v_mul_f32 v69, v69, v9
  v_cvt_pk_bf16_f32 v66, v68, v69
  v_fmaak_f32 v10, v70, v70, 0x409d30fc
  v_fmaak_f32 v11, v71, v71, 0x409d30fc
  v_mul_f32 v10, v70, v10
  v_mul_f32 v11, v71, v11
  v_exp_f32 v10, -v10
  v_exp_f32 v11, -v11
  v_fma_f32 v10, v10, s36, s36
  v_fma_f32 v11, v11, s36, s36
  v_rcp_f32 v10, v10
  v_rcp_f32 v11, v11
  v_mul_f32 v70, v70, v10
  v_mul_f32 v71, v71, v11
  v_mfma_f32_32x32x16_bf16 v[240:255], v[32:35], v[96:99], v[240:255]
  s_waitcnt lgkmcnt(4)
  ds_read_b64_tr_b16 v[24:25], v7 offset:39936
  ds_read_b64_tr_b16 v[26:27], v7 offset:41472
  v_cvt_pk_bf16_f32 v67, v70, v71
  v_fmaak_f32 v8, v72, v72, 0x409d30fc
  v_fmaak_f32 v9, v73, v73, 0x409d30fc
  v_mul_f32 v8, v72, v8
  v_mul_f32 v9, v73, v9
  v_exp_f32 v8, -v8
  v_exp_f32 v9, -v9
  v_fma_f32 v8, v8, s36, s36
  v_fma_f32 v9, v9, s36, s36
  v_rcp_f32 v8, v8
  v_rcp_f32 v9, v9
  v_mul_f32 v72, v72, v8
  v_mul_f32 v73, v73, v9
  v_cvt_pk_bf16_f32 v72, v72, v73
  v_fmaak_f32 v10, v74, v74, 0x409d30fc
  v_fmaak_f32 v11, v75, v75, 0x409d30fc
  v_mul_f32 v10, v74, v10
  v_mul_f32 v11, v75, v11
  v_exp_f32 v10, -v10
  v_mfma_f32_32x32x16_bf16 v[240:255], v[36:39], v[104:107], v[240:255]
  s_waitcnt lgkmcnt(4)
  ds_read_b64_tr_b16 v[28:29], v7 offset:40000
  ds_read_b64_tr_b16 v[30:31], v7 offset:41536
  v_exp_f32 v11, -v11
  v_fma_f32 v10, v10, s36, s36
  v_fma_f32 v11, v11, s36, s36
  v_rcp_f32 v10, v10
  v_rcp_f32 v11, v11
  v_mul_f32 v74, v74, v10
  v_mul_f32 v75, v75, v11
  v_cvt_pk_bf16_f32 v73, v74, v75
  v_fmaak_f32 v8, v76, v76, 0x409d30fc
  v_fmaak_f32 v9, v77, v77, 0x409d30fc
  v_mul_f32 v8, v76, v8
  v_mul_f32 v9, v77, v9
  v_exp_f32 v8, -v8
  v_exp_f32 v9, -v9
  v_fma_f32 v8, v8, s36, s36
  v_fma_f32 v9, v9, s36, s36
  v_mfma_f32_32x32x16_bf16 v[208:223], v[16:19], v[64:67], v[208:223]
  s_waitcnt lgkmcnt(4)
  ds_read_b64_tr_b16 v[32:33], v7 offset:36992
  ds_read_b64_tr_b16 v[34:35], v7 offset:38528
  v_rcp_f32 v8, v8
  v_rcp_f32 v9, v9
  v_mul_f32 v76, v76, v8
  v_mul_f32 v77, v77, v9
  v_cvt_pk_bf16_f32 v74, v76, v77
  v_fmaak_f32 v10, v78, v78, 0x409d30fc
  v_fmaak_f32 v11, v79, v79, 0x409d30fc
  v_mul_f32 v10, v78, v10
  v_mul_f32 v11, v79, v11
  v_exp_f32 v10, -v10
  v_mfma_f32_32x32x16_bf16 v[224:239], v[20:23], v[64:67], v[224:239]
  s_waitcnt lgkmcnt(4)
  ds_read_b64_tr_b16 v[36:37], v7 offset:40064
  ds_read_b64_tr_b16 v[38:39], v7 offset:41600
  v_exp_f32 v11, -v11
  v_fma_f32 v10, v10, s36, s36
  v_fma_f32 v11, v11, s36, s36
  v_rcp_f32 v10, v10
  v_rcp_f32 v11, v11
  v_mul_f32 v78, v78, v10
  v_mul_f32 v79, v79, v11
  v_cvt_pk_bf16_f32 v75, v78, v79
  s_nop 1
  v_mfma_f32_32x32x16_bf16 v[208:223], v[24:27], v[72:75], v[208:223]
  s_waitcnt lgkmcnt(4)
  s_nop 10
  v_cvt_pk_bf16_f32 v208, v208, v209
  v_cvt_pk_bf16_f32 v209, v210, v211
  v_cvt_pk_bf16_f32 v210, v212, v213
  v_cvt_pk_bf16_f32 v211, v214, v215
  v_cvt_pk_bf16_f32 v216, v216, v217
  v_cvt_pk_bf16_f32 v217, v218, v219
  v_cvt_pk_bf16_f32 v218, v220, v221
  v_cvt_pk_bf16_f32 v219, v222, v223
  s_nop 1
  v_permlane16_swap_b32 v208, v216
  v_permlane16_swap_b32 v209, v217
  v_permlane16_swap_b32 v210, v218
  v_permlane16_swap_b32 v211, v219
  v_mfma_f32_32x32x16_bf16 v[224:239], v[28:31], v[72:75], v[224:239]
  s_waitcnt lgkmcnt(2)
  buffer_store_dwordx4 v[208:211], v2, s[28:31], s40 offen offset:0 sc1
  s_nop 9
  v_cvt_pk_bf16_f32 v224, v224, v225
  v_cvt_pk_bf16_f32 v225, v226, v227
  v_cvt_pk_bf16_f32 v226, v228, v229
  v_cvt_pk_bf16_f32 v227, v230, v231
  v_cvt_pk_bf16_f32 v232, v232, v233
  v_cvt_pk_bf16_f32 v233, v234, v235
  v_cvt_pk_bf16_f32 v234, v236, v237
  v_cvt_pk_bf16_f32 v235, v238, v239
  s_nop 1
  v_permlane16_swap_b32 v224, v232
  v_permlane16_swap_b32 v225, v233
  v_permlane16_swap_b32 v226, v234
  v_permlane16_swap_b32 v227, v235
  v_mfma_f32_32x32x16_bf16 v[240:255], v[32:35], v[64:67], v[240:255]
  s_waitcnt lgkmcnt(0)
  buffer_store_dwordx4 v[216:219], v2, s[28:31], s40 offen offset:192 sc1
  buffer_store_dwordx4 v[224:227], v2, s[28:31], s40 offen offset:64 sc1
  v_mfma_f32_32x32x16_bf16 v[240:255], v[36:39], v[72:75], v[240:255]
  buffer_store_dwordx4 v[232:235], v2, s[28:31], s40 offen offset:256 sc1
  s_nop 10
  v_cvt_pk_bf16_f32 v240, v240, v241
  v_cvt_pk_bf16_f32 v241, v242, v243
  v_cvt_pk_bf16_f32 v242, v244, v245
  v_cvt_pk_bf16_f32 v243, v246, v247
  v_cvt_pk_bf16_f32 v248, v248, v249
  v_cvt_pk_bf16_f32 v249, v250, v251
  v_cvt_pk_bf16_f32 v250, v252, v253
  v_cvt_pk_bf16_f32 v251, v254, v255
  s_nop 1
  v_permlane16_swap_b32 v240, v248
  v_permlane16_swap_b32 v241, v249
  v_permlane16_swap_b32 v242, v250
  v_permlane16_swap_b32 v243, v251
  buffer_store_dwordx4 v[240:243], v2, s[28:31], s40 offen offset:128 sc1
  buffer_store_dwordx4 v[248:251], v2, s[28:31], s40 offen offset:320 sc1
  s_add_u32 s40, s40, s41
F_end:
  s_endpgm
.section .rodata,"a"
.p2align 6
.amdhsa_kernel standalone__convnext_block__vision_kernel
  .amdhsa_next_free_vgpr 256
  .amdhsa_next_free_sgpr 72
  .amdhsa_accum_offset 256
  .amdhsa_group_segment_fixed_size 0
  .amdhsa_kernarg_size 56
  .amdhsa_user_sgpr_count 2
  .amdhsa_user_sgpr_kernarg_segment_ptr 1
  .amdhsa_system_sgpr_workgroup_id_x 1
  .amdhsa_float_denorm_mode_32 3
.end_amdhsa_kernel
```
